```python
import torch

def _softmax(x, axis=-1):
    return torch.softmax(x, dim=axis)

def _gelu(x):
    return torch.nn.functional.gelu(x, approximate='tanh')

def _silu(x):
    return torch.nn.functional.silu(x)

def _sigmoid(x):
    return torch.sigmoid(x)

def _layernorm(x, axis=-1, eps=1e-05):
    m = x.mean(dim=axis, keepdim=True)
    v = x.var(dim=axis, keepdim=True, unbiased=False)
    return (x - m) / torch.sqrt(v + eps)

def _scatter_add(tgt, idx, src, axis=0):
    return tgt.clone().index_add_(axis, idx, src)

def _segment_sum(src, seg, n):
    out = torch.zeros((n,) + src.shape[1:], dtype=src.dtype)
    return out.index_add_(0, seg, src)

def _pad(x, pw):
    flat = tuple((v for pair in reversed(pw) for v in pair))
    return torch.nn.functional.pad(x, flat)
kernel_name = 'adaLN_cond__compressed_kv_cla__glu_gated_geglu__prompt'

def setup_inputs():

    _w = lambda a: (lambda t: t.to(torch.bfloat16) if t.is_floating_point() else t)(torch.as_tensor(a))

    def _A_setup():
        B, H, Sq, Sk, D, M = (1, 32, 2048, 2048, 128, 640)
        Dc = 4 * D
        return {'x': _w((lambda *s: torch.randn(*s, dtype=torch.bfloat16) * 0.1)(B, Sq, M)), 'c_kv': _w((lambda *s: torch.randn(*s, dtype=torch.bfloat16) * 3.2)(B, Sk, Dc)), 'w_q': _w((lambda *s: torch.randn(*s, dtype=torch.bfloat16) * 0.4)(M, H, D) * M ** (-0.5)), 'w_uk': _w((lambda *s: torch.randn(*s, dtype=torch.bfloat16) * 0.4)(Dc, H, D) * Dc ** (-0.5)), 'w_uv': _w((lambda *s: torch.randn(*s, dtype=torch.bfloat16) * 3.2)(Dc, H, D) * Dc ** (-0.5)), 'w_o': _w((lambda *s: torch.randn(*s, dtype=torch.bfloat16) * 3.2)(H, D, M) * (H * D) ** (-0.5))}
    _A_in = _A_setup()

    def _B_setup():
        B, S, Dm, Df = (1, 2048, 640, 1728)
        return {'x': _w((lambda *s: torch.randn(*s, dtype=torch.bfloat16) * 0.1)(B, S, Dm)), 'w_gate': _w((lambda *s: torch.randn(*s, dtype=torch.bfloat16) * 3.2)(Dm, Df) * Dm ** (-0.5)), 'w_up': _w((lambda *s: torch.randn(*s, dtype=torch.bfloat16) * 3.2)(Dm, Df) * Dm ** (-0.5)), 'w_down': _w((lambda *s: torch.randn(*s, dtype=torch.bfloat16) * 3.2)(Df, Dm) * Df ** (-0.5))}
    _B_in = _B_setup()
    return {'A_x': _A_in['x'], 'A_c_kv': _A_in['c_kv'], 'A_w_q': _A_in['w_q'], 'A_w_uk': _A_in['w_uk'], 'A_w_uv': _A_in['w_uv'], 'A_w_o': _A_in['w_o'], 'B_x': _B_in['x'], 'B_w_gate': _B_in['w_gate'], 'B_w_up': _B_in['w_up'], 'B_w_down': _B_in['w_down'], 'c': _w((lambda *s: torch.randn(*s, dtype=torch.bfloat16) * 0.4)(1, 640) * 8.0), 'w_mod': _w((lambda *s: torch.randn(*s, dtype=torch.bfloat16) * 0.4)(640, 6 * 640) * 640 ** (-0.5) * 8.0)}

def reference(A_x, A_c_kv, A_w_q, A_w_uk, A_w_uv, A_w_o, B_x, B_w_gate, B_w_up, B_w_down, c, w_mod):

    def _A_ref(x, c_kv, w_q, w_uk, w_uv, w_o):
        B, Sq, M = (x.shape[0], x.shape[1], x.shape[2])
        Sk = c_kv.shape[1]
        H, D = (w_q.shape[1], w_q.shape[2])
        q = torch.einsum('bqm,mhd->bhqd', x, w_q)
        k = torch.einsum('bkc,chd->bhkd', c_kv, w_uk)
        v = torch.einsum('bkc,chd->bhkd', c_kv, w_uv)
        scores = torch.einsum('bhqd,bhkd->bhqk', q, k) * D ** (-0.5)
        off = Sk - Sq
        qi = torch.arange(Sq)[:, None]
        kj = torch.arange(Sk)[None, :]
        cmask = kj <= qi + off
        scores = torch.where(cmask[None, None], scores, -1000000000.0)
        p = _softmax(scores, axis=-1)
        ctx = torch.einsum('bhqk,bhkd->bhqd', p, v)
        return torch.einsum('bhqd,hdm->bqm', ctx, w_o)

    def _B_ref(x, w_gate, w_up, w_down):
        g = torch.einsum('bsd,df->bsf', x, w_gate)
        u = torch.einsum('bsd,df->bsf', x, w_up)
        h = _gelu(g) * u
        return torch.einsum('bsf,fd->bsd', h, w_down)
    x = A_x
    mod = (_silu(c) @ w_mod).reshape(c.shape[0], 6, 1, -1)
    sa, ca, ga, sb, cb, gb = (mod[:, 0].clone(), mod[:, 1].clone(), mod[:, 2].clone(), mod[:, 3].clone(), mod[:, 4].clone(), mod[:, 5].clone())
    h = _layernorm(x, axis=-1) * (1 + ca) + sa
    x = x + ga * _A_ref(h, A_c_kv, A_w_q, A_w_uk, A_w_uv, A_w_o)
    h = _layernorm(x, axis=-1) * (1 + cb) + sb
    x = x + gb * _B_ref(h, B_w_gate, B_w_up, B_w_down)
    return x
```

```asm
; @launch grid=(256,1,1) block=(256,1,1) lds=163840
.amdgcn_target "amdgcn-amd-amdhsa--gfx950"
.text
.globl adaLN_cond__compressed_kv_cla__glu_gated_geglu__prompt_kernel
.p2align 8
.type adaLN_cond__compressed_kv_cla__glu_gated_geglu__prompt_kernel,@function
adaLN_cond__compressed_kv_cla__glu_gated_geglu__prompt_kernel:
    s_cmp_ge_u32 s2, 256
    s_cbranch_scc1 KA_end
    s_load_dwordx4 s[16:19], s[0:1], 0
    s_load_dwordx4 s[20:23], s[0:1], 24
    s_load_dwordx4 s[32:35], s[0:1], 80
    s_load_dwordx4 s[36:39], s[0:1], 104
    s_load_dwordx2 s[6:7], s[0:1], 16
    s_load_dwordx2 s[96:97], s[0:1], 40
    s_load_dwordx2 s[98:99], s[0:1], 72
    s_load_dwordx4 s[84:87], s[0:1], 56
    s_getpc_b64 s[8:9]
    s_mov_b32 s10, KA_last-adaLN_cond__compressed_kv_cla__glu_gated_geglu__prompt_kernel-64
    s_mov_b32 s11, 0x20000
    s_lshr_b32 s28, s2, 3
    s_lshl_b32 s28, s28, 7
    v_lshlrev_b32 v1, 12, v0
    buffer_load_dword a250, v1, s[8:11], s28 offen
    v_lshrrev_b32 v1, 6, v0
    s_nop 0
    v_readfirstlane_b32 s3, v1
    v_and_b32 v1, 63, v0
    s_and_b32 s26, s2, 7
    s_lshl_b32 s26, s26, 2
    s_bfe_u32 s28, s2, 0x20003
    s_add_u32 s26, s26, s28
    s_lshr_b32 s27, s2, 5
    s_lshl_b32 s40, s3, 13
    s_mov_b32 s44, 0
    s_mov_b32 s52, 0
    s_mov_b32 s45, 130048
    s_mov_b32 s53, 7168
    s_mov_b32 s46, 30720
    s_mov_b32 s54, 14336
    s_mov_b32 s47, 160768
    s_mov_b32 s55, 21504
    s_mov_b32 s48, 262144
    s_mov_b32 s56, 32768
    s_mov_b32 s49, 392192
    s_mov_b32 s57, 39936
    s_mov_b32 s50, 292864
    s_mov_b32 s58, 47104
    s_mov_b32 s51, 422912
    s_mov_b32 s59, 54272
    s_movk_i32 s28, 8192
    v_lshrrev_b32 v13, 3, v1
    v_and_b32 v14, 4, v13
    v_add_u32 v13, v13, v14
    v_mul_lo_u32 v3, v13, s28
    v_lshrrev_b32 v13, 3, v1
    v_and_b32 v13, 6, v13
    v_and_b32 v14, 7, v1
    v_xor_b32 v13, v13, v14
    v_lshlrev_b32 v13, 4, v13
    v_add_u32 v3, v3, v13
    v_lshrrev_b32 v13, 3, v1
    v_lshrrev_b32 v16, 1, v13
    v_and_b32 v15, 7, v1
    v_xor_b32 v14, v16, v15
    v_lshlrev_b32 v14, 4, v14
    v_lshl_add_u32 v7, v13, 10, v14
    v_xor_b32 v12, 64, v7
    s_lshl_b32 s30, s27, 18
    s_lshl_b32 s29, s3, 16
    s_add_u32 s30, s30, s29
    s_lshl_b32 s28, s26, 8
    s_and_b32 s29, s3, 1
    s_lshl_b32 s29, s29, 7
    s_add_u32 s28, s28, s29
    v_and_b32 v36, 0xfe, v0
    s_lshr_b32 s41, s2, 3
    s_lshl_b32 s41, s41, 2
    s_add_u32 s41, s41, s3
    s_mul_i32 s41, s41, 38400
    s_and_b32 s31, s2, 7
    s_lshl_b32 s31, s31, 7
    s_add_u32 s41, s41, s31
    v_and_b32 v18, 7, v1
    v_mul_u32_u24 v19, 7680, v18
    v_lshrrev_b32 v20, 3, v1
    v_lshl_add_u32 v19, v20, 10, v19
    v_add_u32 v19, s41, v19
    v_add_u32 v18, 3, v18
    v_lshrrev_b32 v18, 3, v18
    v_lshl_or_b32 v19, v18, 26, v19
    s_waitcnt lgkmcnt(0)
    s_mov_b32 s64, s34
    s_mov_b32 s65, s35
    s_mov_b32 s66, 4915200
    s_mov_b32 s67, 0x20000
    buffer_load_dword a251, v19, s[64:67], 0 offen
    s_add_u32 s12, s18, s30
    s_addc_u32 s13, s19, 0
    s_mov_b32 s14, 65536
    s_mov_b32 s15, 0x20000
    s_cmp_ge_u32 s3, 2
    s_cselect_b32 s20, s22, s20
    s_cselect_b32 s21, s23, s21
    s_add_u32 s8, s20, s28
    s_addc_u32 s9, s21, 0
    s_sub_u32 s10, 4194304, s28
    s_mov_b32 s11, 0x20000
    s_add_u32 m0, s40, 0
    s_nop 0
    buffer_load_dwordx4 v3, s[8:11], s44 offen offset:0 lds
    buffer_load_dwordx4 v3, s[8:11], s45 offen offset:1024 lds
    buffer_load_dwordx4 v3, s[8:11], s46 offen offset:2048 lds
    buffer_load_dwordx4 v3, s[8:11], s47 offen offset:3072 lds
    s_add_u32 m0, s40, 4096
    s_nop 0
    buffer_load_dwordx4 v3, s[8:11], s48 offen offset:0 lds
    buffer_load_dwordx4 v3, s[8:11], s49 offen offset:1024 lds
    buffer_load_dwordx4 v3, s[8:11], s50 offen offset:2048 lds
    buffer_load_dwordx4 v3, s[8:11], s51 offen offset:3072 lds
    v_add_u32 v3, 524288, v3
    s_mov_b32 s68, s32
    s_mov_b32 s69, s33
    s_mov_b32 s70, 1280
    s_mov_b32 s71, 0x20000
    buffer_load_ushort v40, v36, s[68:71], 0 offen offset:0
    buffer_load_ushort v41, v36, s[68:71], 0 offen offset:256
    buffer_load_ushort v42, v36, s[68:71], 0 offen offset:512
    buffer_load_ushort v43, v36, s[68:71], 0 offen offset:768
    buffer_load_ushort v44, v36, s[68:71], 0 offen offset:1024
    s_lshr_b32 s31, s2, 3
    s_lshl_b32 s31, s31, 1
    s_and_b32 s41, s3, 1
    s_add_u32 s31, s31, s41
    s_lshl_b32 s31, s31, 13
    s_and_b32 s41, s28, 0x3ff
    s_sub_u32 s31, s31, s41
    v_lshlrev_b32 v22, 19, v13
    v_lshl_add_u32 v22, v15, 7, v22
    v_add_u32 v22, s31, v22
    v_lshl_or_b32 v22, v16, 26, v22
    v_lshrrev_b32 v23, 1, v1
    s_and_b32 s31, s26, 3
    s_lshl_b32 s31, s31, 14
    v_lshl_add_u32 v23, v23, 10, s31
    v_and_b32 v17, 1, v1
    v_lshl_add_u32 v23, v17, 7, v23
    v_lshrrev_b32 v17, 5, v1
    v_lshl_or_b32 v23, v17, 26, v23
    v_accvgpr_write_b32 a124, v22
    v_accvgpr_write_b32 a125, v23
    v_lshlrev_b32 v2, 4, v1
    s_mov_b32 s4, s38
    s_mov_b32 s5, s39
    s_lshr_b32 s29, s3, 1
    s_lshl_b32 s29, s29, 19
    s_add_u32 s28, s28, s29
    s_add_u32 s68, s6, s28
    s_addc_u32 s69, s7, 0
    s_sub_u32 s70, 5242880, s28
    s_mov_b32 s71, 0x20000
    s_mov_b32 s72, s4
    s_mov_b32 s73, s5
    s_mov_b32 s74, 16777216
    s_mov_b32 s75, 0x20000
    s_mov_b32 s76, s36
    s_mov_b32 s77, s37
    s_mov_b32 s78, 256
    s_mov_b32 s79, 0x20000
    s_lshl_b32 s60, s27, 5
    s_add_u32 s60, s60, s26
    s_cmp_lt_u32 s60, 240
    s_cselect_b32 s66, s66, 0
    s_mov_b32 s20, s16
    s_mov_b32 s21, s17
    s_mov_b32 s22, 2621440
    s_mov_b32 s23, 0x20000
    v_lshrrev_b32 v33, 1, v0
    s_movk_i32 s28, 7680
    v_mul_lo_u32 v28, v33, s28
    v_and_b32 v35, 1, v0
    v_lshl_add_u32 v28, v35, 4, v28
    s_lshl_b32 s29, s60, 5
    v_add_u32 v28, s29, v28
    v_lshrrev_b32 v37, 5, v1
    s_lshl_b32 s28, s2, 3
    s_lshl_b32 s29, s3, 1
    s_add_u32 s28, s28, s29
    v_add_u32 v37, s28, v37
    v_and_b32 v38, 31, v1
    s_movk_i32 s28, 1280
    v_mul_lo_u32 v31, v37, s28
    v_lshl_add_u32 v30, v38, 3, v31
    v_lshl_add_u32 v31, v38, 4, v31
    v_mov_b32 v13, 0x7ffffff0
    v_cmp_eq_u32 vcc, 0, v0
    s_nop 1
    v_cndmask_b32 v29, v13, 0, vcc
    s_getreg_b32 s63, hwreg(HW_REG_XCC_ID, 0, 3)
    s_lshl_b32 s63, s63, 2
    v_lshlrev_b32 v15, 7, v0
    s_cmp_eq_u32 s2, 0
    s_cselect_b32 s28, 64, 0
    v_cmp_gt_u32 vcc, s28, v0
    v_mov_b32 v16, 0
    v_mov_b32 v17, 0
    v_mov_b32 v18, 0
    v_mov_b32 v19, 0
    s_movk_i32 s28, 16384
    v_cndmask_b32 v15, v13, v15, vcc
    s_movk_i32 s29, 24576
    buffer_store_dwordx4 v[16:19], v15, s[72:75], s28 offen sc1
    buffer_store_dwordx4 v[16:19], v15, s[72:75], s29 offen sc1
    s_cmp_eq_u32 s3, 0
    s_cselect_b32 s43, 0, 67108864
    s_cmp_eq_u32 s2, 0
    s_cselect_b32 s31, 0, 0x1000
    v_lshrrev_b32 v13, 2, v1
    v_lshrrev_b32 v14, 3, v1
    v_and_b32 v14, 3, v14
    v_lshlrev_b32 v14, 5, v14
    v_lshlrev_b32 v13, 7, v13
    v_add_u32 v13, v13, v14
    v_and_b32 v14, 3, v1
    v_lshlrev_b32 v14, 3, v14
    v_add_u32 v13, v13, v14
    v_xor_b32 v8, 0, v13
    v_xor_b32 v9, 32, v13
    v_xor_b32 v10, 64, v13
    v_xor_b32 v11, 96, v13
    v_add_u32 v24, 0x10000, v8
    v_add_u32 v25, 0x10000, v9
    v_add_u32 v26, 0x10000, v10
    v_add_u32 v27, 0x10000, v11
    v_and_b32 v13, 15, v1
    v_lshrrev_b32 v14, 4, v1
    v_lshrrev_b32 v15, 1, v13
    v_xor_b32 v14, v14, v15
    v_lshlrev_b32 v14, 4, v14
    v_lshl_add_u32 v13, v13, 7, v14
    s_add_u32 s28, s40, 0x18000
    v_add_u32 v5, s28, v13
    v_xor_b32 v6, 64, v5
    v_lshrrev_b32 v13, 4, v37
    v_mul_u32_u24 v13, 20, v13
    v_lshrrev_b32 v14, 3, v38
    v_add_u32 v13, v13, v14
    v_lshlrev_b32 v13, 6, v13
    v_bfe_u32 v14, v38, 1, 2
    v_lshl_add_u32 v13, v14, 4, v13
    v_and_b32 v14, 15, v37
    v_add_u32 v13, v13, v14
    v_lshlrev_b32 v13, 4, v13
    v_and_b32 v14, 1, v38
    v_lshl_add_u32 v13, v14, 3, v13
    v_add_u32 v13, 1064960, v13
    v_accvgpr_write_b32 a127, v13
    v_lshrrev_b32 v13, 4, v37
    v_mul_u32_u24 v13, 20480, v13
    v_lshl_add_u32 v13, v38, 8, v13
    v_and_b32 v14, 15, v37
    v_lshl_add_u32 v13, v14, 4, v13
    v_add_u32 v0, 1048576, v13
    s_lshl_b32 s39, s3, 11
    s_lshl_b32 s30, s27, 2
    s_add_u32 s30, s30, 4
    s_sub_u32 s37, s30, 1
    s_sub_u32 s42, s30, 4
    s_mov_b32 s38, 0
    s_lshr_b32 s28, s2, 4
    s_sub_u32 s29, 15, s28
    s_min_u32 s28, s28, s29
    s_lshl_b32 s28, s28, 3
    s_and_b32 s29, s2, 3
    s_add_u32 s28, s28, s29
    s_lshl_b32 s28, s28, 7
    s_add_u32 s24, s28, 17408
    s_lshl_b32 s28, s27, 10
    s_add_u32 s25, s28, 17408
    s_lshl_b32 s28, s26, 7
    s_add_u32 s62, s28, 25600
    s_lshl_b32 s28, s27, 16
    s_lshl_b32 s29, s3, 14
    s_add_u32 s32, s28, s29
    s_add_u32 s33, s32, 4096
    s_add_u32 s34, s32, 8192
    s_add_u32 s35, s32, 12288
    s_and_b32 s28, s60, 3
    s_lshl_b32 s28, s28, 7
    s_add_u32 s28, s28, 16384
    s_cmp_lt_u32 s60, 80
    s_cselect_b32 s61, s28, 0x2000000
    s_mul_i32 s28, s60, 1639
    s_lshr_b32 s28, s28, 16
    s_mov_b32 s80, 0
    s_cmp_eq_u32 s28, 1
    s_cmov_b32 s80, 1.0
    s_cmp_eq_u32 s28, 4
    s_cmov_b32 s80, 1.0
    s_cmp_eq_u32 s28, 0
    s_cselect_b32 s81, 0x3e0293ee, 1.0
    s_mul_i32 s29, s28, 40
    s_sub_u32 s29, s60, s29
    s_lshr_b32 s18, s29, 4
    s_lshl_b32 s18, s18, 10
    s_bfe_u32 s41, s29, 0x30001
    s_lshl_b32 s41, s41, 5
    s_add_u32 s18, s18, s41
    s_and_b32 s29, s29, 1
    s_lshl_b32 s29, s29, 3
    s_add_u32 s18, s18, s29
    s_add_u32 s18, s18, 32768
    s_cmp_eq_u32 s28, 3
    s_cselect_b32 s29, 16, 0
    s_add_u32 s18, s18, s29
    s_sub_u32 s28, s28, 3
    s_cmp_lt_u32 s28, 2
    s_cselect_b32 s18, s18, 0x2000000
    s_cmp_lt_u32 s60, 240
    s_cselect_b32 s82, 16, 0
    s_cmp_lg_u32 s3, 0
    s_cmov_b32 s82, 0
    s_lshl_b32 s60, s60, 6
    s_add_u32 m0, s40, 131072
    s_nop 0
    buffer_load_dwordx4 v7, s[12:15], s52 offen offset:0 lds
    buffer_load_dwordx4 v12, s[12:15], s53 offen offset:1024 lds
    buffer_load_dwordx4 v7, s[12:15], s54 offen offset:2048 lds
    buffer_load_dwordx4 v12, s[12:15], s55 offen offset:3072 lds
    s_add_u32 m0, s40, 135168
    s_nop 0
    buffer_load_dwordx4 v7, s[12:15], s56 offen offset:0 lds
    buffer_load_dwordx4 v12, s[12:15], s57 offen offset:1024 lds
    buffer_load_dwordx4 v7, s[12:15], s58 offen offset:2048 lds
    buffer_load_dwordx4 v12, s[12:15], s59 offen offset:3072 lds
    v_add_u32 v7, 128, v7
    v_add_u32 v12, 128, v12
    s_cmp_ge_u32 s3, 2
    s_cselect_b32 s86, s86, s84
    s_cselect_b32 s87, s87, s85
    s_lshl_b32 s28, s2, 2
    s_add_u32 s28, s28, s3
    s_cmp_lt_u32 s28, 640
    s_cselect_b32 s96, s96, s98
    s_cselect_b32 s97, s97, s99
    s_mov_b32 s98, 2211840
    s_cmov_b32 s98, 5242880
    s_mov_b32 s99, 0x20000
    s_cselect_b32 s29, 0, 640
    s_mov_b32 s84, 55296
    s_cmov_b32 s84, 131072
    s_mov_b32 s83, 6291456
    s_cmov_b32 s83, 0
    s_cmp_lt_u32 s28, 910
    s_cselect_b32 s83, s83, 0x4000000
    s_cselect_b32 s28, s28, 640
    s_sub_u32 s28, s28, s29
    s_mul_i32 s29, s28, 13108
    s_lshr_b32 s29, s29, 16
    s_mul_i32 s41, s29, 5
    s_sub_u32 s28, s28, s41
    s_mul_i32 s41, s28, s84
    s_lshl_b32 s41, s41, 3
    s_add_u32 s83, s83, s41
    s_lshr_b32 s36, s29, 1
    s_mul_i32 s41, s36, 37
    s_lshr_b32 s41, s41, 8
    s_mul_i32 s41, s41, 7
    s_add_u32 s41, s41, s36
    s_cmp_ge_u32 s36, 21
    s_cselect_b32 s36, 6, 7
    s_bitcmp1_b32 s29, 0
    s_cselect_b32 s36, s36, 0
    s_add_u32 s41, s41, s36
    s_cmp_eq_u32 s84, 131072
    s_cselect_b32 s41, s29, s41
    s_lshl_b32 s41, s41, 10
    s_add_u32 s83, s83, s41
    s_mul_i32 s36, s29, 40960
    s_lshl_b32 s28, s28, 8
    s_add_u32 s36, s36, s28
    s_and_b32 s28, s2, 31
    s_min_u32 s28, s28, 26
    s_lshl_b32 s28, s28, 7
    s_lshl_b32 s29, s27, 1
    s_and_b32 s41, s3, 1
    s_add_u32 s29, s29, s41
    s_mul_i32 s29, s29, 138240
    s_add_u32 s28, s28, s29
    s_add_u32 s6, s86, s28
    s_addc_u32 s7, s87, 0
    s_waitcnt vmcnt(10)
    v_lshlrev_b32 v40, 16, v40
    v_mul_f32 v70, 0xbfb8aa3b, v40
    v_lshlrev_b32 v41, 16, v41
    v_mul_f32 v71, 0xbfb8aa3b, v41
    v_lshlrev_b32 v42, 16, v42
    v_mul_f32 v72, 0xbfb8aa3b, v42
    v_lshlrev_b32 v43, 16, v43
    v_mul_f32 v73, 0xbfb8aa3b, v43
    v_lshlrev_b32 v44, 16, v44
    v_mul_f32 v74, 0xbfb8aa3b, v44
    v_exp_f32 v70, v70
    v_exp_f32 v71, v71
    v_exp_f32 v72, v72
    v_exp_f32 v73, v73
    v_exp_f32 v74, v74
    v_add_f32 v70, 1.0, v70
    v_add_f32 v71, 1.0, v71
    v_add_f32 v72, 1.0, v72
    v_add_f32 v73, 1.0, v73
    v_add_f32 v74, 1.0, v74
    v_rcp_f32 v70, v70
    v_rcp_f32 v71, v71
    v_rcp_f32 v72, v72
    v_rcp_f32 v73, v73
    v_rcp_f32 v74, v74
    v_mul_f32 v70, v70, v40
    v_mul_f32 v71, v71, v41
    v_mul_f32 v72, v72, v42
    v_mul_f32 v73, v73, v43
    v_mul_f32 v74, v74, v44
    v_cvt_pk_bf16_f32 v70, v70, v70
    v_cvt_pk_bf16_f32 v71, v71, v71
    v_cvt_pk_bf16_f32 v72, v72, v72
    v_cvt_pk_bf16_f32 v73, v73, v73
    v_cvt_pk_bf16_f32 v74, v74, v74
    v_lshlrev_b32 v40, 16, v70
    v_lshlrev_b32 v41, 16, v71
    v_lshlrev_b32 v42, 16, v72
    v_lshlrev_b32 v43, 16, v73
    v_lshlrev_b32 v44, 16, v74
    v_accvgpr_write_b32 a244, v40
    v_accvgpr_write_b32 a245, v41
    v_accvgpr_write_b32 a246, v42
    v_accvgpr_write_b32 a247, v43
    v_accvgpr_write_b32 a248, v44
    s_mov_b32 s28, 0
    buffer_load_dwordx4 a[72:75], v28, s[64:67], s28 offen
    s_mov_b32 s28, 983040
    buffer_load_dwordx4 a[76:79], v28, s[64:67], s28 offen
    s_mov_b32 s28, 1966080
    buffer_load_dwordx4 a[80:83], v28, s[64:67], s28 offen
    s_mov_b32 s28, 2949120
    buffer_load_dwordx4 a[84:87], v28, s[64:67], s28 offen
    s_mov_b32 s28, 3932160
    buffer_load_dwordx4 a[88:91], v28, s[64:67], s28 offen
    s_add_u32 m0, s40, 32768
    s_nop 0
    buffer_load_dwordx4 v3, s[8:11], s44 offen offset:0 lds
    buffer_load_dwordx4 v3, s[8:11], s45 offen offset:1024 lds
    buffer_load_dwordx4 v3, s[8:11], s46 offen offset:2048 lds
    buffer_load_dwordx4 v3, s[8:11], s47 offen offset:3072 lds
    s_add_u32 m0, s40, 36864
    s_nop 0
    buffer_load_dwordx4 v3, s[8:11], s48 offen offset:0 lds
    buffer_load_dwordx4 v3, s[8:11], s49 offen offset:1024 lds
    buffer_load_dwordx4 v3, s[8:11], s50 offen offset:2048 lds
    buffer_load_dwordx4 v3, s[8:11], s51 offen offset:3072 lds
    v_add_u32 v3, 524288, v3
    s_waitcnt vmcnt(13)
    s_barrier
    ds_read_b128 a[128:131], v5 offset:32768
    ds_read_b128 a[132:135], v6 offset:32768
    ds_read_b128 a[136:139], v5 offset:34816
    ds_read_b128 a[140:143], v6 offset:34816
    ds_read_b128 a[144:147], v5 offset:36864
    ds_read_b128 a[148:151], v6 offset:36864
    ds_read_b128 a[152:155], v5 offset:38912
    ds_read_b128 a[156:159], v6 offset:38912
    ds_read_b64_tr_b16 a[192:193], v8 offset:0
    ds_read_b64_tr_b16 a[194:195], v8 offset:2048
    ds_read_b64_tr_b16 a[196:197], v8 offset:4096
    ds_read_b64_tr_b16 a[198:199], v8 offset:6144
    s_waitcnt lgkmcnt(2)
    ds_read_b64_tr_b16 a[200:201], v9 offset:0
    ds_read_b64_tr_b16 a[202:203], v9 offset:2048
    ds_read_b64_tr_b16 a[204:205], v9 offset:4096
    ds_read_b64_tr_b16 a[206:207], v9 offset:6144
    s_waitcnt lgkmcnt(4)
    v_mfma_f32_16x16x32_bf16 v[32:35], a[192:195], a[128:131], 0
    ds_read_b64_tr_b16 a[208:209], v10 offset:0
    ds_read_b64_tr_b16 a[210:211], v10 offset:2048
    v_mfma_f32_16x16x32_bf16 v[32:35], a[196:199], a[132:135], v[32:35]
    s_add_u32 m0, s40, 98304
    ds_read_b64_tr_b16 a[212:213], v10 offset:4096
    ds_read_b64_tr_b16 a[214:215], v10 offset:6144
    v_mfma_f32_16x16x32_bf16 v[40:43], a[196:199], a[140:143], 0
    buffer_load_dwordx4 v7, s[12:15], s52 offen offset:0 lds
    v_mfma_f32_16x16x32_bf16 v[40:43], a[192:195], a[136:139], v[40:43]
    v_mfma_f32_16x16x32_bf16 v[48:51], a[192:195], a[144:147], 0
    buffer_load_dwordx4 v12, s[12:15], s53 offen offset:1024 lds
    v_mfma_f32_16x16x32_bf16 v[48:51], a[196:199], a[148:151], v[48:51]
    v_mfma_f32_16x16x32_bf16 v[56:59], a[196:199], a[156:159], 0
    v_mfma_f32_16x16x32_bf16 v[56:59], a[192:195], a[152:155], v[56:59]
    s_waitcnt lgkmcnt(4)
    v_mfma_f32_16x16x32_bf16 v[60:63], a[200:203], a[152:155], 0
    s_waitcnt vmcnt(10)
    ds_read_b64_tr_b16 a[216:217], v11 offset:0
    ds_read_b64_tr_b16 a[218:219], v11 offset:2048
    v_mfma_f32_16x16x32_bf16 v[60:63], a[204:207], a[156:159], v[60:63]
    ds_read_b64_tr_b16 a[220:221], v11 offset:4096
    ds_read_b64_tr_b16 a[222:223], v11 offset:6144
    v_mfma_f32_16x16x32_bf16 v[52:55], a[204:207], a[148:151], 0
    buffer_load_dwordx4 v7, s[12:15], s54 offen offset:2048 lds
    v_mfma_f32_16x16x32_bf16 v[52:55], a[200:203], a[144:147], v[52:55]
    buffer_load_dwordx4 v12, s[12:15], s55 offen offset:3072 lds
    v_mfma_f32_16x16x32_bf16 v[44:47], a[200:203], a[136:139], 0
    s_add_u32 m0, s40, 102400
    v_accvgpr_read_b32 v28, a244
    v_accvgpr_read_b32 v22, a72
    v_mfma_f32_16x16x32_bf16 v[44:47], a[204:207], a[140:143], v[44:47]
    buffer_load_dwordx4 v7, s[12:15], s56 offen offset:0 lds
    v_mfma_f32_16x16x32_bf16 v[36:39], a[204:207], a[132:135], 0
    v_lshlrev_b32 v23, 16, v22
    v_and_b32 v22, 0xffff0000, v22
    v_mfma_f32_16x16x32_bf16 v[36:39], a[200:203], a[128:131], v[36:39]
    s_waitcnt lgkmcnt(4)
    v_mul_f32 v14, v23, v28
    v_mul_f32 v15, v22, v28
    v_mfma_f32_16x16x32_bf16 v[64:67], a[208:211], a[128:131], 0
    ds_read_b64_tr_b16 a[192:193], v8 offset:8192
    ds_read_b64_tr_b16 a[194:195], v8 offset:10240
    v_mfma_f32_16x16x32_bf16 v[64:67], a[212:215], a[132:135], v[64:67]
    ds_read_b64_tr_b16 a[196:197], v8 offset:12288
    ds_read_b64_tr_b16 a[198:199], v8 offset:14336
    v_mfma_f32_16x16x32_bf16 v[72:75], a[212:215], a[140:143], 0
    buffer_load_dwordx4 v12, s[12:15], s57 offen offset:1024 lds
    v_mfma_f32_16x16x32_bf16 v[72:75], a[208:211], a[136:139], v[72:75]
    buffer_load_dwordx4 v7, s[12:15], s58 offen offset:2048 lds
    v_mfma_f32_16x16x32_bf16 v[80:83], a[208:211], a[144:147], 0
    v_accvgpr_read_b32 v22, a73
    v_lshlrev_b32 v23, 16, v22
    v_mfma_f32_16x16x32_bf16 v[80:83], a[212:215], a[148:151], v[80:83]
    v_and_b32 v22, 0xffff0000, v22
    v_mul_f32 v16, v23, v28
    v_mfma_f32_16x16x32_bf16 v[88:91], a[212:215], a[156:159], 0
    buffer_load_dwordx4 v12, s[12:15], s59 offen offset:3072 lds
    v_mfma_f32_16x16x32_bf16 v[88:91], a[208:211], a[152:155], v[88:91]
    s_waitcnt lgkmcnt(4)
    v_add_u32 v7, 128, v7
    v_add_u32 v12, 128, v12
    v_mfma_f32_16x16x32_bf16 v[92:95], a[216:219], a[152:155], 0
    s_waitcnt vmcnt(29)
    ds_read_b64_tr_b16 a[200:201], v9 offset:8192
    ds_read_b64_tr_b16 a[202:203], v9 offset:10240
    v_mfma_f32_16x16x32_bf16 v[92:95], a[220:223], a[156:159], v[92:95]
    ds_read_b64_tr_b16 a[204:205], v9 offset:12288
    ds_read_b64_tr_b16 a[206:207], v9 offset:14336
    v_mfma_f32_16x16x32_bf16 v[84:87], a[220:223], a[148:151], 0
    v_mov_b32 v13, 1
    v_mul_f32 v17, v22, v28
    v_mfma_f32_16x16x32_bf16 v[84:87], a[216:219], a[144:147], v[84:87]
    buffer_atomic_add v13, v29, s[76:79], s31 offen
    v_mfma_f32_16x16x32_bf16 v[76:79], a[216:219], a[136:139], 0
    s_add_u32 m0, s40, 65536
    v_accvgpr_read_b32 v22, a74
    v_lshlrev_b32 v23, 16, v22
    v_mfma_f32_16x16x32_bf16 v[76:79], a[220:223], a[140:143], v[76:79]
    buffer_load_dwordx4 v3, s[8:11], s44 offen offset:0 lds
    v_mfma_f32_16x16x32_bf16 v[68:71], a[220:223], a[132:135], 0
    v_and_b32 v22, 0xffff0000, v22
    v_mul_f32 v18, v23, v28
    v_mfma_f32_16x16x32_bf16 v[68:71], a[216:219], a[128:131], v[68:71]
    s_waitcnt lgkmcnt(4)
    v_mul_f32 v19, v22, v28
    v_accvgpr_read_b32 v22, a75
    v_mfma_f32_16x16x32_bf16 v[96:99], a[192:195], a[128:131], 0
    ds_read_b64_tr_b16 a[208:209], v10 offset:8192
    ds_read_b64_tr_b16 a[210:211], v10 offset:10240
    v_mfma_f32_16x16x32_bf16 v[96:99], a[196:199], a[132:135], v[96:99]
    ds_read_b64_tr_b16 a[212:213], v10 offset:12288
    ds_read_b64_tr_b16 a[214:215], v10 offset:14336
    v_mfma_f32_16x16x32_bf16 v[104:107], a[196:199], a[140:143], 0
    buffer_load_dwordx4 v3, s[8:11], s45 offen offset:1024 lds
    v_mfma_f32_16x16x32_bf16 v[104:107], a[192:195], a[136:139], v[104:107]
    buffer_load_dwordx4 v3, s[8:11], s46 offen offset:2048 lds
    v_mfma_f32_16x16x32_bf16 v[112:115], a[192:195], a[144:147], 0
    v_lshlrev_b32 v23, 16, v22
    v_and_b32 v22, 0xffff0000, v22
    v_mfma_f32_16x16x32_bf16 v[112:115], a[196:199], a[148:151], v[112:115]
    v_mul_f32 v20, v23, v28
    v_mul_f32 v21, v22, v28
    v_mfma_f32_16x16x32_bf16 v[120:123], a[196:199], a[156:159], 0
    v_accvgpr_read_b32 v28, a245
    v_accvgpr_read_b32 v22, a76
    v_mfma_f32_16x16x32_bf16 v[120:123], a[192:195], a[152:155], v[120:123]
    s_waitcnt lgkmcnt(4)
    v_lshlrev_b32 v23, 16, v22
    v_and_b32 v22, 0xffff0000, v22
    v_mfma_f32_16x16x32_bf16 v[124:127], a[200:203], a[152:155], 0
    ds_read_b64_tr_b16 a[216:217], v11 offset:8192
    ds_read_b64_tr_b16 a[218:219], v11 offset:10240
    v_mfma_f32_16x16x32_bf16 v[124:127], a[204:207], a[156:159], v[124:127]
    ds_read_b64_tr_b16 a[220:221], v11 offset:12288
    ds_read_b64_tr_b16 a[222:223], v11 offset:14336
    v_mfma_f32_16x16x32_bf16 v[116:119], a[204:207], a[148:151], 0
    buffer_load_dwordx4 v3, s[8:11], s47 offen offset:3072 lds
    v_mfma_f32_16x16x32_bf16 v[116:119], a[200:203], a[144:147], v[116:119]
    s_add_u32 m0, s40, 69632
    v_fmac_f32 v14, v23, v28
    v_fmac_f32 v15, v22, v28
    v_mfma_f32_16x16x32_bf16 v[108:111], a[200:203], a[136:139], 0
    buffer_load_dwordx4 v3, s[8:11], s48 offen offset:0 lds
    v_mfma_f32_16x16x32_bf16 v[108:111], a[204:207], a[140:143], v[108:111]
    v_accvgpr_read_b32 v22, a77
    v_lshlrev_b32 v23, 16, v22
    v_mfma_f32_16x16x32_bf16 v[100:103], a[204:207], a[132:135], 0
    buffer_load_dwordx4 v3, s[8:11], s49 offen offset:1024 lds
    v_mfma_f32_16x16x32_bf16 v[100:103], a[200:203], a[128:131], v[100:103]
    s_waitcnt lgkmcnt(4)
    v_and_b32 v22, 0xffff0000, v22
    v_fmac_f32 v16, v23, v28
    v_mfma_f32_16x16x32_bf16 v[128:131], a[208:211], a[128:131], 0
    ds_read_b64_tr_b16 a[192:193], v8 offset:16384
    ds_read_b64_tr_b16 a[194:195], v8 offset:18432
    v_mfma_f32_16x16x32_bf16 v[128:131], a[212:215], a[132:135], v[128:131]
    ds_read_b64_tr_b16 a[196:197], v8 offset:20480
    ds_read_b64_tr_b16 a[198:199], v8 offset:22528
    v_mfma_f32_16x16x32_bf16 v[136:139], a[212:215], a[140:143], 0
    buffer_load_dwordx4 v3, s[8:11], s50 offen offset:2048 lds
    v_mfma_f32_16x16x32_bf16 v[136:139], a[208:211], a[136:139], v[136:139]
    v_fmac_f32 v17, v22, v28
    v_accvgpr_read_b32 v22, a78
    v_mfma_f32_16x16x32_bf16 v[144:147], a[208:211], a[144:147], 0
    v_lshlrev_b32 v23, 16, v22
    v_and_b32 v22, 0xffff0000, v22
    v_mfma_f32_16x16x32_bf16 v[144:147], a[212:215], a[148:151], v[144:147]
    v_fmac_f32 v18, v23, v28
    v_fmac_f32 v19, v22, v28
    v_mfma_f32_16x16x32_bf16 v[152:155], a[212:215], a[156:159], 0
    buffer_load_dwordx4 v3, s[8:11], s51 offen offset:3072 lds
    v_mfma_f32_16x16x32_bf16 v[152:155], a[208:211], a[152:155], v[152:155]
    s_waitcnt lgkmcnt(4)
    v_add_u32 v3, 524288, v3
    v_accvgpr_read_b32 v13, a124
    v_mfma_f32_16x16x32_bf16 v[156:159], a[216:219], a[152:155], 0
    s_mov_b32 s41, 2097152
    ds_read_b64_tr_b16 a[200:201], v9 offset:16384
    ds_read_b64_tr_b16 a[202:203], v9 offset:18432
    v_mfma_f32_16x16x32_bf16 v[156:159], a[220:223], a[156:159], v[156:159]
    ds_read_b64_tr_b16 a[204:205], v9 offset:20480
    ds_read_b64_tr_b16 a[206:207], v9 offset:22528
    v_mfma_f32_16x16x32_bf16 v[148:151], a[220:223], a[148:151], 0
    buffer_load_dword a252, v13, s[8:11], s41 offen
    v_mfma_f32_16x16x32_bf16 v[148:151], a[216:219], a[144:147], v[148:151]
    v_accvgpr_read_b32 v13, a125
    v_accvgpr_read_b32 v22, a79
    v_mfma_f32_16x16x32_bf16 v[140:143], a[216:219], a[136:139], 0
    s_add_u32 m0, s40, 131072
    v_lshlrev_b32 v23, 16, v22
    v_and_b32 v22, 0xffff0000, v22
    v_mfma_f32_16x16x32_bf16 v[140:143], a[220:223], a[140:143], v[140:143]
    buffer_load_dwordx4 v7, s[12:15], s52 offen offset:0 lds
    v_mfma_f32_16x16x32_bf16 v[132:135], a[220:223], a[132:135], 0
    v_fmac_f32 v20, v23, v28
    v_fmac_f32 v21, v22, v28
    v_mfma_f32_16x16x32_bf16 v[132:135], a[216:219], a[128:131], v[132:135]
    s_waitcnt lgkmcnt(4)
    v_accvgpr_read_b32 v28, a246
    v_accvgpr_read_b32 v22, a80
    v_mfma_f32_16x16x32_bf16 v[160:163], a[128:131], a[192:195], 0
    ds_read_b64_tr_b16 a[208:209], v10 offset:16384
    ds_read_b64_tr_b16 a[210:211], v10 offset:18432
    v_mfma_f32_16x16x32_bf16 v[160:163], a[132:135], a[196:199], v[160:163]
    ds_read_b64_tr_b16 a[212:213], v10 offset:20480
    ds_read_b64_tr_b16 a[214:215], v10 offset:22528
    v_mfma_f32_16x16x32_bf16 v[164:167], a[140:143], a[196:199], 0
    buffer_load_dwordx4 v12, s[12:15], s53 offen offset:1024 lds
    v_mfma_f32_16x16x32_bf16 v[164:167], a[136:139], a[192:195], v[164:167]
    v_lshlrev_b32 v23, 16, v22
    v_and_b32 v22, 0xffff0000, v22
    v_mfma_f32_16x16x32_bf16 v[168:171], a[144:147], a[192:195], 0
    v_fmac_f32 v14, v23, v28
    v_fmac_f32 v15, v22, v28
    v_mfma_f32_16x16x32_bf16 v[168:171], a[148:151], a[196:199], v[168:171]
    buffer_load_dwordx4 v7, s[12:15], s54 offen offset:2048 lds
    v_mfma_f32_16x16x32_bf16 v[172:175], a[156:159], a[196:199], 0
    v_accvgpr_read_b32 v22, a81
    v_lshlrev_b32 v23, 16, v22
    v_mfma_f32_16x16x32_bf16 v[172:175], a[152:155], a[192:195], v[172:175]
    s_waitcnt lgkmcnt(4)
    v_and_b32 v22, 0xffff0000, v22
    v_fmac_f32 v16, v23, v28
    v_mfma_f32_16x16x32_bf16 v[188:191], a[152:155], a[200:203], 0
    ds_read_b64_tr_b16 a[216:217], v11 offset:16384
    ds_read_b64_tr_b16 a[218:219], v11 offset:18432
    v_mfma_f32_16x16x32_bf16 v[188:191], a[156:159], a[204:207], v[188:191]
    ds_read_b64_tr_b16 a[220:221], v11 offset:20480
    ds_read_b64_tr_b16 a[222:223], v11 offset:22528
    v_mfma_f32_16x16x32_bf16 v[184:187], a[148:151], a[204:207], 0
    buffer_load_dwordx4 v12, s[12:15], s55 offen offset:3072 lds
    v_mfma_f32_16x16x32_bf16 v[184:187], a[144:147], a[200:203], v[184:187]
    s_add_u32 m0, s40, 135168
    v_fmac_f32 v17, v22, v28
    v_accvgpr_read_b32 v22, a82
    v_mfma_f32_16x16x32_bf16 v[180:183], a[136:139], a[200:203], 0
    buffer_load_dwordx4 v7, s[12:15], s56 offen offset:0 lds
    v_mfma_f32_16x16x32_bf16 v[180:183], a[140:143], a[204:207], v[180:183]
    v_lshlrev_b32 v23, 16, v22
    v_and_b32 v22, 0xffff0000, v22
    v_mfma_f32_16x16x32_bf16 v[176:179], a[132:135], a[204:207], 0
    v_fmac_f32 v18, v23, v28
    v_fmac_f32 v19, v22, v28
    v_mfma_f32_16x16x32_bf16 v[176:179], a[128:131], a[200:203], v[176:179]
    s_waitcnt lgkmcnt(4)
    v_accvgpr_read_b32 v22, a83
    v_lshlrev_b32 v23, 16, v22
    v_mfma_f32_16x16x32_bf16 v[192:195], a[128:131], a[208:211], 0
    ds_read_b64_tr_b16 a[192:193], v8 offset:24576
    ds_read_b64_tr_b16 a[194:195], v8 offset:26624
    v_mfma_f32_16x16x32_bf16 v[192:195], a[132:135], a[212:215], v[192:195]
    ds_read_b64_tr_b16 a[196:197], v8 offset:28672
    ds_read_b64_tr_b16 a[198:199], v8 offset:30720
    v_mfma_f32_16x16x32_bf16 v[196:199], a[140:143], a[212:215], 0
    buffer_load_dwordx4 v12, s[12:15], s57 offen offset:1024 lds
    v_mfma_f32_16x16x32_bf16 v[196:199], a[136:139], a[208:211], v[196:199]
    v_and_b32 v22, 0xffff0000, v22
    v_fmac_f32 v20, v23, v28
    v_mfma_f32_16x16x32_bf16 v[200:203], a[144:147], a[208:211], 0
    buffer_load_dwordx4 v7, s[12:15], s58 offen offset:2048 lds
    v_mfma_f32_16x16x32_bf16 v[200:203], a[148:151], a[212:215], v[200:203]
    v_fmac_f32 v21, v22, v28
    v_accvgpr_read_b32 v28, a247
    v_mfma_f32_16x16x32_bf16 v[204:207], a[156:159], a[212:215], 0
    v_accvgpr_read_b32 v22, a84
    v_lshlrev_b32 v23, 16, v22
    v_mfma_f32_16x16x32_bf16 v[204:207], a[152:155], a[208:211], v[204:207]
    s_waitcnt lgkmcnt(4)
    v_and_b32 v22, 0xffff0000, v22
    v_fmac_f32 v14, v23, v28
    v_mfma_f32_16x16x32_bf16 v[220:223], a[152:155], a[216:219], 0
    ds_read_b64_tr_b16 a[200:201], v9 offset:24576
    ds_read_b64_tr_b16 a[202:203], v9 offset:26624
    v_mfma_f32_16x16x32_bf16 v[220:223], a[156:159], a[220:223], v[220:223]
    ds_read_b64_tr_b16 a[204:205], v9 offset:28672
    ds_read_b64_tr_b16 a[206:207], v9 offset:30720
    v_mfma_f32_16x16x32_bf16 v[216:219], a[148:151], a[220:223], 0
    buffer_load_dwordx4 v12, s[12:15], s59 offen offset:3072 lds
    v_mfma_f32_16x16x32_bf16 v[216:219], a[144:147], a[216:219], v[216:219]
    v_add_u32 v7, 128, v7
    v_add_u32 v12, 128, v12
    v_mfma_f32_16x16x32_bf16 v[212:215], a[136:139], a[216:219], 0
    buffer_load_dwordx4 a[96:99], v31, s[20:23], 0 offen offset:0
    v_mfma_f32_16x16x32_bf16 v[212:215], a[140:143], a[220:223], v[212:215]
    v_fmac_f32 v15, v22, v28
    v_accvgpr_read_b32 v22, a85
    v_mfma_f32_16x16x32_bf16 v[208:211], a[132:135], a[220:223], 0
    v_lshlrev_b32 v23, 16, v22
    v_and_b32 v22, 0xffff0000, v22
    v_mfma_f32_16x16x32_bf16 v[208:211], a[128:131], a[216:219], v[208:211]
    s_waitcnt lgkmcnt(4)
    v_fmac_f32 v16, v23, v28
    v_fmac_f32 v17, v22, v28
    v_mfma_f32_16x16x32_bf16 v[224:227], a[128:131], a[192:195], 0
    ds_read_b64_tr_b16 a[208:209], v10 offset:24576
    ds_read_b64_tr_b16 a[210:211], v10 offset:26624
    v_mfma_f32_16x16x32_bf16 v[224:227], a[132:135], a[196:199], v[224:227]
    ds_read_b64_tr_b16 a[212:213], v10 offset:28672
    ds_read_b64_tr_b16 a[214:215], v10 offset:30720
    v_mfma_f32_16x16x32_bf16 v[228:231], a[140:143], a[196:199], 0
    buffer_load_dwordx4 a[100:103], v31, s[20:23], 0 offen offset:512
    v_mfma_f32_16x16x32_bf16 v[228:231], a[136:139], a[192:195], v[228:231]
    buffer_load_dwordx2 a[104:105], v30, s[20:23], 0 offen offset:1024
    v_mfma_f32_16x16x32_bf16 v[232:235], a[144:147], a[192:195], 0
    v_accvgpr_read_b32 v22, a86
    v_lshlrev_b32 v23, 16, v22
    v_mfma_f32_16x16x32_bf16 v[232:235], a[148:151], a[196:199], v[232:235]
    v_and_b32 v22, 0xffff0000, v22
    v_fmac_f32 v18, v23, v28
    v_mfma_f32_16x16x32_bf16 v[236:239], a[156:159], a[196:199], 0
    v_fmac_f32 v19, v22, v28
    v_accvgpr_read_b32 v22, a87
    v_mfma_f32_16x16x32_bf16 v[236:239], a[152:155], a[192:195], v[236:239]
    s_waitcnt lgkmcnt(4)
    v_lshlrev_b32 v23, 16, v22
    v_and_b32 v22, 0xffff0000, v22
    v_mfma_f32_16x16x32_bf16 v[252:255], a[152:155], a[200:203], 0
    ds_read_b64_tr_b16 a[216:217], v11 offset:24576
    ds_read_b64_tr_b16 a[218:219], v11 offset:26624
    v_mfma_f32_16x16x32_bf16 v[252:255], a[156:159], a[204:207], v[252:255]
    ds_read_b64_tr_b16 a[220:221], v11 offset:28672
    ds_read_b64_tr_b16 a[222:223], v11 offset:30720
    v_mfma_f32_16x16x32_bf16 v[248:251], a[148:151], a[204:207], 0
    buffer_load_dword v31, v29, s[76:79], 0 offen sc1
    v_mfma_f32_16x16x32_bf16 v[248:251], a[144:147], a[200:203], v[248:251]
    v_fmac_f32 v20, v23, v28
    v_fmac_f32 v21, v22, v28
    v_mfma_f32_16x16x32_bf16 v[244:247], a[136:139], a[200:203], 0
    v_accvgpr_read_b32 v28, a248
    v_accvgpr_read_b32 v22, a88
    v_mfma_f32_16x16x32_bf16 v[244:247], a[140:143], a[204:207], v[244:247]
    v_lshlrev_b32 v23, 16, v22
    v_and_b32 v22, 0xffff0000, v22
    v_mfma_f32_16x16x32_bf16 v[240:243], a[132:135], a[204:207], 0
    v_fmac_f32 v14, v23, v28
    v_fmac_f32 v15, v22, v28
    v_mfma_f32_16x16x32_bf16 v[240:243], a[128:131], a[200:203], v[240:243]
    s_waitcnt lgkmcnt(4)
    v_mfma_f32_16x16x32_bf16 a[0:3], a[128:131], a[208:211], 0
    s_waitcnt vmcnt(22) lgkmcnt(0)
    v_mfma_f32_16x16x32_bf16 a[0:3], a[132:135], a[212:215], a[0:3]
    s_barrier
    v_mfma_f32_16x16x32_bf16 a[4:7], a[140:143], a[212:215], 0
    ds_read_b64_tr_b16 a[192:193], v8 offset:32768
    ds_read_b64_tr_b16 a[194:195], v8 offset:34816
    v_mfma_f32_16x16x32_bf16 a[4:7], a[136:139], a[208:211], a[4:7]
    ds_read_b64_tr_b16 a[196:197], v8 offset:36864
    ds_read_b64_tr_b16 a[198:199], v8 offset:38912
    v_mfma_f32_16x16x32_bf16 a[8:11], a[144:147], a[208:211], 0
    ds_read_b128 a[160:163], v5 offset:0
    ds_read_b128 a[164:167], v6 offset:0
    v_mfma_f32_16x16x32_bf16 a[8:11], a[148:151], a[212:215], a[8:11]
    ds_read_b128 a[168:171], v5 offset:2048
    ds_read_b128 a[172:175], v6 offset:2048
    v_mfma_f32_16x16x32_bf16 a[12:15], a[156:159], a[212:215], 0
    ds_read_b128 a[176:179], v5 offset:4096
    ds_read_b128 a[180:183], v6 offset:4096
    v_mfma_f32_16x16x32_bf16 a[12:15], a[152:155], a[208:211], a[12:15]
    ds_read_b128 a[184:187], v5 offset:6144
    ds_read_b128 a[188:191], v6 offset:6144
    v_mfma_f32_16x16x32_bf16 a[28:31], a[152:155], a[216:219], 0
    s_waitcnt lgkmcnt(8)
    ds_read_b64_tr_b16 a[200:201], v9 offset:32768
    ds_read_b64_tr_b16 a[202:203], v9 offset:34816
    v_mfma_f32_16x16x32_bf16 a[28:31], a[156:159], a[220:223], a[28:31]
    ds_read_b64_tr_b16 a[204:205], v9 offset:36864
    ds_read_b64_tr_b16 a[206:207], v9 offset:38912
    v_mfma_f32_16x16x32_bf16 a[24:27], a[148:151], a[220:223], 0
    v_mfma_f32_16x16x32_bf16 a[24:27], a[144:147], a[216:219], a[24:27]
    v_mfma_f32_16x16x32_bf16 a[20:23], a[136:139], a[216:219], 0
    v_mfma_f32_16x16x32_bf16 a[20:23], a[140:143], a[220:223], a[20:23]
    v_mfma_f32_16x16x32_bf16 a[16:19], a[132:135], a[220:223], 0
    v_mfma_f32_16x16x32_bf16 a[16:19], a[128:131], a[216:219], a[16:19]
    s_waitcnt lgkmcnt(4)
    v_mfma_f32_16x16x32_bf16 v[32:35], a[192:195], a[160:163], v[32:35]
    ds_read_b64_tr_b16 a[208:209], v10 offset:32768
    ds_read_b64_tr_b16 a[210:211], v10 offset:34816
    v_mfma_f32_16x16x32_bf16 v[32:35], a[196:199], a[164:167], v[32:35]
    ds_read_b64_tr_b16 a[212:213], v10 offset:36864
    ds_read_b64_tr_b16 a[214:215], v10 offset:38912
    v_mfma_f32_16x16x32_bf16 v[40:43], a[196:199], a[172:175], v[40:43]
    s_add_u32 m0, s40, 0
    v_accvgpr_read_b32 v22, a89
    v_lshlrev_b32 v23, 16, v22
    v_mfma_f32_16x16x32_bf16 v[40:43], a[192:195], a[168:171], v[40:43]
    buffer_load_dwordx4 v3, s[8:11], s44 offen offset:0 lds
    v_mfma_f32_16x16x32_bf16 v[48:51], a[192:195], a[176:179], v[48:51]
    v_and_b32 v22, 0xffff0000, v22
    v_fmac_f32 v16, v23, v28
    v_mfma_f32_16x16x32_bf16 v[48:51], a[196:199], a[180:183], v[48:51]
    v_fmac_f32 v17, v22, v28
    v_accvgpr_read_b32 v22, a90
    v_mfma_f32_16x16x32_bf16 v[56:59], a[196:199], a[188:191], v[56:59]
    v_lshlrev_b32 v23, 16, v22
    v_and_b32 v22, 0xffff0000, v22
    v_mfma_f32_16x16x32_bf16 v[56:59], a[192:195], a[184:187], v[56:59]
    s_waitcnt lgkmcnt(4)
    v_fmac_f32 v18, v23, v28
    v_fmac_f32 v19, v22, v28
    v_mfma_f32_16x16x32_bf16 v[60:63], a[200:203], a[184:187], v[60:63]
    ds_read_b64_tr_b16 a[216:217], v11 offset:32768
    ds_read_b64_tr_b16 a[218:219], v11 offset:34816
    v_mfma_f32_16x16x32_bf16 v[60:63], a[204:207], a[188:191], v[60:63]
    ds_read_b64_tr_b16 a[220:221], v11 offset:36864
    ds_read_b64_tr_b16 a[222:223], v11 offset:38912
    v_mfma_f32_16x16x32_bf16 v[52:55], a[204:207], a[180:183], v[52:55]
    buffer_load_dwordx4 v3, s[8:11], s45 offen offset:1024 lds
    v_mfma_f32_16x16x32_bf16 v[52:55], a[200:203], a[176:179], v[52:55]
    v_accvgpr_read_b32 v22, a91
    v_lshlrev_b32 v23, 16, v22
    v_mfma_f32_16x16x32_bf16 v[44:47], a[200:203], a[168:171], v[44:47]
    v_and_b32 v22, 0xffff0000, v22
    v_fmac_f32 v20, v23, v28
    v_mfma_f32_16x16x32_bf16 v[44:47], a[204:207], a[172:175], v[44:47]
    v_fmac_f32 v21, v22, v28
    v_mfma_f32_16x16x32_bf16 v[36:39], a[204:207], a[164:167], v[36:39]
    buffer_load_dwordx4 v3, s[8:11], s46 offen offset:2048 lds
    v_mfma_f32_16x16x32_bf16 v[36:39], a[200:203], a[160:163], v[36:39]
    s_waitcnt lgkmcnt(4)
    v_add_f32 v14, v14, v14 row_ror:2
    v_add_f32 v15, v15, v15 row_ror:2
    v_mfma_f32_16x16x32_bf16 v[64:67], a[208:211], a[160:163], v[64:67]
    ds_read_b64_tr_b16 a[192:193], v8 offset:40960
    ds_read_b64_tr_b16 a[194:195], v8 offset:43008
    v_mfma_f32_16x16x32_bf16 v[64:67], a[212:215], a[164:167], v[64:67]
    ds_read_b64_tr_b16 a[196:197], v8 offset:45056
    ds_read_b64_tr_b16 a[198:199], v8 offset:47104
    v_mfma_f32_16x16x32_bf16 v[72:75], a[212:215], a[172:175], v[72:75]
    v_add_f32 v16, v16, v16 row_ror:2
    v_add_f32 v17, v17, v17 row_ror:2
    v_mfma_f32_16x16x32_bf16 v[72:75], a[208:211], a[168:171], v[72:75]
    v_add_f32 v18, v18, v18 row_ror:2
    v_add_f32 v19, v19, v19 row_ror:2
    v_mfma_f32_16x16x32_bf16 v[80:83], a[208:211], a[176:179], v[80:83]
    buffer_load_dwordx4 v3, s[8:11], s47 offen offset:3072 lds
    v_mfma_f32_16x16x32_bf16 v[80:83], a[212:215], a[180:183], v[80:83]
    s_add_u32 m0, s40, 4096
    v_add_f32 v20, v20, v20 row_ror:2
    v_add_f32 v21, v21, v21 row_ror:2
    v_mfma_f32_16x16x32_bf16 v[88:91], a[212:215], a[188:191], v[88:91]
    v_add_f32 v14, v14, v14 row_ror:4
    v_add_f32 v15, v15, v15 row_ror:4
    v_mfma_f32_16x16x32_bf16 v[88:91], a[208:211], a[184:187], v[88:91]
    s_waitcnt lgkmcnt(4)
    v_add_f32 v16, v16, v16 row_ror:4
    v_add_f32 v17, v17, v17 row_ror:4
    v_mfma_f32_16x16x32_bf16 v[92:95], a[216:219], a[184:187], v[92:95]
    ds_read_b64_tr_b16 a[200:201], v9 offset:40960
    ds_read_b64_tr_b16 a[202:203], v9 offset:43008
    v_mfma_f32_16x16x32_bf16 v[92:95], a[220:223], a[188:191], v[92:95]
    ds_read_b64_tr_b16 a[204:205], v9 offset:45056
    ds_read_b64_tr_b16 a[206:207], v9 offset:47104
    v_mfma_f32_16x16x32_bf16 v[84:87], a[220:223], a[180:183], v[84:87]
    buffer_load_dwordx4 v3, s[8:11], s48 offen offset:0 lds
    v_mfma_f32_16x16x32_bf16 v[84:87], a[216:219], a[176:179], v[84:87]
    v_add_f32 v18, v18, v18 row_ror:4
    v_add_f32 v19, v19, v19 row_ror:4
    v_mfma_f32_16x16x32_bf16 v[76:79], a[216:219], a[168:171], v[76:79]
    v_add_f32 v20, v20, v20 row_ror:4
    v_add_f32 v21, v21, v21 row_ror:4
    v_mfma_f32_16x16x32_bf16 v[76:79], a[220:223], a[172:175], v[76:79]
    v_add_f32 v14, v14, v14 row_ror:8
    v_add_f32 v15, v15, v15 row_ror:8
    v_mfma_f32_16x16x32_bf16 v[68:71], a[220:223], a[164:167], v[68:71]
    v_add_f32 v16, v16, v16 row_ror:8
    v_add_f32 v17, v17, v17 row_ror:8
    v_mfma_f32_16x16x32_bf16 v[68:71], a[216:219], a[160:163], v[68:71]
    s_waitcnt lgkmcnt(4)
    v_add_f32 v18, v18, v18 row_ror:8
    v_add_f32 v19, v19, v19 row_ror:8
    v_mfma_f32_16x16x32_bf16 v[96:99], a[192:195], a[160:163], v[96:99]
    ds_read_b64_tr_b16 a[208:209], v10 offset:40960
    ds_read_b64_tr_b16 a[210:211], v10 offset:43008
    v_mfma_f32_16x16x32_bf16 v[96:99], a[196:199], a[164:167], v[96:99]
    ds_read_b64_tr_b16 a[212:213], v10 offset:45056
    ds_read_b64_tr_b16 a[214:215], v10 offset:47104
    v_mfma_f32_16x16x32_bf16 v[104:107], a[196:199], a[172:175], v[104:107]
    buffer_load_dwordx4 v3, s[8:11], s49 offen offset:1024 lds
    v_mfma_f32_16x16x32_bf16 v[104:107], a[192:195], a[168:171], v[104:107]
    v_add_f32 v20, v20, v20 row_ror:8
    v_add_f32 v21, v21, v21 row_ror:8
    v_mfma_f32_16x16x32_bf16 v[112:115], a[192:195], a[176:179], v[112:115]
    v_lshrrev_b32 v13, 4, v1
    v_lshlrev_b32 v13, 6, v13
    v_mfma_f32_16x16x32_bf16 v[112:115], a[196:199], a[180:183], v[112:115]
    v_and_b32 v22, 1, v1
    v_lshl_add_u32 v13, v22, 5, v13
    v_mfma_f32_16x16x32_bf16 v[120:123], a[196:199], a[188:191], v[120:123]
    buffer_load_dwordx4 v3, s[8:11], s50 offen offset:2048 lds
    v_mfma_f32_16x16x32_bf16 v[120:123], a[192:195], a[184:187], v[120:123]
    s_waitcnt lgkmcnt(4)
    v_add_u32 v13, s40, v13
    v_add_u32 v13, 7168, v13
    v_mfma_f32_16x16x32_bf16 v[124:127], a[200:203], a[184:187], v[124:127]
    ds_read_b64_tr_b16 a[216:217], v11 offset:40960
    ds_read_b64_tr_b16 a[218:219], v11 offset:43008
    v_mfma_f32_16x16x32_bf16 v[124:127], a[204:207], a[188:191], v[124:127]
    ds_read_b64_tr_b16 a[220:221], v11 offset:45056
    ds_read_b64_tr_b16 a[222:223], v11 offset:47104
    v_mfma_f32_16x16x32_bf16 v[116:119], a[204:207], a[180:183], v[116:119]
    ds_write_b128 v13, v[14:17]
    ds_write_b128 v13, v[18:21] offset:16
    v_mfma_f32_16x16x32_bf16 v[116:119], a[200:203], a[176:179], v[116:119]
    v_and_b32 v22, 15, v1
    v_lshrrev_b32 v23, 4, v1
    v_mfma_f32_16x16x32_bf16 v[108:111], a[200:203], a[168:171], v[108:111]
    v_lshlrev_b32 v28, 2, v22
    v_lshl_add_u32 v13, v23, 13, v28
    v_mfma_f32_16x16x32_bf16 v[108:111], a[204:207], a[172:175], v[108:111]
    v_add_u32 v13, 7168, v13
    v_mfma_f32_16x16x32_bf16 v[100:103], a[204:207], a[164:167], v[100:103]
    v_mfma_f32_16x16x32_bf16 v[100:103], a[200:203], a[160:163], v[100:103]
    s_waitcnt lgkmcnt(6)
    s_waitcnt lgkmcnt(0)
    v_mfma_f32_16x16x32_bf16 v[128:131], a[208:211], a[160:163], v[128:131]
    ds_read_b64_tr_b16 a[192:193], v8 offset:49152
    ds_read_b64_tr_b16 a[194:195], v8 offset:51200
    v_mfma_f32_16x16x32_bf16 v[128:131], a[212:215], a[164:167], v[128:131]
    ds_read_b64_tr_b16 a[196:197], v8 offset:53248
    ds_read_b64_tr_b16 a[198:199], v8 offset:55296
    v_mfma_f32_16x16x32_bf16 v[136:139], a[212:215], a[172:175], v[136:139]
    s_barrier
    v_mfma_f32_16x16x32_bf16 v[136:139], a[208:211], a[168:171], v[136:139]
    ds_read_b32 v14, v13 offset:0
    ds_read_b32 v15, v13 offset:64
    v_mfma_f32_16x16x32_bf16 v[144:147], a[208:211], a[176:179], v[144:147]
    ds_read_b32 v16, v13 offset:128
    ds_read_b32 v17, v13 offset:192
    v_mfma_f32_16x16x32_bf16 v[144:147], a[212:215], a[180:183], v[144:147]
    v_cmp_gt_u32 s[16:17], s82, v1
    v_mov_b32 v23, 0x7ffffff0
    v_mfma_f32_16x16x32_bf16 v[152:155], a[212:215], a[188:191], v[152:155]
    v_cndmask_b32 v28, v23, v28, s[16:17]
    v_mfma_f32_16x16x32_bf16 v[152:155], a[208:211], a[184:187], v[152:155]
    s_waitcnt lgkmcnt(10)
    v_mfma_f32_16x16x32_bf16 v[156:159], a[216:219], a[184:187], v[156:159]
    s_waitcnt lgkmcnt(0)
    ds_read_b64_tr_b16 a[200:201], v9 offset:49152
    ds_read_b64_tr_b16 a[202:203], v9 offset:51200
    v_mfma_f32_16x16x32_bf16 v[156:159], a[220:223], a[188:191], v[156:159]
    ds_read_b64_tr_b16 a[204:205], v9 offset:53248
    ds_read_b64_tr_b16 a[206:207], v9 offset:55296
    v_mfma_f32_16x16x32_bf16 v[148:151], a[220:223], a[180:183], v[148:151]
    v_add_f32 v14, v14, v15
    v_add_f32 v16, v16, v17
    v_mfma_f32_16x16x32_bf16 v[148:151], a[216:219], a[176:179], v[148:151]
    v_add_f32 v14, v14, v16
    v_mov_b32 v15, v14
    v_mfma_f32_16x16x32_bf16 v[140:143], a[216:219], a[168:171], v[140:143]
    v_mfma_f32_16x16x32_bf16 v[140:143], a[220:223], a[172:175], v[140:143]
    v_permlane32_swap_b32 v14, v15
    v_add_f32 v14, v14, v15
    v_mfma_f32_16x16x32_bf16 v[132:135], a[220:223], a[164:167], v[132:135]
    v_mov_b32 v15, v14
    v_mfma_f32_16x16x32_bf16 v[132:135], a[216:219], a[160:163], v[132:135]
    s_waitcnt lgkmcnt(8)
    v_mfma_f32_16x16x32_bf16 v[160:163], a[160:163], a[192:195], v[160:163]
    ds_read_b64_tr_b16 a[208:209], v10 offset:49152
    ds_read_b64_tr_b16 a[210:211], v10 offset:51200
    v_mfma_f32_16x16x32_bf16 v[160:163], a[164:167], a[196:199], v[160:163]
    ds_read_b64_tr_b16 a[212:213], v10 offset:53248
    ds_read_b64_tr_b16 a[214:215], v10 offset:55296
    v_mfma_f32_16x16x32_bf16 v[164:167], a[172:175], a[196:199], v[164:167]
    v_permlane16_swap_b32 v14, v15
    v_add_f32 v14, v14, v15
    v_mfma_f32_16x16x32_bf16 v[164:167], a[168:171], a[192:195], v[164:167]
    v_cvt_pk_bf16_f32 v14, v14, v14
    v_lshlrev_b32 v14, 16, v14
    v_mfma_f32_16x16x32_bf16 v[168:171], a[176:179], a[192:195], v[168:171]
    v_add_f32 v14, s80, v14
    v_cvt_pk_bf16_f32 v14, v14, v14
    v_mfma_f32_16x16x32_bf16 v[168:171], a[180:183], a[196:199], v[168:171]
    v_lshlrev_b32 v14, 16, v14
    v_mul_f32 v15, s81, v14
    v_mfma_f32_16x16x32_bf16 v[172:175], a[188:191], a[196:199], v[172:175]
    buffer_store_dword v15, v28, s[72:75], s60 offen sc1
    v_mfma_f32_16x16x32_bf16 v[172:175], a[184:187], a[192:195], v[172:175]
    s_waitcnt lgkmcnt(4)
    v_lshrrev_b32 v16, 2, v22
    v_lshlrev_b32 v16, 8, v16
    v_mfma_f32_16x16x32_bf16 v[188:191], a[184:187], a[200:203], v[188:191]
    ds_read_b64_tr_b16 a[216:217], v11 offset:49152
    ds_read_b64_tr_b16 a[218:219], v11 offset:51200
    v_mfma_f32_16x16x32_bf16 v[188:191], a[188:191], a[204:207], v[188:191]
    ds_read_b64_tr_b16 a[220:221], v11 offset:53248
    ds_read_b64_tr_b16 a[222:223], v11 offset:55296
    v_mfma_f32_16x16x32_bf16 v[184:187], a[180:183], a[204:207], v[184:187]
    v_and_b32 v22, 3, v22
    v_lshl_add_u32 v16, v22, 1, v16
    v_mfma_f32_16x16x32_bf16 v[184:187], a[176:179], a[200:203], v[184:187]
    v_cndmask_b32 v16, v23, v16, s[16:17]
    v_and_b32 v22, 1, v22
    v_mfma_f32_16x16x32_bf16 v[180:183], a[168:171], a[200:203], v[180:183]
    v_lshl_or_b32 v16, v22, 28, v16
    v_mov_b32 v17, v14 quad_perm:[1,1,3,3] row_mask:0xf bank_mask:0xf
    v_mfma_f32_16x16x32_bf16 v[180:183], a[172:175], a[204:207], v[180:183]
    v_cvt_pk_bf16_f32 v17, v14, v17
    v_mfma_f32_16x16x32_bf16 v[176:179], a[164:167], a[204:207], v[176:179]
    buffer_store_dword v17, v16, s[72:75], s18 offen sc1
    v_mfma_f32_16x16x32_bf16 v[176:179], a[160:163], a[200:203], v[176:179]
    s_waitcnt lgkmcnt(4)
    s_add_u32 m0, s40, 98304
    v_mfma_f32_16x16x32_bf16 v[192:195], a[160:163], a[208:211], v[192:195]
    ds_read_b64_tr_b16 a[192:193], v8 offset:57344
    ds_read_b64_tr_b16 a[194:195], v8 offset:59392
    v_mfma_f32_16x16x32_bf16 v[192:195], a[164:167], a[212:215], v[192:195]
    ds_read_b64_tr_b16 a[196:197], v8 offset:61440
    ds_read_b64_tr_b16 a[198:199], v8 offset:63488
    v_mfma_f32_16x16x32_bf16 v[196:199], a[172:175], a[212:215], v[196:199]
    buffer_load_dwordx4 v7, s[12:15], s52 offen offset:0 lds
    v_mfma_f32_16x16x32_bf16 v[196:199], a[168:171], a[208:211], v[196:199]
    buffer_load_dwordx4 v12, s[12:15], s53 offen offset:1024 lds
    v_mfma_f32_16x16x32_bf16 v[200:203], a[176:179], a[208:211], v[200:203]
    v_mfma_f32_16x16x32_bf16 v[200:203], a[180:183], a[212:215], v[200:203]
    v_mfma_f32_16x16x32_bf16 v[204:207], a[188:191], a[212:215], v[204:207]
    buffer_load_dwordx4 v7, s[12:15], s54 offen offset:2048 lds
    v_mfma_f32_16x16x32_bf16 v[204:207], a[184:187], a[208:211], v[204:207]
    s_waitcnt lgkmcnt(4)
    v_mfma_f32_16x16x32_bf16 v[220:223], a[184:187], a[216:219], v[220:223]
    ds_read_b64_tr_b16 a[200:201], v9 offset:57344
    ds_read_b64_tr_b16 a[202:203], v9 offset:59392
    v_mfma_f32_16x16x32_bf16 v[220:223], a[188:191], a[220:223], v[220:223]
    ds_read_b64_tr_b16 a[204:205], v9 offset:61440
    ds_read_b64_tr_b16 a[206:207], v9 offset:63488
    v_mfma_f32_16x16x32_bf16 v[216:219], a[180:183], a[220:223], v[216:219]
    buffer_load_dwordx4 v12, s[12:15], s55 offen offset:3072 lds
    v_mfma_f32_16x16x32_bf16 v[216:219], a[176:179], a[216:219], v[216:219]
    s_add_u32 m0, s40, 102400
    v_mfma_f32_16x16x32_bf16 v[212:215], a[168:171], a[216:219], v[212:215]
    v_mfma_f32_16x16x32_bf16 v[212:215], a[172:175], a[220:223], v[212:215]
    v_mfma_f32_16x16x32_bf16 v[208:211], a[164:167], a[220:223], v[208:211]
    buffer_load_dwordx4 v7, s[12:15], s56 offen offset:0 lds
    v_mfma_f32_16x16x32_bf16 v[208:211], a[160:163], a[216:219], v[208:211]
    s_waitcnt lgkmcnt(4)
    v_mfma_f32_16x16x32_bf16 v[224:227], a[160:163], a[192:195], v[224:227]
    ds_read_b64_tr_b16 a[208:209], v10 offset:57344
    ds_read_b64_tr_b16 a[210:211], v10 offset:59392
    v_mfma_f32_16x16x32_bf16 v[224:227], a[164:167], a[196:199], v[224:227]
    ds_read_b64_tr_b16 a[212:213], v10 offset:61440
    ds_read_b64_tr_b16 a[214:215], v10 offset:63488
    v_mfma_f32_16x16x32_bf16 v[228:231], a[172:175], a[196:199], v[228:231]
    buffer_load_dwordx4 v12, s[12:15], s57 offen offset:1024 lds
    v_mfma_f32_16x16x32_bf16 v[228:231], a[168:171], a[192:195], v[228:231]
    v_mfma_f32_16x16x32_bf16 v[232:235], a[176:179], a[192:195], v[232:235]
    s_waitcnt vmcnt(7)
    v_cmp_gt_u32 vcc, 1, v31
    v_mfma_f32_16x16x32_bf16 v[232:235], a[180:183], a[196:199], v[232:235]
    s_and_b32 s28, vcc_lo, 1
    v_mfma_f32_16x16x32_bf16 v[236:239], a[188:191], a[196:199], v[236:239]
    s_cmp_gt_u32 s28, s40
    s_cbranch_scc1 KA_spin_ini
KA_ret_ini:
    v_mfma_f32_16x16x32_bf16 v[236:239], a[184:187], a[192:195], v[236:239]
    s_waitcnt lgkmcnt(4)
    v_mov_b32 v13, 1
    v_mfma_f32_16x16x32_bf16 v[252:255], a[184:187], a[200:203], v[252:255]
    ds_read_b64_tr_b16 a[216:217], v11 offset:57344
    ds_read_b64_tr_b16 a[218:219], v11 offset:59392
    v_mfma_f32_16x16x32_bf16 v[252:255], a[188:191], a[204:207], v[252:255]
    ds_read_b64_tr_b16 a[220:221], v11 offset:61440
    ds_read_b64_tr_b16 a[222:223], v11 offset:63488
    v_mfma_f32_16x16x32_bf16 v[248:251], a[180:183], a[204:207], v[248:251]
    buffer_atomic_add v13, v29, s[72:75], s61 offen
    v_mfma_f32_16x16x32_bf16 v[248:251], a[176:179], a[200:203], v[248:251]
    buffer_load_dwordx4 v7, s[12:15], s58 offen offset:2048 lds
    v_mfma_f32_16x16x32_bf16 v[244:247], a[168:171], a[200:203], v[244:247]
    buffer_load_dwordx4 v12, s[12:15], s59 offen offset:3072 lds
    v_mfma_f32_16x16x32_bf16 v[244:247], a[172:175], a[204:207], v[244:247]
    v_add_u32 v7, 128, v7
    v_add_u32 v12, 128, v12
    v_mfma_f32_16x16x32_bf16 v[240:243], a[164:167], a[204:207], v[240:243]
    v_mfma_f32_16x16x32_bf16 v[240:243], a[160:163], a[200:203], v[240:243]
    s_waitcnt lgkmcnt(4)
    v_mfma_f32_16x16x32_bf16 a[0:3], a[160:163], a[208:211], a[0:3]
    s_waitcnt vmcnt(22) lgkmcnt(0)
    v_mfma_f32_16x16x32_bf16 a[0:3], a[164:167], a[212:215], a[0:3]
    s_barrier
    v_mfma_f32_16x16x32_bf16 a[4:7], a[172:175], a[212:215], a[4:7]
    ds_read_b64_tr_b16 a[192:193], v24 offset:0
    ds_read_b64_tr_b16 a[194:195], v24 offset:2048
    v_mfma_f32_16x16x32_bf16 a[4:7], a[168:171], a[208:211], a[4:7]
    ds_read_b64_tr_b16 a[196:197], v24 offset:4096
    ds_read_b64_tr_b16 a[198:199], v24 offset:6144
    v_mfma_f32_16x16x32_bf16 a[8:11], a[176:179], a[208:211], a[8:11]
    ds_read_b128 a[128:131], v5 offset:32768
    ds_read_b128 a[132:135], v6 offset:32768
    v_mfma_f32_16x16x32_bf16 a[8:11], a[180:183], a[212:215], a[8:11]
    ds_read_b128 a[136:139], v5 offset:34816
    ds_read_b128 a[140:143], v6 offset:34816
    v_mfma_f32_16x16x32_bf16 a[12:15], a[188:191], a[212:215], a[12:15]
    ds_read_b128 a[144:147], v5 offset:36864
    ds_read_b128 a[148:151], v6 offset:36864
    v_mfma_f32_16x16x32_bf16 a[12:15], a[184:187], a[208:211], a[12:15]
    ds_read_b128 a[152:155], v5 offset:38912
    ds_read_b128 a[156:159], v6 offset:38912
    v_mfma_f32_16x16x32_bf16 a[28:31], a[184:187], a[216:219], a[28:31]
    s_waitcnt lgkmcnt(8)
    ds_read_b64_tr_b16 a[200:201], v25 offset:0
    ds_read_b64_tr_b16 a[202:203], v25 offset:2048
    v_mfma_f32_16x16x32_bf16 a[28:31], a[188:191], a[220:223], a[28:31]
    ds_read_b64_tr_b16 a[204:205], v25 offset:4096
    ds_read_b64_tr_b16 a[206:207], v25 offset:6144
    v_mfma_f32_16x16x32_bf16 a[24:27], a[180:183], a[220:223], a[24:27]
    v_mfma_f32_16x16x32_bf16 a[24:27], a[176:179], a[216:219], a[24:27]
    v_mfma_f32_16x16x32_bf16 a[20:23], a[168:171], a[216:219], a[20:23]
    v_mfma_f32_16x16x32_bf16 a[20:23], a[172:175], a[220:223], a[20:23]
    v_mfma_f32_16x16x32_bf16 a[16:19], a[164:167], a[220:223], a[16:19]
    v_mfma_f32_16x16x32_bf16 a[16:19], a[160:163], a[216:219], a[16:19]
    s_waitcnt lgkmcnt(4)
    v_mfma_f32_16x16x32_bf16 v[32:35], a[192:195], a[128:131], v[32:35]
    ds_read_b64_tr_b16 a[208:209], v26 offset:0
    ds_read_b64_tr_b16 a[210:211], v26 offset:2048
    v_mfma_f32_16x16x32_bf16 v[32:35], a[196:199], a[132:135], v[32:35]
    ds_read_b64_tr_b16 a[212:213], v26 offset:4096
    ds_read_b64_tr_b16 a[214:215], v26 offset:6144
    v_mfma_f32_16x16x32_bf16 v[40:43], a[196:199], a[140:143], v[40:43]
    s_add_u32 m0, s40, 4096
    v_accvgpr_read_b32 v22, a96
    v_lshlrev_b32 v23, 16, v22
    v_mfma_f32_16x16x32_bf16 v[40:43], a[192:195], a[136:139], v[40:43]
    buffer_load_dwordx4 v3, s[8:11], s51 offen offset:3072 lds
    v_mfma_f32_16x16x32_bf16 v[48:51], a[192:195], a[144:147], v[48:51]
    v_add_u32 v3, 524288, v3
    v_accvgpr_read_b32 v14, a124
    v_mfma_f32_16x16x32_bf16 v[48:51], a[196:199], a[148:151], v[48:51]
    s_mov_b32 s41, 3145728
    v_and_b32 v22, 0xffff0000, v22
    v_add_f32 v30, v23, v22
    v_mfma_f32_16x16x32_bf16 v[56:59], a[196:199], a[156:159], v[56:59]
    v_accvgpr_read_b32 v22, a97
    v_lshlrev_b32 v23, 16, v22
    v_mfma_f32_16x16x32_bf16 v[56:59], a[192:195], a[152:155], v[56:59]
    s_waitcnt lgkmcnt(4)
    v_and_b32 v22, 0xffff0000, v22
    v_add_f32 v30, v30, v23
    v_mfma_f32_16x16x32_bf16 v[60:63], a[200:203], a[152:155], v[60:63]
    ds_read_b64_tr_b16 a[216:217], v27 offset:0
    ds_read_b64_tr_b16 a[218:219], v27 offset:2048
    v_mfma_f32_16x16x32_bf16 v[60:63], a[204:207], a[156:159], v[60:63]
    ds_read_b64_tr_b16 a[220:221], v27 offset:4096
    ds_read_b64_tr_b16 a[222:223], v27 offset:6144
    v_mfma_f32_16x16x32_bf16 v[52:55], a[204:207], a[148:151], v[52:55]
    buffer_load_dword a253, v14, s[8:11], s41 offen
    v_mfma_f32_16x16x32_bf16 v[52:55], a[200:203], a[144:147], v[52:55]
    v_accvgpr_read_b32 v14, a125
    v_add_f32 v30, v30, v22
    v_mfma_f32_16x16x32_bf16 v[44:47], a[200:203], a[136:139], v[44:47]
    s_add_u32 m0, s40, 32768
    v_accvgpr_read_b32 v22, a98
    v_lshlrev_b32 v23, 16, v22
    v_mfma_f32_16x16x32_bf16 v[44:47], a[204:207], a[140:143], v[44:47]
    buffer_load_dwordx4 v3, s[8:11], s44 offen offset:0 lds
    v_mfma_f32_16x16x32_bf16 v[36:39], a[204:207], a[132:135], v[36:39]
    v_and_b32 v22, 0xffff0000, v22
    v_add_f32 v30, v30, v23
    v_mfma_f32_16x16x32_bf16 v[36:39], a[200:203], a[128:131], v[36:39]
    s_waitcnt lgkmcnt(4)
    v_add_f32 v30, v30, v22
    v_accvgpr_read_b32 v22, a99
    v_mfma_f32_16x16x32_bf16 v[64:67], a[208:211], a[128:131], v[64:67]
    ds_read_b64_tr_b16 a[192:193], v24 offset:8192
    ds_read_b64_tr_b16 a[194:195], v24 offset:10240
    v_mfma_f32_16x16x32_bf16 v[64:67], a[212:215], a[132:135], v[64:67]
    ds_read_b64_tr_b16 a[196:197], v24 offset:12288
    ds_read_b64_tr_b16 a[198:199], v24 offset:14336
    v_mfma_f32_16x16x32_bf16 v[72:75], a[212:215], a[140:143], v[72:75]
    buffer_load_dwordx4 v3, s[8:11], s45 offen offset:1024 lds
    v_mfma_f32_16x16x32_bf16 v[72:75], a[208:211], a[136:139], v[72:75]
    v_lshlrev_b32 v23, 16, v22
    v_and_b32 v22, 0xffff0000, v22
    v_mfma_f32_16x16x32_bf16 v[80:83], a[208:211], a[144:147], v[80:83]
    v_add_f32 v30, v30, v23
    v_add_f32 v30, v30, v22
    v_mfma_f32_16x16x32_bf16 v[80:83], a[212:215], a[148:151], v[80:83]
    v_accvgpr_read_b32 v22, a100
    v_lshlrev_b32 v23, 16, v22
    v_mfma_f32_16x16x32_bf16 v[88:91], a[212:215], a[156:159], v[88:91]
    buffer_load_dwordx4 v3, s[8:11], s46 offen offset:2048 lds
    v_mfma_f32_16x16x32_bf16 v[88:91], a[208:211], a[152:155], v[88:91]
    s_waitcnt lgkmcnt(4)
    v_and_b32 v22, 0xffff0000, v22
    v_add_f32 v30, v30, v23
    v_mfma_f32_16x16x32_bf16 v[92:95], a[216:219], a[152:155], v[92:95]
    ds_read_b64_tr_b16 a[200:201], v25 offset:8192
    ds_read_b64_tr_b16 a[202:203], v25 offset:10240
    v_mfma_f32_16x16x32_bf16 v[92:95], a[220:223], a[156:159], v[92:95]
    ds_read_b64_tr_b16 a[204:205], v25 offset:12288
    ds_read_b64_tr_b16 a[206:207], v25 offset:14336
    v_mfma_f32_16x16x32_bf16 v[84:87], a[220:223], a[148:151], v[84:87]
    v_add_f32 v30, v30, v22
    v_accvgpr_read_b32 v22, a101
    v_mfma_f32_16x16x32_bf16 v[84:87], a[216:219], a[144:147], v[84:87]
    buffer_load_dwordx4 v3, s[8:11], s47 offen offset:3072 lds
    v_mfma_f32_16x16x32_bf16 v[76:79], a[216:219], a[136:139], v[76:79]
    s_add_u32 m0, s40, 36864
    v_lshlrev_b32 v23, 16, v22
    v_and_b32 v22, 0xffff0000, v22
    v_mfma_f32_16x16x32_bf16 v[76:79], a[220:223], a[140:143], v[76:79]
    v_add_f32 v30, v30, v23
    v_add_f32 v30, v30, v22
    v_mfma_f32_16x16x32_bf16 v[68:71], a[220:223], a[132:135], v[68:71]
    v_accvgpr_read_b32 v22, a102
    v_lshlrev_b32 v23, 16, v22
    v_mfma_f32_16x16x32_bf16 v[68:71], a[216:219], a[128:131], v[68:71]
    s_waitcnt lgkmcnt(4)
    v_and_b32 v22, 0xffff0000, v22
    v_add_f32 v30, v30, v23
    v_mfma_f32_16x16x32_bf16 v[96:99], a[192:195], a[128:131], v[96:99]
    ds_read_b64_tr_b16 a[208:209], v26 offset:8192
    ds_read_b64_tr_b16 a[210:211], v26 offset:10240
    v_mfma_f32_16x16x32_bf16 v[96:99], a[196:199], a[132:135], v[96:99]
    ds_read_b64_tr_b16 a[212:213], v26 offset:12288
    ds_read_b64_tr_b16 a[214:215], v26 offset:14336
    v_mfma_f32_16x16x32_bf16 v[104:107], a[196:199], a[140:143], v[104:107]
    buffer_load_dwordx4 v3, s[8:11], s48 offen offset:0 lds
    v_mfma_f32_16x16x32_bf16 v[104:107], a[192:195], a[136:139], v[104:107]
    v_add_f32 v30, v30, v22
    v_accvgpr_read_b32 v22, a103
    v_mfma_f32_16x16x32_bf16 v[112:115], a[192:195], a[144:147], v[112:115]
    v_lshlrev_b32 v23, 16, v22
    v_and_b32 v22, 0xffff0000, v22
    v_mfma_f32_16x16x32_bf16 v[112:115], a[196:199], a[148:151], v[112:115]
    buffer_load_dwordx4 v3, s[8:11], s49 offen offset:1024 lds
    v_mfma_f32_16x16x32_bf16 v[120:123], a[196:199], a[156:159], v[120:123]
    v_add_f32 v30, v30, v23
    v_add_f32 v30, v30, v22
    v_mfma_f32_16x16x32_bf16 v[120:123], a[192:195], a[152:155], v[120:123]
    s_waitcnt lgkmcnt(4)
    v_accvgpr_read_b32 v22, a104
    v_lshlrev_b32 v23, 16, v22
    v_mfma_f32_16x16x32_bf16 v[124:127], a[200:203], a[152:155], v[124:127]
    ds_read_b64_tr_b16 a[216:217], v27 offset:8192
    ds_read_b64_tr_b16 a[218:219], v27 offset:10240
    v_mfma_f32_16x16x32_bf16 v[124:127], a[204:207], a[156:159], v[124:127]
    ds_read_b64_tr_b16 a[220:221], v27 offset:12288
    ds_read_b64_tr_b16 a[222:223], v27 offset:14336
    v_mfma_f32_16x16x32_bf16 v[116:119], a[204:207], a[148:151], v[116:119]
    buffer_load_dwordx4 v3, s[8:11], s50 offen offset:2048 lds
    v_mfma_f32_16x16x32_bf16 v[116:119], a[200:203], a[144:147], v[116:119]
    v_and_b32 v22, 0xffff0000, v22
    v_add_f32 v30, v30, v23
    v_mfma_f32_16x16x32_bf16 v[108:111], a[200:203], a[136:139], v[108:111]
    v_add_f32 v30, v30, v22
    v_accvgpr_read_b32 v22, a105
    v_mfma_f32_16x16x32_bf16 v[108:111], a[204:207], a[140:143], v[108:111]
    v_lshlrev_b32 v23, 16, v22
    v_and_b32 v22, 0xffff0000, v22
    v_mfma_f32_16x16x32_bf16 v[100:103], a[204:207], a[132:135], v[100:103]
    v_add_f32 v30, v30, v23
    v_add_f32 v30, v30, v22
    v_mfma_f32_16x16x32_bf16 v[100:103], a[200:203], a[128:131], v[100:103]
    s_waitcnt lgkmcnt(4)
    v_mfma_f32_16x16x32_bf16 v[128:131], a[208:211], a[128:131], v[128:131]
    ds_read_b64_tr_b16 a[192:193], v24 offset:16384
    ds_read_b64_tr_b16 a[194:195], v24 offset:18432
    v_mfma_f32_16x16x32_bf16 v[128:131], a[212:215], a[132:135], v[128:131]
    ds_read_b64_tr_b16 a[196:197], v24 offset:20480
    ds_read_b64_tr_b16 a[198:199], v24 offset:22528
    v_mfma_f32_16x16x32_bf16 v[136:139], a[212:215], a[140:143], v[136:139]
    buffer_load_dwordx4 v3, s[8:11], s51 offen offset:3072 lds
    v_mfma_f32_16x16x32_bf16 v[136:139], a[208:211], a[136:139], v[136:139]
    v_add_u32 v3, 524288, v3
    v_add_f32 v30, v30, v30 row_ror:8
    v_mfma_f32_16x16x32_bf16 v[144:147], a[208:211], a[144:147], v[144:147]
    s_add_u32 m0, s40, 131072
    v_mfma_f32_16x16x32_bf16 v[144:147], a[212:215], a[148:151], v[144:147]
    buffer_load_dwordx4 v7, s[12:15], s52 offen offset:0 lds
    v_mfma_f32_16x16x32_bf16 v[152:155], a[212:215], a[156:159], v[152:155]
    v_add_f32 v30, v30, v30 row_ror:4
    v_mfma_f32_16x16x32_bf16 v[152:155], a[208:211], a[152:155], v[152:155]
    s_waitcnt lgkmcnt(4)
    v_mfma_f32_16x16x32_bf16 v[156:159], a[216:219], a[152:155], v[156:159]
    ds_read_b64_tr_b16 a[200:201], v25 offset:16384
    ds_read_b64_tr_b16 a[202:203], v25 offset:18432
    v_mfma_f32_16x16x32_bf16 v[156:159], a[220:223], a[156:159], v[156:159]
    ds_read_b64_tr_b16 a[204:205], v25 offset:20480
    ds_read_b64_tr_b16 a[206:207], v25 offset:22528
    v_mfma_f32_16x16x32_bf16 v[148:151], a[220:223], a[148:151], v[148:151]
    buffer_load_dwordx4 v12, s[12:15], s53 offen offset:1024 lds
    v_mfma_f32_16x16x32_bf16 v[148:151], a[216:219], a[144:147], v[148:151]
    v_add_f32 v30, v30, v30 row_ror:2
    v_mfma_f32_16x16x32_bf16 v[140:143], a[216:219], a[136:139], v[140:143]
    v_mfma_f32_16x16x32_bf16 v[140:143], a[220:223], a[140:143], v[140:143]
    v_add_f32 v30, v30, v30 row_ror:1
    v_mov_b32 v13, v30
    v_mfma_f32_16x16x32_bf16 v[132:135], a[220:223], a[132:135], v[132:135]
    buffer_load_dwordx4 v7, s[12:15], s54 offen offset:2048 lds
    v_mfma_f32_16x16x32_bf16 v[132:135], a[216:219], a[128:131], v[132:135]
    s_waitcnt lgkmcnt(4)
    v_permlane16_swap_b32 v30, v13
    v_add_f32 v30, v30, v13
    v_mfma_f32_16x16x32_bf16 v[160:163], a[128:131], a[192:195], v[160:163]
    ds_read_b64_tr_b16 a[208:209], v26 offset:16384
    ds_read_b64_tr_b16 a[210:211], v26 offset:18432
    v_mfma_f32_16x16x32_bf16 v[160:163], a[132:135], a[196:199], v[160:163]
    ds_read_b64_tr_b16 a[212:213], v26 offset:20480
    ds_read_b64_tr_b16 a[214:215], v26 offset:22528
    v_mfma_f32_16x16x32_bf16 v[164:167], a[140:143], a[196:199], v[164:167]
    v_mul_f32 v30, 0xbacccccd, v30
    v_accvgpr_read_b32 v22, a96
    v_mfma_f32_16x16x32_bf16 v[164:167], a[136:139], a[192:195], v[164:167]
    buffer_load_dwordx4 v12, s[12:15], s55 offen offset:3072 lds
    v_mfma_f32_16x16x32_bf16 v[168:171], a[144:147], a[192:195], v[168:171]
    s_add_u32 m0, s40, 135168
    v_lshlrev_b32 v23, 16, v22
    v_and_b32 v22, 0xffff0000, v22
    v_mfma_f32_16x16x32_bf16 v[168:171], a[148:151], a[196:199], v[168:171]
    v_add_f32 v23, v23, v30
    v_add_f32 v22, v22, v30
    v_mfma_f32_16x16x32_bf16 v[172:175], a[156:159], a[196:199], v[172:175]
    v_mul_f32 v4, v23, v23
    v_fmac_f32 v4, v22, v22
    v_mfma_f32_16x16x32_bf16 v[172:175], a[152:155], a[192:195], v[172:175]
    s_waitcnt lgkmcnt(4)
    v_accvgpr_read_b32 v22, a97
    v_lshlrev_b32 v23, 16, v22
    v_mfma_f32_16x16x32_bf16 v[188:191], a[152:155], a[200:203], v[188:191]
    ds_read_b64_tr_b16 a[216:217], v27 offset:16384
    ds_read_b64_tr_b16 a[218:219], v27 offset:18432
    v_mfma_f32_16x16x32_bf16 v[188:191], a[156:159], a[204:207], v[188:191]
    ds_read_b64_tr_b16 a[220:221], v27 offset:20480
    ds_read_b64_tr_b16 a[222:223], v27 offset:22528
    v_mfma_f32_16x16x32_bf16 v[184:187], a[148:151], a[204:207], v[184:187]
    buffer_load_dwordx4 v7, s[12:15], s56 offen offset:0 lds
    v_mfma_f32_16x16x32_bf16 v[184:187], a[144:147], a[200:203], v[184:187]
    v_and_b32 v22, 0xffff0000, v22
    v_add_f32 v23, v23, v30
    v_mfma_f32_16x16x32_bf16 v[180:183], a[136:139], a[200:203], v[180:183]
    v_add_f32 v22, v22, v30
    v_fmac_f32 v4, v23, v23
    v_mfma_f32_16x16x32_bf16 v[180:183], a[140:143], a[204:207], v[180:183]
    buffer_load_dwordx4 v12, s[12:15], s57 offen offset:1024 lds
    v_mfma_f32_16x16x32_bf16 v[176:179], a[132:135], a[204:207], v[176:179]
    v_fmac_f32 v4, v22, v22
    v_accvgpr_read_b32 v22, a98
    v_mfma_f32_16x16x32_bf16 v[176:179], a[128:131], a[200:203], v[176:179]
    s_waitcnt lgkmcnt(4)
    v_lshlrev_b32 v23, 16, v22
    v_and_b32 v22, 0xffff0000, v22
    v_mfma_f32_16x16x32_bf16 v[192:195], a[128:131], a[208:211], v[192:195]
    ds_read_b64_tr_b16 a[192:193], v24 offset:24576
    ds_read_b64_tr_b16 a[194:195], v24 offset:26624
    v_mfma_f32_16x16x32_bf16 v[192:195], a[132:135], a[212:215], v[192:195]
    ds_read_b64_tr_b16 a[196:197], v24 offset:28672
    ds_read_b64_tr_b16 a[198:199], v24 offset:30720
    v_mfma_f32_16x16x32_bf16 v[196:199], a[140:143], a[212:215], v[196:199]
    buffer_load_dwordx4 v7, s[12:15], s58 offen offset:2048 lds
    v_mfma_f32_16x16x32_bf16 v[196:199], a[136:139], a[208:211], v[196:199]
    v_add_f32 v23, v23, v30
    v_add_f32 v22, v22, v30
    v_mfma_f32_16x16x32_bf16 v[200:203], a[144:147], a[208:211], v[200:203]
    v_fmac_f32 v4, v23, v23
    v_fmac_f32 v4, v22, v22
    v_mfma_f32_16x16x32_bf16 v[200:203], a[148:151], a[212:215], v[200:203]
    v_accvgpr_read_b32 v22, a99
    v_lshlrev_b32 v23, 16, v22
    v_mfma_f32_16x16x32_bf16 v[204:207], a[156:159], a[212:215], v[204:207]
    v_and_b32 v22, 0xffff0000, v22
    v_add_f32 v23, v23, v30
    v_mfma_f32_16x16x32_bf16 v[204:207], a[152:155], a[208:211], v[204:207]
    s_waitcnt lgkmcnt(4)
    v_add_f32 v22, v22, v30
    v_fmac_f32 v4, v23, v23
    v_mfma_f32_16x16x32_bf16 v[220:223], a[152:155], a[216:219], v[220:223]
    s_movk_i32 s41, 16384
    ds_read_b64_tr_b16 a[200:201], v25 offset:24576
    ds_read_b64_tr_b16 a[202:203], v25 offset:26624
    v_mfma_f32_16x16x32_bf16 v[220:223], a[156:159], a[220:223], v[220:223]
    s_load_dword s16, s[4:5], 16384
    ds_read_b64_tr_b16 a[204:205], v25 offset:28672
    ds_read_b64_tr_b16 a[206:207], v25 offset:30720
    v_mfma_f32_16x16x32_bf16 v[216:219], a[148:151], a[220:223], v[216:219]
    buffer_load_dwordx4 v12, s[12:15], s59 offen offset:3072 lds
    v_mfma_f32_16x16x32_bf16 v[216:219], a[144:147], a[216:219], v[216:219]
    s_load_dword s17, s[4:5], 16512
    v_add_u32 v7, 128, v7
    v_add_u32 v12, 128, v12
    v_mfma_f32_16x16x32_bf16 v[212:215], a[136:139], a[216:219], v[212:215]
    s_load_dword s18, s[4:5], 16640
    s_load_dword s19, s[4:5], 16768
    v_fmac_f32 v4, v22, v22
    v_mfma_f32_16x16x32_bf16 v[212:215], a[140:143], a[220:223], v[212:215]
    v_accvgpr_read_b32 v22, a100
    v_lshlrev_b32 v23, 16, v22
    v_mfma_f32_16x16x32_bf16 v[208:211], a[132:135], a[220:223], v[208:211]
    v_and_b32 v22, 0xffff0000, v22
    v_add_f32 v23, v23, v30
    v_mfma_f32_16x16x32_bf16 v[208:211], a[128:131], a[216:219], v[208:211]
    s_waitcnt lgkmcnt(4)
    v_add_f32 v22, v22, v30
    v_fmac_f32 v4, v23, v23
    v_mfma_f32_16x16x32_bf16 v[224:227], a[128:131], a[192:195], v[224:227]
    ds_read_b64_tr_b16 a[208:209], v26 offset:24576
    ds_read_b64_tr_b16 a[210:211], v26 offset:26624
    v_mfma_f32_16x16x32_bf16 v[224:227], a[132:135], a[196:199], v[224:227]
    ds_read_b64_tr_b16 a[212:213], v26 offset:28672
    ds_read_b64_tr_b16 a[214:215], v26 offset:30720
    v_mfma_f32_16x16x32_bf16 v[228:231], a[140:143], a[196:199], v[228:231]
    v_fmac_f32 v4, v22, v22
    v_accvgpr_read_b32 v22, a101
    v_mfma_f32_16x16x32_bf16 v[228:231], a[136:139], a[192:195], v[228:231]
    v_lshlrev_b32 v23, 16, v22
    v_and_b32 v22, 0xffff0000, v22
    v_mfma_f32_16x16x32_bf16 v[232:235], a[144:147], a[192:195], v[232:235]
    v_add_f32 v23, v23, v30
    v_add_f32 v22, v22, v30
    v_mfma_f32_16x16x32_bf16 v[232:235], a[148:151], a[196:199], v[232:235]
    v_fmac_f32 v4, v23, v23
    v_fmac_f32 v4, v22, v22
    v_mfma_f32_16x16x32_bf16 v[236:239], a[156:159], a[196:199], v[236:239]
    v_accvgpr_read_b32 v22, a102
    v_lshlrev_b32 v23, 16, v22
    v_mfma_f32_16x16x32_bf16 v[236:239], a[152:155], a[192:195], v[236:239]
    s_waitcnt lgkmcnt(4)
    v_and_b32 v22, 0xffff0000, v22
    v_add_f32 v23, v23, v30
    v_mfma_f32_16x16x32_bf16 v[252:255], a[152:155], a[200:203], v[252:255]
    ds_read_b64_tr_b16 a[216:217], v27 offset:24576
    ds_read_b64_tr_b16 a[218:219], v27 offset:26624
    v_mfma_f32_16x16x32_bf16 v[252:255], a[156:159], a[204:207], v[252:255]
    ds_read_b64_tr_b16 a[220:221], v27 offset:28672
    ds_read_b64_tr_b16 a[222:223], v27 offset:30720
    v_mfma_f32_16x16x32_bf16 v[248:251], a[148:151], a[204:207], v[248:251]
    v_add_f32 v22, v22, v30
    v_fmac_f32 v4, v23, v23
    v_mfma_f32_16x16x32_bf16 v[248:251], a[144:147], a[200:203], v[248:251]
    v_fmac_f32 v4, v22, v22
    v_accvgpr_read_b32 v22, a103
    v_mfma_f32_16x16x32_bf16 v[244:247], a[136:139], a[200:203], v[244:247]
    v_lshlrev_b32 v23, 16, v22
    v_and_b32 v22, 0xffff0000, v22
    v_mfma_f32_16x16x32_bf16 v[244:247], a[140:143], a[204:207], v[244:247]
    v_add_f32 v23, v23, v30
    v_add_f32 v22, v22, v30
    v_mfma_f32_16x16x32_bf16 v[240:243], a[132:135], a[204:207], v[240:243]
    v_fmac_f32 v4, v23, v23
    v_fmac_f32 v4, v22, v22
    v_mfma_f32_16x16x32_bf16 v[240:243], a[128:131], a[200:203], v[240:243]
    s_waitcnt lgkmcnt(4)
    v_mfma_f32_16x16x32_bf16 a[0:3], a[128:131], a[208:211], a[0:3]
    s_waitcnt vmcnt(17) lgkmcnt(0)
    v_mfma_f32_16x16x32_bf16 a[0:3], a[132:135], a[212:215], a[0:3]
    s_min_u32 s16, s16, s17
    s_min_u32 s16, s16, s18
    s_min_u32 s16, s16, s19
    s_cmp_lt_u32 s16, 20
    s_cbranch_scc1 KA_spin_mod
KA_ret_mod:
    v_mfma_f32_16x16x32_bf16 a[4:7], a[140:143], a[212:215], a[4:7]
    s_barrier
    v_mfma_f32_16x16x32_bf16 a[4:7], a[136:139], a[208:211], a[4:7]
    ds_read_b64_tr_b16 a[192:193], v8 offset:0
    ds_read_b64_tr_b16 a[194:195], v8 offset:2048
    v_mfma_f32_16x16x32_bf16 a[8:11], a[144:147], a[208:211], a[8:11]
    ds_read_b64_tr_b16 a[196:197], v8 offset:4096
    ds_read_b64_tr_b16 a[198:199], v8 offset:6144
    v_mfma_f32_16x16x32_bf16 a[8:11], a[148:151], a[212:215], a[8:11]
    ds_read_b128 a[160:163], v5 offset:0
    ds_read_b128 a[164:167], v6 offset:0
    v_mfma_f32_16x16x32_bf16 a[12:15], a[156:159], a[212:215], a[12:15]
    ds_read_b128 a[168:171], v5 offset:2048
    ds_read_b128 a[172:175], v6 offset:2048
    v_mfma_f32_16x16x32_bf16 a[12:15], a[152:155], a[208:211], a[12:15]
    ds_read_b128 a[176:179], v5 offset:4096
    ds_read_b128 a[180:183], v6 offset:4096
    v_mfma_f32_16x16x32_bf16 a[28:31], a[152:155], a[216:219], a[28:31]
    ds_read_b128 a[184:187], v5 offset:6144
    ds_read_b128 a[188:191], v6 offset:6144
    v_mfma_f32_16x16x32_bf16 a[28:31], a[156:159], a[220:223], a[28:31]
    s_waitcnt lgkmcnt(8)
    ds_read_b64_tr_b16 a[200:201], v9 offset:0
    ds_read_b64_tr_b16 a[202:203], v9 offset:2048
    v_mfma_f32_16x16x32_bf16 a[24:27], a[148:151], a[220:223], a[24:27]
    ds_read_b64_tr_b16 a[204:205], v9 offset:4096
    ds_read_b64_tr_b16 a[206:207], v9 offset:6144
    v_mfma_f32_16x16x32_bf16 a[24:27], a[144:147], a[216:219], a[24:27]
    v_mfma_f32_16x16x32_bf16 a[20:23], a[136:139], a[216:219], a[20:23]
    v_mfma_f32_16x16x32_bf16 a[20:23], a[140:143], a[220:223], a[20:23]
    v_mfma_f32_16x16x32_bf16 a[16:19], a[132:135], a[220:223], a[16:19]
    v_mfma_f32_16x16x32_bf16 a[16:19], a[128:131], a[216:219], a[16:19]
    s_waitcnt lgkmcnt(4)
    v_mfma_f32_16x16x32_bf16 v[32:35], a[192:195], a[160:163], v[32:35]
    ds_read_b64_tr_b16 a[208:209], v10 offset:0
    ds_read_b64_tr_b16 a[210:211], v10 offset:2048
    v_mfma_f32_16x16x32_bf16 v[32:35], a[196:199], a[164:167], v[32:35]
    ds_read_b64_tr_b16 a[212:213], v10 offset:4096
    ds_read_b64_tr_b16 a[214:215], v10 offset:6144
    v_mfma_f32_16x16x32_bf16 v[40:43], a[196:199], a[172:175], v[40:43]
    v_and_b32 v28, 31, v1
    v_lshlrev_b32 v28, 4, v28
    v_mfma_f32_16x16x32_bf16 v[40:43], a[192:195], a[168:171], v[40:43]
    s_movk_i32 s29, 2560
    v_accvgpr_read_b32 v22, a104
    v_lshlrev_b32 v23, 16, v22
    v_mfma_f32_16x16x32_bf16 v[48:51], a[192:195], a[176:179], v[48:51]
    buffer_load_dwordx4 a[48:51], v28, s[72:75], 0 offen offset:2048 sc1
    v_mfma_f32_16x16x32_bf16 v[48:51], a[196:199], a[180:183], v[48:51]
    buffer_load_dwordx4 a[68:71], v28, s[72:75], s29 offen offset:2048 sc1
    v_mfma_f32_16x16x32_bf16 v[56:59], a[196:199], a[188:191], v[56:59]
    v_lshlrev_b32 v28, 1, v28
    v_and_b32 v22, 0xffff0000, v22
    v_mfma_f32_16x16x32_bf16 v[56:59], a[192:195], a[184:187], v[56:59]
    s_waitcnt lgkmcnt(4)
    v_add_f32 v23, v23, v30
    v_add_f32 v22, v22, v30
    v_mfma_f32_16x16x32_bf16 v[60:63], a[200:203], a[184:187], v[60:63]
    ds_read_b64_tr_b16 a[216:217], v11 offset:0
    ds_read_b64_tr_b16 a[218:219], v11 offset:2048
    v_mfma_f32_16x16x32_bf16 v[60:63], a[204:207], a[188:191], v[60:63]
    ds_read_b64_tr_b16 a[220:221], v11 offset:4096
    ds_read_b64_tr_b16 a[222:223], v11 offset:6144
    v_mfma_f32_16x16x32_bf16 v[52:55], a[204:207], a[180:183], v[52:55]
    buffer_load_dwordx4 a[32:35], v28, s[72:75], 0 offen offset:0 sc1
    v_mfma_f32_16x16x32_bf16 v[52:55], a[200:203], a[176:179], v[52:55]
    buffer_load_dwordx4 a[36:39], v28, s[72:75], 0 offen offset:16 sc1
    v_mfma_f32_16x16x32_bf16 v[44:47], a[200:203], a[168:171], v[44:47]
    buffer_load_dwordx4 a[40:43], v28, s[72:75], 0 offen offset:1024 sc1
    v_mfma_f32_16x16x32_bf16 v[44:47], a[204:207], a[172:175], v[44:47]
    buffer_load_dwordx4 a[44:47], v28, s[72:75], 0 offen offset:1040 sc1
    v_mfma_f32_16x16x32_bf16 v[36:39], a[204:207], a[164:167], v[36:39]
    buffer_load_dwordx4 a[52:55], v28, s[72:75], s29 offen offset:0 sc1
    v_mfma_f32_16x16x32_bf16 v[36:39], a[200:203], a[160:163], v[36:39]
    s_waitcnt lgkmcnt(4)
    v_fmac_f32 v4, v23, v23
    v_fmac_f32 v4, v22, v22
    v_mfma_f32_16x16x32_bf16 v[64:67], a[208:211], a[160:163], v[64:67]
    ds_read_b64_tr_b16 a[192:193], v8 offset:8192
    ds_read_b64_tr_b16 a[194:195], v8 offset:10240
    v_mfma_f32_16x16x32_bf16 v[64:67], a[212:215], a[164:167], v[64:67]
    ds_read_b64_tr_b16 a[196:197], v8 offset:12288
    ds_read_b64_tr_b16 a[198:199], v8 offset:14336
    v_mfma_f32_16x16x32_bf16 v[72:75], a[212:215], a[172:175], v[72:75]
    buffer_load_dwordx4 a[56:59], v28, s[72:75], s29 offen offset:16 sc1
    v_mfma_f32_16x16x32_bf16 v[72:75], a[208:211], a[168:171], v[72:75]
    buffer_load_dwordx4 a[60:63], v28, s[72:75], s29 offen offset:1024 sc1
    v_mfma_f32_16x16x32_bf16 v[80:83], a[208:211], a[176:179], v[80:83]
    buffer_load_dwordx4 a[64:67], v28, s[72:75], s29 offen offset:1040 sc1
    v_mfma_f32_16x16x32_bf16 v[80:83], a[212:215], a[180:183], v[80:83]
    s_add_u32 m0, s40, 65536
    v_accvgpr_read_b32 v22, a105
    v_lshlrev_b32 v23, 16, v22
    v_mfma_f32_16x16x32_bf16 v[88:91], a[212:215], a[188:191], v[88:91]
    buffer_load_dwordx4 v3, s[8:11], s44 offen offset:0 lds
    v_mfma_f32_16x16x32_bf16 v[88:91], a[208:211], a[184:187], v[88:91]
    s_waitcnt lgkmcnt(4)
    v_and_b32 v22, 0xffff0000, v22
    v_add_f32 v23, v23, v30
    v_mfma_f32_16x16x32_bf16 v[92:95], a[216:219], a[184:187], v[92:95]
    ds_read_b64_tr_b16 a[200:201], v9 offset:8192
    ds_read_b64_tr_b16 a[202:203], v9 offset:10240
    v_mfma_f32_16x16x32_bf16 v[92:95], a[220:223], a[188:191], v[92:95]
    ds_read_b64_tr_b16 a[204:205], v9 offset:12288
    ds_read_b64_tr_b16 a[206:207], v9 offset:14336
    v_mfma_f32_16x16x32_bf16 v[84:87], a[220:223], a[180:183], v[84:87]
    buffer_load_dwordx4 v3, s[8:11], s45 offen offset:1024 lds
    v_mfma_f32_16x16x32_bf16 v[84:87], a[216:219], a[176:179], v[84:87]
    v_add_f32 v22, v22, v30
    v_fmac_f32 v4, v23, v23
    v_mfma_f32_16x16x32_bf16 v[76:79], a[216:219], a[168:171], v[76:79]
    v_fmac_f32 v4, v22, v22
    v_mfma_f32_16x16x32_bf16 v[76:79], a[220:223], a[172:175], v[76:79]
    v_mfma_f32_16x16x32_bf16 v[68:71], a[220:223], a[164:167], v[68:71]
    v_add_f32 v4, v4, v4 row_ror:8
    v_mfma_f32_16x16x32_bf16 v[68:71], a[216:219], a[160:163], v[68:71]
    s_waitcnt lgkmcnt(4)
    v_mfma_f32_16x16x32_bf16 v[96:99], a[192:195], a[160:163], v[96:99]
    ds_read_b64_tr_b16 a[208:209], v10 offset:8192
    ds_read_b64_tr_b16 a[210:211], v10 offset:10240
    v_mfma_f32_16x16x32_bf16 v[96:99], a[196:199], a[164:167], v[96:99]
    ds_read_b64_tr_b16 a[212:213], v10 offset:12288
    ds_read_b64_tr_b16 a[214:215], v10 offset:14336
    v_mfma_f32_16x16x32_bf16 v[104:107], a[196:199], a[172:175], v[104:107]
    buffer_load_dwordx4 v3, s[8:11], s46 offen offset:2048 lds
    v_mfma_f32_16x16x32_bf16 v[104:107], a[192:195], a[168:171], v[104:107]
    v_add_f32 v4, v4, v4 row_ror:4
    v_mfma_f32_16x16x32_bf16 v[112:115], a[192:195], a[176:179], v[112:115]
    v_mfma_f32_16x16x32_bf16 v[112:115], a[196:199], a[180:183], v[112:115]
    buffer_load_dwordx4 v3, s[8:11], s47 offen offset:3072 lds
    v_mfma_f32_16x16x32_bf16 v[120:123], a[196:199], a[188:191], v[120:123]
    s_add_u32 m0, s40, 69632
    v_add_f32 v4, v4, v4 row_ror:2
    v_mfma_f32_16x16x32_bf16 v[120:123], a[192:195], a[184:187], v[120:123]
    s_waitcnt lgkmcnt(4)
    v_mfma_f32_16x16x32_bf16 v[124:127], a[200:203], a[184:187], v[124:127]
    ds_read_b64_tr_b16 a[216:217], v11 offset:8192
    ds_read_b64_tr_b16 a[218:219], v11 offset:10240
    v_mfma_f32_16x16x32_bf16 v[124:127], a[204:207], a[188:191], v[124:127]
    ds_read_b64_tr_b16 a[220:221], v11 offset:12288
    ds_read_b64_tr_b16 a[222:223], v11 offset:14336
    v_mfma_f32_16x16x32_bf16 v[116:119], a[204:207], a[180:183], v[116:119]
    buffer_load_dwordx4 v3, s[8:11], s48 offen offset:0 lds
    v_mfma_f32_16x16x32_bf16 v[116:119], a[200:203], a[176:179], v[116:119]
    v_add_f32 v4, v4, v4 row_ror:1
    v_mov_b32 v13, v4
    v_mfma_f32_16x16x32_bf16 v[108:111], a[200:203], a[168:171], v[108:111]
    v_mfma_f32_16x16x32_bf16 v[108:111], a[204:207], a[172:175], v[108:111]
    v_permlane16_swap_b32 v4, v13
    v_add_f32 v4, v4, v13
    v_mfma_f32_16x16x32_bf16 v[100:103], a[204:207], a[164:167], v[100:103]
    v_mov_b32 v13, 0x3727c5ac
    v_fmac_f32 v13, 0x3acccccd, v4
    v_mfma_f32_16x16x32_bf16 v[100:103], a[200:203], a[160:163], v[100:103]
    s_waitcnt lgkmcnt(4)
    v_rsq_f32 v4, v13
    v_mfma_f32_16x16x32_bf16 v[128:131], a[208:211], a[160:163], v[128:131]
    ds_read_b64_tr_b16 a[192:193], v8 offset:16384
    ds_read_b64_tr_b16 a[194:195], v8 offset:18432
    v_mfma_f32_16x16x32_bf16 v[128:131], a[212:215], a[164:167], v[128:131]
    ds_read_b64_tr_b16 a[196:197], v8 offset:20480
    ds_read_b64_tr_b16 a[198:199], v8 offset:22528
    v_mfma_f32_16x16x32_bf16 v[136:139], a[212:215], a[172:175], v[136:139]
    buffer_load_dwordx4 v3, s[8:11], s49 offen offset:1024 lds
    v_mfma_f32_16x16x32_bf16 v[136:139], a[208:211], a[168:171], v[136:139]
    v_mul_f32 v4, 0x3e0293ee, v4
    v_mul_f32 v30, v30, v4
    v_mfma_f32_16x16x32_bf16 v[144:147], a[208:211], a[176:179], v[144:147]
    s_waitcnt vmcnt(6)
    v_accvgpr_read_b32 v22, a96
    v_lshlrev_b32 v23, 16, v22
    v_mfma_f32_16x16x32_bf16 v[144:147], a[212:215], a[180:183], v[144:147]
    buffer_load_dwordx4 v3, s[8:11], s50 offen offset:2048 lds
    v_mfma_f32_16x16x32_bf16 v[152:155], a[212:215], a[188:191], v[152:155]
    v_and_b32 v22, 0xffff0000, v22
    v_fma_f32 v23, v23, v4, v30
    v_mfma_f32_16x16x32_bf16 v[152:155], a[208:211], a[184:187], v[152:155]
    s_waitcnt lgkmcnt(4)
    v_fma_f32 v22, v22, v4, v30
    v_accvgpr_read_b32 v14, a52
    v_mfma_f32_16x16x32_bf16 v[156:159], a[216:219], a[184:187], v[156:159]
    ds_read_b64_tr_b16 a[200:201], v9 offset:16384
    ds_read_b64_tr_b16 a[202:203], v9 offset:18432
    v_mfma_f32_16x16x32_bf16 v[156:159], a[220:223], a[188:191], v[156:159]
    ds_read_b64_tr_b16 a[204:205], v9 offset:20480
    ds_read_b64_tr_b16 a[206:207], v9 offset:22528
    v_mfma_f32_16x16x32_bf16 v[148:151], a[220:223], a[180:183], v[148:151]
    buffer_load_dwordx4 v3, s[8:11], s51 offen offset:3072 lds
    v_mfma_f32_16x16x32_bf16 v[148:151], a[216:219], a[176:179], v[148:151]
    v_add_u32 v3, 524288, v3
    v_accvgpr_read_b32 v16, a32
    v_mfma_f32_16x16x32_bf16 v[140:143], a[216:219], a[168:171], v[140:143]
    s_add_u32 m0, s40, 98304
    v_accvgpr_read_b32 v15, a53
    v_accvgpr_read_b32 v17, a33
    v_mfma_f32_16x16x32_bf16 v[140:143], a[220:223], a[172:175], v[140:143]
    v_fma_f32 v23, v23, v14, v16
    v_fma_f32 v22, v22, v15, v17
    v_mfma_f32_16x16x32_bf16 v[132:135], a[220:223], a[164:167], v[132:135]
    v_cvt_pk_bf16_f32 v18, v23, v22
    v_accvgpr_read_b32 v22, a97
    v_mfma_f32_16x16x32_bf16 v[132:135], a[216:219], a[160:163], v[132:135]
    s_waitcnt lgkmcnt(4)
    v_lshlrev_b32 v23, 16, v22
    v_and_b32 v22, 0xffff0000, v22
    v_mfma_f32_16x16x32_bf16 v[160:163], a[160:163], a[192:195], v[160:163]
    ds_read_b64_tr_b16 a[208:209], v10 offset:16384
    ds_read_b64_tr_b16 a[210:211], v10 offset:18432
    v_mfma_f32_16x16x32_bf16 v[160:163], a[164:167], a[196:199], v[160:163]
    ds_read_b64_tr_b16 a[212:213], v10 offset:20480
    ds_read_b64_tr_b16 a[214:215], v10 offset:22528
    v_mfma_f32_16x16x32_bf16 v[164:167], a[172:175], a[196:199], v[164:167]
    buffer_load_dwordx4 v7, s[12:15], s52 offen offset:0 lds
    v_mfma_f32_16x16x32_bf16 v[164:167], a[168:171], a[192:195], v[164:167]
    v_fma_f32 v23, v23, v4, v30
    v_fma_f32 v22, v22, v4, v30
    v_mfma_f32_16x16x32_bf16 v[168:171], a[176:179], a[192:195], v[168:171]
    v_accvgpr_read_b32 v14, a54
    v_accvgpr_read_b32 v16, a34
    v_mfma_f32_16x16x32_bf16 v[168:171], a[180:183], a[196:199], v[168:171]
    buffer_load_dwordx4 v12, s[12:15], s53 offen offset:1024 lds
    v_mfma_f32_16x16x32_bf16 v[172:175], a[188:191], a[196:199], v[172:175]
    v_accvgpr_read_b32 v15, a55
    v_accvgpr_read_b32 v17, a35
    v_mfma_f32_16x16x32_bf16 v[172:175], a[184:187], a[192:195], v[172:175]
    s_waitcnt lgkmcnt(4)
    v_fma_f32 v23, v23, v14, v16
    v_fma_f32 v22, v22, v15, v17
    v_mfma_f32_16x16x32_bf16 v[188:191], a[184:187], a[200:203], v[188:191]
    ds_read_b64_tr_b16 a[216:217], v11 offset:16384
    ds_read_b64_tr_b16 a[218:219], v11 offset:18432
    v_mfma_f32_16x16x32_bf16 v[188:191], a[188:191], a[204:207], v[188:191]
    ds_read_b64_tr_b16 a[220:221], v11 offset:20480
    ds_read_b64_tr_b16 a[222:223], v11 offset:22528
    v_mfma_f32_16x16x32_bf16 v[184:187], a[180:183], a[204:207], v[184:187]
    buffer_load_dwordx4 v7, s[12:15], s54 offen offset:2048 lds
    v_mfma_f32_16x16x32_bf16 v[184:187], a[176:179], a[200:203], v[184:187]
    v_cvt_pk_bf16_f32 v19, v23, v22
    v_accvgpr_read_b32 v22, a98
    v_mfma_f32_16x16x32_bf16 v[180:183], a[168:171], a[200:203], v[180:183]
    v_lshlrev_b32 v23, 16, v22
    v_and_b32 v22, 0xffff0000, v22
    v_mfma_f32_16x16x32_bf16 v[180:183], a[172:175], a[204:207], v[180:183]
    v_fma_f32 v23, v23, v4, v30
    v_fma_f32 v22, v22, v4, v30
    v_mfma_f32_16x16x32_bf16 v[176:179], a[164:167], a[204:207], v[176:179]
    v_accvgpr_read_b32 v14, a56
    v_accvgpr_read_b32 v16, a36
    v_mfma_f32_16x16x32_bf16 v[176:179], a[160:163], a[200:203], v[176:179]
    s_waitcnt lgkmcnt(4)
    v_accvgpr_read_b32 v15, a57
    v_accvgpr_read_b32 v17, a37
    v_mfma_f32_16x16x32_bf16 v[192:195], a[160:163], a[208:211], v[192:195]
    ds_read_b64_tr_b16 a[192:193], v8 offset:24576
    ds_read_b64_tr_b16 a[194:195], v8 offset:26624
    v_mfma_f32_16x16x32_bf16 v[192:195], a[164:167], a[212:215], v[192:195]
    ds_read_b64_tr_b16 a[196:197], v8 offset:28672
    ds_read_b64_tr_b16 a[198:199], v8 offset:30720
    v_mfma_f32_16x16x32_bf16 v[196:199], a[172:175], a[212:215], v[196:199]
    buffer_load_dwordx4 v12, s[12:15], s55 offen offset:3072 lds
    v_mfma_f32_16x16x32_bf16 v[196:199], a[168:171], a[208:211], v[196:199]
    s_add_u32 m0, s40, 102400
    v_fma_f32 v23, v23, v14, v16
    v_fma_f32 v22, v22, v15, v17
    v_mfma_f32_16x16x32_bf16 v[200:203], a[176:179], a[208:211], v[200:203]
    v_cvt_pk_bf16_f32 v20, v23, v22
    v_accvgpr_read_b32 v22, a99
    v_mfma_f32_16x16x32_bf16 v[200:203], a[180:183], a[212:215], v[200:203]
    buffer_load_dwordx4 v7, s[12:15], s56 offen offset:0 lds
    v_mfma_f32_16x16x32_bf16 v[204:207], a[188:191], a[212:215], v[204:207]
    v_lshlrev_b32 v23, 16, v22
    v_and_b32 v22, 0xffff0000, v22
    v_mfma_f32_16x16x32_bf16 v[204:207], a[184:187], a[208:211], v[204:207]
    s_waitcnt lgkmcnt(4)
    v_fma_f32 v23, v23, v4, v30
    v_fma_f32 v22, v22, v4, v30
    v_mfma_f32_16x16x32_bf16 v[220:223], a[184:187], a[216:219], v[220:223]
    ds_read_b64_tr_b16 a[200:201], v9 offset:24576
    ds_read_b64_tr_b16 a[202:203], v9 offset:26624
    v_mfma_f32_16x16x32_bf16 v[220:223], a[188:191], a[220:223], v[220:223]
    ds_read_b64_tr_b16 a[204:205], v9 offset:28672
    ds_read_b64_tr_b16 a[206:207], v9 offset:30720
    v_mfma_f32_16x16x32_bf16 v[216:219], a[180:183], a[220:223], v[216:219]
    buffer_load_dwordx4 v12, s[12:15], s57 offen offset:1024 lds
    v_mfma_f32_16x16x32_bf16 v[216:219], a[176:179], a[216:219], v[216:219]
    v_accvgpr_read_b32 v14, a58
    v_accvgpr_read_b32 v16, a38
    v_mfma_f32_16x16x32_bf16 v[212:215], a[168:171], a[216:219], v[212:215]
    v_accvgpr_read_b32 v15, a59
    v_accvgpr_read_b32 v17, a39
    v_mfma_f32_16x16x32_bf16 v[212:215], a[172:175], a[220:223], v[212:215]
    v_fma_f32 v23, v23, v14, v16
    v_fma_f32 v22, v22, v15, v17
    v_mfma_f32_16x16x32_bf16 v[208:211], a[164:167], a[220:223], v[208:211]
    v_cvt_pk_bf16_f32 v21, v23, v22
    v_mfma_f32_16x16x32_bf16 v[208:211], a[160:163], a[216:219], v[208:211]
    s_waitcnt lgkmcnt(4)
    v_mfma_f32_16x16x32_bf16 v[224:227], a[160:163], a[192:195], v[224:227]
    ds_read_b64_tr_b16 a[208:209], v10 offset:24576
    ds_read_b64_tr_b16 a[210:211], v10 offset:26624
    v_mfma_f32_16x16x32_bf16 v[224:227], a[164:167], a[196:199], v[224:227]
    ds_read_b64_tr_b16 a[212:213], v10 offset:28672
    ds_read_b64_tr_b16 a[214:215], v10 offset:30720
    v_mfma_f32_16x16x32_bf16 v[228:231], a[172:175], a[196:199], v[228:231]
    buffer_load_dwordx4 v7, s[12:15], s58 offen offset:2048 lds
    v_mfma_f32_16x16x32_bf16 v[228:231], a[168:171], a[192:195], v[228:231]
    buffer_store_dwordx4 v[18:21], v0, s[72:75], 0 offen sc1
    v_mfma_f32_16x16x32_bf16 v[232:235], a[176:179], a[192:195], v[232:235]
    v_accvgpr_read_b32 v22, a100
    v_lshlrev_b32 v23, 16, v22
    v_mfma_f32_16x16x32_bf16 v[232:235], a[180:183], a[196:199], v[232:235]
    buffer_load_dwordx4 v12, s[12:15], s59 offen offset:3072 lds
    v_mfma_f32_16x16x32_bf16 v[236:239], a[188:191], a[196:199], v[236:239]
    v_add_u32 v7, 128, v7
    v_add_u32 v12, 128, v12
    v_mfma_f32_16x16x32_bf16 v[236:239], a[184:187], a[192:195], v[236:239]
    s_waitcnt lgkmcnt(4)
    v_and_b32 v22, 0xffff0000, v22
    v_fma_f32 v23, v23, v4, v30
    v_mfma_f32_16x16x32_bf16 v[252:255], a[184:187], a[200:203], v[252:255]
    ds_read_b64_tr_b16 a[216:217], v11 offset:24576
    ds_read_b64_tr_b16 a[218:219], v11 offset:26624
    v_mfma_f32_16x16x32_bf16 v[252:255], a[188:191], a[204:207], v[252:255]
    ds_read_b64_tr_b16 a[220:221], v11 offset:28672
    ds_read_b64_tr_b16 a[222:223], v11 offset:30720
    v_mfma_f32_16x16x32_bf16 v[248:251], a[180:183], a[204:207], v[248:251]
    v_fma_f32 v22, v22, v4, v30
    v_accvgpr_read_b32 v14, a60
    v_mfma_f32_16x16x32_bf16 v[248:251], a[176:179], a[200:203], v[248:251]
    v_accvgpr_read_b32 v16, a40
    v_accvgpr_read_b32 v15, a61
    v_mfma_f32_16x16x32_bf16 v[244:247], a[168:171], a[200:203], v[244:247]
    v_accvgpr_read_b32 v17, a41
    v_fma_f32 v23, v23, v14, v16
    v_mfma_f32_16x16x32_bf16 v[244:247], a[172:175], a[204:207], v[244:247]
    v_fma_f32 v22, v22, v15, v17
    v_cvt_pk_bf16_f32 v18, v23, v22
    v_mfma_f32_16x16x32_bf16 v[240:243], a[164:167], a[204:207], v[240:243]
    v_mfma_f32_16x16x32_bf16 v[240:243], a[160:163], a[200:203], v[240:243]
    s_waitcnt lgkmcnt(4)
    v_mfma_f32_16x16x32_bf16 a[0:3], a[160:163], a[208:211], a[0:3]
    s_waitcnt vmcnt(27) lgkmcnt(0)
    v_mfma_f32_16x16x32_bf16 a[0:3], a[164:167], a[212:215], a[0:3]
    s_barrier
    v_mfma_f32_16x16x32_bf16 a[4:7], a[172:175], a[212:215], a[4:7]
    ds_read_b64_tr_b16 a[192:193], v8 offset:32768
    ds_read_b64_tr_b16 a[194:195], v8 offset:34816
    v_mfma_f32_16x16x32_bf16 a[4:7], a[168:171], a[208:211], a[4:7]
    ds_read_b64_tr_b16 a[196:197], v8 offset:36864
    ds_read_b64_tr_b16 a[198:199], v8 offset:38912
    v_mfma_f32_16x16x32_bf16 a[8:11], a[176:179], a[208:211], a[8:11]
    ds_read_b128 a[128:131], v5 offset:32768
    ds_read_b128 a[132:135], v6 offset:32768
    v_mfma_f32_16x16x32_bf16 a[8:11], a[180:183], a[212:215], a[8:11]
    ds_read_b128 a[136:139], v5 offset:34816
    ds_read_b128 a[140:143], v6 offset:34816
    v_mfma_f32_16x16x32_bf16 a[12:15], a[188:191], a[212:215], a[12:15]
    ds_read_b128 a[144:147], v5 offset:36864
    ds_read_b128 a[148:151], v6 offset:36864
    v_mfma_f32_16x16x32_bf16 a[12:15], a[184:187], a[208:211], a[12:15]
    ds_read_b128 a[152:155], v5 offset:38912
    ds_read_b128 a[156:159], v6 offset:38912
    v_mfma_f32_16x16x32_bf16 a[28:31], a[184:187], a[216:219], a[28:31]
    s_waitcnt lgkmcnt(8)
    ds_read_b64_tr_b16 a[200:201], v9 offset:32768
    ds_read_b64_tr_b16 a[202:203], v9 offset:34816
    v_mfma_f32_16x16x32_bf16 a[28:31], a[188:191], a[220:223], a[28:31]
    ds_read_b64_tr_b16 a[204:205], v9 offset:36864
    ds_read_b64_tr_b16 a[206:207], v9 offset:38912
    v_mfma_f32_16x16x32_bf16 a[24:27], a[180:183], a[220:223], a[24:27]
    v_mfma_f32_16x16x32_bf16 a[24:27], a[176:179], a[216:219], a[24:27]
    v_mfma_f32_16x16x32_bf16 a[20:23], a[168:171], a[216:219], a[20:23]
    v_mfma_f32_16x16x32_bf16 a[20:23], a[172:175], a[220:223], a[20:23]
    v_mfma_f32_16x16x32_bf16 a[16:19], a[164:167], a[220:223], a[16:19]
    v_mfma_f32_16x16x32_bf16 a[16:19], a[160:163], a[216:219], a[16:19]
    s_waitcnt lgkmcnt(4)
    v_mfma_f32_16x16x32_bf16 v[32:35], a[192:195], a[128:131], v[32:35]
    ds_read_b64_tr_b16 a[208:209], v10 offset:32768
    ds_read_b64_tr_b16 a[210:211], v10 offset:34816
    v_mfma_f32_16x16x32_bf16 v[32:35], a[196:199], a[132:135], v[32:35]
    ds_read_b64_tr_b16 a[212:213], v10 offset:36864
    ds_read_b64_tr_b16 a[214:215], v10 offset:38912
    v_mfma_f32_16x16x32_bf16 v[40:43], a[196:199], a[140:143], v[40:43]
    s_add_u32 m0, s40, 0
    v_accvgpr_read_b32 v22, a101
    v_lshlrev_b32 v23, 16, v22
    v_mfma_f32_16x16x32_bf16 v[40:43], a[192:195], a[136:139], v[40:43]
    buffer_load_dwordx4 v3, s[8:11], s44 offen offset:0 lds
    v_mfma_f32_16x16x32_bf16 v[48:51], a[192:195], a[144:147], v[48:51]
    v_and_b32 v22, 0xffff0000, v22
    v_fma_f32 v23, v23, v4, v30
    v_mfma_f32_16x16x32_bf16 v[48:51], a[196:199], a[148:151], v[48:51]
    v_fma_f32 v22, v22, v4, v30
    v_accvgpr_read_b32 v14, a62
    v_mfma_f32_16x16x32_bf16 v[56:59], a[196:199], a[156:159], v[56:59]
    v_accvgpr_read_b32 v16, a42
    v_accvgpr_read_b32 v15, a63
    v_mfma_f32_16x16x32_bf16 v[56:59], a[192:195], a[152:155], v[56:59]
    s_waitcnt lgkmcnt(4)
    v_accvgpr_read_b32 v17, a43
    v_fma_f32 v23, v23, v14, v16
    v_mfma_f32_16x16x32_bf16 v[60:63], a[200:203], a[152:155], v[60:63]
    ds_read_b64_tr_b16 a[216:217], v11 offset:32768
    ds_read_b64_tr_b16 a[218:219], v11 offset:34816
    v_mfma_f32_16x16x32_bf16 v[60:63], a[204:207], a[156:159], v[60:63]
    ds_read_b64_tr_b16 a[220:221], v11 offset:36864
    ds_read_b64_tr_b16 a[222:223], v11 offset:38912
    v_mfma_f32_16x16x32_bf16 v[52:55], a[204:207], a[148:151], v[52:55]
    buffer_load_dwordx4 v3, s[8:11], s45 offen offset:1024 lds
    v_mfma_f32_16x16x32_bf16 v[52:55], a[200:203], a[144:147], v[52:55]
    v_fma_f32 v22, v22, v15, v17
    v_cvt_pk_bf16_f32 v19, v23, v22
    v_mfma_f32_16x16x32_bf16 v[44:47], a[200:203], a[136:139], v[44:47]
    v_accvgpr_read_b32 v22, a102
    v_lshlrev_b32 v23, 16, v22
    v_mfma_f32_16x16x32_bf16 v[44:47], a[204:207], a[140:143], v[44:47]
    v_and_b32 v22, 0xffff0000, v22
    v_fma_f32 v23, v23, v4, v30
    v_mfma_f32_16x16x32_bf16 v[36:39], a[204:207], a[132:135], v[36:39]
    buffer_load_dwordx4 v3, s[8:11], s46 offen offset:2048 lds
    v_mfma_f32_16x16x32_bf16 v[36:39], a[200:203], a[128:131], v[36:39]
    s_waitcnt lgkmcnt(4)
    v_fma_f32 v22, v22, v4, v30
    v_accvgpr_read_b32 v14, a64
    v_mfma_f32_16x16x32_bf16 v[64:67], a[208:211], a[128:131], v[64:67]
    ds_read_b64_tr_b16 a[192:193], v8 offset:40960
    ds_read_b64_tr_b16 a[194:195], v8 offset:43008
    v_mfma_f32_16x16x32_bf16 v[64:67], a[212:215], a[132:135], v[64:67]
    ds_read_b64_tr_b16 a[196:197], v8 offset:45056
    ds_read_b64_tr_b16 a[198:199], v8 offset:47104
    v_mfma_f32_16x16x32_bf16 v[72:75], a[212:215], a[140:143], v[72:75]
    v_accvgpr_read_b32 v16, a44
    v_accvgpr_read_b32 v15, a65
    v_mfma_f32_16x16x32_bf16 v[72:75], a[208:211], a[136:139], v[72:75]
    v_accvgpr_read_b32 v17, a45
    v_fma_f32 v23, v23, v14, v16
    v_mfma_f32_16x16x32_bf16 v[80:83], a[208:211], a[144:147], v[80:83]
    buffer_load_dwordx4 v3, s[8:11], s47 offen offset:3072 lds
    v_mfma_f32_16x16x32_bf16 v[80:83], a[212:215], a[148:151], v[80:83]
    s_add_u32 m0, s40, 4096
    v_fma_f32 v22, v22, v15, v17
    v_cvt_pk_bf16_f32 v20, v23, v22
    v_mfma_f32_16x16x32_bf16 v[88:91], a[212:215], a[156:159], v[88:91]
    v_accvgpr_read_b32 v22, a103
    v_lshlrev_b32 v23, 16, v22
    v_mfma_f32_16x16x32_bf16 v[88:91], a[208:211], a[152:155], v[88:91]
    s_waitcnt lgkmcnt(4)
    v_and_b32 v22, 0xffff0000, v22
    v_fma_f32 v23, v23, v4, v30
    v_mfma_f32_16x16x32_bf16 v[92:95], a[216:219], a[152:155], v[92:95]
    ds_read_b64_tr_b16 a[200:201], v9 offset:40960
    ds_read_b64_tr_b16 a[202:203], v9 offset:43008
    v_mfma_f32_16x16x32_bf16 v[92:95], a[220:223], a[156:159], v[92:95]
    ds_read_b64_tr_b16 a[204:205], v9 offset:45056
    ds_read_b64_tr_b16 a[206:207], v9 offset:47104
    v_mfma_f32_16x16x32_bf16 v[84:87], a[220:223], a[148:151], v[84:87]
    buffer_load_dwordx4 v3, s[8:11], s48 offen offset:0 lds
    v_mfma_f32_16x16x32_bf16 v[84:87], a[216:219], a[144:147], v[84:87]
    v_fma_f32 v22, v22, v4, v30
    v_accvgpr_read_b32 v14, a66
    v_mfma_f32_16x16x32_bf16 v[76:79], a[216:219], a[136:139], v[76:79]
    v_accvgpr_read_b32 v16, a46
    v_accvgpr_read_b32 v15, a67
    v_mfma_f32_16x16x32_bf16 v[76:79], a[220:223], a[140:143], v[76:79]
    v_accvgpr_read_b32 v17, a47
    v_fma_f32 v23, v23, v14, v16
    v_mfma_f32_16x16x32_bf16 v[68:71], a[220:223], a[132:135], v[68:71]
    v_fma_f32 v22, v22, v15, v17
    v_cvt_pk_bf16_f32 v21, v23, v22
    v_mfma_f32_16x16x32_bf16 v[68:71], a[216:219], a[128:131], v[68:71]
    s_waitcnt lgkmcnt(4)
    s_movk_i32 s29, 8192
    v_mfma_f32_16x16x32_bf16 v[96:99], a[192:195], a[128:131], v[96:99]
    ds_read_b64_tr_b16 a[208:209], v10 offset:40960
    ds_read_b64_tr_b16 a[210:211], v10 offset:43008
    v_mfma_f32_16x16x32_bf16 v[96:99], a[196:199], a[132:135], v[96:99]
    ds_read_b64_tr_b16 a[212:213], v10 offset:45056
    ds_read_b64_tr_b16 a[214:215], v10 offset:47104
    v_mfma_f32_16x16x32_bf16 v[104:107], a[196:199], a[140:143], v[104:107]
    buffer_load_dwordx4 v3, s[8:11], s49 offen offset:1024 lds
    v_mfma_f32_16x16x32_bf16 v[104:107], a[192:195], a[136:139], v[104:107]
    buffer_store_dwordx4 v[18:21], v0, s[72:75], s29 offen sc1
    v_mfma_f32_16x16x32_bf16 v[112:115], a[192:195], a[144:147], v[112:115]
    v_accvgpr_read_b32 v22, a104
    v_lshlrev_b32 v23, 16, v22
    v_mfma_f32_16x16x32_bf16 v[112:115], a[196:199], a[148:151], v[112:115]
    v_and_b32 v22, 0xffff0000, v22
    v_fma_f32 v23, v23, v4, v30
    v_mfma_f32_16x16x32_bf16 v[120:123], a[196:199], a[156:159], v[120:123]
    buffer_load_dwordx4 v3, s[8:11], s50 offen offset:2048 lds
    v_mfma_f32_16x16x32_bf16 v[120:123], a[192:195], a[152:155], v[120:123]
    s_waitcnt lgkmcnt(4)
    v_fma_f32 v22, v22, v4, v30
    v_accvgpr_read_b32 v14, a68
    v_mfma_f32_16x16x32_bf16 v[124:127], a[200:203], a[152:155], v[124:127]
    ds_read_b64_tr_b16 a[216:217], v11 offset:40960
    ds_read_b64_tr_b16 a[218:219], v11 offset:43008
    v_mfma_f32_16x16x32_bf16 v[124:127], a[204:207], a[156:159], v[124:127]
    ds_read_b64_tr_b16 a[220:221], v11 offset:45056
    ds_read_b64_tr_b16 a[222:223], v11 offset:47104
    v_mfma_f32_16x16x32_bf16 v[116:119], a[204:207], a[148:151], v[116:119]
    v_accvgpr_read_b32 v16, a48
    v_accvgpr_read_b32 v15, a69
    v_mfma_f32_16x16x32_bf16 v[116:119], a[200:203], a[144:147], v[116:119]
    v_accvgpr_read_b32 v17, a49
    v_fma_f32 v23, v23, v14, v16
    v_mfma_f32_16x16x32_bf16 v[108:111], a[200:203], a[136:139], v[108:111]
    buffer_load_dwordx4 v3, s[8:11], s51 offen offset:3072 lds
    v_mfma_f32_16x16x32_bf16 v[108:111], a[204:207], a[140:143], v[108:111]
    v_add_u32 v3, 524288, v3
    v_fma_f32 v22, v22, v15, v17
    v_mfma_f32_16x16x32_bf16 v[100:103], a[204:207], a[132:135], v[100:103]
    v_cvt_pk_bf16_f32 v18, v23, v22
    v_accvgpr_read_b32 v22, a105
    v_mfma_f32_16x16x32_bf16 v[100:103], a[200:203], a[128:131], v[100:103]
    s_waitcnt lgkmcnt(4)
    v_lshlrev_b32 v23, 16, v22
    v_and_b32 v22, 0xffff0000, v22
    v_mfma_f32_16x16x32_bf16 v[128:131], a[208:211], a[128:131], v[128:131]
    ds_read_b64_tr_b16 a[192:193], v8 offset:49152
    ds_read_b64_tr_b16 a[194:195], v8 offset:51200
    v_mfma_f32_16x16x32_bf16 v[128:131], a[212:215], a[132:135], v[128:131]
    ds_read_b64_tr_b16 a[196:197], v8 offset:53248
    ds_read_b64_tr_b16 a[198:199], v8 offset:55296
    v_mfma_f32_16x16x32_bf16 v[136:139], a[212:215], a[140:143], v[136:139]
    v_fma_f32 v23, v23, v4, v30
    v_fma_f32 v22, v22, v4, v30
    v_mfma_f32_16x16x32_bf16 v[136:139], a[208:211], a[136:139], v[136:139]
    v_accvgpr_read_b32 v14, a70
    v_accvgpr_read_b32 v16, a50
    v_mfma_f32_16x16x32_bf16 v[144:147], a[208:211], a[144:147], v[144:147]
    v_accvgpr_read_b32 v15, a71
    v_accvgpr_read_b32 v17, a51
    v_mfma_f32_16x16x32_bf16 v[144:147], a[212:215], a[148:151], v[144:147]
    v_fma_f32 v23, v23, v14, v16
    v_fma_f32 v22, v22, v15, v17
    v_mfma_f32_16x16x32_bf16 v[152:155], a[212:215], a[156:159], v[152:155]
    v_cvt_pk_bf16_f32 v19, v23, v22
    v_accvgpr_read_b32 v28, a127
    v_mfma_f32_16x16x32_bf16 v[152:155], a[208:211], a[152:155], v[152:155]
    s_waitcnt lgkmcnt(4)
    v_mfma_f32_16x16x32_bf16 v[156:159], a[216:219], a[152:155], v[156:159]
    ds_read_b64_tr_b16 a[200:201], v9 offset:49152
    ds_read_b64_tr_b16 a[202:203], v9 offset:51200
    v_mfma_f32_16x16x32_bf16 v[156:159], a[220:223], a[156:159], v[156:159]
    ds_read_b64_tr_b16 a[204:205], v9 offset:53248
    ds_read_b64_tr_b16 a[206:207], v9 offset:55296
    v_mfma_f32_16x16x32_bf16 v[148:151], a[220:223], a[148:151], v[148:151]
    buffer_store_dwordx2 v[18:19], v28, s[72:75], 0 offen sc1
    v_mfma_f32_16x16x32_bf16 v[148:151], a[216:219], a[144:147], v[148:151]
    v_accvgpr_read_b32 v13, a124
    v_mfma_f32_16x16x32_bf16 v[140:143], a[216:219], a[136:139], v[140:143]
    s_lshr_b32 s41, s3, 1
    s_lshl_b32 s41, s41, 19
    s_add_u32 s41, s41, 0
    v_mfma_f32_16x16x32_bf16 v[140:143], a[220:223], a[140:143], v[140:143]
    buffer_load_dword a254, v13, s[68:71], s41 offen
    v_mfma_f32_16x16x32_bf16 v[132:135], a[220:223], a[132:135], v[132:135]
    s_add_u32 m0, s40, 131072
    v_mfma_f32_16x16x32_bf16 v[132:135], a[216:219], a[128:131], v[132:135]
    s_waitcnt lgkmcnt(4)
    v_mfma_f32_16x16x32_bf16 v[160:163], a[128:131], a[192:195], v[160:163]
    ds_read_b64_tr_b16 a[208:209], v10 offset:49152
    ds_read_b64_tr_b16 a[210:211], v10 offset:51200
    v_mfma_f32_16x16x32_bf16 v[160:163], a[132:135], a[196:199], v[160:163]
    ds_read_b64_tr_b16 a[212:213], v10 offset:53248
    ds_read_b64_tr_b16 a[214:215], v10 offset:55296
    v_mfma_f32_16x16x32_bf16 v[164:167], a[140:143], a[196:199], v[164:167]
    buffer_load_dwordx4 v7, s[12:15], s52 offen offset:0 lds
    v_mfma_f32_16x16x32_bf16 v[164:167], a[136:139], a[192:195], v[164:167]
    v_mfma_f32_16x16x32_bf16 v[168:171], a[144:147], a[192:195], v[168:171]
    v_mfma_f32_16x16x32_bf16 v[168:171], a[148:151], a[196:199], v[168:171]
    v_mfma_f32_16x16x32_bf16 v[172:175], a[156:159], a[196:199], v[172:175]
    buffer_load_dwordx4 v12, s[12:15], s53 offen offset:1024 lds
    v_mfma_f32_16x16x32_bf16 v[172:175], a[152:155], a[192:195], v[172:175]
    s_waitcnt lgkmcnt(4)
    v_mfma_f32_16x16x32_bf16 v[188:191], a[152:155], a[200:203], v[188:191]
    ds_read_b64_tr_b16 a[216:217], v11 offset:49152
    ds_read_b64_tr_b16 a[218:219], v11 offset:51200
    v_mfma_f32_16x16x32_bf16 v[188:191], a[156:159], a[204:207], v[188:191]
    ds_read_b64_tr_b16 a[220:221], v11 offset:53248
    ds_read_b64_tr_b16 a[222:223], v11 offset:55296
    v_mfma_f32_16x16x32_bf16 v[184:187], a[148:151], a[204:207], v[184:187]
    v_mfma_f32_16x16x32_bf16 v[184:187], a[144:147], a[200:203], v[184:187]
    buffer_load_dwordx4 v7, s[12:15], s54 offen offset:2048 lds
    v_mfma_f32_16x16x32_bf16 v[180:183], a[136:139], a[200:203], v[180:183]
    v_mfma_f32_16x16x32_bf16 v[180:183], a[140:143], a[204:207], v[180:183]
    v_mfma_f32_16x16x32_bf16 v[176:179], a[132:135], a[204:207], v[176:179]
    v_mfma_f32_16x16x32_bf16 v[176:179], a[128:131], a[200:203], v[176:179]
    s_waitcnt lgkmcnt(4)
    v_mfma_f32_16x16x32_bf16 v[192:195], a[128:131], a[208:211], v[192:195]
    ds_read_b64_tr_b16 a[192:193], v8 offset:57344
    ds_read_b64_tr_b16 a[194:195], v8 offset:59392
    v_mfma_f32_16x16x32_bf16 v[192:195], a[132:135], a[212:215], v[192:195]
    ds_read_b64_tr_b16 a[196:197], v8 offset:61440
    ds_read_b64_tr_b16 a[198:199], v8 offset:63488
    v_mfma_f32_16x16x32_bf16 v[196:199], a[140:143], a[212:215], v[196:199]
    buffer_load_dwordx4 v12, s[12:15], s55 offen offset:3072 lds
    v_mfma_f32_16x16x32_bf16 v[196:199], a[136:139], a[208:211], v[196:199]
    s_add_u32 m0, s40, 135168
    v_mfma_f32_16x16x32_bf16 v[200:203], a[144:147], a[208:211], v[200:203]
    v_mfma_f32_16x16x32_bf16 v[200:203], a[148:151], a[212:215], v[200:203]
    v_mfma_f32_16x16x32_bf16 v[204:207], a[156:159], a[212:215], v[204:207]
    buffer_load_dwordx4 v7, s[12:15], s56 offen offset:0 lds
    v_mfma_f32_16x16x32_bf16 v[204:207], a[152:155], a[208:211], v[204:207]
    s_waitcnt lgkmcnt(4)
    v_mfma_f32_16x16x32_bf16 v[220:223], a[152:155], a[216:219], v[220:223]
    ds_read_b64_tr_b16 a[200:201], v9 offset:57344
    ds_read_b64_tr_b16 a[202:203], v9 offset:59392
    v_mfma_f32_16x16x32_bf16 v[220:223], a[156:159], a[220:223], v[220:223]
    ds_read_b64_tr_b16 a[204:205], v9 offset:61440
    ds_read_b64_tr_b16 a[206:207], v9 offset:63488
    v_mfma_f32_16x16x32_bf16 v[216:219], a[148:151], a[220:223], v[216:219]
    v_mfma_f32_16x16x32_bf16 v[216:219], a[144:147], a[216:219], v[216:219]
    v_mfma_f32_16x16x32_bf16 v[212:215], a[136:139], a[216:219], v[212:215]
    buffer_load_dwordx4 v12, s[12:15], s57 offen offset:1024 lds
    v_mfma_f32_16x16x32_bf16 v[212:215], a[140:143], a[220:223], v[212:215]
    v_mfma_f32_16x16x32_bf16 v[208:211], a[132:135], a[220:223], v[208:211]
    v_mfma_f32_16x16x32_bf16 v[208:211], a[128:131], a[216:219], v[208:211]
    s_waitcnt lgkmcnt(4)
    v_mfma_f32_16x16x32_bf16 v[224:227], a[128:131], a[192:195], v[224:227]
    ds_read_b64_tr_b16 a[208:209], v10 offset:57344
    ds_read_b64_tr_b16 a[210:211], v10 offset:59392
    v_mfma_f32_16x16x32_bf16 v[224:227], a[132:135], a[196:199], v[224:227]
    ds_read_b64_tr_b16 a[212:213], v10 offset:61440
    ds_read_b64_tr_b16 a[214:215], v10 offset:63488
    v_mfma_f32_16x16x32_bf16 v[228:231], a[140:143], a[196:199], v[228:231]
    buffer_load_dwordx4 v7, s[12:15], s58 offen offset:2048 lds
    v_mfma_f32_16x16x32_bf16 v[228:231], a[136:139], a[192:195], v[228:231]
    v_mfma_f32_16x16x32_bf16 v[232:235], a[144:147], a[192:195], v[232:235]
    v_mfma_f32_16x16x32_bf16 v[232:235], a[148:151], a[196:199], v[232:235]
    v_mfma_f32_16x16x32_bf16 v[236:239], a[156:159], a[196:199], v[236:239]
    v_mfma_f32_16x16x32_bf16 v[236:239], a[152:155], a[192:195], v[236:239]
    s_waitcnt lgkmcnt(4)
    v_mfma_f32_16x16x32_bf16 v[252:255], a[152:155], a[200:203], v[252:255]
    ds_read_b64_tr_b16 a[216:217], v11 offset:57344
    ds_read_b64_tr_b16 a[218:219], v11 offset:59392
    v_mfma_f32_16x16x32_bf16 v[252:255], a[156:159], a[204:207], v[252:255]
    ds_read_b64_tr_b16 a[220:221], v11 offset:61440
    ds_read_b64_tr_b16 a[222:223], v11 offset:63488
    v_mfma_f32_16x16x32_bf16 v[248:251], a[148:151], a[204:207], v[248:251]
    buffer_load_dwordx4 v12, s[12:15], s59 offen offset:3072 lds
    v_mfma_f32_16x16x32_bf16 v[248:251], a[144:147], a[200:203], v[248:251]
    v_add_u32 v7, 128, v7
    v_add_u32 v12, 128, v12
    v_mfma_f32_16x16x32_bf16 v[244:247], a[136:139], a[200:203], v[244:247]
    v_mfma_f32_16x16x32_bf16 v[244:247], a[140:143], a[204:207], v[244:247]
    v_mfma_f32_16x16x32_bf16 v[240:243], a[132:135], a[204:207], v[240:243]
    v_mfma_f32_16x16x32_bf16 v[240:243], a[128:131], a[200:203], v[240:243]
    s_waitcnt lgkmcnt(4)
    v_mfma_f32_16x16x32_bf16 a[0:3], a[128:131], a[208:211], a[0:3]
    s_waitcnt vmcnt(9) lgkmcnt(0)
    v_mfma_f32_16x16x32_bf16 a[0:3], a[132:135], a[212:215], a[0:3]
    s_barrier
    v_mfma_f32_16x16x32_bf16 a[4:7], a[140:143], a[212:215], a[4:7]
    ds_read_b64_tr_b16 a[192:193], v24 offset:0
    ds_read_b64_tr_b16 a[194:195], v24 offset:2048
    v_mfma_f32_16x16x32_bf16 a[4:7], a[136:139], a[208:211], a[4:7]
    ds_read_b64_tr_b16 a[196:197], v24 offset:4096
    ds_read_b64_tr_b16 a[198:199], v24 offset:6144
    v_mfma_f32_16x16x32_bf16 a[8:11], a[144:147], a[208:211], a[8:11]
    ds_read_b128 a[160:163], v5 offset:0
    ds_read_b128 a[164:167], v6 offset:0
    v_mfma_f32_16x16x32_bf16 a[8:11], a[148:151], a[212:215], a[8:11]
    ds_read_b128 a[168:171], v5 offset:2048
    ds_read_b128 a[172:175], v6 offset:2048
    v_mfma_f32_16x16x32_bf16 a[12:15], a[156:159], a[212:215], a[12:15]
    ds_read_b128 a[176:179], v5 offset:4096
    ds_read_b128 a[180:183], v6 offset:4096
    v_mfma_f32_16x16x32_bf16 a[12:15], a[152:155], a[208:211], a[12:15]
    ds_read_b128 a[184:187], v5 offset:6144
    ds_read_b128 a[188:191], v6 offset:6144
    v_mfma_f32_16x16x32_bf16 a[28:31], a[152:155], a[216:219], a[28:31]
    s_waitcnt lgkmcnt(8)
    ds_read_b64_tr_b16 a[200:201], v25 offset:0
    ds_read_b64_tr_b16 a[202:203], v25 offset:2048
    v_mfma_f32_16x16x32_bf16 a[28:31], a[156:159], a[220:223], a[28:31]
    ds_read_b64_tr_b16 a[204:205], v25 offset:4096
    ds_read_b64_tr_b16 a[206:207], v25 offset:6144
    v_mfma_f32_16x16x32_bf16 a[24:27], a[148:151], a[220:223], a[24:27]
    v_mfma_f32_16x16x32_bf16 a[24:27], a[144:147], a[216:219], a[24:27]
    v_mfma_f32_16x16x32_bf16 a[20:23], a[136:139], a[216:219], a[20:23]
    v_mfma_f32_16x16x32_bf16 a[20:23], a[140:143], a[220:223], a[20:23]
    v_mfma_f32_16x16x32_bf16 a[16:19], a[132:135], a[220:223], a[16:19]
    v_mfma_f32_16x16x32_bf16 a[16:19], a[128:131], a[216:219], a[16:19]
    s_waitcnt lgkmcnt(4)
    v_mfma_f32_16x16x32_bf16 v[32:35], a[192:195], a[160:163], v[32:35]
    ds_read_b64_tr_b16 a[208:209], v26 offset:0
    ds_read_b64_tr_b16 a[210:211], v26 offset:2048
    v_mfma_f32_16x16x32_bf16 v[32:35], a[196:199], a[164:167], v[32:35]
    ds_read_b64_tr_b16 a[212:213], v26 offset:4096
    ds_read_b64_tr_b16 a[214:215], v26 offset:6144
    v_mfma_f32_16x16x32_bf16 v[40:43], a[196:199], a[172:175], v[40:43]
    s_bfe_u32 s20, s2, 0x20003
    v_mov_b32 v13, 1
    v_mfma_f32_16x16x32_bf16 v[40:43], a[192:195], a[168:171], v[40:43]
    buffer_atomic_add v13, v29, s[72:75], s24 offen
    v_mfma_f32_16x16x32_bf16 v[48:51], a[192:195], a[176:179], v[48:51]
    s_lshl_b32 s28, 1, s63
    v_mov_b32 v4, s28
    v_mfma_f32_16x16x32_bf16 v[48:51], a[196:199], a[180:183], v[48:51]
    buffer_atomic_add v4, v29, s[72:75], s62 offen offset:4
    v_mfma_f32_16x16x32_bf16 v[56:59], a[196:199], a[188:191], v[56:59]
    s_lshl_b32 s20, s20, 1
    v_accvgpr_read_b32 v30, a124
    v_mfma_f32_16x16x32_bf16 v[56:59], a[192:195], a[184:187], v[56:59]
    s_waitcnt lgkmcnt(4)
    s_lshr_b32 s41, s3, 1
    s_lshl_b32 s41, s41, 19
    v_mfma_f32_16x16x32_bf16 v[60:63], a[200:203], a[184:187], v[60:63]
    s_add_u32 s41, s41, 2097152
    ds_read_b64_tr_b16 a[216:217], v27 offset:0
    ds_read_b64_tr_b16 a[218:219], v27 offset:2048
    v_mfma_f32_16x16x32_bf16 v[60:63], a[204:207], a[188:191], v[60:63]
    s_and_b32 s21, s2, 1
    ds_read_b64_tr_b16 a[220:221], v27 offset:4096
    ds_read_b64_tr_b16 a[222:223], v27 offset:6144
    v_mfma_f32_16x16x32_bf16 v[52:55], a[204:207], a[180:183], v[52:55]
    buffer_load_dword a255, v30, s[68:71], s41 offen
    v_mfma_f32_16x16x32_bf16 v[52:55], a[200:203], a[176:179], v[52:55]
    s_add_u32 m0, s40, 32768
    s_add_u32 s20, s20, s21
    s_lshr_b32 s21, s3, 1
    v_mfma_f32_16x16x32_bf16 v[44:47], a[200:203], a[168:171], v[44:47]
    s_xor_b32 s21, s21, 1
    s_xor_b32 s20, s20, s21
    s_mul_i32 s20, s20, 10
    v_mfma_f32_16x16x32_bf16 v[44:47], a[204:207], a[172:175], v[44:47]
    s_and_b32 s21, s3, 1
    s_mul_i32 s21, s21, 5
    s_add_u32 s20, s20, s21
    v_mfma_f32_16x16x32_bf16 v[36:39], a[204:207], a[164:167], v[36:39]
    s_lshr_b32 s21, s20, 1
    s_lshl_b32 s21, s21, 17
    s_and_b32 s22, s20, 1
    v_mfma_f32_16x16x32_bf16 v[36:39], a[200:203], a[160:163], v[36:39]
    s_waitcnt lgkmcnt(4)
    s_lshl_b32 s22, s22, 10
    s_add_u32 s21, s21, s22
    v_mfma_f32_16x16x32_bf16 v[64:67], a[208:211], a[160:163], v[64:67]
    ds_read_b64_tr_b16 a[192:193], v24 offset:8192
    ds_read_b64_tr_b16 a[194:195], v24 offset:10240
    v_mfma_f32_16x16x32_bf16 v[64:67], a[212:215], a[164:167], v[64:67]
    ds_read_b64_tr_b16 a[196:197], v24 offset:12288
    ds_read_b64_tr_b16 a[198:199], v24 offset:14336
    v_mfma_f32_16x16x32_bf16 v[72:75], a[212:215], a[172:175], v[72:75]
    buffer_load_dwordx4 v3, s[8:11], s44 offen offset:0 lds
    v_mfma_f32_16x16x32_bf16 v[72:75], a[208:211], a[168:171], v[72:75]
    v_add_u32 v14, s21, v2
    v_accvgpr_write_b32 a227, v14
    v_mfma_f32_16x16x32_bf16 v[80:83], a[208:211], a[176:179], v[80:83]
    buffer_load_dwordx4 v3, s[8:11], s45 offen offset:1024 lds
    v_mfma_f32_16x16x32_bf16 v[80:83], a[212:215], a[180:183], v[80:83]
    s_add_u32 s20, s20, 1
    s_lshr_b32 s21, s20, 1
    s_lshl_b32 s21, s21, 17
    v_mfma_f32_16x16x32_bf16 v[88:91], a[212:215], a[188:191], v[88:91]
    s_and_b32 s22, s20, 1
    s_lshl_b32 s22, s22, 10
    s_add_u32 s21, s21, s22
    v_mfma_f32_16x16x32_bf16 v[88:91], a[208:211], a[184:187], v[88:91]
    s_waitcnt lgkmcnt(4)
    v_add_u32 v14, s21, v2
    v_accvgpr_write_b32 a228, v14
    v_mfma_f32_16x16x32_bf16 v[92:95], a[216:219], a[184:187], v[92:95]
    s_add_u32 s20, s20, 1
    ds_read_b64_tr_b16 a[200:201], v25 offset:8192
    ds_read_b64_tr_b16 a[202:203], v25 offset:10240
    v_mfma_f32_16x16x32_bf16 v[92:95], a[220:223], a[188:191], v[92:95]
    s_lshr_b32 s21, s20, 1
    ds_read_b64_tr_b16 a[204:205], v25 offset:12288
    ds_read_b64_tr_b16 a[206:207], v25 offset:14336
    v_mfma_f32_16x16x32_bf16 v[84:87], a[220:223], a[180:183], v[84:87]
    buffer_load_dwordx4 v3, s[8:11], s46 offen offset:2048 lds
    v_mfma_f32_16x16x32_bf16 v[84:87], a[216:219], a[176:179], v[84:87]
    s_lshl_b32 s21, s21, 17
    s_and_b32 s22, s20, 1
    s_lshl_b32 s22, s22, 10
    v_mfma_f32_16x16x32_bf16 v[76:79], a[216:219], a[168:171], v[76:79]
    s_add_u32 s21, s21, s22
    v_add_u32 v14, s21, v2
    v_accvgpr_write_b32 a229, v14
    v_mfma_f32_16x16x32_bf16 v[76:79], a[220:223], a[172:175], v[76:79]
    s_add_u32 s20, s20, 1
    s_lshr_b32 s21, s20, 1
    s_lshl_b32 s21, s21, 17
    v_mfma_f32_16x16x32_bf16 v[68:71], a[220:223], a[164:167], v[68:71]
    s_and_b32 s22, s20, 1
    s_lshl_b32 s22, s22, 10
    s_add_u32 s21, s21, s22
    v_mfma_f32_16x16x32_bf16 v[68:71], a[216:219], a[160:163], v[68:71]
    s_waitcnt lgkmcnt(4)
    v_add_u32 v14, s21, v2
    v_accvgpr_write_b32 a230, v14
    v_mfma_f32_16x16x32_bf16 v[96:99], a[192:195], a[160:163], v[96:99]
    s_add_u32 s20, s20, 1
    ds_read_b64_tr_b16 a[208:209], v26 offset:8192
    ds_read_b64_tr_b16 a[210:211], v26 offset:10240
    v_mfma_f32_16x16x32_bf16 v[96:99], a[196:199], a[164:167], v[96:99]
    s_lshr_b32 s21, s20, 1
    ds_read_b64_tr_b16 a[212:213], v26 offset:12288
    ds_read_b64_tr_b16 a[214:215], v26 offset:14336
    v_mfma_f32_16x16x32_bf16 v[104:107], a[196:199], a[172:175], v[104:107]
    buffer_load_dwordx4 v3, s[8:11], s47 offen offset:3072 lds
    v_mfma_f32_16x16x32_bf16 v[104:107], a[192:195], a[168:171], v[104:107]
    s_add_u32 m0, s40, 36864
    s_lshl_b32 s21, s21, 17
    s_and_b32 s22, s20, 1
    v_mfma_f32_16x16x32_bf16 v[112:115], a[192:195], a[176:179], v[112:115]
    s_lshl_b32 s22, s22, 10
    s_add_u32 s21, s21, s22
    v_add_u32 v14, s21, v2
    v_mfma_f32_16x16x32_bf16 v[112:115], a[196:199], a[180:183], v[112:115]
    buffer_load_dwordx4 v3, s[8:11], s48 offen offset:0 lds
    v_mfma_f32_16x16x32_bf16 v[120:123], a[196:199], a[188:191], v[120:123]
    v_accvgpr_write_b32 a231, v14
    v_mfma_f32_16x16x32_bf16 v[120:123], a[192:195], a[184:187], v[120:123]
    s_waitcnt lgkmcnt(4)
    s_add_u32 s20, s20, 1
    v_mfma_f32_16x16x32_bf16 v[124:127], a[200:203], a[184:187], v[124:127]
    ds_read_b64_tr_b16 a[216:217], v27 offset:8192
    ds_read_b64_tr_b16 a[218:219], v27 offset:10240
    v_mfma_f32_16x16x32_bf16 v[124:127], a[204:207], a[188:191], v[124:127]
    ds_read_b64_tr_b16 a[220:221], v27 offset:12288
    ds_read_b64_tr_b16 a[222:223], v27 offset:14336
    v_mfma_f32_16x16x32_bf16 v[116:119], a[204:207], a[180:183], v[116:119]
    v_mfma_f32_16x16x32_bf16 v[116:119], a[200:203], a[176:179], v[116:119]
    buffer_load_dwordx4 v3, s[8:11], s49 offen offset:1024 lds
    v_mfma_f32_16x16x32_bf16 v[108:111], a[200:203], a[168:171], v[108:111]
    v_mfma_f32_16x16x32_bf16 v[108:111], a[204:207], a[172:175], v[108:111]
    v_mfma_f32_16x16x32_bf16 v[100:103], a[204:207], a[164:167], v[100:103]
    v_mfma_f32_16x16x32_bf16 v[100:103], a[200:203], a[160:163], v[100:103]
    s_waitcnt lgkmcnt(4)
    v_mfma_f32_16x16x32_bf16 v[128:131], a[208:211], a[160:163], v[128:131]
    ds_read_b64_tr_b16 a[192:193], v24 offset:16384
    ds_read_b64_tr_b16 a[194:195], v24 offset:18432
    v_mfma_f32_16x16x32_bf16 v[128:131], a[212:215], a[164:167], v[128:131]
    ds_read_b64_tr_b16 a[196:197], v24 offset:20480
    ds_read_b64_tr_b16 a[198:199], v24 offset:22528
    v_mfma_f32_16x16x32_bf16 v[136:139], a[212:215], a[172:175], v[136:139]
    buffer_load_dwordx4 v3, s[8:11], s50 offen offset:2048 lds
    v_mfma_f32_16x16x32_bf16 v[136:139], a[208:211], a[168:171], v[136:139]
    v_mfma_f32_16x16x32_bf16 v[144:147], a[208:211], a[176:179], v[144:147]
    v_mfma_f32_16x16x32_bf16 v[144:147], a[212:215], a[180:183], v[144:147]
    v_mfma_f32_16x16x32_bf16 v[152:155], a[212:215], a[188:191], v[152:155]
    buffer_load_dwordx4 v3, s[8:11], s51 offen offset:3072 lds
    v_mfma_f32_16x16x32_bf16 v[152:155], a[208:211], a[184:187], v[152:155]
    s_waitcnt lgkmcnt(4)
    v_add_u32 v3, 524288, v3
    v_mfma_f32_16x16x32_bf16 v[156:159], a[216:219], a[184:187], v[156:159]
    s_add_u32 m0, s40, 98304
    ds_read_b64_tr_b16 a[200:201], v25 offset:16384
    ds_read_b64_tr_b16 a[202:203], v25 offset:18432
    v_mfma_f32_16x16x32_bf16 v[156:159], a[220:223], a[188:191], v[156:159]
    ds_read_b64_tr_b16 a[204:205], v25 offset:20480
    ds_read_b64_tr_b16 a[206:207], v25 offset:22528
    v_mfma_f32_16x16x32_bf16 v[148:151], a[220:223], a[180:183], v[148:151]
    v_mfma_f32_16x16x32_bf16 v[148:151], a[216:219], a[176:179], v[148:151]
    v_mfma_f32_16x16x32_bf16 v[140:143], a[216:219], a[168:171], v[140:143]
    buffer_load_dwordx4 v7, s[12:15], s52 offen offset:0 lds
    v_mfma_f32_16x16x32_bf16 v[140:143], a[220:223], a[172:175], v[140:143]
    v_mfma_f32_16x16x32_bf16 v[132:135], a[220:223], a[164:167], v[132:135]
    v_mfma_f32_16x16x32_bf16 v[132:135], a[216:219], a[160:163], v[132:135]
    s_waitcnt lgkmcnt(4)
    v_mfma_f32_16x16x32_bf16 v[160:163], a[160:163], a[192:195], v[160:163]
    ds_read_b64_tr_b16 a[208:209], v26 offset:16384
    ds_read_b64_tr_b16 a[210:211], v26 offset:18432
    v_mfma_f32_16x16x32_bf16 v[160:163], a[164:167], a[196:199], v[160:163]
    ds_read_b64_tr_b16 a[212:213], v26 offset:20480
    ds_read_b64_tr_b16 a[214:215], v26 offset:22528
    v_mfma_f32_16x16x32_bf16 v[164:167], a[172:175], a[196:199], v[164:167]
    buffer_load_dwordx4 v12, s[12:15], s53 offen offset:1024 lds
    v_mfma_f32_16x16x32_bf16 v[164:167], a[168:171], a[192:195], v[164:167]
    v_mfma_f32_16x16x32_bf16 v[168:171], a[176:179], a[192:195], v[168:171]
    v_mfma_f32_16x16x32_bf16 v[168:171], a[180:183], a[196:199], v[168:171]
    v_mfma_f32_16x16x32_bf16 v[172:175], a[188:191], a[196:199], v[172:175]
    v_mfma_f32_16x16x32_bf16 v[172:175], a[184:187], a[192:195], v[172:175]
    s_waitcnt lgkmcnt(4)
    v_mfma_f32_16x16x32_bf16 v[188:191], a[184:187], a[200:203], v[188:191]
    ds_read_b64_tr_b16 a[216:217], v27 offset:16384
    ds_read_b64_tr_b16 a[218:219], v27 offset:18432
    v_mfma_f32_16x16x32_bf16 v[188:191], a[188:191], a[204:207], v[188:191]
    ds_read_b64_tr_b16 a[220:221], v27 offset:20480
    ds_read_b64_tr_b16 a[222:223], v27 offset:22528
    v_mfma_f32_16x16x32_bf16 v[184:187], a[180:183], a[204:207], v[184:187]
    buffer_load_dwordx4 v7, s[12:15], s54 offen offset:2048 lds
    v_mfma_f32_16x16x32_bf16 v[184:187], a[176:179], a[200:203], v[184:187]
    v_mfma_f32_16x16x32_bf16 v[180:183], a[168:171], a[200:203], v[180:183]
    buffer_load_dwordx4 v12, s[12:15], s55 offen offset:3072 lds
    v_mfma_f32_16x16x32_bf16 v[180:183], a[172:175], a[204:207], v[180:183]
    s_add_u32 m0, s40, 102400
    v_mfma_f32_16x16x32_bf16 v[176:179], a[164:167], a[204:207], v[176:179]
    v_mfma_f32_16x16x32_bf16 v[176:179], a[160:163], a[200:203], v[176:179]
    s_waitcnt lgkmcnt(4)
    v_mfma_f32_16x16x32_bf16 v[192:195], a[160:163], a[208:211], v[192:195]
    ds_read_b64_tr_b16 a[192:193], v24 offset:24576
    ds_read_b64_tr_b16 a[194:195], v24 offset:26624
    v_mfma_f32_16x16x32_bf16 v[192:195], a[164:167], a[212:215], v[192:195]
    ds_read_b64_tr_b16 a[196:197], v24 offset:28672
    ds_read_b64_tr_b16 a[198:199], v24 offset:30720
    v_mfma_f32_16x16x32_bf16 v[196:199], a[172:175], a[212:215], v[196:199]
    buffer_load_dwordx4 v7, s[12:15], s56 offen offset:0 lds
    v_mfma_f32_16x16x32_bf16 v[196:199], a[168:171], a[208:211], v[196:199]
    v_mfma_f32_16x16x32_bf16 v[200:203], a[176:179], a[208:211], v[200:203]
    v_mfma_f32_16x16x32_bf16 v[200:203], a[180:183], a[212:215], v[200:203]
    v_mfma_f32_16x16x32_bf16 v[204:207], a[188:191], a[212:215], v[204:207]
    v_mfma_f32_16x16x32_bf16 v[204:207], a[184:187], a[208:211], v[204:207]
    s_waitcnt lgkmcnt(4)
    v_mfma_f32_16x16x32_bf16 v[220:223], a[184:187], a[216:219], v[220:223]
    s_add_u32 s80, s4, s25
    s_addc_u32 s81, s5, 0
    ds_read_b64_tr_b16 a[200:201], v25 offset:24576
    ds_read_b64_tr_b16 a[202:203], v25 offset:26624
    v_mfma_f32_16x16x32_bf16 v[220:223], a[188:191], a[220:223], v[220:223]
    s_load_dword s16, s[80:81], 0
    ds_read_b64_tr_b16 a[204:205], v25 offset:28672
    ds_read_b64_tr_b16 a[206:207], v25 offset:30720
    v_mfma_f32_16x16x32_bf16 v[216:219], a[180:183], a[220:223], v[216:219]
    buffer_load_dwordx4 v12, s[12:15], s57 offen offset:1024 lds
    v_mfma_f32_16x16x32_bf16 v[216:219], a[176:179], a[216:219], v[216:219]
    s_load_dword s17, s[80:81], 128
    s_load_dword s18, s[80:81], 256
    s_load_dword s19, s[80:81], 384
    v_mfma_f32_16x16x32_bf16 v[212:215], a[168:171], a[216:219], v[212:215]
    v_mfma_f32_16x16x32_bf16 v[212:215], a[172:175], a[220:223], v[212:215]
    buffer_load_dwordx4 v7, s[12:15], s58 offen offset:2048 lds
    v_mfma_f32_16x16x32_bf16 v[208:211], a[164:167], a[220:223], v[208:211]
    v_mfma_f32_16x16x32_bf16 v[208:211], a[160:163], a[216:219], v[208:211]
    s_waitcnt lgkmcnt(4)
    v_mfma_f32_16x16x32_bf16 v[224:227], a[160:163], a[192:195], v[224:227]
    ds_read_b64_tr_b16 a[208:209], v26 offset:24576
    ds_read_b64_tr_b16 a[210:211], v26 offset:26624
    v_mfma_f32_16x16x32_bf16 v[224:227], a[164:167], a[196:199], v[224:227]
    ds_read_b64_tr_b16 a[212:213], v26 offset:28672
    ds_read_b64_tr_b16 a[214:215], v26 offset:30720
    v_mfma_f32_16x16x32_bf16 v[228:231], a[172:175], a[196:199], v[228:231]
    v_mfma_f32_16x16x32_bf16 v[228:231], a[168:171], a[192:195], v[228:231]
    buffer_load_dwordx4 v12, s[12:15], s59 offen offset:3072 lds
    v_mfma_f32_16x16x32_bf16 v[232:235], a[176:179], a[192:195], v[232:235]
    v_add_u32 v7, 128, v7
    v_add_u32 v12, 128, v12
    v_mfma_f32_16x16x32_bf16 v[232:235], a[180:183], a[196:199], v[232:235]
    v_mfma_f32_16x16x32_bf16 v[236:239], a[188:191], a[196:199], v[236:239]
    v_mfma_f32_16x16x32_bf16 v[236:239], a[184:187], a[192:195], v[236:239]
    s_waitcnt lgkmcnt(4)
    v_mfma_f32_16x16x32_bf16 v[252:255], a[184:187], a[200:203], v[252:255]
    ds_read_b64_tr_b16 a[216:217], v27 offset:24576
    ds_read_b64_tr_b16 a[218:219], v27 offset:26624
    v_mfma_f32_16x16x32_bf16 v[252:255], a[188:191], a[204:207], v[252:255]
    ds_read_b64_tr_b16 a[220:221], v27 offset:28672
    ds_read_b64_tr_b16 a[222:223], v27 offset:30720
    v_mfma_f32_16x16x32_bf16 v[248:251], a[180:183], a[204:207], v[248:251]
    v_mfma_f32_16x16x32_bf16 v[248:251], a[176:179], a[200:203], v[248:251]
    v_mfma_f32_16x16x32_bf16 v[244:247], a[168:171], a[200:203], v[244:247]
    v_mfma_f32_16x16x32_bf16 v[244:247], a[172:175], a[204:207], v[244:247]
    v_mfma_f32_16x16x32_bf16 v[240:243], a[164:167], a[204:207], v[240:243]
    v_mfma_f32_16x16x32_bf16 v[240:243], a[160:163], a[200:203], v[240:243]
    s_waitcnt lgkmcnt(4)
    v_mfma_f32_16x16x32_bf16 a[0:3], a[160:163], a[208:211], a[0:3]
    s_waitcnt vmcnt(19) lgkmcnt(0)
    v_mfma_f32_16x16x32_bf16 a[0:3], a[164:167], a[212:215], a[0:3]
    s_min_u32 s16, s16, s17
    s_min_u32 s16, s16, s18
    s_min_u32 s16, s16, s19
    s_cmp_lt_u32 s16, 8
    s_cbranch_scc1 KA_spin_h
KA_ret_h:
    v_mfma_f32_16x16x32_bf16 a[4:7], a[172:175], a[212:215], a[4:7]
    s_barrier
    v_mfma_f32_16x16x32_bf16 a[4:7], a[168:171], a[208:211], a[4:7]
    ds_read_b64_tr_b16 a[192:193], v8 offset:0
    ds_read_b64_tr_b16 a[194:195], v8 offset:2048
    v_mfma_f32_16x16x32_bf16 a[8:11], a[176:179], a[208:211], a[8:11]
    ds_read_b64_tr_b16 a[196:197], v8 offset:4096
    ds_read_b64_tr_b16 a[198:199], v8 offset:6144
    v_mfma_f32_16x16x32_bf16 a[8:11], a[180:183], a[212:215], a[8:11]
    ds_read_b128 a[128:131], v5 offset:32768
    ds_read_b128 a[132:135], v6 offset:32768
    v_mfma_f32_16x16x32_bf16 a[12:15], a[188:191], a[212:215], a[12:15]
    ds_read_b128 a[136:139], v5 offset:34816
    ds_read_b128 a[140:143], v6 offset:34816
    v_mfma_f32_16x16x32_bf16 a[12:15], a[184:187], a[208:211], a[12:15]
    ds_read_b128 a[144:147], v5 offset:36864
    ds_read_b128 a[148:151], v6 offset:36864
    v_mfma_f32_16x16x32_bf16 a[28:31], a[184:187], a[216:219], a[28:31]
    ds_read_b128 a[152:155], v5 offset:38912
    ds_read_b128 a[156:159], v6 offset:38912
    v_mfma_f32_16x16x32_bf16 a[28:31], a[188:191], a[220:223], a[28:31]
    s_waitcnt lgkmcnt(8)
    ds_read_b64_tr_b16 a[200:201], v9 offset:0
    ds_read_b64_tr_b16 a[202:203], v9 offset:2048
    v_mfma_f32_16x16x32_bf16 a[24:27], a[180:183], a[220:223], a[24:27]
    ds_read_b64_tr_b16 a[204:205], v9 offset:4096
    ds_read_b64_tr_b16 a[206:207], v9 offset:6144
    v_mfma_f32_16x16x32_bf16 a[24:27], a[176:179], a[216:219], a[24:27]
    v_mfma_f32_16x16x32_bf16 a[20:23], a[168:171], a[216:219], a[20:23]
    v_mfma_f32_16x16x32_bf16 a[20:23], a[172:175], a[220:223], a[20:23]
    v_mfma_f32_16x16x32_bf16 a[16:19], a[164:167], a[220:223], a[16:19]
    v_mfma_f32_16x16x32_bf16 a[16:19], a[160:163], a[216:219], a[16:19]
    s_waitcnt lgkmcnt(4)
    v_mfma_f32_16x16x32_bf16 v[32:35], a[192:195], a[128:131], v[32:35]
    s_lshl_b32 s28, s27, 3
    ds_read_b64_tr_b16 a[208:209], v10 offset:0
    ds_read_b64_tr_b16 a[210:211], v10 offset:2048
    v_mfma_f32_16x16x32_bf16 v[32:35], a[196:199], a[132:135], v[32:35]
    s_add_u32 s56, s28, s3
    ds_read_b64_tr_b16 a[212:213], v10 offset:4096
    ds_read_b64_tr_b16 a[214:215], v10 offset:6144
    v_mfma_f32_16x16x32_bf16 v[40:43], a[196:199], a[140:143], v[40:43]
    s_xor_b32 s57, s56, 7
    s_sub_u32 s58, 120, s28
    s_add_u32 s58, s58, s3
    v_mfma_f32_16x16x32_bf16 v[40:43], a[192:195], a[136:139], v[40:43]
    s_xor_b32 s59, s58, 7
    s_mul_i32 s52, s56, 20480
    s_add_u32 s52, s52, 1048576
    v_mfma_f32_16x16x32_bf16 v[48:51], a[192:195], a[144:147], v[48:51]
    s_mul_i32 s53, s57, 20480
    s_add_u32 s53, s53, 1048576
    s_mul_i32 s54, s58, 20480
    v_mfma_f32_16x16x32_bf16 v[48:51], a[196:199], a[148:151], v[48:51]
    s_add_u32 s54, s54, 1048576
    s_mul_i32 s55, s59, 20480
    s_add_u32 s55, s55, 1048576
    v_mfma_f32_16x16x32_bf16 v[56:59], a[196:199], a[156:159], v[56:59]
    v_accvgpr_read_b32 v30, a124
    v_mfma_f32_16x16x32_bf16 v[56:59], a[192:195], a[152:155], v[56:59]
    s_waitcnt lgkmcnt(4)
    s_lshr_b32 s41, s3, 1
    s_lshl_b32 s41, s41, 19
    v_mfma_f32_16x16x32_bf16 v[60:63], a[200:203], a[152:155], v[60:63]
    s_add_u32 s41, s41, 4194304
    ds_read_b64_tr_b16 a[216:217], v11 offset:0
    ds_read_b64_tr_b16 a[218:219], v11 offset:2048
    v_mfma_f32_16x16x32_bf16 v[60:63], a[204:207], a[156:159], v[60:63]
    ds_read_b64_tr_b16 a[220:221], v11 offset:4096
    ds_read_b64_tr_b16 a[222:223], v11 offset:6144
    v_mfma_f32_16x16x32_bf16 v[52:55], a[204:207], a[148:151], v[52:55]
    buffer_load_dword a249, v30, s[68:71], s41 offen
    v_mfma_f32_16x16x32_bf16 v[52:55], a[200:203], a[144:147], v[52:55]
    v_subrev_u32 v3, 4194304, v3
    v_mfma_f32_16x16x32_bf16 v[44:47], a[200:203], a[136:139], v[44:47]
    s_add_u32 m0, s40, 65536
    v_mfma_f32_16x16x32_bf16 v[44:47], a[204:207], a[140:143], v[44:47]
    buffer_load_dwordx4 v3, s[68:71], s44 offen offset:0 lds
    v_mfma_f32_16x16x32_bf16 v[36:39], a[204:207], a[132:135], v[36:39]
    buffer_load_dwordx4 v3, s[68:71], s45 offen offset:1024 lds
    v_mfma_f32_16x16x32_bf16 v[36:39], a[200:203], a[128:131], v[36:39]
    s_waitcnt lgkmcnt(4)
    v_mfma_f32_16x16x32_bf16 v[64:67], a[208:211], a[128:131], v[64:67]
    ds_read_b64_tr_b16 a[192:193], v8 offset:8192
    ds_read_b64_tr_b16 a[194:195], v8 offset:10240
    v_mfma_f32_16x16x32_bf16 v[64:67], a[212:215], a[132:135], v[64:67]
    ds_read_b64_tr_b16 a[196:197], v8 offset:12288
    ds_read_b64_tr_b16 a[198:199], v8 offset:14336
    v_mfma_f32_16x16x32_bf16 v[72:75], a[212:215], a[140:143], v[72:75]
    buffer_load_dwordx4 v3, s[68:71], s46 offen offset:2048 lds
    v_mfma_f32_16x16x32_bf16 v[72:75], a[208:211], a[136:139], v[72:75]
    buffer_load_dwordx4 v3, s[68:71], s47 offen offset:3072 lds
    v_mfma_f32_16x16x32_bf16 v[80:83], a[208:211], a[144:147], v[80:83]
    s_add_u32 m0, s40, 69632
    v_mfma_f32_16x16x32_bf16 v[80:83], a[212:215], a[148:151], v[80:83]
    buffer_load_dwordx4 v3, s[68:71], s48 offen offset:0 lds
    v_mfma_f32_16x16x32_bf16 v[88:91], a[212:215], a[156:159], v[88:91]
    v_mfma_f32_16x16x32_bf16 v[88:91], a[208:211], a[152:155], v[88:91]
    s_waitcnt lgkmcnt(4)
    v_mfma_f32_16x16x32_bf16 v[92:95], a[216:219], a[152:155], v[92:95]
    ds_read_b64_tr_b16 a[200:201], v9 offset:8192
    ds_read_b64_tr_b16 a[202:203], v9 offset:10240
    v_mfma_f32_16x16x32_bf16 v[92:95], a[220:223], a[156:159], v[92:95]
    ds_read_b64_tr_b16 a[204:205], v9 offset:12288
    ds_read_b64_tr_b16 a[206:207], v9 offset:14336
    v_mfma_f32_16x16x32_bf16 v[84:87], a[220:223], a[148:151], v[84:87]
    buffer_load_dwordx4 v3, s[68:71], s49 offen offset:1024 lds
    v_mfma_f32_16x16x32_bf16 v[84:87], a[216:219], a[144:147], v[84:87]
    buffer_load_dwordx4 v3, s[68:71], s50 offen offset:2048 lds
    v_mfma_f32_16x16x32_bf16 v[76:79], a[216:219], a[136:139], v[76:79]
    v_mfma_f32_16x16x32_bf16 v[76:79], a[220:223], a[140:143], v[76:79]
    v_mfma_f32_16x16x32_bf16 v[68:71], a[220:223], a[132:135], v[68:71]
    buffer_load_dwordx4 v3, s[68:71], s51 offen offset:3072 lds
    v_mfma_f32_16x16x32_bf16 v[68:71], a[216:219], a[128:131], v[68:71]
    s_waitcnt lgkmcnt(4)
    v_add_u32 v3, 1048576, v3
    v_mfma_f32_16x16x32_bf16 v[96:99], a[192:195], a[128:131], v[96:99]
    s_lshl_b32 s31, s26, 19
    ds_read_b64_tr_b16 a[208:209], v10 offset:8192
    ds_read_b64_tr_b16 a[210:211], v10 offset:10240
    v_mfma_f32_16x16x32_bf16 v[96:99], a[196:199], a[132:135], v[96:99]
    s_add_u32 s82, s31, 0x2000000
    ds_read_b64_tr_b16 a[212:213], v10 offset:12288
    ds_read_b64_tr_b16 a[214:215], v10 offset:14336
    v_mfma_f32_16x16x32_bf16 v[104:107], a[196:199], a[140:143], v[104:107]
    buffer_load_dwordx4 a[32:35], v2, s[72:75], s52 offen offset:0 sc1
    v_mfma_f32_16x16x32_bf16 v[104:107], a[192:195], a[136:139], v[104:107]
    s_add_u32 s16, s4, s82
    s_addc_u32 s17, s5, 0
    v_mfma_f32_16x16x32_bf16 v[112:115], a[192:195], a[144:147], v[112:115]
    s_add_u32 s82, s31, 0x3000000
    v_mfma_f32_16x16x32_bf16 v[112:115], a[196:199], a[148:151], v[112:115]
    buffer_load_dwordx4 a[36:39], v2, s[72:75], s52 offen offset:1024 sc1
    v_mfma_f32_16x16x32_bf16 v[120:123], a[196:199], a[156:159], v[120:123]
    s_add_u32 s20, s4, s82
    s_addc_u32 s21, s5, 0
    v_mfma_f32_16x16x32_bf16 v[120:123], a[192:195], a[152:155], v[120:123]
    s_waitcnt lgkmcnt(4)
    s_mov_b32 s18, 524288
    v_mfma_f32_16x16x32_bf16 v[124:127], a[200:203], a[152:155], v[124:127]
    s_mov_b32 s22, 524288
    ds_read_b64_tr_b16 a[216:217], v11 offset:8192
    ds_read_b64_tr_b16 a[218:219], v11 offset:10240
    v_mfma_f32_16x16x32_bf16 v[124:127], a[204:207], a[156:159], v[124:127]
    s_mov_b32 s19, 0x20000
    ds_read_b64_tr_b16 a[220:221], v11 offset:12288
    ds_read_b64_tr_b16 a[222:223], v11 offset:14336
    v_mfma_f32_16x16x32_bf16 v[116:119], a[204:207], a[148:151], v[116:119]
    buffer_load_dwordx4 a[40:43], v2, s[72:75], s53 offen offset:0 sc1
    v_mfma_f32_16x16x32_bf16 v[116:119], a[200:203], a[144:147], v[116:119]
    buffer_load_dwordx4 a[44:47], v2, s[72:75], s53 offen offset:1024 sc1
    v_mfma_f32_16x16x32_bf16 v[108:111], a[200:203], a[136:139], v[108:111]
    s_mov_b32 s23, 0x20000
    v_mfma_f32_16x16x32_bf16 v[108:111], a[204:207], a[140:143], v[108:111]
    s_lshl_b32 s31, s26, 12
    v_mfma_f32_16x16x32_bf16 v[100:103], a[204:207], a[132:135], v[100:103]
    buffer_load_dwordx4 a[48:51], v2, s[72:75], s54 offen offset:0 sc1
    v_mfma_f32_16x16x32_bf16 v[100:103], a[200:203], a[128:131], v[100:103]
    s_waitcnt lgkmcnt(4)
    s_add_u32 s31, s31, 0x4000000
    v_mfma_f32_16x16x32_bf16 v[128:131], a[208:211], a[128:131], v[128:131]
    s_add_u32 s64, s4, s31
    s_addc_u32 s65, s5, 0
    ds_read_b64_tr_b16 a[192:193], v8 offset:16384
    ds_read_b64_tr_b16 a[194:195], v8 offset:18432
    v_mfma_f32_16x16x32_bf16 v[128:131], a[212:215], a[132:135], v[128:131]
    s_mov_b32 s66, 16777216
    ds_read_b64_tr_b16 a[196:197], v8 offset:20480
    ds_read_b64_tr_b16 a[198:199], v8 offset:22528
    v_mfma_f32_16x16x32_bf16 v[136:139], a[212:215], a[140:143], v[136:139]
    buffer_load_dwordx4 a[52:55], v2, s[72:75], s54 offen offset:1024 sc1
    v_mfma_f32_16x16x32_bf16 v[136:139], a[208:211], a[136:139], v[136:139]
    s_mov_b32 s67, 0x20000
    v_mfma_f32_16x16x32_bf16 v[144:147], a[208:211], a[144:147], v[144:147]
    buffer_load_dwordx4 a[56:59], v2, s[72:75], s55 offen offset:0 sc1
    v_mfma_f32_16x16x32_bf16 v[144:147], a[212:215], a[148:151], v[144:147]
    v_mfma_f32_16x16x32_bf16 v[152:155], a[212:215], a[156:159], v[152:155]
    v_mfma_f32_16x16x32_bf16 v[152:155], a[208:211], a[152:155], v[152:155]
    s_waitcnt lgkmcnt(4)
    v_mfma_f32_16x16x32_bf16 v[156:159], a[216:219], a[152:155], v[156:159]
    ds_read_b64_tr_b16 a[200:201], v9 offset:16384
    ds_read_b64_tr_b16 a[202:203], v9 offset:18432
    v_mfma_f32_16x16x32_bf16 v[156:159], a[220:223], a[156:159], v[156:159]
    ds_read_b64_tr_b16 a[204:205], v9 offset:20480
    ds_read_b64_tr_b16 a[206:207], v9 offset:22528
    v_mfma_f32_16x16x32_bf16 v[148:151], a[220:223], a[148:151], v[148:151]
    buffer_load_dwordx4 a[60:63], v2, s[72:75], s55 offen offset:1024 sc1
    v_mfma_f32_16x16x32_bf16 v[148:151], a[216:219], a[144:147], v[148:151]
    buffer_load_dwordx4 a[64:67], v2, s[72:75], s52 offen offset:2048 sc1
    v_mfma_f32_16x16x32_bf16 v[140:143], a[216:219], a[136:139], v[140:143]
    v_mfma_f32_16x16x32_bf16 v[140:143], a[220:223], a[140:143], v[140:143]
    v_mfma_f32_16x16x32_bf16 v[132:135], a[220:223], a[132:135], v[132:135]
    buffer_load_dwordx4 a[68:71], v2, s[72:75], s52 offen offset:3072 sc1
    v_mfma_f32_16x16x32_bf16 v[132:135], a[216:219], a[128:131], v[132:135]
    s_waitcnt lgkmcnt(4)
    v_mfma_f32_16x16x32_bf16 v[160:163], a[128:131], a[192:195], v[160:163]
    ds_read_b64_tr_b16 a[208:209], v10 offset:16384
    ds_read_b64_tr_b16 a[210:211], v10 offset:18432
    v_mfma_f32_16x16x32_bf16 v[160:163], a[132:135], a[196:199], v[160:163]
    ds_read_b64_tr_b16 a[212:213], v10 offset:20480
    ds_read_b64_tr_b16 a[214:215], v10 offset:22528
    v_mfma_f32_16x16x32_bf16 v[164:167], a[140:143], a[196:199], v[164:167]
    buffer_load_dwordx4 a[72:75], v2, s[72:75], s53 offen offset:2048 sc1
    v_mfma_f32_16x16x32_bf16 v[164:167], a[136:139], a[192:195], v[164:167]
    v_mfma_f32_16x16x32_bf16 v[168:171], a[144:147], a[192:195], v[168:171]
    buffer_load_dwordx4 a[76:79], v2, s[72:75], s53 offen offset:3072 sc1
    v_mfma_f32_16x16x32_bf16 v[168:171], a[148:151], a[196:199], v[168:171]
    v_mfma_f32_16x16x32_bf16 v[172:175], a[156:159], a[196:199], v[172:175]
    v_mfma_f32_16x16x32_bf16 v[172:175], a[152:155], a[192:195], v[172:175]
    s_waitcnt lgkmcnt(4)
    v_mfma_f32_16x16x32_bf16 v[188:191], a[152:155], a[200:203], v[188:191]
    ds_read_b64_tr_b16 a[216:217], v11 offset:16384
    ds_read_b64_tr_b16 a[218:219], v11 offset:18432
    v_mfma_f32_16x16x32_bf16 v[188:191], a[156:159], a[204:207], v[188:191]
    ds_read_b64_tr_b16 a[220:221], v11 offset:20480
    ds_read_b64_tr_b16 a[222:223], v11 offset:22528
    v_mfma_f32_16x16x32_bf16 v[184:187], a[148:151], a[204:207], v[184:187]
    buffer_load_dwordx4 a[80:83], v2, s[72:75], s54 offen offset:2048 sc1
    v_mfma_f32_16x16x32_bf16 v[184:187], a[144:147], a[200:203], v[184:187]
    buffer_load_dwordx4 a[84:87], v2, s[72:75], s54 offen offset:3072 sc1
    v_mfma_f32_16x16x32_bf16 v[180:183], a[136:139], a[200:203], v[180:183]
    v_mfma_f32_16x16x32_bf16 v[180:183], a[140:143], a[204:207], v[180:183]
    buffer_load_dwordx4 a[88:91], v2, s[72:75], s55 offen offset:2048 sc1
    v_mfma_f32_16x16x32_bf16 v[176:179], a[132:135], a[204:207], v[176:179]
    v_mfma_f32_16x16x32_bf16 v[176:179], a[128:131], a[200:203], v[176:179]
    s_waitcnt lgkmcnt(4)
    v_mfma_f32_16x16x32_bf16 v[192:195], a[128:131], a[208:211], v[192:195]
    ds_read_b64_tr_b16 a[192:193], v8 offset:24576
    ds_read_b64_tr_b16 a[194:195], v8 offset:26624
    v_mfma_f32_16x16x32_bf16 v[192:195], a[132:135], a[212:215], v[192:195]
    ds_read_b64_tr_b16 a[196:197], v8 offset:28672
    ds_read_b64_tr_b16 a[198:199], v8 offset:30720
    v_mfma_f32_16x16x32_bf16 v[196:199], a[140:143], a[212:215], v[196:199]
    buffer_load_dwordx4 a[92:95], v2, s[72:75], s55 offen offset:3072 sc1
    v_mfma_f32_16x16x32_bf16 v[196:199], a[136:139], a[208:211], v[196:199]
    s_add_u32 s52, s52, 4096
    s_add_u32 s53, s53, 4096
    s_add_u32 s54, s54, 4096
    v_mfma_f32_16x16x32_bf16 v[200:203], a[144:147], a[208:211], v[200:203]
    s_add_u32 s55, s55, 4096
    v_mfma_f32_16x16x32_bf16 v[200:203], a[148:151], a[212:215], v[200:203]
    buffer_load_dwordx4 a[96:99], v2, s[72:75], s52 offen offset:0 sc1
    v_mfma_f32_16x16x32_bf16 v[204:207], a[156:159], a[212:215], v[204:207]
    v_mfma_f32_16x16x32_bf16 v[204:207], a[152:155], a[208:211], v[204:207]
    s_waitcnt lgkmcnt(4)
    v_mfma_f32_16x16x32_bf16 v[220:223], a[152:155], a[216:219], v[220:223]
    ds_read_b64_tr_b16 a[200:201], v9 offset:24576
    ds_read_b64_tr_b16 a[202:203], v9 offset:26624
    v_mfma_f32_16x16x32_bf16 v[220:223], a[156:159], a[220:223], v[220:223]
    ds_read_b64_tr_b16 a[204:205], v9 offset:28672
    ds_read_b64_tr_b16 a[206:207], v9 offset:30720
    v_mfma_f32_16x16x32_bf16 v[216:219], a[148:151], a[220:223], v[216:219]
    buffer_load_dwordx4 a[100:103], v2, s[72:75], s52 offen offset:1024 sc1
    v_mfma_f32_16x16x32_bf16 v[216:219], a[144:147], a[216:219], v[216:219]
    buffer_load_dwordx4 a[104:107], v2, s[72:75], s53 offen offset:0 sc1
    v_mfma_f32_16x16x32_bf16 v[212:215], a[136:139], a[216:219], v[212:215]
    v_mfma_f32_16x16x32_bf16 v[212:215], a[140:143], a[220:223], v[212:215]
    buffer_load_dwordx4 a[108:111], v2, s[72:75], s53 offen offset:1024 sc1
    v_mfma_f32_16x16x32_bf16 v[208:211], a[132:135], a[220:223], v[208:211]
    v_mfma_f32_16x16x32_bf16 v[208:211], a[128:131], a[216:219], v[208:211]
    s_waitcnt lgkmcnt(4)
    v_mfma_f32_16x16x32_bf16 v[224:227], a[128:131], a[192:195], v[224:227]
    ds_read_b64_tr_b16 a[208:209], v10 offset:24576
    ds_read_b64_tr_b16 a[210:211], v10 offset:26624
    v_mfma_f32_16x16x32_bf16 v[224:227], a[132:135], a[196:199], v[224:227]
    ds_read_b64_tr_b16 a[212:213], v10 offset:28672
    ds_read_b64_tr_b16 a[214:215], v10 offset:30720
    v_mfma_f32_16x16x32_bf16 v[228:231], a[140:143], a[196:199], v[228:231]
    buffer_load_dwordx4 a[112:115], v2, s[72:75], s54 offen offset:0 sc1
    v_mfma_f32_16x16x32_bf16 v[228:231], a[136:139], a[192:195], v[228:231]
    buffer_load_dwordx4 a[116:119], v2, s[72:75], s54 offen offset:1024 sc1
    v_mfma_f32_16x16x32_bf16 v[232:235], a[144:147], a[192:195], v[232:235]
    v_mfma_f32_16x16x32_bf16 v[232:235], a[148:151], a[196:199], v[232:235]
    v_mfma_f32_16x16x32_bf16 v[236:239], a[156:159], a[196:199], v[236:239]
    buffer_load_dwordx4 a[120:123], v2, s[72:75], s55 offen offset:0 sc1
    v_mfma_f32_16x16x32_bf16 v[236:239], a[152:155], a[192:195], v[236:239]
    s_waitcnt lgkmcnt(4)
    v_mfma_f32_16x16x32_bf16 v[252:255], a[152:155], a[200:203], v[252:255]
    ds_read_b64_tr_b16 a[216:217], v11 offset:24576
    ds_read_b64_tr_b16 a[218:219], v11 offset:26624
    v_mfma_f32_16x16x32_bf16 v[252:255], a[156:159], a[204:207], v[252:255]
    ds_read_b64_tr_b16 a[220:221], v11 offset:28672
    ds_read_b64_tr_b16 a[222:223], v11 offset:30720
    v_mfma_f32_16x16x32_bf16 v[248:251], a[148:151], a[204:207], v[248:251]
    buffer_load_dwordx4 a[124:127], v2, s[72:75], s55 offen offset:1024 sc1
    v_mfma_f32_16x16x32_bf16 v[248:251], a[144:147], a[200:203], v[248:251]
    v_mfma_f32_16x16x32_bf16 v[244:247], a[136:139], a[200:203], v[244:247]
    v_mfma_f32_16x16x32_bf16 v[244:247], a[140:143], a[204:207], v[244:247]
    v_mfma_f32_16x16x32_bf16 v[240:243], a[132:135], a[204:207], v[240:243]
    v_mfma_f32_16x16x32_bf16 v[240:243], a[128:131], a[200:203], v[240:243]
    s_waitcnt lgkmcnt(4)
    v_mfma_f32_16x16x32_bf16 a[0:3], a[128:131], a[208:211], a[0:3]
    s_waitcnt vmcnt(33) lgkmcnt(0)
    v_mfma_f32_16x16x32_bf16 a[0:3], a[132:135], a[212:215], a[0:3]
    s_barrier
    v_mfma_f32_16x16x32_bf16 a[4:7], a[140:143], a[212:215], a[4:7]
    ds_read_b64_tr_b16 a[192:193], v8 offset:32768
    ds_read_b64_tr_b16 a[194:195], v8 offset:34816
    v_mfma_f32_16x16x32_bf16 a[4:7], a[136:139], a[208:211], a[4:7]
    ds_read_b64_tr_b16 a[196:197], v8 offset:36864
    ds_read_b64_tr_b16 a[198:199], v8 offset:38912
    v_mfma_f32_16x16x32_bf16 a[8:11], a[144:147], a[208:211], a[8:11]
    ds_read_b128 a[160:163], v5 offset:0
    ds_read_b128 a[164:167], v6 offset:0
    v_mfma_f32_16x16x32_bf16 a[8:11], a[148:151], a[212:215], a[8:11]
    ds_read_b128 a[168:171], v5 offset:2048
    ds_read_b128 a[172:175], v6 offset:2048
    v_mfma_f32_16x16x32_bf16 a[12:15], a[156:159], a[212:215], a[12:15]
    ds_read_b128 a[176:179], v5 offset:4096
    ds_read_b128 a[180:183], v6 offset:4096
    v_mfma_f32_16x16x32_bf16 a[12:15], a[152:155], a[208:211], a[12:15]
    ds_read_b128 a[184:187], v5 offset:6144
    ds_read_b128 a[188:191], v6 offset:6144
    v_mfma_f32_16x16x32_bf16 a[28:31], a[152:155], a[216:219], a[28:31]
    s_waitcnt lgkmcnt(8)
    ds_read_b64_tr_b16 a[200:201], v9 offset:32768
    ds_read_b64_tr_b16 a[202:203], v9 offset:34816
    v_mfma_f32_16x16x32_bf16 a[28:31], a[156:159], a[220:223], a[28:31]
    ds_read_b64_tr_b16 a[204:205], v9 offset:36864
    ds_read_b64_tr_b16 a[206:207], v9 offset:38912
    v_mfma_f32_16x16x32_bf16 a[24:27], a[148:151], a[220:223], a[24:27]
    v_mfma_f32_16x16x32_bf16 a[24:27], a[144:147], a[216:219], a[24:27]
    v_mfma_f32_16x16x32_bf16 a[20:23], a[136:139], a[216:219], a[20:23]
    v_mfma_f32_16x16x32_bf16 a[20:23], a[140:143], a[220:223], a[20:23]
    v_mfma_f32_16x16x32_bf16 a[16:19], a[132:135], a[220:223], a[16:19]
    v_mfma_f32_16x16x32_bf16 a[16:19], a[128:131], a[216:219], a[16:19]
    s_waitcnt lgkmcnt(4)
    v_mfma_f32_16x16x32_bf16 v[32:35], a[192:195], a[160:163], v[32:35]
    ds_read_b64_tr_b16 a[208:209], v10 offset:32768
    ds_read_b64_tr_b16 a[210:211], v10 offset:34816
    v_mfma_f32_16x16x32_bf16 v[32:35], a[196:199], a[164:167], v[32:35]
    ds_read_b64_tr_b16 a[212:213], v10 offset:36864
    ds_read_b64_tr_b16 a[214:215], v10 offset:38912
    v_mfma_f32_16x16x32_bf16 v[40:43], a[196:199], a[172:175], v[40:43]
    s_add_u32 m0, s40, 0
    v_mfma_f32_16x16x32_bf16 v[40:43], a[192:195], a[168:171], v[40:43]
    buffer_load_dwordx4 v3, s[68:71], s44 offen offset:0 lds
    v_mfma_f32_16x16x32_bf16 v[48:51], a[192:195], a[176:179], v[48:51]
    v_mfma_f32_16x16x32_bf16 v[48:51], a[196:199], a[180:183], v[48:51]
    v_mfma_f32_16x16x32_bf16 v[56:59], a[196:199], a[188:191], v[56:59]
    v_mfma_f32_16x16x32_bf16 v[56:59], a[192:195], a[184:187], v[56:59]
    s_waitcnt lgkmcnt(4)
    v_mfma_f32_16x16x32_bf16 v[60:63], a[200:203], a[184:187], v[60:63]
    ds_read_b64_tr_b16 a[216:217], v11 offset:32768
    ds_read_b64_tr_b16 a[218:219], v11 offset:34816
    v_mfma_f32_16x16x32_bf16 v[60:63], a[204:207], a[188:191], v[60:63]
    ds_read_b64_tr_b16 a[220:221], v11 offset:36864
    ds_read_b64_tr_b16 a[222:223], v11 offset:38912
    v_mfma_f32_16x16x32_bf16 v[52:55], a[204:207], a[180:183], v[52:55]
    buffer_load_dwordx4 v3, s[68:71], s45 offen offset:1024 lds
    v_mfma_f32_16x16x32_bf16 v[52:55], a[200:203], a[176:179], v[52:55]
    v_mfma_f32_16x16x32_bf16 v[44:47], a[200:203], a[168:171], v[44:47]
    v_mfma_f32_16x16x32_bf16 v[44:47], a[204:207], a[172:175], v[44:47]
    v_mfma_f32_16x16x32_bf16 v[36:39], a[204:207], a[164:167], v[36:39]
    buffer_load_dwordx4 v3, s[68:71], s46 offen offset:2048 lds
    v_mfma_f32_16x16x32_bf16 v[36:39], a[200:203], a[160:163], v[36:39]
    s_waitcnt lgkmcnt(4)
    v_mfma_f32_16x16x32_bf16 v[64:67], a[208:211], a[160:163], v[64:67]
    ds_read_b64_tr_b16 a[192:193], v8 offset:40960
    ds_read_b64_tr_b16 a[194:195], v8 offset:43008
    v_mfma_f32_16x16x32_bf16 v[64:67], a[212:215], a[164:167], v[64:67]
    ds_read_b64_tr_b16 a[196:197], v8 offset:45056
    ds_read_b64_tr_b16 a[198:199], v8 offset:47104
    v_mfma_f32_16x16x32_bf16 v[72:75], a[212:215], a[172:175], v[72:75]
    v_mfma_f32_16x16x32_bf16 v[72:75], a[208:211], a[168:171], v[72:75]
    v_mfma_f32_16x16x32_bf16 v[80:83], a[208:211], a[176:179], v[80:83]
    buffer_load_dwordx4 v3, s[68:71], s47 offen offset:3072 lds
    v_mfma_f32_16x16x32_bf16 v[80:83], a[212:215], a[180:183], v[80:83]
    s_add_u32 m0, s40, 4096
    v_cvt_pk_bf16_f32 v32, v32, v33
    v_cvt_pk_bf16_f32 v33, v34, v35
    v_mfma_f32_16x16x32_bf16 v[88:91], a[212:215], a[188:191], v[88:91]
    v_cvt_pk_bf16_f32 v34, v36, v37
    v_cvt_pk_bf16_f32 v35, v38, v39
    v_mfma_f32_16x16x32_bf16 v[88:91], a[208:211], a[184:187], v[88:91]
    s_waitcnt lgkmcnt(4)
    v_mfma_f32_16x16x32_bf16 v[92:95], a[216:219], a[184:187], v[92:95]
    ds_read_b64_tr_b16 a[200:201], v9 offset:40960
    ds_read_b64_tr_b16 a[202:203], v9 offset:43008
    v_mfma_f32_16x16x32_bf16 v[92:95], a[220:223], a[188:191], v[92:95]
    ds_read_b64_tr_b16 a[204:205], v9 offset:45056
    ds_read_b64_tr_b16 a[206:207], v9 offset:47104
    v_mfma_f32_16x16x32_bf16 v[84:87], a[220:223], a[180:183], v[84:87]
    buffer_load_dwordx4 v3, s[68:71], s48 offen offset:0 lds
    v_mfma_f32_16x16x32_bf16 v[84:87], a[216:219], a[176:179], v[84:87]
    buffer_store_dwordx4 v[32:35], v2, s[16:19], s32 offen offset:0
    v_mfma_f32_16x16x32_bf16 v[76:79], a[216:219], a[168:171], v[76:79]
    v_mfma_f32_16x16x32_bf16 v[76:79], a[220:223], a[172:175], v[76:79]
    v_mfma_f32_16x16x32_bf16 v[68:71], a[220:223], a[164:167], v[68:71]
    v_cvt_pk_bf16_f32 v36, v40, v41
    v_cvt_pk_bf16_f32 v37, v42, v43
    v_mfma_f32_16x16x32_bf16 v[68:71], a[216:219], a[160:163], v[68:71]
    s_waitcnt lgkmcnt(4)
    v_cvt_pk_bf16_f32 v38, v44, v45
    v_cvt_pk_bf16_f32 v39, v46, v47
    v_mfma_f32_16x16x32_bf16 v[96:99], a[192:195], a[160:163], v[96:99]
    ds_read_b64_tr_b16 a[208:209], v10 offset:40960
    ds_read_b64_tr_b16 a[210:211], v10 offset:43008
    v_mfma_f32_16x16x32_bf16 v[96:99], a[196:199], a[164:167], v[96:99]
    ds_read_b64_tr_b16 a[212:213], v10 offset:45056
    ds_read_b64_tr_b16 a[214:215], v10 offset:47104
    v_mfma_f32_16x16x32_bf16 v[104:107], a[196:199], a[172:175], v[104:107]
    buffer_load_dwordx4 v3, s[68:71], s49 offen offset:1024 lds
    v_mfma_f32_16x16x32_bf16 v[104:107], a[192:195], a[168:171], v[104:107]
    buffer_store_dwordx4 v[36:39], v2, s[16:19], s33 offen offset:0
    v_mfma_f32_16x16x32_bf16 v[112:115], a[192:195], a[176:179], v[112:115]
    v_mfma_f32_16x16x32_bf16 v[112:115], a[196:199], a[180:183], v[112:115]
    v_mfma_f32_16x16x32_bf16 v[120:123], a[196:199], a[188:191], v[120:123]
    buffer_load_dwordx4 v3, s[68:71], s50 offen offset:2048 lds
    v_mfma_f32_16x16x32_bf16 v[120:123], a[192:195], a[184:187], v[120:123]
    s_waitcnt lgkmcnt(4)
    v_mfma_f32_16x16x32_bf16 v[124:127], a[200:203], a[184:187], v[124:127]
    ds_read_b64_tr_b16 a[216:217], v11 offset:40960
    ds_read_b64_tr_b16 a[218:219], v11 offset:43008
    v_mfma_f32_16x16x32_bf16 v[124:127], a[204:207], a[188:191], v[124:127]
    ds_read_b64_tr_b16 a[220:221], v11 offset:45056
    ds_read_b64_tr_b16 a[222:223], v11 offset:47104
    v_mfma_f32_16x16x32_bf16 v[116:119], a[204:207], a[180:183], v[116:119]
    v_cvt_pk_bf16_f32 v40, v48, v49
    v_cvt_pk_bf16_f32 v41, v50, v51
    v_mfma_f32_16x16x32_bf16 v[116:119], a[200:203], a[176:179], v[116:119]
    v_cvt_pk_bf16_f32 v42, v52, v53
    v_cvt_pk_bf16_f32 v43, v54, v55
    v_mfma_f32_16x16x32_bf16 v[108:111], a[200:203], a[168:171], v[108:111]
    buffer_load_dwordx4 v3, s[68:71], s51 offen offset:3072 lds
    v_mfma_f32_16x16x32_bf16 v[108:111], a[204:207], a[172:175], v[108:111]
    v_add_u32 v3, 1048576, v3
    v_mfma_f32_16x16x32_bf16 v[100:103], a[204:207], a[164:167], v[100:103]
    buffer_store_dwordx4 v[40:43], v2, s[16:19], s34 offen offset:0
    v_mfma_f32_16x16x32_bf16 v[100:103], a[200:203], a[160:163], v[100:103]
    s_waitcnt lgkmcnt(4)
    v_mfma_f32_16x16x32_bf16 v[128:131], a[208:211], a[160:163], v[128:131]
    ds_read_b64_tr_b16 a[192:193], v8 offset:49152
    ds_read_b64_tr_b16 a[194:195], v8 offset:51200
    v_mfma_f32_16x16x32_bf16 v[128:131], a[212:215], a[164:167], v[128:131]
    ds_read_b64_tr_b16 a[196:197], v8 offset:53248
    ds_read_b64_tr_b16 a[198:199], v8 offset:55296
    v_mfma_f32_16x16x32_bf16 v[136:139], a[212:215], a[172:175], v[136:139]
    buffer_load_dwordx4 a[128:131], v2, s[72:75], s52 offen offset:2048 sc1
    v_mfma_f32_16x16x32_bf16 v[136:139], a[208:211], a[168:171], v[136:139]
    v_cvt_pk_bf16_f32 v44, v56, v57
    v_cvt_pk_bf16_f32 v45, v58, v59
    v_mfma_f32_16x16x32_bf16 v[144:147], a[208:211], a[176:179], v[144:147]
    v_cvt_pk_bf16_f32 v46, v60, v61
    v_cvt_pk_bf16_f32 v47, v62, v63
    v_mfma_f32_16x16x32_bf16 v[144:147], a[212:215], a[180:183], v[144:147]
    buffer_store_dwordx4 v[44:47], v2, s[16:19], s35 offen offset:0
    v_mfma_f32_16x16x32_bf16 v[152:155], a[212:215], a[188:191], v[152:155]
    v_mfma_f32_16x16x32_bf16 v[152:155], a[208:211], a[184:187], v[152:155]
    s_waitcnt lgkmcnt(4)
    v_mfma_f32_16x16x32_bf16 v[156:159], a[216:219], a[184:187], v[156:159]
    ds_read_b64_tr_b16 a[200:201], v9 offset:49152
    ds_read_b64_tr_b16 a[202:203], v9 offset:51200
    v_mfma_f32_16x16x32_bf16 v[156:159], a[220:223], a[188:191], v[156:159]
    ds_read_b64_tr_b16 a[204:205], v9 offset:53248
    ds_read_b64_tr_b16 a[206:207], v9 offset:55296
    v_mfma_f32_16x16x32_bf16 v[148:151], a[220:223], a[180:183], v[148:151]
    buffer_load_dwordx4 a[132:135], v2, s[72:75], s52 offen offset:3072 sc1
    v_mfma_f32_16x16x32_bf16 v[148:151], a[216:219], a[176:179], v[148:151]
    v_mfma_f32_16x16x32_bf16 v[140:143], a[216:219], a[168:171], v[140:143]
    v_cvt_pk_bf16_f32 v48, v64, v65
    v_cvt_pk_bf16_f32 v49, v66, v67
    v_mfma_f32_16x16x32_bf16 v[140:143], a[220:223], a[172:175], v[140:143]
    v_cvt_pk_bf16_f32 v50, v68, v69
    v_cvt_pk_bf16_f32 v51, v70, v71
    v_mfma_f32_16x16x32_bf16 v[132:135], a[220:223], a[164:167], v[132:135]
    buffer_load_dwordx4 a[136:139], v2, s[72:75], s53 offen offset:2048 sc1
    v_mfma_f32_16x16x32_bf16 v[132:135], a[216:219], a[160:163], v[132:135]
    s_waitcnt lgkmcnt(4)
    v_mfma_f32_16x16x32_bf16 v[160:163], a[160:163], a[192:195], v[160:163]
    ds_read_b64_tr_b16 a[208:209], v10 offset:49152
    ds_read_b64_tr_b16 a[210:211], v10 offset:51200
    v_mfma_f32_16x16x32_bf16 v[160:163], a[164:167], a[196:199], v[160:163]
    ds_read_b64_tr_b16 a[212:213], v10 offset:53248
    ds_read_b64_tr_b16 a[214:215], v10 offset:55296
    v_mfma_f32_16x16x32_bf16 v[164:167], a[172:175], a[196:199], v[164:167]
    buffer_store_dwordx4 v[48:51], v2, s[16:19], s32 offen offset:1024
    v_mfma_f32_16x16x32_bf16 v[164:167], a[168:171], a[192:195], v[164:167]
    v_mfma_f32_16x16x32_bf16 v[168:171], a[176:179], a[192:195], v[168:171]
    buffer_load_dwordx4 a[140:143], v2, s[72:75], s53 offen offset:3072 sc1
    v_mfma_f32_16x16x32_bf16 v[168:171], a[180:183], a[196:199], v[168:171]
    v_mfma_f32_16x16x32_bf16 v[172:175], a[188:191], a[196:199], v[172:175]
    v_cvt_pk_bf16_f32 v52, v72, v73
    v_cvt_pk_bf16_f32 v53, v74, v75
    v_mfma_f32_16x16x32_bf16 v[172:175], a[184:187], a[192:195], v[172:175]
    s_waitcnt lgkmcnt(4)
    v_cvt_pk_bf16_f32 v54, v76, v77
    v_cvt_pk_bf16_f32 v55, v78, v79
    v_mfma_f32_16x16x32_bf16 v[188:191], a[184:187], a[200:203], v[188:191]
    ds_read_b64_tr_b16 a[216:217], v11 offset:49152
    ds_read_b64_tr_b16 a[218:219], v11 offset:51200
    v_mfma_f32_16x16x32_bf16 v[188:191], a[188:191], a[204:207], v[188:191]
    ds_read_b64_tr_b16 a[220:221], v11 offset:53248
    ds_read_b64_tr_b16 a[222:223], v11 offset:55296
    v_mfma_f32_16x16x32_bf16 v[184:187], a[180:183], a[204:207], v[184:187]
    buffer_load_dwordx4 a[144:147], v2, s[72:75], s54 offen offset:2048 sc1
    v_mfma_f32_16x16x32_bf16 v[184:187], a[176:179], a[200:203], v[184:187]
    buffer_store_dwordx4 v[52:55], v2, s[16:19], s33 offen offset:1024
    v_mfma_f32_16x16x32_bf16 v[180:183], a[168:171], a[200:203], v[180:183]
    v_mfma_f32_16x16x32_bf16 v[180:183], a[172:175], a[204:207], v[180:183]
    v_mfma_f32_16x16x32_bf16 v[176:179], a[164:167], a[204:207], v[176:179]
    v_mfma_f32_16x16x32_bf16 v[176:179], a[160:163], a[200:203], v[176:179]
    s_waitcnt lgkmcnt(4)
    v_mfma_f32_16x16x32_bf16 v[192:195], a[160:163], a[208:211], v[192:195]
    ds_read_b64_tr_b16 a[192:193], v8 offset:57344
    ds_read_b64_tr_b16 a[194:195], v8 offset:59392
    v_mfma_f32_16x16x32_bf16 v[192:195], a[164:167], a[212:215], v[192:195]
    ds_read_b64_tr_b16 a[196:197], v8 offset:61440
    ds_read_b64_tr_b16 a[198:199], v8 offset:63488
    v_mfma_f32_16x16x32_bf16 v[196:199], a[172:175], a[212:215], v[196:199]
    buffer_load_dwordx4 a[148:151], v2, s[72:75], s54 offen offset:3072 sc1
    v_mfma_f32_16x16x32_bf16 v[196:199], a[168:171], a[208:211], v[196:199]
    v_cvt_pk_bf16_f32 v56, v80, v81
    v_cvt_pk_bf16_f32 v57, v82, v83
    v_mfma_f32_16x16x32_bf16 v[200:203], a[176:179], a[208:211], v[200:203]
    v_cvt_pk_bf16_f32 v58, v84, v85
    v_cvt_pk_bf16_f32 v59, v86, v87
    v_mfma_f32_16x16x32_bf16 v[200:203], a[180:183], a[212:215], v[200:203]
    buffer_store_dwordx4 v[56:59], v2, s[16:19], s34 offen offset:1024
    v_mfma_f32_16x16x32_bf16 v[204:207], a[188:191], a[212:215], v[204:207]
    buffer_load_dwordx4 a[152:155], v2, s[72:75], s55 offen offset:2048 sc1
    v_mfma_f32_16x16x32_bf16 v[204:207], a[184:187], a[208:211], v[204:207]
    s_waitcnt lgkmcnt(4)
    v_mfma_f32_16x16x32_bf16 v[220:223], a[184:187], a[216:219], v[220:223]
    ds_read_b64_tr_b16 a[200:201], v9 offset:57344
    ds_read_b64_tr_b16 a[202:203], v9 offset:59392
    v_mfma_f32_16x16x32_bf16 v[220:223], a[188:191], a[220:223], v[220:223]
    ds_read_b64_tr_b16 a[204:205], v9 offset:61440
    ds_read_b64_tr_b16 a[206:207], v9 offset:63488
    v_mfma_f32_16x16x32_bf16 v[216:219], a[180:183], a[220:223], v[216:219]
    v_cvt_pk_bf16_f32 v60, v88, v89
    v_cvt_pk_bf16_f32 v61, v90, v91
    v_mfma_f32_16x16x32_bf16 v[216:219], a[176:179], a[216:219], v[216:219]
    v_cvt_pk_bf16_f32 v62, v92, v93
    v_cvt_pk_bf16_f32 v63, v94, v95
    v_mfma_f32_16x16x32_bf16 v[212:215], a[168:171], a[216:219], v[212:215]
    buffer_load_dwordx4 a[156:159], v2, s[72:75], s55 offen offset:3072 sc1
    v_mfma_f32_16x16x32_bf16 v[212:215], a[172:175], a[220:223], v[212:215]
    s_add_u32 s52, s52, 4096
    s_add_u32 s53, s53, 4096
    s_add_u32 s54, s54, 4096
    v_mfma_f32_16x16x32_bf16 v[208:211], a[164:167], a[220:223], v[208:211]
    s_add_u32 s55, s55, 4096
    v_mfma_f32_16x16x32_bf16 v[208:211], a[160:163], a[216:219], v[208:211]
    s_waitcnt lgkmcnt(4)
    v_mfma_f32_16x16x32_bf16 v[224:227], a[160:163], a[192:195], v[224:227]
    ds_read_b64_tr_b16 a[208:209], v10 offset:57344
    ds_read_b64_tr_b16 a[210:211], v10 offset:59392
    v_mfma_f32_16x16x32_bf16 v[224:227], a[164:167], a[196:199], v[224:227]
    ds_read_b64_tr_b16 a[212:213], v10 offset:61440
    ds_read_b64_tr_b16 a[214:215], v10 offset:63488
    v_mfma_f32_16x16x32_bf16 v[228:231], a[172:175], a[196:199], v[228:231]
    buffer_store_dwordx4 v[60:63], v2, s[16:19], s35 offen offset:1024
    v_mfma_f32_16x16x32_bf16 v[228:231], a[168:171], a[192:195], v[228:231]
    v_cvt_pk_bf16_f32 v64, v96, v97
    v_cvt_pk_bf16_f32 v65, v98, v99
    v_mfma_f32_16x16x32_bf16 v[232:235], a[176:179], a[192:195], v[232:235]
    v_cvt_pk_bf16_f32 v66, v100, v101
    v_cvt_pk_bf16_f32 v67, v102, v103
    v_mfma_f32_16x16x32_bf16 v[232:235], a[180:183], a[196:199], v[232:235]
    v_cvt_pk_bf16_f32 v68, v104, v105
    v_cvt_pk_bf16_f32 v69, v106, v107
    v_mfma_f32_16x16x32_bf16 v[236:239], a[188:191], a[196:199], v[236:239]
    v_cvt_pk_bf16_f32 v70, v108, v109
    v_cvt_pk_bf16_f32 v71, v110, v111
    v_mfma_f32_16x16x32_bf16 v[236:239], a[184:187], a[192:195], v[236:239]
    s_waitcnt lgkmcnt(4)
    v_cvt_pk_bf16_f32 v72, v112, v113
    v_cvt_pk_bf16_f32 v73, v114, v115
    v_mfma_f32_16x16x32_bf16 v[252:255], a[184:187], a[200:203], v[252:255]
    ds_read_b64_tr_b16 a[216:217], v11 offset:57344
    ds_read_b64_tr_b16 a[218:219], v11 offset:59392
    v_mfma_f32_16x16x32_bf16 v[252:255], a[188:191], a[204:207], v[252:255]
    ds_read_b64_tr_b16 a[220:221], v11 offset:61440
    ds_read_b64_tr_b16 a[222:223], v11 offset:63488
    v_mfma_f32_16x16x32_bf16 v[248:251], a[180:183], a[204:207], v[248:251]
    v_cvt_pk_bf16_f32 v74, v116, v117
    v_cvt_pk_bf16_f32 v75, v118, v119
    v_mfma_f32_16x16x32_bf16 v[248:251], a[176:179], a[200:203], v[248:251]
    v_cvt_pk_bf16_f32 v76, v120, v121
    v_cvt_pk_bf16_f32 v77, v122, v123
    v_mfma_f32_16x16x32_bf16 v[244:247], a[168:171], a[200:203], v[244:247]
    v_cvt_pk_bf16_f32 v78, v124, v125
    v_cvt_pk_bf16_f32 v79, v126, v127
    v_mfma_f32_16x16x32_bf16 v[244:247], a[172:175], a[204:207], v[244:247]
    v_cvt_pk_bf16_f32 v80, v128, v129
    v_cvt_pk_bf16_f32 v81, v130, v131
    v_mfma_f32_16x16x32_bf16 v[240:243], a[164:167], a[204:207], v[240:243]
    v_cvt_pk_bf16_f32 v82, v132, v133
    v_cvt_pk_bf16_f32 v83, v134, v135
    v_mfma_f32_16x16x32_bf16 v[240:243], a[160:163], a[200:203], v[240:243]
    s_waitcnt lgkmcnt(4)
    v_cvt_pk_bf16_f32 v84, v136, v137
    v_cvt_pk_bf16_f32 v85, v138, v139
    v_mfma_f32_16x16x32_bf16 a[0:3], a[160:163], a[208:211], a[0:3]
    s_waitcnt vmcnt(40) lgkmcnt(0)
    v_cvt_pk_bf16_f32 v86, v140, v141
    v_cvt_pk_bf16_f32 v87, v142, v143
    v_mfma_f32_16x16x32_bf16 a[0:3], a[164:167], a[212:215], a[0:3]
    s_barrier
    v_mfma_f32_16x16x32_bf16 a[4:7], a[172:175], a[212:215], a[4:7]
    ds_read_b64_tr_b16 a[192:193], v24 offset:0
    ds_read_b64_tr_b16 a[194:195], v24 offset:2048
    v_mfma_f32_16x16x32_bf16 a[4:7], a[168:171], a[208:211], a[4:7]
    ds_read_b64_tr_b16 a[196:197], v24 offset:4096
    ds_read_b64_tr_b16 a[198:199], v24 offset:6144
    v_mfma_f32_16x16x32_bf16 a[8:11], a[176:179], a[208:211], a[8:11]
    ds_read_b64_tr_b16 a[200:201], v25 offset:0
    ds_read_b64_tr_b16 a[202:203], v25 offset:2048
    v_mfma_f32_16x16x32_bf16 a[8:11], a[180:183], a[212:215], a[8:11]
    ds_read_b64_tr_b16 a[204:205], v25 offset:4096
    ds_read_b64_tr_b16 a[206:207], v25 offset:6144
    v_mfma_f32_16x16x32_bf16 a[12:15], a[188:191], a[212:215], a[12:15]
    v_cvt_pk_bf16_f32 v88, v144, v145
    v_cvt_pk_bf16_f32 v89, v146, v147
    v_mfma_f32_16x16x32_bf16 a[12:15], a[184:187], a[208:211], a[12:15]
    v_cvt_pk_bf16_f32 v90, v148, v149
    v_cvt_pk_bf16_f32 v91, v150, v151
    v_mfma_f32_16x16x32_bf16 a[28:31], a[184:187], a[216:219], a[28:31]
    v_cvt_pk_bf16_f32 v92, v152, v153
    v_cvt_pk_bf16_f32 v93, v154, v155
    v_mfma_f32_16x16x32_bf16 a[28:31], a[188:191], a[220:223], a[28:31]
    v_cvt_pk_bf16_f32 v94, v156, v157
    v_cvt_pk_bf16_f32 v95, v158, v159
    v_mfma_f32_16x16x32_bf16 a[24:27], a[180:183], a[220:223], a[24:27]
    v_mfma_f32_16x16x32_bf16 a[24:27], a[176:179], a[216:219], a[24:27]
    v_mfma_f32_16x16x32_bf16 a[20:23], a[168:171], a[216:219], a[20:23]
    v_mfma_f32_16x16x32_bf16 a[20:23], a[172:175], a[220:223], a[20:23]
    v_mfma_f32_16x16x32_bf16 a[16:19], a[164:167], a[220:223], a[16:19]
    v_mfma_f32_16x16x32_bf16 a[16:19], a[160:163], a[216:219], a[16:19]
    s_waitcnt lgkmcnt(4)
KA_q0:
    v_mfma_f32_16x16x32_bf16 v[128:131], a[192:195], a[32:35], 0
    ds_read_b64_tr_b16 a[208:209], v26 offset:0
    ds_read_b64_tr_b16 a[210:211], v26 offset:2048
    v_mfma_f32_16x16x32_bf16 v[128:131], a[196:199], a[36:39], v[128:131]
    ds_read_b64_tr_b16 a[212:213], v26 offset:4096
    ds_read_b64_tr_b16 a[214:215], v26 offset:6144
    v_mfma_f32_16x16x32_bf16 v[132:135], a[196:199], a[44:47], 0
    buffer_load_dwordx4 a[160:163], v2, s[72:75], s52 offen offset:0 sc1
    v_mfma_f32_16x16x32_bf16 v[132:135], a[192:195], a[40:43], v[132:135]
    v_cvt_pk_bf16_f32 v96, v160, v161
    v_cvt_pk_bf16_f32 v97, v162, v163
    v_mfma_f32_16x16x32_bf16 v[136:139], a[192:195], a[48:51], 0
    v_cvt_pk_bf16_f32 v98, v164, v165
    v_cvt_pk_bf16_f32 v99, v166, v167
    v_mfma_f32_16x16x32_bf16 v[136:139], a[196:199], a[52:55], v[136:139]
    v_cvt_pk_bf16_f32 v100, v168, v169
    v_cvt_pk_bf16_f32 v101, v170, v171
    v_mfma_f32_16x16x32_bf16 v[140:143], a[196:199], a[60:63], 0
    buffer_load_dwordx4 a[164:167], v2, s[72:75], s52 offen offset:1024 sc1
    v_mfma_f32_16x16x32_bf16 v[140:143], a[192:195], a[56:59], v[140:143]
    s_waitcnt lgkmcnt(4)
    v_cvt_pk_bf16_f32 v102, v172, v173
    v_cvt_pk_bf16_f32 v103, v174, v175
    v_mfma_f32_16x16x32_bf16 v[156:159], a[200:203], a[56:59], 0
    ds_read_b64_tr_b16 a[216:217], v27 offset:0
    ds_read_b64_tr_b16 a[218:219], v27 offset:2048
    v_mfma_f32_16x16x32_bf16 v[156:159], a[204:207], a[60:63], v[156:159]
    ds_read_b64_tr_b16 a[220:221], v27 offset:4096
    ds_read_b64_tr_b16 a[222:223], v27 offset:6144
    v_mfma_f32_16x16x32_bf16 v[152:155], a[204:207], a[52:55], 0
    v_cvt_pk_bf16_f32 v104, v176, v177
    v_cvt_pk_bf16_f32 v105, v178, v179
    v_mfma_f32_16x16x32_bf16 v[152:155], a[200:203], a[48:51], v[152:155]
    buffer_store_dwordx4 v[64:67], v2, s[16:19], s32 offen offset:2048
    v_mfma_f32_16x16x32_bf16 v[148:151], a[200:203], a[40:43], 0
    v_cvt_pk_bf16_f32 v106, v180, v181
    v_cvt_pk_bf16_f32 v107, v182, v183
    v_mfma_f32_16x16x32_bf16 v[148:151], a[204:207], a[44:47], v[148:151]
    v_cvt_pk_bf16_f32 v108, v184, v185
    v_cvt_pk_bf16_f32 v109, v186, v187
    v_mfma_f32_16x16x32_bf16 v[144:147], a[204:207], a[36:39], 0
    v_cvt_pk_bf16_f32 v110, v188, v189
    v_cvt_pk_bf16_f32 v111, v190, v191
    v_mfma_f32_16x16x32_bf16 v[144:147], a[200:203], a[32:35], v[144:147]
    s_waitcnt lgkmcnt(4)
    v_cvt_pk_bf16_f32 v112, v192, v193
    v_cvt_pk_bf16_f32 v113, v194, v195
    v_mfma_f32_16x16x32_bf16 v[160:163], a[208:211], a[32:35], 0
    ds_read_b64_tr_b16 a[192:193], v24 offset:8192
    ds_read_b64_tr_b16 a[194:195], v24 offset:10240
    v_mfma_f32_16x16x32_bf16 v[160:163], a[212:215], a[36:39], v[160:163]
    ds_read_b64_tr_b16 a[196:197], v24 offset:12288
    ds_read_b64_tr_b16 a[198:199], v24 offset:14336
    v_mfma_f32_16x16x32_bf16 v[164:167], a[212:215], a[44:47], 0
    buffer_load_dwordx4 a[168:171], v2, s[72:75], s53 offen offset:0 sc1
    v_mfma_f32_16x16x32_bf16 v[164:167], a[208:211], a[40:43], v[164:167]
    v_cvt_pk_bf16_f32 v114, v196, v197
    v_cvt_pk_bf16_f32 v115, v198, v199
    v_mfma_f32_16x16x32_bf16 v[168:171], a[208:211], a[48:51], 0
    v_cvt_pk_bf16_f32 v116, v200, v201
    v_cvt_pk_bf16_f32 v117, v202, v203
    v_mfma_f32_16x16x32_bf16 v[168:171], a[212:215], a[52:55], v[168:171]
    buffer_load_dwordx4 a[172:175], v2, s[72:75], s53 offen offset:1024 sc1
    v_mfma_f32_16x16x32_bf16 v[172:175], a[212:215], a[60:63], 0
    v_cvt_pk_bf16_f32 v118, v204, v205
    v_cvt_pk_bf16_f32 v119, v206, v207
    v_mfma_f32_16x16x32_bf16 v[172:175], a[208:211], a[56:59], v[172:175]
    s_waitcnt lgkmcnt(4)
    v_cvt_pk_bf16_f32 v120, v208, v209
    v_cvt_pk_bf16_f32 v121, v210, v211
    v_mfma_f32_16x16x32_bf16 v[188:191], a[216:219], a[56:59], 0
    ds_read_b64_tr_b16 a[200:201], v25 offset:8192
    ds_read_b64_tr_b16 a[202:203], v25 offset:10240
    v_mfma_f32_16x16x32_bf16 v[188:191], a[220:223], a[60:63], v[188:191]
    ds_read_b64_tr_b16 a[204:205], v25 offset:12288
    ds_read_b64_tr_b16 a[206:207], v25 offset:14336
    v_mfma_f32_16x16x32_bf16 v[184:187], a[220:223], a[52:55], 0
    buffer_store_dwordx4 v[68:71], v2, s[16:19], s33 offen offset:2048
    v_mfma_f32_16x16x32_bf16 v[184:187], a[216:219], a[48:51], v[184:187]
    v_cvt_pk_bf16_f32 v122, v212, v213
    v_cvt_pk_bf16_f32 v123, v214, v215
    v_mfma_f32_16x16x32_bf16 v[180:183], a[216:219], a[40:43], 0
    v_cvt_pk_bf16_f32 v124, v216, v217
    v_cvt_pk_bf16_f32 v125, v218, v219
    v_mfma_f32_16x16x32_bf16 v[180:183], a[220:223], a[44:47], v[180:183]
    v_cvt_pk_bf16_f32 v126, v220, v221
    v_cvt_pk_bf16_f32 v127, v222, v223
    v_mfma_f32_16x16x32_bf16 v[176:179], a[220:223], a[36:39], 0
    buffer_load_dwordx4 a[176:179], v2, s[72:75], s54 offen offset:0 sc1
    v_mfma_f32_16x16x32_bf16 v[176:179], a[216:219], a[32:35], v[176:179]
    s_waitcnt lgkmcnt(4)
    v_cvt_pk_bf16_f32 v32, v224, v225
    v_cvt_pk_bf16_f32 v33, v226, v227
    v_mfma_f32_16x16x32_bf16 v[192:195], a[192:195], a[32:35], 0
    ds_read_b64_tr_b16 a[208:209], v26 offset:8192
    ds_read_b64_tr_b16 a[210:211], v26 offset:10240
    v_mfma_f32_16x16x32_bf16 v[192:195], a[196:199], a[36:39], v[192:195]
    ds_read_b64_tr_b16 a[212:213], v26 offset:12288
    ds_read_b64_tr_b16 a[214:215], v26 offset:14336
    v_mfma_f32_16x16x32_bf16 v[196:199], a[196:199], a[44:47], 0
    v_cvt_pk_bf16_f32 v34, v228, v229
    v_cvt_pk_bf16_f32 v35, v230, v231
    v_mfma_f32_16x16x32_bf16 v[196:199], a[192:195], a[40:43], v[196:199]
    buffer_load_dwordx4 a[180:183], v2, s[72:75], s54 offen offset:1024 sc1
    v_mfma_f32_16x16x32_bf16 v[200:203], a[192:195], a[48:51], 0
    v_cvt_pk_bf16_f32 v36, v232, v233
    v_cvt_pk_bf16_f32 v37, v234, v235
    v_mfma_f32_16x16x32_bf16 v[200:203], a[196:199], a[52:55], v[200:203]
    v_cvt_pk_bf16_f32 v38, v236, v237
    v_cvt_pk_bf16_f32 v39, v238, v239
    v_mfma_f32_16x16x32_bf16 v[204:207], a[196:199], a[60:63], 0
    v_cvt_pk_bf16_f32 v40, v240, v241
    v_cvt_pk_bf16_f32 v41, v242, v243
    v_mfma_f32_16x16x32_bf16 v[204:207], a[192:195], a[56:59], v[204:207]
    s_waitcnt lgkmcnt(4)
    v_cvt_pk_bf16_f32 v42, v244, v245
    v_cvt_pk_bf16_f32 v43, v246, v247
    v_mfma_f32_16x16x32_bf16 v[220:223], a[200:203], a[56:59], 0
    ds_read_b64_tr_b16 a[216:217], v27 offset:8192
    ds_read_b64_tr_b16 a[218:219], v27 offset:10240
    v_mfma_f32_16x16x32_bf16 v[220:223], a[204:207], a[60:63], v[220:223]
    ds_read_b64_tr_b16 a[220:221], v27 offset:12288
    ds_read_b64_tr_b16 a[222:223], v27 offset:14336
    v_mfma_f32_16x16x32_bf16 v[216:219], a[204:207], a[52:55], 0
    buffer_store_dwordx4 v[72:75], v2, s[16:19], s34 offen offset:2048
    v_mfma_f32_16x16x32_bf16 v[216:219], a[200:203], a[48:51], v[216:219]
    v_cvt_pk_bf16_f32 v44, v248, v249
    v_cvt_pk_bf16_f32 v45, v250, v251
    v_mfma_f32_16x16x32_bf16 v[212:215], a[200:203], a[40:43], 0
    buffer_load_dwordx4 a[184:187], v2, s[72:75], s55 offen offset:0 sc1
    v_mfma_f32_16x16x32_bf16 v[212:215], a[204:207], a[44:47], v[212:215]
    v_cvt_pk_bf16_f32 v46, v252, v253
    v_cvt_pk_bf16_f32 v47, v254, v255
    v_mfma_f32_16x16x32_bf16 v[208:211], a[204:207], a[36:39], 0
    v_accvgpr_read_b32 v13, a0
    v_accvgpr_read_b32 v14, a1
    v_mfma_f32_16x16x32_bf16 v[208:211], a[200:203], a[32:35], v[208:211]
    s_waitcnt lgkmcnt(4)
    v_accvgpr_read_b32 v15, a2
    v_accvgpr_read_b32 v16, a3
    v_mfma_f32_16x16x32_bf16 v[224:227], a[208:211], a[32:35], 0
    ds_read_b64_tr_b16 a[192:193], v24 offset:16384
    ds_read_b64_tr_b16 a[194:195], v24 offset:18432
    v_mfma_f32_16x16x32_bf16 v[224:227], a[212:215], a[36:39], v[224:227]
    ds_read_b64_tr_b16 a[196:197], v24 offset:20480
    ds_read_b64_tr_b16 a[198:199], v24 offset:22528
    v_mfma_f32_16x16x32_bf16 v[228:231], a[212:215], a[44:47], 0
    buffer_load_dwordx4 a[188:191], v2, s[72:75], s55 offen offset:1024 sc1
    v_mfma_f32_16x16x32_bf16 v[228:231], a[208:211], a[40:43], v[228:231]
    v_cvt_pk_bf16_f32 v48, v13, v14
    v_cvt_pk_bf16_f32 v49, v15, v16
    v_mfma_f32_16x16x32_bf16 v[232:235], a[208:211], a[48:51], 0
    v_accvgpr_read_b32 v17, a4
    v_accvgpr_read_b32 v18, a5
    v_mfma_f32_16x16x32_bf16 v[232:235], a[212:215], a[52:55], v[232:235]
    v_accvgpr_read_b32 v19, a6
    v_accvgpr_read_b32 v20, a7
    v_mfma_f32_16x16x32_bf16 v[236:239], a[212:215], a[60:63], 0
    buffer_store_dwordx4 v[76:79], v2, s[16:19], s35 offen offset:2048
    v_mfma_f32_16x16x32_bf16 v[236:239], a[208:211], a[56:59], v[236:239]
    s_waitcnt vmcnt(44) lgkmcnt(4)
    v_cvt_pk_bf16_f32 v50, v17, v18
    v_cvt_pk_bf16_f32 v51, v19, v20
    v_mfma_f32_16x16x32_bf16 v[252:255], a[216:219], a[56:59], 0
    ds_read_b64_tr_b16 a[200:201], v25 offset:16384
    ds_read_b64_tr_b16 a[202:203], v25 offset:18432
    v_mfma_f32_16x16x32_bf16 v[252:255], a[220:223], a[60:63], v[252:255]
    ds_read_b64_tr_b16 a[204:205], v25 offset:20480
    ds_read_b64_tr_b16 a[206:207], v25 offset:22528
    v_mfma_f32_16x16x32_bf16 v[248:251], a[220:223], a[52:55], 0
    v_mfma_f32_16x16x32_bf16 v[248:251], a[216:219], a[48:51], v[248:251]
    v_mfma_f32_16x16x32_bf16 v[244:247], a[216:219], a[40:43], 0
    v_mfma_f32_16x16x32_bf16 v[244:247], a[220:223], a[44:47], v[244:247]
    v_mfma_f32_16x16x32_bf16 v[240:243], a[220:223], a[36:39], 0
    v_mfma_f32_16x16x32_bf16 v[240:243], a[216:219], a[32:35], v[240:243]
    s_waitcnt lgkmcnt(4)
    v_mfma_f32_16x16x32_bf16 v[128:131], a[192:195], a[64:67], v[128:131]
    ds_read_b64_tr_b16 a[208:209], v26 offset:16384
    ds_read_b64_tr_b16 a[210:211], v26 offset:18432
    v_mfma_f32_16x16x32_bf16 v[128:131], a[196:199], a[68:71], v[128:131]
    ds_read_b64_tr_b16 a[212:213], v26 offset:20480
    ds_read_b64_tr_b16 a[214:215], v26 offset:22528
    v_mfma_f32_16x16x32_bf16 v[132:135], a[196:199], a[76:79], v[132:135]
    s_add_u32 m0, s40, 32768
    v_accvgpr_read_b32 v13, a8
    v_accvgpr_read_b32 v14, a9
    v_mfma_f32_16x16x32_bf16 v[132:135], a[192:195], a[72:75], v[132:135]
    buffer_load_dwordx4 v3, s[68:71], s44 offen offset:0 lds
    v_mfma_f32_16x16x32_bf16 v[136:139], a[192:195], a[80:83], v[136:139]
    v_accvgpr_read_b32 v15, a10
    v_accvgpr_read_b32 v16, a11
    v_mfma_f32_16x16x32_bf16 v[136:139], a[196:199], a[84:87], v[136:139]
    v_cvt_pk_bf16_f32 v52, v13, v14
    v_cvt_pk_bf16_f32 v53, v15, v16
    v_mfma_f32_16x16x32_bf16 v[140:143], a[196:199], a[92:95], v[140:143]
    v_accvgpr_read_b32 v17, a12
    v_accvgpr_read_b32 v18, a13
    v_mfma_f32_16x16x32_bf16 v[140:143], a[192:195], a[88:91], v[140:143]
    s_waitcnt lgkmcnt(4)
    v_accvgpr_read_b32 v19, a14
    v_accvgpr_read_b32 v20, a15
    v_mfma_f32_16x16x32_bf16 v[156:159], a[200:203], a[88:91], v[156:159]
    ds_read_b64_tr_b16 a[216:217], v27 offset:16384
    ds_read_b64_tr_b16 a[218:219], v27 offset:18432
    v_mfma_f32_16x16x32_bf16 v[156:159], a[204:207], a[92:95], v[156:159]
    ds_read_b64_tr_b16 a[220:221], v27 offset:20480
    ds_read_b64_tr_b16 a[222:223], v27 offset:22528
    v_mfma_f32_16x16x32_bf16 v[152:155], a[204:207], a[84:87], v[152:155]
    buffer_load_dwordx4 v3, s[68:71], s45 offen offset:1024 lds
    v_mfma_f32_16x16x32_bf16 v[152:155], a[200:203], a[80:83], v[152:155]
    v_cvt_pk_bf16_f32 v54, v17, v18
    v_cvt_pk_bf16_f32 v55, v19, v20
    v_mfma_f32_16x16x32_bf16 v[148:151], a[200:203], a[72:75], v[148:151]
    buffer_load_dwordx4 v3, s[68:71], s46 offen offset:2048 lds
    v_mfma_f32_16x16x32_bf16 v[148:151], a[204:207], a[76:79], v[148:151]
    v_accvgpr_read_b32 v13, a16
    v_accvgpr_read_b32 v14, a17
    v_mfma_f32_16x16x32_bf16 v[144:147], a[204:207], a[68:71], v[144:147]
    v_accvgpr_read_b32 v15, a18
    v_accvgpr_read_b32 v16, a19
    v_mfma_f32_16x16x32_bf16 v[144:147], a[200:203], a[64:67], v[144:147]
    s_waitcnt lgkmcnt(4)
    v_cvt_pk_bf16_f32 v56, v13, v14
    v_cvt_pk_bf16_f32 v57, v15, v16
    v_mfma_f32_16x16x32_bf16 v[160:163], a[208:211], a[64:67], v[160:163]
    ds_read_b64_tr_b16 a[192:193], v24 offset:24576
    ds_read_b64_tr_b16 a[194:195], v24 offset:26624
    v_mfma_f32_16x16x32_bf16 v[160:163], a[212:215], a[68:71], v[160:163]
    ds_read_b64_tr_b16 a[196:197], v24 offset:28672
    ds_read_b64_tr_b16 a[198:199], v24 offset:30720
    v_mfma_f32_16x16x32_bf16 v[164:167], a[212:215], a[76:79], v[164:167]
    buffer_store_dwordx4 v[80:83], v2, s[16:19], s32 offen offset:3072
    v_mfma_f32_16x16x32_bf16 v[164:167], a[208:211], a[72:75], v[164:167]
    v_accvgpr_read_b32 v17, a20
    v_accvgpr_read_b32 v18, a21
    v_mfma_f32_16x16x32_bf16 v[168:171], a[208:211], a[80:83], v[168:171]
    v_accvgpr_read_b32 v19, a22
    v_accvgpr_read_b32 v20, a23
    v_mfma_f32_16x16x32_bf16 v[168:171], a[212:215], a[84:87], v[168:171]
    v_cvt_pk_bf16_f32 v58, v17, v18
    v_cvt_pk_bf16_f32 v59, v19, v20
    v_mfma_f32_16x16x32_bf16 v[172:175], a[212:215], a[92:95], v[172:175]
    buffer_load_dwordx4 v3, s[68:71], s47 offen offset:3072 lds
    v_mfma_f32_16x16x32_bf16 v[172:175], a[208:211], a[88:91], v[172:175]
    s_waitcnt lgkmcnt(4)
    s_add_u32 m0, s40, 36864
    v_accvgpr_read_b32 v13, a24
    v_mfma_f32_16x16x32_bf16 v[188:191], a[216:219], a[88:91], v[188:191]
    ds_read_b64_tr_b16 a[200:201], v25 offset:24576
    ds_read_b64_tr_b16 a[202:203], v25 offset:26624
    v_mfma_f32_16x16x32_bf16 v[188:191], a[220:223], a[92:95], v[188:191]
    ds_read_b64_tr_b16 a[204:205], v25 offset:28672
    ds_read_b64_tr_b16 a[206:207], v25 offset:30720
    v_mfma_f32_16x16x32_bf16 v[184:187], a[220:223], a[84:87], v[184:187]
    v_accvgpr_read_b32 v14, a25
    v_accvgpr_read_b32 v15, a26
    v_mfma_f32_16x16x32_bf16 v[184:187], a[216:219], a[80:83], v[184:187]
    buffer_load_dwordx4 v3, s[68:71], s48 offen offset:0 lds
    v_mfma_f32_16x16x32_bf16 v[180:183], a[216:219], a[72:75], v[180:183]
    v_accvgpr_read_b32 v16, a27
    v_cvt_pk_bf16_f32 v60, v13, v14
    v_mfma_f32_16x16x32_bf16 v[180:183], a[220:223], a[76:79], v[180:183]
    v_cvt_pk_bf16_f32 v61, v15, v16
    v_accvgpr_read_b32 v17, a28
    v_mfma_f32_16x16x32_bf16 v[176:179], a[220:223], a[68:71], v[176:179]
    v_accvgpr_read_b32 v18, a29
    v_accvgpr_read_b32 v19, a30
    v_mfma_f32_16x16x32_bf16 v[176:179], a[216:219], a[64:67], v[176:179]
    s_waitcnt lgkmcnt(4)
    v_accvgpr_read_b32 v20, a31
    v_cvt_pk_bf16_f32 v62, v17, v18
    v_mfma_f32_16x16x32_bf16 v[192:195], a[192:195], a[64:67], v[192:195]
    ds_read_b64_tr_b16 a[208:209], v26 offset:24576
    ds_read_b64_tr_b16 a[210:211], v26 offset:26624
    v_mfma_f32_16x16x32_bf16 v[192:195], a[196:199], a[68:71], v[192:195]
    ds_read_b64_tr_b16 a[212:213], v26 offset:28672
    ds_read_b64_tr_b16 a[214:215], v26 offset:30720
    v_mfma_f32_16x16x32_bf16 v[196:199], a[196:199], a[76:79], v[196:199]
    buffer_load_dwordx4 v3, s[68:71], s49 offen offset:1024 lds
    v_mfma_f32_16x16x32_bf16 v[196:199], a[192:195], a[72:75], v[196:199]
    v_cvt_pk_bf16_f32 v63, v19, v20
    v_mfma_f32_16x16x32_bf16 v[200:203], a[192:195], a[80:83], v[200:203]
    v_mfma_f32_16x16x32_bf16 v[200:203], a[196:199], a[84:87], v[200:203]
    v_mfma_f32_16x16x32_bf16 v[204:207], a[196:199], a[92:95], v[204:207]
    buffer_store_dwordx4 v[84:87], v2, s[16:19], s33 offen offset:3072
    v_mfma_f32_16x16x32_bf16 v[204:207], a[192:195], a[88:91], v[204:207]
    s_waitcnt lgkmcnt(4)
    v_mfma_f32_16x16x32_bf16 v[220:223], a[200:203], a[88:91], v[220:223]
    ds_read_b64_tr_b16 a[216:217], v27 offset:24576
    ds_read_b64_tr_b16 a[218:219], v27 offset:26624
    v_mfma_f32_16x16x32_bf16 v[220:223], a[204:207], a[92:95], v[220:223]
    ds_read_b64_tr_b16 a[220:221], v27 offset:28672
    ds_read_b64_tr_b16 a[222:223], v27 offset:30720
    v_mfma_f32_16x16x32_bf16 v[216:219], a[204:207], a[84:87], v[216:219]
    v_mfma_f32_16x16x32_bf16 v[216:219], a[200:203], a[80:83], v[216:219]
    buffer_load_dwordx4 v3, s[68:71], s50 offen offset:2048 lds
    v_mfma_f32_16x16x32_bf16 v[212:215], a[200:203], a[72:75], v[212:215]
    v_mfma_f32_16x16x32_bf16 v[212:215], a[204:207], a[76:79], v[212:215]
    v_mfma_f32_16x16x32_bf16 v[208:211], a[204:207], a[68:71], v[208:211]
    v_mfma_f32_16x16x32_bf16 v[208:211], a[200:203], a[64:67], v[208:211]
    s_waitcnt lgkmcnt(4)
    v_mfma_f32_16x16x32_bf16 v[224:227], a[208:211], a[64:67], v[224:227]
    s_waitcnt vmcnt(35) lgkmcnt(0)
    v_mfma_f32_16x16x32_bf16 v[224:227], a[212:215], a[68:71], v[224:227]
    s_barrier
    v_mfma_f32_16x16x32_bf16 v[228:231], a[212:215], a[76:79], v[228:231]
    ds_read_b64_tr_b16 a[192:193], v8 offset:0
    ds_read_b64_tr_b16 a[194:195], v8 offset:2048
    v_mfma_f32_16x16x32_bf16 v[228:231], a[208:211], a[72:75], v[228:231]
    ds_read_b64_tr_b16 a[196:197], v8 offset:4096
    ds_read_b64_tr_b16 a[198:199], v8 offset:6144
    v_mfma_f32_16x16x32_bf16 v[232:235], a[208:211], a[80:83], v[232:235]
    buffer_load_dwordx4 v3, s[68:71], s51 offen offset:3072 lds
    v_mfma_f32_16x16x32_bf16 v[232:235], a[212:215], a[84:87], v[232:235]
    buffer_store_dwordx4 v[88:91], v2, s[16:19], s34 offen offset:3072
    v_mfma_f32_16x16x32_bf16 v[236:239], a[212:215], a[92:95], v[236:239]
    v_add_u32 v3, 1048576, v3
    v_mfma_f32_16x16x32_bf16 v[236:239], a[208:211], a[88:91], v[236:239]
    v_mfma_f32_16x16x32_bf16 v[252:255], a[216:219], a[88:91], v[252:255]
    ds_read_b64_tr_b16 a[200:201], v9 offset:0
    ds_read_b64_tr_b16 a[202:203], v9 offset:2048
    v_mfma_f32_16x16x32_bf16 v[252:255], a[220:223], a[92:95], v[252:255]
    ds_read_b64_tr_b16 a[204:205], v9 offset:4096
    ds_read_b64_tr_b16 a[206:207], v9 offset:6144
    v_mfma_f32_16x16x32_bf16 v[248:251], a[220:223], a[84:87], v[248:251]
    v_mfma_f32_16x16x32_bf16 v[248:251], a[216:219], a[80:83], v[248:251]
    v_mfma_f32_16x16x32_bf16 v[244:247], a[216:219], a[72:75], v[244:247]
    v_mfma_f32_16x16x32_bf16 v[244:247], a[220:223], a[76:79], v[244:247]
    v_mfma_f32_16x16x32_bf16 v[240:243], a[220:223], a[68:71], v[240:243]
    v_mfma_f32_16x16x32_bf16 v[240:243], a[216:219], a[64:67], v[240:243]
    s_waitcnt lgkmcnt(4)
    v_mfma_f32_16x16x32_bf16 v[128:131], a[192:195], a[96:99], v[128:131]
    ds_read_b64_tr_b16 a[208:209], v10 offset:0
    ds_read_b64_tr_b16 a[210:211], v10 offset:2048
    v_mfma_f32_16x16x32_bf16 v[128:131], a[196:199], a[100:103], v[128:131]
    ds_read_b64_tr_b16 a[212:213], v10 offset:4096
    ds_read_b64_tr_b16 a[214:215], v10 offset:6144
    v_mfma_f32_16x16x32_bf16 v[132:135], a[196:199], a[108:111], v[132:135]
    buffer_load_dwordx4 a[0:3], v2, s[72:75], s52 offen offset:2048 sc1
    v_mfma_f32_16x16x32_bf16 v[132:135], a[192:195], a[104:107], v[132:135]
    v_mfma_f32_16x16x32_bf16 v[136:139], a[192:195], a[112:115], v[136:139]
    v_mfma_f32_16x16x32_bf16 v[136:139], a[196:199], a[116:119], v[136:139]
    v_mfma_f32_16x16x32_bf16 v[140:143], a[196:199], a[124:127], v[140:143]
    v_mfma_f32_16x16x32_bf16 v[140:143], a[192:195], a[120:123], v[140:143]
    s_waitcnt lgkmcnt(4)
    v_mfma_f32_16x16x32_bf16 v[156:159], a[200:203], a[120:123], v[156:159]
    ds_read_b64_tr_b16 a[216:217], v11 offset:0
    ds_read_b64_tr_b16 a[218:219], v11 offset:2048
    v_mfma_f32_16x16x32_bf16 v[156:159], a[204:207], a[124:127], v[156:159]
    ds_read_b64_tr_b16 a[220:221], v11 offset:4096
    ds_read_b64_tr_b16 a[222:223], v11 offset:6144
    v_mfma_f32_16x16x32_bf16 v[152:155], a[204:207], a[116:119], v[152:155]
    buffer_load_dwordx4 a[4:7], v2, s[72:75], s52 offen offset:3072 sc1
    v_mfma_f32_16x16x32_bf16 v[152:155], a[200:203], a[112:115], v[152:155]
    v_mfma_f32_16x16x32_bf16 v[148:151], a[200:203], a[104:107], v[148:151]
    buffer_load_dwordx4 a[8:11], v2, s[72:75], s53 offen offset:2048 sc1
    v_mfma_f32_16x16x32_bf16 v[148:151], a[204:207], a[108:111], v[148:151]
    v_mfma_f32_16x16x32_bf16 v[144:147], a[204:207], a[100:103], v[144:147]
    v_mfma_f32_16x16x32_bf16 v[144:147], a[200:203], a[96:99], v[144:147]
    s_waitcnt lgkmcnt(4)
    v_mfma_f32_16x16x32_bf16 v[160:163], a[208:211], a[96:99], v[160:163]
    ds_read_b64_tr_b16 a[192:193], v8 offset:8192
    ds_read_b64_tr_b16 a[194:195], v8 offset:10240
    v_mfma_f32_16x16x32_bf16 v[160:163], a[212:215], a[100:103], v[160:163]
    ds_read_b64_tr_b16 a[196:197], v8 offset:12288
    ds_read_b64_tr_b16 a[198:199], v8 offset:14336
    v_mfma_f32_16x16x32_bf16 v[164:167], a[212:215], a[108:111], v[164:167]
    buffer_store_dwordx4 v[92:95], v2, s[16:19], s35 offen offset:3072
    v_mfma_f32_16x16x32_bf16 v[164:167], a[208:211], a[104:107], v[164:167]
    v_mfma_f32_16x16x32_bf16 v[168:171], a[208:211], a[112:115], v[168:171]
    v_mfma_f32_16x16x32_bf16 v[168:171], a[212:215], a[116:119], v[168:171]
    v_mfma_f32_16x16x32_bf16 v[172:175], a[212:215], a[124:127], v[172:175]
    buffer_load_dwordx4 a[12:15], v2, s[72:75], s53 offen offset:3072 sc1
    v_mfma_f32_16x16x32_bf16 v[172:175], a[208:211], a[120:123], v[172:175]
    s_waitcnt lgkmcnt(4)
    v_mfma_f32_16x16x32_bf16 v[188:191], a[216:219], a[120:123], v[188:191]
    ds_read_b64_tr_b16 a[200:201], v9 offset:8192
    ds_read_b64_tr_b16 a[202:203], v9 offset:10240
    v_mfma_f32_16x16x32_bf16 v[188:191], a[220:223], a[124:127], v[188:191]
    ds_read_b64_tr_b16 a[204:205], v9 offset:12288
    ds_read_b64_tr_b16 a[206:207], v9 offset:14336
    v_mfma_f32_16x16x32_bf16 v[184:187], a[220:223], a[116:119], v[184:187]
    v_mfma_f32_16x16x32_bf16 v[184:187], a[216:219], a[112:115], v[184:187]
    buffer_load_dwordx4 a[16:19], v2, s[72:75], s54 offen offset:2048 sc1
    v_mfma_f32_16x16x32_bf16 v[180:183], a[216:219], a[104:107], v[180:183]
    v_mfma_f32_16x16x32_bf16 v[180:183], a[220:223], a[108:111], v[180:183]
    v_mfma_f32_16x16x32_bf16 v[176:179], a[220:223], a[100:103], v[176:179]
    v_mfma_f32_16x16x32_bf16 v[176:179], a[216:219], a[96:99], v[176:179]
    s_waitcnt lgkmcnt(4)
    v_mfma_f32_16x16x32_bf16 v[192:195], a[192:195], a[96:99], v[192:195]
    ds_read_b64_tr_b16 a[208:209], v10 offset:8192
    ds_read_b64_tr_b16 a[210:211], v10 offset:10240
    v_mfma_f32_16x16x32_bf16 v[192:195], a[196:199], a[100:103], v[192:195]
    ds_read_b64_tr_b16 a[212:213], v10 offset:12288
    ds_read_b64_tr_b16 a[214:215], v10 offset:14336
    v_mfma_f32_16x16x32_bf16 v[196:199], a[196:199], a[108:111], v[196:199]
    buffer_load_dwordx4 a[20:23], v2, s[72:75], s54 offen offset:3072 sc1
    v_mfma_f32_16x16x32_bf16 v[196:199], a[192:195], a[104:107], v[196:199]
    v_mfma_f32_16x16x32_bf16 v[200:203], a[192:195], a[112:115], v[200:203]
    v_mfma_f32_16x16x32_bf16 v[200:203], a[196:199], a[116:119], v[200:203]
    v_mfma_f32_16x16x32_bf16 v[204:207], a[196:199], a[124:127], v[204:207]
    buffer_store_dwordx4 v[96:99], v2, s[20:23], s32 offen offset:0
    v_mfma_f32_16x16x32_bf16 v[204:207], a[192:195], a[120:123], v[204:207]
    s_waitcnt lgkmcnt(4)
    v_mfma_f32_16x16x32_bf16 v[220:223], a[200:203], a[120:123], v[220:223]
    ds_read_b64_tr_b16 a[216:217], v11 offset:8192
    ds_read_b64_tr_b16 a[218:219], v11 offset:10240
    v_mfma_f32_16x16x32_bf16 v[220:223], a[204:207], a[124:127], v[220:223]
    ds_read_b64_tr_b16 a[220:221], v11 offset:12288
    ds_read_b64_tr_b16 a[222:223], v11 offset:14336
    v_mfma_f32_16x16x32_bf16 v[216:219], a[204:207], a[116:119], v[216:219]
    v_mfma_f32_16x16x32_bf16 v[216:219], a[200:203], a[112:115], v[216:219]
    buffer_load_dwordx4 a[24:27], v2, s[72:75], s55 offen offset:2048 sc1
    v_mfma_f32_16x16x32_bf16 v[212:215], a[200:203], a[104:107], v[212:215]
    v_mfma_f32_16x16x32_bf16 v[212:215], a[204:207], a[108:111], v[212:215]
    v_mfma_f32_16x16x32_bf16 v[208:211], a[204:207], a[100:103], v[208:211]
    v_mfma_f32_16x16x32_bf16 v[208:211], a[200:203], a[96:99], v[208:211]
    s_waitcnt lgkmcnt(4)
    v_mfma_f32_16x16x32_bf16 v[224:227], a[208:211], a[96:99], v[224:227]
    ds_read_b64_tr_b16 a[192:193], v8 offset:16384
    ds_read_b64_tr_b16 a[194:195], v8 offset:18432
    v_mfma_f32_16x16x32_bf16 v[224:227], a[212:215], a[100:103], v[224:227]
    ds_read_b64_tr_b16 a[196:197], v8 offset:20480
    ds_read_b64_tr_b16 a[198:199], v8 offset:22528
    v_mfma_f32_16x16x32_bf16 v[228:231], a[212:215], a[108:111], v[228:231]
    buffer_load_dwordx4 a[28:31], v2, s[72:75], s55 offen offset:3072 sc1
    v_mfma_f32_16x16x32_bf16 v[228:231], a[208:211], a[104:107], v[228:231]
    v_mfma_f32_16x16x32_bf16 v[232:235], a[208:211], a[112:115], v[232:235]
    v_mfma_f32_16x16x32_bf16 v[232:235], a[212:215], a[116:119], v[232:235]
    buffer_store_dwordx4 v[100:103], v2, s[20:23], s34 offen offset:0
    v_mfma_f32_16x16x32_bf16 v[236:239], a[212:215], a[124:127], v[236:239]
    s_add_u32 s52, s52, 4096
    s_add_u32 s53, s53, 4096
    s_add_u32 s54, s54, 4096
    v_mfma_f32_16x16x32_bf16 v[236:239], a[208:211], a[120:123], v[236:239]
    s_waitcnt vmcnt(35) lgkmcnt(4)
    s_add_u32 s55, s55, 4096
    v_mfma_f32_16x16x32_bf16 v[252:255], a[216:219], a[120:123], v[252:255]
    ds_read_b64_tr_b16 a[200:201], v9 offset:16384
    ds_read_b64_tr_b16 a[202:203], v9 offset:18432
    v_mfma_f32_16x16x32_bf16 v[252:255], a[220:223], a[124:127], v[252:255]
    ds_read_b64_tr_b16 a[204:205], v9 offset:20480
    ds_read_b64_tr_b16 a[206:207], v9 offset:22528
    v_mfma_f32_16x16x32_bf16 v[248:251], a[220:223], a[116:119], v[248:251]
    v_mfma_f32_16x16x32_bf16 v[248:251], a[216:219], a[112:115], v[248:251]
    v_mfma_f32_16x16x32_bf16 v[244:247], a[216:219], a[104:107], v[244:247]
    v_mfma_f32_16x16x32_bf16 v[244:247], a[220:223], a[108:111], v[244:247]
    v_mfma_f32_16x16x32_bf16 v[240:243], a[220:223], a[100:103], v[240:243]
    v_mfma_f32_16x16x32_bf16 v[240:243], a[216:219], a[96:99], v[240:243]
    s_waitcnt lgkmcnt(4)
    v_mfma_f32_16x16x32_bf16 v[128:131], a[192:195], a[128:131], v[128:131]
    ds_read_b64_tr_b16 a[208:209], v10 offset:16384
    ds_read_b64_tr_b16 a[210:211], v10 offset:18432
    v_mfma_f32_16x16x32_bf16 v[128:131], a[196:199], a[132:135], v[128:131]
    ds_read_b64_tr_b16 a[212:213], v10 offset:20480
    ds_read_b64_tr_b16 a[214:215], v10 offset:22528
    v_mfma_f32_16x16x32_bf16 v[132:135], a[196:199], a[140:143], v[132:135]
    s_add_u32 s29, s62, 4
    v_accvgpr_write_b32 a96, 0
    v_accvgpr_write_b32 a97, 0
    v_mfma_f32_16x16x32_bf16 v[132:135], a[192:195], a[136:139], v[132:135]
    buffer_load_dword v31, v29, s[72:75], s29 offen sc1
    v_mfma_f32_16x16x32_bf16 v[136:139], a[192:195], a[144:147], v[136:139]
    s_add_u32 m0, s40, 65536
    v_accvgpr_write_b32 a98, 0
    v_accvgpr_write_b32 a99, 0
    v_mfma_f32_16x16x32_bf16 v[136:139], a[196:199], a[148:151], v[136:139]
    v_accvgpr_write_b32 a100, 0
    v_accvgpr_write_b32 a101, 0
    v_mfma_f32_16x16x32_bf16 v[140:143], a[196:199], a[156:159], v[140:143]
    buffer_load_dwordx4 v3, s[68:71], s44 offen offset:0 lds
    v_mfma_f32_16x16x32_bf16 v[140:143], a[192:195], a[152:155], v[140:143]
    s_waitcnt lgkmcnt(4)
    v_accvgpr_write_b32 a102, 0
    v_accvgpr_write_b32 a103, 0
    v_mfma_f32_16x16x32_bf16 v[156:159], a[200:203], a[152:155], v[156:159]
    ds_read_b64_tr_b16 a[216:217], v11 offset:16384
    ds_read_b64_tr_b16 a[218:219], v11 offset:18432
    v_mfma_f32_16x16x32_bf16 v[156:159], a[204:207], a[156:159], v[156:159]
    ds_read_b64_tr_b16 a[220:221], v11 offset:20480
    ds_read_b64_tr_b16 a[222:223], v11 offset:22528
    v_mfma_f32_16x16x32_bf16 v[152:155], a[204:207], a[148:151], v[152:155]
    v_accvgpr_write_b32 a104, 0
    v_accvgpr_write_b32 a105, 0
    v_mfma_f32_16x16x32_bf16 v[152:155], a[200:203], a[144:147], v[152:155]
    buffer_load_dwordx4 v3, s[68:71], s45 offen offset:1024 lds
    v_mfma_f32_16x16x32_bf16 v[148:151], a[200:203], a[136:139], v[148:151]
    v_accvgpr_write_b32 a106, 0
    v_accvgpr_write_b32 a107, 0
    v_mfma_f32_16x16x32_bf16 v[148:151], a[204:207], a[140:143], v[148:151]
    v_accvgpr_write_b32 a108, 0
    v_accvgpr_write_b32 a109, 0
    v_mfma_f32_16x16x32_bf16 v[144:147], a[204:207], a[132:135], v[144:147]
    v_accvgpr_write_b32 a110, 0
    v_accvgpr_write_b32 a111, 0
    v_mfma_f32_16x16x32_bf16 v[144:147], a[200:203], a[128:131], v[144:147]
    s_waitcnt lgkmcnt(4)
    v_accvgpr_write_b32 a112, 0
    v_accvgpr_write_b32 a113, 0
    v_mfma_f32_16x16x32_bf16 v[160:163], a[208:211], a[128:131], v[160:163]
    ds_read_b64_tr_b16 a[192:193], v8 offset:24576
    ds_read_b64_tr_b16 a[194:195], v8 offset:26624
    v_mfma_f32_16x16x32_bf16 v[160:163], a[212:215], a[132:135], v[160:163]
    ds_read_b64_tr_b16 a[196:197], v8 offset:28672
    ds_read_b64_tr_b16 a[198:199], v8 offset:30720
    v_mfma_f32_16x16x32_bf16 v[164:167], a[212:215], a[140:143], v[164:167]
    buffer_load_dwordx4 v3, s[68:71], s46 offen offset:2048 lds
    v_mfma_f32_16x16x32_bf16 v[164:167], a[208:211], a[136:139], v[164:167]
    v_accvgpr_write_b32 a114, 0
    v_accvgpr_write_b32 a115, 0
    v_mfma_f32_16x16x32_bf16 v[168:171], a[208:211], a[144:147], v[168:171]
    v_accvgpr_write_b32 a116, 0
    v_accvgpr_write_b32 a117, 0
    v_mfma_f32_16x16x32_bf16 v[168:171], a[212:215], a[148:151], v[168:171]
    buffer_store_dwordx4 v[104:107], v2, s[20:23], s32 offen offset:1024
    v_mfma_f32_16x16x32_bf16 v[172:175], a[212:215], a[156:159], v[172:175]
    v_accvgpr_write_b32 a118, 0
    v_accvgpr_write_b32 a119, 0
    v_mfma_f32_16x16x32_bf16 v[172:175], a[208:211], a[152:155], v[172:175]
    s_waitcnt lgkmcnt(4)
    v_accvgpr_write_b32 a120, 0
    v_accvgpr_write_b32 a121, 0
    v_mfma_f32_16x16x32_bf16 v[188:191], a[216:219], a[152:155], v[188:191]
    ds_read_b64_tr_b16 a[200:201], v9 offset:24576
    ds_read_b64_tr_b16 a[202:203], v9 offset:26624
    v_mfma_f32_16x16x32_bf16 v[188:191], a[220:223], a[156:159], v[188:191]
    ds_read_b64_tr_b16 a[204:205], v9 offset:28672
    ds_read_b64_tr_b16 a[206:207], v9 offset:30720
    v_mfma_f32_16x16x32_bf16 v[184:187], a[220:223], a[148:151], v[184:187]
    buffer_load_dwordx4 v3, s[68:71], s47 offen offset:3072 lds
    v_mfma_f32_16x16x32_bf16 v[184:187], a[216:219], a[144:147], v[184:187]
    s_add_u32 m0, s40, 69632
    v_accvgpr_write_b32 a122, 0
    v_accvgpr_write_b32 a123, 0
    v_mfma_f32_16x16x32_bf16 v[180:183], a[216:219], a[136:139], v[180:183]
    v_accvgpr_write_b32 a124, 0
    v_accvgpr_write_b32 a125, 0
    v_mfma_f32_16x16x32_bf16 v[180:183], a[220:223], a[140:143], v[180:183]
    v_accvgpr_write_b32 a126, 0
    v_accvgpr_write_b32 a127, 0
    v_mfma_f32_16x16x32_bf16 v[176:179], a[220:223], a[132:135], v[176:179]
    buffer_load_dwordx4 v3, s[68:71], s48 offen offset:0 lds
    v_mfma_f32_16x16x32_bf16 v[176:179], a[216:219], a[128:131], v[176:179]
    s_waitcnt lgkmcnt(4)
    v_mfma_f32_16x16x32_bf16 v[192:195], a[192:195], a[128:131], v[192:195]
    ds_read_b64_tr_b16 a[208:209], v10 offset:24576
    ds_read_b64_tr_b16 a[210:211], v10 offset:26624
    v_mfma_f32_16x16x32_bf16 v[192:195], a[196:199], a[132:135], v[192:195]
    ds_read_b64_tr_b16 a[212:213], v10 offset:28672
    ds_read_b64_tr_b16 a[214:215], v10 offset:30720
    v_mfma_f32_16x16x32_bf16 v[196:199], a[196:199], a[140:143], v[196:199]
    v_mfma_f32_16x16x32_bf16 v[196:199], a[192:195], a[136:139], v[196:199]
    buffer_load_dwordx4 v3, s[68:71], s49 offen offset:1024 lds
    v_mfma_f32_16x16x32_bf16 v[200:203], a[192:195], a[144:147], v[200:203]
    v_mfma_f32_16x16x32_bf16 v[200:203], a[196:199], a[148:151], v[200:203]
    v_mfma_f32_16x16x32_bf16 v[204:207], a[196:199], a[156:159], v[204:207]
    v_mfma_f32_16x16x32_bf16 v[204:207], a[192:195], a[152:155], v[204:207]
    s_waitcnt lgkmcnt(4)
    v_mfma_f32_16x16x32_bf16 v[220:223], a[200:203], a[152:155], v[220:223]
    ds_read_b64_tr_b16 a[216:217], v11 offset:24576
    ds_read_b64_tr_b16 a[218:219], v11 offset:26624
    v_mfma_f32_16x16x32_bf16 v[220:223], a[204:207], a[156:159], v[220:223]
    ds_read_b64_tr_b16 a[220:221], v11 offset:28672
    ds_read_b64_tr_b16 a[222:223], v11 offset:30720
    v_mfma_f32_16x16x32_bf16 v[216:219], a[204:207], a[148:151], v[216:219]
    buffer_store_dwordx4 v[108:111], v2, s[20:23], s34 offen offset:1024
    v_mfma_f32_16x16x32_bf16 v[216:219], a[200:203], a[144:147], v[216:219]
    v_mfma_f32_16x16x32_bf16 v[212:215], a[200:203], a[136:139], v[212:215]
    buffer_load_dwordx4 v3, s[68:71], s50 offen offset:2048 lds
    v_mfma_f32_16x16x32_bf16 v[212:215], a[204:207], a[140:143], v[212:215]
    v_mfma_f32_16x16x32_bf16 v[208:211], a[204:207], a[132:135], v[208:211]
    v_mfma_f32_16x16x32_bf16 v[208:211], a[200:203], a[128:131], v[208:211]
    s_waitcnt lgkmcnt(4)
    v_mfma_f32_16x16x32_bf16 v[224:227], a[208:211], a[128:131], v[224:227]
    s_waitcnt vmcnt(22) lgkmcnt(0)
    v_mfma_f32_16x16x32_bf16 v[224:227], a[212:215], a[132:135], v[224:227]
    s_barrier
    v_mfma_f32_16x16x32_bf16 v[228:231], a[212:215], a[140:143], v[228:231]
    ds_read_b64_tr_b16 a[192:193], v8 offset:32768
    ds_read_b64_tr_b16 a[194:195], v8 offset:34816
    v_mfma_f32_16x16x32_bf16 v[228:231], a[208:211], a[136:139], v[228:231]
    ds_read_b64_tr_b16 a[196:197], v8 offset:36864
    ds_read_b64_tr_b16 a[198:199], v8 offset:38912
    v_mfma_f32_16x16x32_bf16 v[232:235], a[208:211], a[144:147], v[232:235]
    buffer_load_dwordx4 v3, s[68:71], s51 offen offset:3072 lds
    v_mfma_f32_16x16x32_bf16 v[232:235], a[212:215], a[148:151], v[232:235]
    v_mfma_f32_16x16x32_bf16 v[236:239], a[212:215], a[156:159], v[236:239]
    buffer_store_dwordx4 v[112:115], v2, s[20:23], s32 offen offset:2048
    v_mfma_f32_16x16x32_bf16 v[236:239], a[208:211], a[152:155], v[236:239]
    v_add_u32 v3, 1048576, v3
    v_mfma_f32_16x16x32_bf16 v[252:255], a[216:219], a[152:155], v[252:255]
    ds_read_b64_tr_b16 a[200:201], v9 offset:32768
    ds_read_b64_tr_b16 a[202:203], v9 offset:34816
    v_mfma_f32_16x16x32_bf16 v[252:255], a[220:223], a[156:159], v[252:255]
    ds_read_b64_tr_b16 a[204:205], v9 offset:36864
    ds_read_b64_tr_b16 a[206:207], v9 offset:38912
    v_mfma_f32_16x16x32_bf16 v[248:251], a[220:223], a[148:151], v[248:251]
    v_mfma_f32_16x16x32_bf16 v[248:251], a[216:219], a[144:147], v[248:251]
    v_mfma_f32_16x16x32_bf16 v[244:247], a[216:219], a[136:139], v[244:247]
    v_mfma_f32_16x16x32_bf16 v[244:247], a[220:223], a[140:143], v[244:247]
    v_mfma_f32_16x16x32_bf16 v[240:243], a[220:223], a[132:135], v[240:243]
    v_mfma_f32_16x16x32_bf16 v[240:243], a[216:219], a[128:131], v[240:243]
    s_waitcnt lgkmcnt(4)
    v_mfma_f32_16x16x32_bf16 v[128:131], a[192:195], a[160:163], v[128:131]
    ds_read_b64_tr_b16 a[208:209], v10 offset:32768
    ds_read_b64_tr_b16 a[210:211], v10 offset:34816
    v_mfma_f32_16x16x32_bf16 v[128:131], a[196:199], a[164:167], v[128:131]
    ds_read_b64_tr_b16 a[212:213], v10 offset:36864
    ds_read_b64_tr_b16 a[214:215], v10 offset:38912
    v_mfma_f32_16x16x32_bf16 v[132:135], a[196:199], a[172:175], v[132:135]
    buffer_load_dwordx4 a[32:35], v2, s[72:75], s52 offen offset:0 sc1
    v_mfma_f32_16x16x32_bf16 v[132:135], a[192:195], a[168:171], v[132:135]
    v_mfma_f32_16x16x32_bf16 v[136:139], a[192:195], a[176:179], v[136:139]
    v_mfma_f32_16x16x32_bf16 v[136:139], a[196:199], a[180:183], v[136:139]
    v_mfma_f32_16x16x32_bf16 v[140:143], a[196:199], a[188:191], v[140:143]
    v_mfma_f32_16x16x32_bf16 v[140:143], a[192:195], a[184:187], v[140:143]
    s_waitcnt lgkmcnt(4)
    v_mfma_f32_16x16x32_bf16 v[156:159], a[200:203], a[184:187], v[156:159]
    ds_read_b64_tr_b16 a[216:217], v11 offset:32768
    ds_read_b64_tr_b16 a[218:219], v11 offset:34816
    v_mfma_f32_16x16x32_bf16 v[156:159], a[204:207], a[188:191], v[156:159]
    ds_read_b64_tr_b16 a[220:221], v11 offset:36864
    ds_read_b64_tr_b16 a[222:223], v11 offset:38912
    v_mfma_f32_16x16x32_bf16 v[152:155], a[204:207], a[180:183], v[152:155]
    buffer_load_dwordx4 a[36:39], v2, s[72:75], s52 offen offset:1024 sc1
    v_mfma_f32_16x16x32_bf16 v[152:155], a[200:203], a[176:179], v[152:155]
    v_mfma_f32_16x16x32_bf16 v[148:151], a[200:203], a[168:171], v[148:151]
    buffer_load_dwordx4 a[40:43], v2, s[72:75], s53 offen offset:0 sc1
    v_mfma_f32_16x16x32_bf16 v[148:151], a[204:207], a[172:175], v[148:151]
    v_mfma_f32_16x16x32_bf16 v[144:147], a[204:207], a[164:167], v[144:147]
    v_mfma_f32_16x16x32_bf16 v[144:147], a[200:203], a[160:163], v[144:147]
    s_waitcnt lgkmcnt(4)
    v_mfma_f32_16x16x32_bf16 v[160:163], a[208:211], a[160:163], v[160:163]
    ds_read_b64_tr_b16 a[192:193], v8 offset:40960
    ds_read_b64_tr_b16 a[194:195], v8 offset:43008
    v_mfma_f32_16x16x32_bf16 v[160:163], a[212:215], a[164:167], v[160:163]
    ds_read_b64_tr_b16 a[196:197], v8 offset:45056
    ds_read_b64_tr_b16 a[198:199], v8 offset:47104
    v_mfma_f32_16x16x32_bf16 v[164:167], a[212:215], a[172:175], v[164:167]
    buffer_store_dwordx4 v[116:119], v2, s[20:23], s34 offen offset:2048
    v_mfma_f32_16x16x32_bf16 v[164:167], a[208:211], a[168:171], v[164:167]
    v_mfma_f32_16x16x32_bf16 v[168:171], a[208:211], a[176:179], v[168:171]
    v_mfma_f32_16x16x32_bf16 v[168:171], a[212:215], a[180:183], v[168:171]
    v_mfma_f32_16x16x32_bf16 v[172:175], a[212:215], a[188:191], v[172:175]
    buffer_load_dwordx4 a[44:47], v2, s[72:75], s53 offen offset:1024 sc1
    v_mfma_f32_16x16x32_bf16 v[172:175], a[208:211], a[184:187], v[172:175]
    s_waitcnt lgkmcnt(4)
    v_mfma_f32_16x16x32_bf16 v[188:191], a[216:219], a[184:187], v[188:191]
    ds_read_b64_tr_b16 a[200:201], v9 offset:40960
    ds_read_b64_tr_b16 a[202:203], v9 offset:43008
    v_mfma_f32_16x16x32_bf16 v[188:191], a[220:223], a[188:191], v[188:191]
    ds_read_b64_tr_b16 a[204:205], v9 offset:45056
    ds_read_b64_tr_b16 a[206:207], v9 offset:47104
    v_mfma_f32_16x16x32_bf16 v[184:187], a[220:223], a[180:183], v[184:187]
    v_mfma_f32_16x16x32_bf16 v[184:187], a[216:219], a[176:179], v[184:187]
    buffer_load_dwordx4 a[48:51], v2, s[72:75], s54 offen offset:0 sc1
    v_mfma_f32_16x16x32_bf16 v[180:183], a[216:219], a[168:171], v[180:183]
    v_mfma_f32_16x16x32_bf16 v[180:183], a[220:223], a[172:175], v[180:183]
    v_mfma_f32_16x16x32_bf16 v[176:179], a[220:223], a[164:167], v[176:179]
    v_mfma_f32_16x16x32_bf16 v[176:179], a[216:219], a[160:163], v[176:179]
    s_waitcnt lgkmcnt(4)
    v_mfma_f32_16x16x32_bf16 v[192:195], a[192:195], a[160:163], v[192:195]
    ds_read_b64_tr_b16 a[208:209], v10 offset:40960
    ds_read_b64_tr_b16 a[210:211], v10 offset:43008
    v_mfma_f32_16x16x32_bf16 v[192:195], a[196:199], a[164:167], v[192:195]
    ds_read_b64_tr_b16 a[212:213], v10 offset:45056
    ds_read_b64_tr_b16 a[214:215], v10 offset:47104
    v_mfma_f32_16x16x32_bf16 v[196:199], a[196:199], a[172:175], v[196:199]
    buffer_load_dwordx4 a[52:55], v2, s[72:75], s54 offen offset:1024 sc1
    v_mfma_f32_16x16x32_bf16 v[196:199], a[192:195], a[168:171], v[196:199]
    v_mfma_f32_16x16x32_bf16 v[200:203], a[192:195], a[176:179], v[200:203]
    v_mfma_f32_16x16x32_bf16 v[200:203], a[196:199], a[180:183], v[200:203]
    v_mfma_f32_16x16x32_bf16 v[204:207], a[196:199], a[188:191], v[204:207]
    buffer_store_dwordx4 v[120:123], v2, s[20:23], s32 offen offset:3072
    v_mfma_f32_16x16x32_bf16 v[204:207], a[192:195], a[184:187], v[204:207]
    s_waitcnt lgkmcnt(4)
    v_mfma_f32_16x16x32_bf16 v[220:223], a[200:203], a[184:187], v[220:223]
    ds_read_b64_tr_b16 a[216:217], v11 offset:40960
    ds_read_b64_tr_b16 a[218:219], v11 offset:43008
    v_mfma_f32_16x16x32_bf16 v[220:223], a[204:207], a[188:191], v[220:223]
    ds_read_b64_tr_b16 a[220:221], v11 offset:45056
    ds_read_b64_tr_b16 a[222:223], v11 offset:47104
    v_mfma_f32_16x16x32_bf16 v[216:219], a[204:207], a[180:183], v[216:219]
    v_mfma_f32_16x16x32_bf16 v[216:219], a[200:203], a[176:179], v[216:219]
    buffer_load_dwordx4 a[56:59], v2, s[72:75], s55 offen offset:0 sc1
    v_mfma_f32_16x16x32_bf16 v[212:215], a[200:203], a[168:171], v[212:215]
    v_mfma_f32_16x16x32_bf16 v[212:215], a[204:207], a[172:175], v[212:215]
    v_mfma_f32_16x16x32_bf16 v[208:211], a[204:207], a[164:167], v[208:211]
    v_mfma_f32_16x16x32_bf16 v[208:211], a[200:203], a[160:163], v[208:211]
    s_waitcnt lgkmcnt(4)
    v_mfma_f32_16x16x32_bf16 v[224:227], a[208:211], a[160:163], v[224:227]
    ds_read_b64_tr_b16 a[192:193], v8 offset:49152
    ds_read_b64_tr_b16 a[194:195], v8 offset:51200
    v_mfma_f32_16x16x32_bf16 v[224:227], a[212:215], a[164:167], v[224:227]
    ds_read_b64_tr_b16 a[196:197], v8 offset:53248
    ds_read_b64_tr_b16 a[198:199], v8 offset:55296
    v_mfma_f32_16x16x32_bf16 v[228:231], a[212:215], a[172:175], v[228:231]
    buffer_load_dwordx4 a[60:63], v2, s[72:75], s55 offen offset:1024 sc1
    v_mfma_f32_16x16x32_bf16 v[228:231], a[208:211], a[168:171], v[228:231]
    v_mfma_f32_16x16x32_bf16 v[232:235], a[208:211], a[176:179], v[232:235]
    v_mfma_f32_16x16x32_bf16 v[232:235], a[212:215], a[180:183], v[232:235]
    buffer_store_dwordx4 v[124:127], v2, s[20:23], s34 offen offset:3072
    v_mfma_f32_16x16x32_bf16 v[236:239], a[212:215], a[188:191], v[236:239]
    v_mfma_f32_16x16x32_bf16 v[236:239], a[208:211], a[184:187], v[236:239]
    s_waitcnt vmcnt(24) lgkmcnt(4)
    v_mfma_f32_16x16x32_bf16 v[252:255], a[216:219], a[184:187], v[252:255]
    ds_read_b64_tr_b16 a[200:201], v9 offset:49152
    ds_read_b64_tr_b16 a[202:203], v9 offset:51200
    v_mfma_f32_16x16x32_bf16 v[252:255], a[220:223], a[188:191], v[252:255]
    ds_read_b64_tr_b16 a[204:205], v9 offset:53248
    ds_read_b64_tr_b16 a[206:207], v9 offset:55296
    v_mfma_f32_16x16x32_bf16 v[248:251], a[220:223], a[180:183], v[248:251]
    v_mfma_f32_16x16x32_bf16 v[248:251], a[216:219], a[176:179], v[248:251]
    v_mfma_f32_16x16x32_bf16 v[244:247], a[216:219], a[168:171], v[244:247]
    v_mfma_f32_16x16x32_bf16 v[244:247], a[220:223], a[172:175], v[244:247]
    v_mfma_f32_16x16x32_bf16 v[240:243], a[220:223], a[164:167], v[240:243]
    v_mfma_f32_16x16x32_bf16 v[240:243], a[216:219], a[160:163], v[240:243]
    s_waitcnt lgkmcnt(4)
    v_mfma_f32_16x16x32_bf16 v[128:131], a[192:195], a[0:3], v[128:131]
    ds_read_b64_tr_b16 a[208:209], v10 offset:49152
    ds_read_b64_tr_b16 a[210:211], v10 offset:51200
    v_mfma_f32_16x16x32_bf16 v[128:131], a[196:199], a[4:7], v[128:131]
    ds_read_b64_tr_b16 a[212:213], v10 offset:53248
    ds_read_b64_tr_b16 a[214:215], v10 offset:55296
    v_mfma_f32_16x16x32_bf16 v[132:135], a[196:199], a[12:15], v[132:135]
    s_add_u32 m0, s40, 0
    v_and_b32 v13, 15, v1
    v_lshrrev_b32 v14, 4, v1
    v_mfma_f32_16x16x32_bf16 v[132:135], a[192:195], a[8:11], v[132:135]
    buffer_load_dwordx4 v3, s[68:71], s44 offen offset:0 lds
    v_mfma_f32_16x16x32_bf16 v[136:139], a[192:195], a[16:19], v[136:139]
    v_lshlrev_b32 v14, 2, v14
    v_sub_u32 v7, v13, v14
    v_mfma_f32_16x16x32_bf16 v[136:139], a[196:199], a[20:23], v[136:139]
    buffer_load_dwordx4 v3, s[68:71], s45 offen offset:1024 lds
    v_mfma_f32_16x16x32_bf16 v[140:143], a[196:199], a[28:31], v[140:143]
    v_mov_b32 v12, 0xff800000
    v_add_u32 v4, s39, v2
    v_mfma_f32_16x16x32_bf16 v[140:143], a[192:195], a[24:27], v[140:143]
    s_waitcnt lgkmcnt(4)
    v_add_u32 v28, 0x2000, v4
    v_mfma_f32_16x16x32_bf16 v[156:159], a[200:203], a[24:27], v[156:159]
    s_mov_b32 s86, 28
    ds_read_b64_tr_b16 a[216:217], v11 offset:49152
    ds_read_b64_tr_b16 a[218:219], v11 offset:51200
    v_mfma_f32_16x16x32_bf16 v[156:159], a[204:207], a[28:31], v[156:159]
    s_add_u32 s8, s4, 0x1200000
    s_addc_u32 s9, s5, 0
    ds_read_b64_tr_b16 a[220:221], v11 offset:53248
    ds_read_b64_tr_b16 a[222:223], v11 offset:55296
    v_mfma_f32_16x16x32_bf16 v[152:155], a[204:207], a[20:23], v[152:155]
    buffer_load_dwordx4 v3, s[68:71], s46 offen offset:2048 lds
    v_mfma_f32_16x16x32_bf16 v[152:155], a[200:203], a[16:19], v[152:155]
    buffer_load_dwordx4 v3, s[68:71], s47 offen offset:3072 lds
    v_mfma_f32_16x16x32_bf16 v[148:151], a[200:203], a[8:11], v[148:151]
    s_add_u32 m0, s40, 4096
    s_mov_b32 s10, 14680064
    s_mov_b32 s11, 0x20000
    v_mfma_f32_16x16x32_bf16 v[148:151], a[204:207], a[12:15], v[148:151]
    v_mfma_f32_16x16x32_bf16 v[144:147], a[204:207], a[4:7], v[144:147]
    buffer_load_dwordx4 v3, s[68:71], s48 offen offset:0 lds
    v_mfma_f32_16x16x32_bf16 v[144:147], a[200:203], a[0:3], v[144:147]
    s_waitcnt lgkmcnt(4)
    v_mfma_f32_16x16x32_bf16 v[160:163], a[208:211], a[0:3], v[160:163]
    ds_read_b64_tr_b16 a[192:193], v8 offset:57344
    ds_read_b64_tr_b16 a[194:195], v8 offset:59392
    v_mfma_f32_16x16x32_bf16 v[160:163], a[212:215], a[4:7], v[160:163]
    ds_read_b64_tr_b16 a[196:197], v8 offset:61440
    ds_read_b64_tr_b16 a[198:199], v8 offset:63488
    v_mfma_f32_16x16x32_bf16 v[164:167], a[212:215], a[12:15], v[164:167]
    buffer_load_dwordx4 v3, s[68:71], s49 offen offset:1024 lds
    v_mfma_f32_16x16x32_bf16 v[164:167], a[208:211], a[8:11], v[164:167]
    v_mfma_f32_16x16x32_bf16 v[168:171], a[208:211], a[16:19], v[168:171]
    v_mfma_f32_16x16x32_bf16 v[168:171], a[212:215], a[20:23], v[168:171]
    buffer_load_dwordx4 v3, s[68:71], s50 offen offset:2048 lds
    v_mfma_f32_16x16x32_bf16 v[172:175], a[212:215], a[28:31], v[172:175]
    v_mfma_f32_16x16x32_bf16 v[172:175], a[208:211], a[24:27], v[172:175]
    s_waitcnt lgkmcnt(4)
    v_mfma_f32_16x16x32_bf16 v[188:191], a[216:219], a[24:27], v[188:191]
    ds_read_b64_tr_b16 a[200:201], v9 offset:57344
    ds_read_b64_tr_b16 a[202:203], v9 offset:59392
    v_mfma_f32_16x16x32_bf16 v[188:191], a[220:223], a[28:31], v[188:191]
    ds_read_b64_tr_b16 a[204:205], v9 offset:61440
    ds_read_b64_tr_b16 a[206:207], v9 offset:63488
    v_mfma_f32_16x16x32_bf16 v[184:187], a[220:223], a[20:23], v[184:187]
    buffer_load_dwordx4 v3, s[68:71], s51 offen offset:3072 lds
    v_mfma_f32_16x16x32_bf16 v[184:187], a[216:219], a[16:19], v[184:187]
    buffer_store_dwordx4 v[32:35], v2, s[20:23], s33 offen offset:0
    v_mfma_f32_16x16x32_bf16 v[180:183], a[216:219], a[8:11], v[180:183]
    v_add_u32 v3, 1048576, v3
    v_mfma_f32_16x16x32_bf16 v[180:183], a[220:223], a[12:15], v[180:183]
    v_mfma_f32_16x16x32_bf16 v[176:179], a[220:223], a[4:7], v[176:179]
    buffer_load_dwordx4 a[64:67], v2, s[72:75], s52 offen offset:2048 sc1
    v_mfma_f32_16x16x32_bf16 v[176:179], a[216:219], a[0:3], v[176:179]
    s_waitcnt lgkmcnt(4)
    v_mfma_f32_16x16x32_bf16 v[192:195], a[192:195], a[0:3], v[192:195]
    ds_read_b64_tr_b16 a[208:209], v10 offset:57344
    ds_read_b64_tr_b16 a[210:211], v10 offset:59392
    v_mfma_f32_16x16x32_bf16 v[192:195], a[196:199], a[4:7], v[192:195]
    ds_read_b64_tr_b16 a[212:213], v10 offset:61440
    ds_read_b64_tr_b16 a[214:215], v10 offset:63488
    v_mfma_f32_16x16x32_bf16 v[196:199], a[196:199], a[12:15], v[196:199]
    buffer_load_dwordx4 a[68:71], v2, s[72:75], s52 offen offset:3072 sc1
    v_mfma_f32_16x16x32_bf16 v[196:199], a[192:195], a[8:11], v[196:199]
    v_mfma_f32_16x16x32_bf16 v[200:203], a[192:195], a[16:19], v[200:203]
    buffer_load_dwordx4 a[72:75], v2, s[72:75], s53 offen offset:2048 sc1
    v_mfma_f32_16x16x32_bf16 v[200:203], a[196:199], a[20:23], v[200:203]
    v_mfma_f32_16x16x32_bf16 v[204:207], a[196:199], a[28:31], v[204:207]
    v_mfma_f32_16x16x32_bf16 v[204:207], a[192:195], a[24:27], v[204:207]
    s_waitcnt lgkmcnt(4)
    v_mfma_f32_16x16x32_bf16 v[220:223], a[200:203], a[24:27], v[220:223]
    ds_read_b64_tr_b16 a[216:217], v11 offset:57344
    ds_read_b64_tr_b16 a[218:219], v11 offset:59392
    v_mfma_f32_16x16x32_bf16 v[220:223], a[204:207], a[28:31], v[220:223]
    ds_read_b64_tr_b16 a[220:221], v11 offset:61440
    ds_read_b64_tr_b16 a[222:223], v11 offset:63488
    v_mfma_f32_16x16x32_bf16 v[216:219], a[204:207], a[20:23], v[216:219]
    buffer_load_dwordx4 a[76:79], v2, s[72:75], s53 offen offset:3072 sc1
    v_mfma_f32_16x16x32_bf16 v[216:219], a[200:203], a[16:19], v[216:219]
    buffer_load_dwordx4 a[80:83], v2, s[72:75], s54 offen offset:2048 sc1
    v_mfma_f32_16x16x32_bf16 v[212:215], a[200:203], a[8:11], v[212:215]
    v_mfma_f32_16x16x32_bf16 v[212:215], a[204:207], a[12:15], v[212:215]
    v_mfma_f32_16x16x32_bf16 v[208:211], a[204:207], a[4:7], v[208:211]
    buffer_load_dwordx4 a[84:87], v2, s[72:75], s54 offen offset:3072 sc1
    v_mfma_f32_16x16x32_bf16 v[208:211], a[200:203], a[0:3], v[208:211]
    s_waitcnt lgkmcnt(4)
    v_mfma_f32_16x16x32_bf16 v[224:227], a[208:211], a[0:3], v[224:227]
    s_waitcnt vmcnt(16) lgkmcnt(0)
    v_mfma_f32_16x16x32_bf16 v[224:227], a[212:215], a[4:7], v[224:227]
    s_barrier
    v_mfma_f32_16x16x32_bf16 v[228:231], a[212:215], a[12:15], v[228:231]
    ds_read_b64_tr_b16 a[192:193], v24 offset:0
    ds_read_b64_tr_b16 a[194:195], v24 offset:2048
    v_mfma_f32_16x16x32_bf16 v[228:231], a[208:211], a[8:11], v[228:231]
    ds_read_b64_tr_b16 a[196:197], v24 offset:4096
    ds_read_b64_tr_b16 a[198:199], v24 offset:6144
    v_mfma_f32_16x16x32_bf16 v[232:235], a[208:211], a[16:19], v[232:235]
    buffer_load_dwordx4 a[88:91], v2, s[72:75], s55 offen offset:2048 sc1
    v_mfma_f32_16x16x32_bf16 v[232:235], a[212:215], a[20:23], v[232:235]
    buffer_load_dwordx4 a[92:95], v2, s[72:75], s55 offen offset:3072 sc1
    v_mfma_f32_16x16x32_bf16 v[236:239], a[212:215], a[28:31], v[236:239]
    v_mfma_f32_16x16x32_bf16 v[236:239], a[208:211], a[24:27], v[236:239]
    buffer_store_dwordx4 v[36:39], v2, s[20:23], s35 offen offset:0
    v_mfma_f32_16x16x32_bf16 v[252:255], a[216:219], a[24:27], v[252:255]
    s_add_u32 s52, s52, 4096
    ds_read_b64_tr_b16 a[200:201], v25 offset:0
    ds_read_b64_tr_b16 a[202:203], v25 offset:2048
    v_mfma_f32_16x16x32_bf16 v[252:255], a[220:223], a[28:31], v[252:255]
    s_add_u32 s53, s53, 4096
    ds_read_b64_tr_b16 a[204:205], v25 offset:4096
    ds_read_b64_tr_b16 a[206:207], v25 offset:6144
    v_mfma_f32_16x16x32_bf16 v[248:251], a[220:223], a[20:23], v[248:251]
    s_add_u32 s54, s54, 4096
    s_add_u32 s55, s55, 4096
    v_mfma_f32_16x16x32_bf16 v[248:251], a[216:219], a[16:19], v[248:251]
    v_mfma_f32_16x16x32_bf16 v[244:247], a[216:219], a[8:11], v[244:247]
    v_mfma_f32_16x16x32_bf16 v[244:247], a[220:223], a[12:15], v[244:247]
    v_mfma_f32_16x16x32_bf16 v[240:243], a[220:223], a[4:7], v[240:243]
    v_mfma_f32_16x16x32_bf16 v[240:243], a[216:219], a[0:3], v[240:243]
    s_waitcnt lgkmcnt(4)
    v_mfma_f32_16x16x32_bf16 v[128:131], a[192:195], a[32:35], v[128:131]
    ds_read_b64_tr_b16 a[208:209], v26 offset:0
    ds_read_b64_tr_b16 a[210:211], v26 offset:2048
    v_mfma_f32_16x16x32_bf16 v[128:131], a[196:199], a[36:39], v[128:131]
    ds_read_b64_tr_b16 a[212:213], v26 offset:4096
    ds_read_b64_tr_b16 a[214:215], v26 offset:6144
    v_mfma_f32_16x16x32_bf16 v[132:135], a[196:199], a[44:47], v[132:135]
    v_readfirstlane_b32 s28, v31
    v_accvgpr_write_b32 a0, 0
    v_mfma_f32_16x16x32_bf16 v[132:135], a[192:195], a[40:43], v[132:135]
    s_lshr_b32 s28, s28, s63
    s_and_b32 s61, s28, 15
    s_max_u32 s61, s61, s40
    v_mfma_f32_16x16x32_bf16 v[136:139], a[192:195], a[48:51], v[136:139]
    s_cmp_lt_u32 s61, 8
    s_cbranch_scc1 KA_wb
KA_wbr:
    v_mfma_f32_16x16x32_bf16 v[136:139], a[196:199], a[52:55], v[136:139]
    v_mov_b32 v13, 1
    v_accvgpr_write_b32 a1, 0
    v_mfma_f32_16x16x32_bf16 v[140:143], a[196:199], a[60:63], v[140:143]
    buffer_atomic_add v13, v29, s[72:75], s62 offen
    v_mfma_f32_16x16x32_bf16 v[140:143], a[192:195], a[56:59], v[140:143]
    s_waitcnt lgkmcnt(4)
    s_getpc_b64 s[12:13]
KA_pcq:
    s_add_u32 s12, s12, K2_PVd1-KA_pcq
    s_addc_u32 s13, s13, 0
    s_mov_b32 s14, K2_slow-K2_PVd1
    v_mfma_f32_16x16x32_bf16 v[156:159], a[200:203], a[56:59], v[156:159]
    s_mov_b32 s15, 0x20000
    ds_read_b64_tr_b16 a[216:217], v27 offset:0
    ds_read_b64_tr_b16 a[218:219], v27 offset:2048
    v_mfma_f32_16x16x32_bf16 v[156:159], a[204:207], a[60:63], v[156:159]
    s_lshr_b32 s29, s2, 3
    ds_read_b64_tr_b16 a[220:221], v27 offset:4096
    ds_read_b64_tr_b16 a[222:223], v27 offset:6144
    v_mfma_f32_16x16x32_bf16 v[152:155], a[204:207], a[52:55], v[152:155]
    s_lshl_b32 s29, s29, 2
    s_add_u32 s29, s29, s3
    s_lshl_b32 s29, s29, 7
    v_mfma_f32_16x16x32_bf16 v[152:155], a[200:203], a[48:51], v[152:155]
    v_lshlrev_b32 v14, 14, v1
    v_accvgpr_write_b32 a2, 0
    v_mfma_f32_16x16x32_bf16 v[148:151], a[200:203], a[40:43], v[148:151]
    buffer_load_dword a250, v14, s[12:15], s29 offen
    v_mfma_f32_16x16x32_bf16 v[148:151], a[204:207], a[44:47], v[148:151]
    buffer_load_dwordx4 a[128:131], v2, s[72:75], s52 offen offset:0 sc1
    v_mfma_f32_16x16x32_bf16 v[144:147], a[204:207], a[36:39], v[144:147]
    v_accvgpr_write_b32 a3, 0
    v_accvgpr_write_b32 a4, 0
    v_mfma_f32_16x16x32_bf16 v[144:147], a[200:203], a[32:35], v[144:147]
    s_waitcnt lgkmcnt(4)
    v_accvgpr_write_b32 a5, 0
    v_accvgpr_write_b32 a6, 0
    v_mfma_f32_16x16x32_bf16 v[160:163], a[208:211], a[32:35], v[160:163]
    ds_read_b64_tr_b16 a[192:193], v24 offset:8192
    ds_read_b64_tr_b16 a[194:195], v24 offset:10240
    v_mfma_f32_16x16x32_bf16 v[160:163], a[212:215], a[36:39], v[160:163]
    ds_read_b64_tr_b16 a[196:197], v24 offset:12288
    ds_read_b64_tr_b16 a[198:199], v24 offset:14336
    v_mfma_f32_16x16x32_bf16 v[164:167], a[212:215], a[44:47], v[164:167]
    buffer_load_dwordx4 a[132:135], v2, s[72:75], s52 offen offset:1024 sc1
    v_mfma_f32_16x16x32_bf16 v[164:167], a[208:211], a[40:43], v[164:167]
    v_accvgpr_write_b32 a7, 0
    v_accvgpr_write_b32 a8, 0
    v_mfma_f32_16x16x32_bf16 v[168:171], a[208:211], a[48:51], v[168:171]
    buffer_load_dwordx4 a[136:139], v2, s[72:75], s53 offen offset:0 sc1
    v_mfma_f32_16x16x32_bf16 v[168:171], a[212:215], a[52:55], v[168:171]
    v_accvgpr_write_b32 a9, 0
    v_accvgpr_write_b32 a10, 0
    v_mfma_f32_16x16x32_bf16 v[172:175], a[212:215], a[60:63], v[172:175]
    v_accvgpr_write_b32 a11, 0
    v_accvgpr_write_b32 a12, 0
    v_mfma_f32_16x16x32_bf16 v[172:175], a[208:211], a[56:59], v[172:175]
    s_waitcnt lgkmcnt(4)
    v_accvgpr_write_b32 a13, 0
    v_accvgpr_write_b32 a14, 0
    v_mfma_f32_16x16x32_bf16 v[188:191], a[216:219], a[56:59], v[188:191]
    ds_read_b64_tr_b16 a[200:201], v25 offset:8192
    ds_read_b64_tr_b16 a[202:203], v25 offset:10240
    v_mfma_f32_16x16x32_bf16 v[188:191], a[220:223], a[60:63], v[188:191]
    ds_read_b64_tr_b16 a[204:205], v25 offset:12288
    ds_read_b64_tr_b16 a[206:207], v25 offset:14336
    v_mfma_f32_16x16x32_bf16 v[184:187], a[220:223], a[52:55], v[184:187]
    buffer_store_dwordx4 v[40:43], v2, s[20:23], s33 offen offset:1024
    v_mfma_f32_16x16x32_bf16 v[184:187], a[216:219], a[48:51], v[184:187]
    v_accvgpr_write_b32 a15, 0
    v_accvgpr_write_b32 a16, 0
    v_mfma_f32_16x16x32_bf16 v[180:183], a[216:219], a[40:43], v[180:183]
    buffer_load_dwordx4 a[140:143], v2, s[72:75], s53 offen offset:1024 sc1
    v_mfma_f32_16x16x32_bf16 v[180:183], a[220:223], a[44:47], v[180:183]
    v_accvgpr_write_b32 a17, 0
    v_accvgpr_write_b32 a18, 0
    v_mfma_f32_16x16x32_bf16 v[176:179], a[220:223], a[36:39], v[176:179]
    v_accvgpr_write_b32 a19, 0
    v_accvgpr_write_b32 a20, 0
    v_mfma_f32_16x16x32_bf16 v[176:179], a[216:219], a[32:35], v[176:179]
    s_waitcnt lgkmcnt(4)
    v_accvgpr_write_b32 a21, 0
    v_accvgpr_write_b32 a22, 0
    v_mfma_f32_16x16x32_bf16 v[192:195], a[192:195], a[32:35], v[192:195]
    ds_read_b64_tr_b16 a[208:209], v26 offset:8192
    ds_read_b64_tr_b16 a[210:211], v26 offset:10240
    v_mfma_f32_16x16x32_bf16 v[192:195], a[196:199], a[36:39], v[192:195]
    ds_read_b64_tr_b16 a[212:213], v26 offset:12288
    ds_read_b64_tr_b16 a[214:215], v26 offset:14336
    v_mfma_f32_16x16x32_bf16 v[196:199], a[196:199], a[44:47], v[196:199]
    buffer_load_dwordx4 a[144:147], v2, s[72:75], s54 offen offset:0 sc1
    v_mfma_f32_16x16x32_bf16 v[196:199], a[192:195], a[40:43], v[196:199]
    v_accvgpr_write_b32 a23, 0
    v_accvgpr_write_b32 a24, 0
    v_mfma_f32_16x16x32_bf16 v[200:203], a[192:195], a[48:51], v[200:203]
    v_accvgpr_write_b32 a25, 0
    v_accvgpr_write_b32 a26, 0
    v_mfma_f32_16x16x32_bf16 v[200:203], a[196:199], a[52:55], v[200:203]
    buffer_load_dwordx4 a[148:151], v2, s[72:75], s54 offen offset:1024 sc1
    v_mfma_f32_16x16x32_bf16 v[204:207], a[196:199], a[60:63], v[204:207]
    v_accvgpr_write_b32 a27, 0
    v_accvgpr_write_b32 a28, 0
    v_mfma_f32_16x16x32_bf16 v[204:207], a[192:195], a[56:59], v[204:207]
    s_waitcnt lgkmcnt(4)
    v_accvgpr_write_b32 a29, 0
    v_accvgpr_write_b32 a30, 0
    v_mfma_f32_16x16x32_bf16 v[220:223], a[200:203], a[56:59], v[220:223]
    ds_read_b64_tr_b16 a[216:217], v27 offset:8192
    ds_read_b64_tr_b16 a[218:219], v27 offset:10240
    v_mfma_f32_16x16x32_bf16 v[220:223], a[204:207], a[60:63], v[220:223]
    ds_read_b64_tr_b16 a[220:221], v27 offset:12288
    ds_read_b64_tr_b16 a[222:223], v27 offset:14336
    v_mfma_f32_16x16x32_bf16 v[216:219], a[204:207], a[52:55], v[216:219]
    buffer_store_dwordx4 v[44:47], v2, s[20:23], s35 offen offset:1024
    v_mfma_f32_16x16x32_bf16 v[216:219], a[200:203], a[48:51], v[216:219]
    v_accvgpr_write_b32 a31, 0
    v_mfma_f32_16x16x32_bf16 v[212:215], a[200:203], a[40:43], v[212:215]
    v_mfma_f32_16x16x32_bf16 v[212:215], a[204:207], a[44:47], v[212:215]
    v_mfma_f32_16x16x32_bf16 v[208:211], a[204:207], a[36:39], v[208:211]
    buffer_load_dwordx4 a[152:155], v2, s[72:75], s55 offen offset:0 sc1
    v_mfma_f32_16x16x32_bf16 v[208:211], a[200:203], a[32:35], v[208:211]
    s_waitcnt lgkmcnt(4)
    v_mfma_f32_16x16x32_bf16 v[224:227], a[208:211], a[32:35], v[224:227]
    ds_read_b64_tr_b16 a[192:193], v24 offset:16384
    ds_read_b64_tr_b16 a[194:195], v24 offset:18432
    v_mfma_f32_16x16x32_bf16 v[224:227], a[212:215], a[36:39], v[224:227]
    ds_read_b64_tr_b16 a[196:197], v24 offset:20480
    ds_read_b64_tr_b16 a[198:199], v24 offset:22528
    v_mfma_f32_16x16x32_bf16 v[228:231], a[212:215], a[44:47], v[228:231]
    buffer_load_dwordx4 a[156:159], v2, s[72:75], s55 offen offset:1024 sc1
    v_mfma_f32_16x16x32_bf16 v[228:231], a[208:211], a[40:43], v[228:231]
    v_mfma_f32_16x16x32_bf16 v[232:235], a[208:211], a[48:51], v[232:235]
    v_mfma_f32_16x16x32_bf16 v[232:235], a[212:215], a[52:55], v[232:235]
    v_mfma_f32_16x16x32_bf16 v[236:239], a[212:215], a[60:63], v[236:239]
    buffer_store_dwordx4 v[48:51], v2, s[20:23], s33 offen offset:2048
    v_mfma_f32_16x16x32_bf16 v[236:239], a[208:211], a[56:59], v[236:239]
    s_waitcnt vmcnt(14) lgkmcnt(4)
    v_mfma_f32_16x16x32_bf16 v[252:255], a[216:219], a[56:59], v[252:255]
    ds_read_b64_tr_b16 a[200:201], v25 offset:16384
    ds_read_b64_tr_b16 a[202:203], v25 offset:18432
    v_mfma_f32_16x16x32_bf16 v[252:255], a[220:223], a[60:63], v[252:255]
    ds_read_b64_tr_b16 a[204:205], v25 offset:20480
    ds_read_b64_tr_b16 a[206:207], v25 offset:22528
    v_mfma_f32_16x16x32_bf16 v[248:251], a[220:223], a[52:55], v[248:251]
    v_mfma_f32_16x16x32_bf16 v[248:251], a[216:219], a[48:51], v[248:251]
    v_mfma_f32_16x16x32_bf16 v[244:247], a[216:219], a[40:43], v[244:247]
    v_mfma_f32_16x16x32_bf16 v[244:247], a[220:223], a[44:47], v[244:247]
    v_mfma_f32_16x16x32_bf16 v[240:243], a[220:223], a[36:39], v[240:243]
    v_mfma_f32_16x16x32_bf16 v[240:243], a[216:219], a[32:35], v[240:243]
    s_waitcnt lgkmcnt(4)
    v_mfma_f32_16x16x32_bf16 v[128:131], a[192:195], a[64:67], v[128:131]
    ds_read_b64_tr_b16 a[208:209], v26 offset:16384
    ds_read_b64_tr_b16 a[210:211], v26 offset:18432
    v_mfma_f32_16x16x32_bf16 v[128:131], a[196:199], a[68:71], v[128:131]
    s_movk_i32 s41, 1280
    ds_read_b64_tr_b16 a[212:213], v26 offset:20480
    ds_read_b64_tr_b16 a[214:215], v26 offset:22528
    v_mfma_f32_16x16x32_bf16 v[132:135], a[196:199], a[76:79], v[132:135]
    buffer_load_dword v31, v29, s[72:75], s62 offen sc1
    v_mfma_f32_16x16x32_bf16 v[132:135], a[192:195], a[72:75], v[132:135]
    v_accvgpr_write_b32 a32, 0
    v_accvgpr_write_b32 a33, 0
    v_mfma_f32_16x16x32_bf16 v[136:139], a[192:195], a[80:83], v[136:139]
    v_accvgpr_write_b32 a34, 0
    v_accvgpr_write_b32 a35, 0
    v_mfma_f32_16x16x32_bf16 v[136:139], a[196:199], a[84:87], v[136:139]
    v_accvgpr_write_b32 a36, 0
    v_accvgpr_write_b32 a37, 0
    v_mfma_f32_16x16x32_bf16 v[140:143], a[196:199], a[92:95], v[140:143]
    buffer_load_dwordx4 a[160:163], v2, s[72:75], s52 offen offset:2048 sc1
    v_mfma_f32_16x16x32_bf16 v[140:143], a[192:195], a[88:91], v[140:143]
    s_waitcnt lgkmcnt(4)
    v_accvgpr_write_b32 a38, 0
    v_accvgpr_write_b32 a39, 0
    v_mfma_f32_16x16x32_bf16 v[156:159], a[200:203], a[88:91], v[156:159]
    ds_read_b64_tr_b16 a[216:217], v27 offset:16384
    ds_read_b64_tr_b16 a[218:219], v27 offset:18432
    v_mfma_f32_16x16x32_bf16 v[156:159], a[204:207], a[92:95], v[156:159]
    ds_read_b64_tr_b16 a[220:221], v27 offset:20480
    ds_read_b64_tr_b16 a[222:223], v27 offset:22528
    v_mfma_f32_16x16x32_bf16 v[152:155], a[204:207], a[84:87], v[152:155]
    v_accvgpr_write_b32 a40, 0
    v_accvgpr_write_b32 a41, 0
    v_mfma_f32_16x16x32_bf16 v[152:155], a[200:203], a[80:83], v[152:155]
    buffer_load_dwordx4 a[164:167], v2, s[72:75], s52 offen offset:3072 sc1
    v_mfma_f32_16x16x32_bf16 v[148:151], a[200:203], a[72:75], v[148:151]
    v_accvgpr_write_b32 a42, 0
    v_accvgpr_write_b32 a43, 0
    v_mfma_f32_16x16x32_bf16 v[148:151], a[204:207], a[76:79], v[148:151]
    v_accvgpr_write_b32 a44, 0
    v_accvgpr_write_b32 a45, 0
    v_mfma_f32_16x16x32_bf16 v[144:147], a[204:207], a[68:71], v[144:147]
    v_accvgpr_write_b32 a46, 0
    v_accvgpr_write_b32 a47, 0
    v_mfma_f32_16x16x32_bf16 v[144:147], a[200:203], a[64:67], v[144:147]
    s_waitcnt lgkmcnt(4)
    v_accvgpr_write_b32 a48, 0
    v_accvgpr_write_b32 a49, 0
    v_mfma_f32_16x16x32_bf16 v[160:163], a[208:211], a[64:67], v[160:163]
    ds_read_b64_tr_b16 a[192:193], v24 offset:24576
    ds_read_b64_tr_b16 a[194:195], v24 offset:26624
    v_mfma_f32_16x16x32_bf16 v[160:163], a[212:215], a[68:71], v[160:163]
    ds_read_b64_tr_b16 a[196:197], v24 offset:28672
    ds_read_b64_tr_b16 a[198:199], v24 offset:30720
    v_mfma_f32_16x16x32_bf16 v[164:167], a[212:215], a[76:79], v[164:167]
    buffer_load_dwordx4 a[168:171], v2, s[72:75], s53 offen offset:2048 sc1
    v_mfma_f32_16x16x32_bf16 v[164:167], a[208:211], a[72:75], v[164:167]
    v_accvgpr_write_b32 a50, 0
    v_accvgpr_write_b32 a51, 0
    v_mfma_f32_16x16x32_bf16 v[168:171], a[208:211], a[80:83], v[168:171]
    v_accvgpr_write_b32 a52, 0
    v_accvgpr_write_b32 a53, 0
    v_mfma_f32_16x16x32_bf16 v[168:171], a[212:215], a[84:87], v[168:171]
    buffer_store_dwordx4 v[52:55], v2, s[20:23], s35 offen offset:2048
    v_mfma_f32_16x16x32_bf16 v[172:175], a[212:215], a[92:95], v[172:175]
    v_accvgpr_write_b32 a54, 0
    v_accvgpr_write_b32 a55, 0
    v_mfma_f32_16x16x32_bf16 v[172:175], a[208:211], a[88:91], v[172:175]
    s_waitcnt lgkmcnt(4)
    v_accvgpr_write_b32 a56, 0
    v_accvgpr_write_b32 a57, 0
    v_mfma_f32_16x16x32_bf16 v[188:191], a[216:219], a[88:91], v[188:191]
    ds_read_b64_tr_b16 a[200:201], v25 offset:24576
    ds_read_b64_tr_b16 a[202:203], v25 offset:26624
    v_mfma_f32_16x16x32_bf16 v[188:191], a[220:223], a[92:95], v[188:191]
    ds_read_b64_tr_b16 a[204:205], v25 offset:28672
    ds_read_b64_tr_b16 a[206:207], v25 offset:30720
    v_mfma_f32_16x16x32_bf16 v[184:187], a[220:223], a[84:87], v[184:187]
    buffer_load_dwordx4 a[172:175], v2, s[72:75], s53 offen offset:3072 sc1
    v_mfma_f32_16x16x32_bf16 v[184:187], a[216:219], a[80:83], v[184:187]
    v_accvgpr_write_b32 a58, 0
    v_accvgpr_write_b32 a59, 0
    v_mfma_f32_16x16x32_bf16 v[180:183], a[216:219], a[72:75], v[180:183]
    v_accvgpr_write_b32 a60, 0
    v_accvgpr_write_b32 a61, 0
    v_mfma_f32_16x16x32_bf16 v[180:183], a[220:223], a[76:79], v[180:183]
    v_accvgpr_write_b32 a62, 0
    v_accvgpr_write_b32 a63, 0
    v_mfma_f32_16x16x32_bf16 v[176:179], a[220:223], a[68:71], v[176:179]
    buffer_load_dwordx4 a[176:179], v2, s[72:75], s54 offen offset:2048 sc1
    v_mfma_f32_16x16x32_bf16 v[176:179], a[216:219], a[64:67], v[176:179]
    s_waitcnt lgkmcnt(4)
    v_lshrrev_b32 v15, 3, v1
    v_mul_lo_u32 v3, v15, s41
    v_mfma_f32_16x16x32_bf16 v[192:195], a[192:195], a[64:67], v[192:195]
    ds_read_b64_tr_b16 a[208:209], v26 offset:24576
    ds_read_b64_tr_b16 a[210:211], v26 offset:26624
    v_mfma_f32_16x16x32_bf16 v[192:195], a[196:199], a[68:71], v[192:195]
    ds_read_b64_tr_b16 a[212:213], v26 offset:28672
    ds_read_b64_tr_b16 a[214:215], v26 offset:30720
    v_mfma_f32_16x16x32_bf16 v[196:199], a[196:199], a[76:79], v[196:199]
    v_lshrrev_b32 v15, 3, v1
    v_and_b32 v15, 6, v15
    v_mfma_f32_16x16x32_bf16 v[196:199], a[192:195], a[72:75], v[196:199]
    buffer_load_dwordx4 a[180:183], v2, s[72:75], s54 offen offset:3072 sc1
    v_mfma_f32_16x16x32_bf16 v[200:203], a[192:195], a[80:83], v[200:203]
    v_and_b32 v16, 7, v1
    v_xor_b32 v15, v15, v16
    v_mfma_f32_16x16x32_bf16 v[200:203], a[196:199], a[84:87], v[200:203]
    v_lshlrev_b32 v15, 4, v15
    v_add_u32 v3, v3, v15
    v_mfma_f32_16x16x32_bf16 v[204:207], a[196:199], a[92:95], v[204:207]
    v_mfma_f32_16x16x32_bf16 v[204:207], a[192:195], a[88:91], v[204:207]
    s_waitcnt lgkmcnt(4)
    v_mfma_f32_16x16x32_bf16 v[220:223], a[200:203], a[88:91], v[220:223]
    ds_read_b64_tr_b16 a[216:217], v27 offset:24576
    ds_read_b64_tr_b16 a[218:219], v27 offset:26624
    v_mfma_f32_16x16x32_bf16 v[220:223], a[204:207], a[92:95], v[220:223]
    ds_read_b64_tr_b16 a[220:221], v27 offset:28672
    ds_read_b64_tr_b16 a[222:223], v27 offset:30720
    v_mfma_f32_16x16x32_bf16 v[216:219], a[204:207], a[84:87], v[216:219]
    buffer_store_dwordx4 v[56:59], v2, s[20:23], s33 offen offset:3072
    v_mfma_f32_16x16x32_bf16 v[216:219], a[200:203], a[80:83], v[216:219]
    v_mfma_f32_16x16x32_bf16 v[212:215], a[200:203], a[72:75], v[212:215]
    buffer_load_dwordx4 a[184:187], v2, s[72:75], s55 offen offset:2048 sc1
    v_mfma_f32_16x16x32_bf16 v[212:215], a[204:207], a[76:79], v[212:215]
    v_mfma_f32_16x16x32_bf16 v[208:211], a[204:207], a[68:71], v[208:211]
    v_mfma_f32_16x16x32_bf16 v[208:211], a[200:203], a[64:67], v[208:211]
    s_waitcnt lgkmcnt(4)
    v_mfma_f32_16x16x32_bf16 v[224:227], a[208:211], a[64:67], v[224:227]
    s_waitcnt vmcnt(9) lgkmcnt(0)
    v_mfma_f32_16x16x32_bf16 v[224:227], a[212:215], a[68:71], v[224:227]
    s_barrier
    v_mfma_f32_16x16x32_bf16 v[228:231], a[212:215], a[76:79], v[228:231]
    ds_read_b64_tr_b16 a[192:193], v8 offset:0
    ds_read_b64_tr_b16 a[194:195], v8 offset:2048
    v_mfma_f32_16x16x32_bf16 v[228:231], a[208:211], a[72:75], v[228:231]
    ds_read_b64_tr_b16 a[196:197], v8 offset:4096
    ds_read_b64_tr_b16 a[198:199], v8 offset:6144
    v_mfma_f32_16x16x32_bf16 v[232:235], a[208:211], a[80:83], v[232:235]
    buffer_load_dwordx4 a[188:191], v2, s[72:75], s55 offen offset:3072 sc1
    v_mfma_f32_16x16x32_bf16 v[232:235], a[212:215], a[84:87], v[232:235]
    v_mfma_f32_16x16x32_bf16 v[236:239], a[212:215], a[92:95], v[236:239]
    buffer_store_dwordx4 v[60:63], v2, s[20:23], s35 offen offset:3072
    v_mfma_f32_16x16x32_bf16 v[236:239], a[208:211], a[88:91], v[236:239]
    s_add_u32 s52, s52, 4096
    s_add_u32 s53, s53, 4096
    s_add_u32 s54, s54, 4096
    v_mfma_f32_16x16x32_bf16 v[252:255], a[216:219], a[88:91], v[252:255]
    s_add_u32 s55, s55, 4096
    ds_read_b64_tr_b16 a[200:201], v9 offset:0
    ds_read_b64_tr_b16 a[202:203], v9 offset:2048
    v_mfma_f32_16x16x32_bf16 v[252:255], a[220:223], a[92:95], v[252:255]
    ds_read_b64_tr_b16 a[204:205], v9 offset:4096
    ds_read_b64_tr_b16 a[206:207], v9 offset:6144
    v_mfma_f32_16x16x32_bf16 v[248:251], a[220:223], a[84:87], v[248:251]
    v_mfma_f32_16x16x32_bf16 v[248:251], a[216:219], a[80:83], v[248:251]
    v_mfma_f32_16x16x32_bf16 v[244:247], a[216:219], a[72:75], v[244:247]
    v_mfma_f32_16x16x32_bf16 v[244:247], a[220:223], a[76:79], v[244:247]
    v_mfma_f32_16x16x32_bf16 v[240:243], a[220:223], a[68:71], v[240:243]
    v_mfma_f32_16x16x32_bf16 v[240:243], a[216:219], a[64:67], v[240:243]
    s_waitcnt lgkmcnt(4)
    v_mfma_f32_16x16x32_bf16 v[128:131], a[192:195], a[128:131], v[128:131]
    ds_read_b64_tr_b16 a[208:209], v10 offset:0
    ds_read_b64_tr_b16 a[210:211], v10 offset:2048
    v_mfma_f32_16x16x32_bf16 v[128:131], a[196:199], a[132:135], v[128:131]
    ds_read_b64_tr_b16 a[212:213], v10 offset:4096
    ds_read_b64_tr_b16 a[214:215], v10 offset:6144
    v_mfma_f32_16x16x32_bf16 v[132:135], a[196:199], a[140:143], v[132:135]
    v_and_b32 v31, 0xff, v31
    v_cmp_gt_u32 vcc, 8, v31
    v_mfma_f32_16x16x32_bf16 v[132:135], a[192:195], a[136:139], v[132:135]
    s_and_b32 s28, vcc_lo, 1
    v_accvgpr_write_b32 a64, 0
    v_accvgpr_write_b32 a65, 0
    v_mfma_f32_16x16x32_bf16 v[136:139], a[192:195], a[144:147], v[136:139]
    s_cmp_gt_u32 s28, s40
    s_cbranch_scc1 KA_spin_kv
KA_ret_kv:
    v_mfma_f32_16x16x32_bf16 v[136:139], a[196:199], a[148:151], v[136:139]
    s_barrier
    v_mfma_f32_16x16x32_bf16 v[140:143], a[196:199], a[156:159], v[140:143]
    s_lshl_b32 s28, s27, 15
    s_sub_u32 s18, 524288, s28
    s_mov_b32 s22, s18
    v_mfma_f32_16x16x32_bf16 v[140:143], a[192:195], a[152:155], v[140:143]
    s_waitcnt lgkmcnt(4)
    s_mov_b32 s32, 0
    s_mov_b32 s33, 0
    v_mfma_f32_16x16x32_bf16 v[156:159], a[200:203], a[152:155], v[156:159]
    s_add_u32 s34, s39, 0x18000
    ds_read_b64_tr_b16 a[216:217], v11 offset:0
    ds_read_b64_tr_b16 a[218:219], v11 offset:2048
    v_mfma_f32_16x16x32_bf16 v[156:159], a[204:207], a[156:159], v[156:159]
    s_add_u32 s35, s39, 0x8000
    ds_read_b64_tr_b16 a[220:221], v11 offset:4096
    ds_read_b64_tr_b16 a[222:223], v11 offset:6144
    v_mfma_f32_16x16x32_bf16 v[152:155], a[204:207], a[148:151], v[152:155]
    s_mov_b32 s31, -1
    s_mov_b32 s43, 0
    s_add_u32 s85, s30, 2
    v_mfma_f32_16x16x32_bf16 v[152:155], a[200:203], a[144:147], v[152:155]
    s_mov_b32 s79, 0x4000000
    s_sub_u32 s87, s30, 2
    s_mov_b32 s60, 0x1000000
    v_mfma_f32_16x16x32_bf16 v[148:151], a[200:203], a[136:139], v[148:151]
    s_movk_i32 s41, 8192
    v_add_u32 v5, 0x18000, v2
    v_add_u32 v6, 0x8000, v2
    v_mfma_f32_16x16x32_bf16 v[148:151], a[204:207], a[140:143], v[148:151]
    s_add_u32 m0, s34, 0
    v_accvgpr_write_b32 a66, 0
    v_accvgpr_write_b32 a67, 0
    v_mfma_f32_16x16x32_bf16 v[144:147], a[204:207], a[132:135], v[144:147]
    buffer_load_dwordx4 v4, s[16:19], s32 offen offset:0 sc1 lds
    v_mfma_f32_16x16x32_bf16 v[144:147], a[200:203], a[128:131], v[144:147]
    s_waitcnt lgkmcnt(4)
    v_accvgpr_write_b32 a68, 0
    v_accvgpr_write_b32 a69, 0
    v_mfma_f32_16x16x32_bf16 v[160:163], a[208:211], a[128:131], v[160:163]
    ds_read_b64_tr_b16 a[192:193], v8 offset:8192
    ds_read_b64_tr_b16 a[194:195], v8 offset:10240
    v_mfma_f32_16x16x32_bf16 v[160:163], a[212:215], a[132:135], v[160:163]
    ds_read_b64_tr_b16 a[196:197], v8 offset:12288
    ds_read_b64_tr_b16 a[198:199], v8 offset:14336
    v_mfma_f32_16x16x32_bf16 v[164:167], a[212:215], a[140:143], v[164:167]
    buffer_load_dwordx4 v4, s[16:19], s32 offen offset:1024 sc1 lds
    v_mfma_f32_16x16x32_bf16 v[164:167], a[208:211], a[136:139], v[164:167]
    s_add_u32 s32, s32, 8192
    s_add_u32 m0, s34, 16384
    v_accvgpr_write_b32 a70, 0
    v_mfma_f32_16x16x32_bf16 v[168:171], a[208:211], a[144:147], v[168:171]
    buffer_load_dwordx4 v4, s[16:19], s32 offen offset:0 sc1 lds
    v_mfma_f32_16x16x32_bf16 v[168:171], a[212:215], a[148:151], v[168:171]
    v_accvgpr_write_b32 a71, 0
    v_accvgpr_write_b32 a72, 0
    v_mfma_f32_16x16x32_bf16 v[172:175], a[212:215], a[156:159], v[172:175]
    v_accvgpr_write_b32 a73, 0
    v_accvgpr_write_b32 a74, 0
    v_mfma_f32_16x16x32_bf16 v[172:175], a[208:211], a[152:155], v[172:175]
    s_waitcnt lgkmcnt(4)
    v_accvgpr_write_b32 a75, 0
    v_accvgpr_write_b32 a76, 0
    v_mfma_f32_16x16x32_bf16 v[188:191], a[216:219], a[152:155], v[188:191]
    ds_read_b64_tr_b16 a[200:201], v9 offset:8192
    ds_read_b64_tr_b16 a[202:203], v9 offset:10240
    v_mfma_f32_16x16x32_bf16 v[188:191], a[220:223], a[156:159], v[188:191]
    ds_read_b64_tr_b16 a[204:205], v9 offset:12288
    ds_read_b64_tr_b16 a[206:207], v9 offset:14336
    v_mfma_f32_16x16x32_bf16 v[184:187], a[220:223], a[148:151], v[184:187]
    buffer_load_dwordx4 v4, s[16:19], s32 offen offset:1024 sc1 lds
    v_mfma_f32_16x16x32_bf16 v[184:187], a[216:219], a[144:147], v[184:187]
    s_add_u32 s32, s32, 8192
    s_xor_b32 s34, s34, 0x38000
    s_add_u32 m0, s34, 0
    v_mfma_f32_16x16x32_bf16 v[180:183], a[216:219], a[136:139], v[180:183]
    v_accvgpr_write_b32 a77, 0
    v_accvgpr_write_b32 a78, 0
    v_mfma_f32_16x16x32_bf16 v[180:183], a[220:223], a[140:143], v[180:183]
    v_accvgpr_write_b32 a79, 0
    v_accvgpr_write_b32 a80, 0
    v_mfma_f32_16x16x32_bf16 v[176:179], a[220:223], a[132:135], v[176:179]
    buffer_load_dwordx4 v4, s[16:19], s32 offen offset:0 sc1 lds
    v_mfma_f32_16x16x32_bf16 v[176:179], a[216:219], a[128:131], v[176:179]
    s_waitcnt lgkmcnt(4)
    v_accvgpr_write_b32 a81, 0
    v_accvgpr_write_b32 a82, 0
    v_mfma_f32_16x16x32_bf16 v[192:195], a[192:195], a[128:131], v[192:195]
    ds_read_b64_tr_b16 a[208:209], v10 offset:8192
    ds_read_b64_tr_b16 a[210:211], v10 offset:10240
    v_mfma_f32_16x16x32_bf16 v[192:195], a[196:199], a[132:135], v[192:195]
    ds_read_b64_tr_b16 a[212:213], v10 offset:12288
    ds_read_b64_tr_b16 a[214:215], v10 offset:14336
    v_mfma_f32_16x16x32_bf16 v[196:199], a[196:199], a[140:143], v[196:199]
    v_accvgpr_write_b32 a83, 0
    v_accvgpr_write_b32 a84, 0
    v_mfma_f32_16x16x32_bf16 v[196:199], a[192:195], a[136:139], v[196:199]
    v_accvgpr_write_b32 a85, 0
    v_accvgpr_write_b32 a86, 0
    v_mfma_f32_16x16x32_bf16 v[200:203], a[192:195], a[144:147], v[200:203]
    buffer_load_dwordx4 v4, s[16:19], s32 offen offset:1024 sc1 lds
    v_mfma_f32_16x16x32_bf16 v[200:203], a[196:199], a[148:151], v[200:203]
    s_add_u32 s32, s32, 8192
    v_accvgpr_write_b32 a87, 0
    v_accvgpr_write_b32 a88, 0
    v_mfma_f32_16x16x32_bf16 v[204:207], a[196:199], a[156:159], v[204:207]
    v_accvgpr_write_b32 a89, 0
    v_accvgpr_write_b32 a90, 0
    v_mfma_f32_16x16x32_bf16 v[204:207], a[192:195], a[152:155], v[204:207]
    s_waitcnt lgkmcnt(4)
    v_accvgpr_write_b32 a91, 0
    v_accvgpr_write_b32 a92, 0
    v_mfma_f32_16x16x32_bf16 v[220:223], a[200:203], a[152:155], v[220:223]
    ds_read_b64_tr_b16 a[216:217], v11 offset:8192
    ds_read_b64_tr_b16 a[218:219], v11 offset:10240
    v_mfma_f32_16x16x32_bf16 v[220:223], a[204:207], a[156:159], v[220:223]
    ds_read_b64_tr_b16 a[220:221], v11 offset:12288
    ds_read_b64_tr_b16 a[222:223], v11 offset:14336
    v_mfma_f32_16x16x32_bf16 v[216:219], a[204:207], a[148:151], v[216:219]
    v_accvgpr_write_b32 a93, 0
    v_accvgpr_write_b32 a94, 0
    v_mfma_f32_16x16x32_bf16 v[216:219], a[200:203], a[144:147], v[216:219]
    v_accvgpr_write_b32 a95, 0
    v_mfma_f32_16x16x32_bf16 v[212:215], a[200:203], a[136:139], v[212:215]
    v_mfma_f32_16x16x32_bf16 v[212:215], a[204:207], a[140:143], v[212:215]
    v_mfma_f32_16x16x32_bf16 v[208:211], a[204:207], a[132:135], v[208:211]
    v_mfma_f32_16x16x32_bf16 v[208:211], a[200:203], a[128:131], v[208:211]
    s_waitcnt lgkmcnt(4)
    v_mfma_f32_16x16x32_bf16 v[224:227], a[208:211], a[128:131], v[224:227]
    ds_read_b64_tr_b16 a[192:193], v8 offset:16384
    ds_read_b64_tr_b16 a[194:195], v8 offset:18432
    v_mfma_f32_16x16x32_bf16 v[224:227], a[212:215], a[132:135], v[224:227]
    ds_read_b64_tr_b16 a[196:197], v8 offset:20480
    ds_read_b64_tr_b16 a[198:199], v8 offset:22528
    v_mfma_f32_16x16x32_bf16 v[228:231], a[212:215], a[140:143], v[228:231]
    v_mfma_f32_16x16x32_bf16 v[228:231], a[208:211], a[136:139], v[228:231]
    v_mfma_f32_16x16x32_bf16 v[232:235], a[208:211], a[144:147], v[232:235]
    v_mfma_f32_16x16x32_bf16 v[232:235], a[212:215], a[148:151], v[232:235]
    v_mfma_f32_16x16x32_bf16 v[236:239], a[212:215], a[156:159], v[236:239]
    v_mfma_f32_16x16x32_bf16 v[236:239], a[208:211], a[152:155], v[236:239]
    s_waitcnt vmcnt(7) lgkmcnt(4)
    v_mfma_f32_16x16x32_bf16 v[252:255], a[216:219], a[152:155], v[252:255]
    ds_read_b64_tr_b16 a[200:201], v9 offset:16384
    ds_read_b64_tr_b16 a[202:203], v9 offset:18432
    v_mfma_f32_16x16x32_bf16 v[252:255], a[220:223], a[156:159], v[252:255]
    ds_read_b64_tr_b16 a[204:205], v9 offset:20480
    ds_read_b64_tr_b16 a[206:207], v9 offset:22528
    v_mfma_f32_16x16x32_bf16 v[248:251], a[220:223], a[148:151], v[248:251]
    v_mfma_f32_16x16x32_bf16 v[248:251], a[216:219], a[144:147], v[248:251]
    v_mfma_f32_16x16x32_bf16 v[244:247], a[216:219], a[136:139], v[244:247]
    v_mfma_f32_16x16x32_bf16 v[244:247], a[220:223], a[140:143], v[244:247]
    v_mfma_f32_16x16x32_bf16 v[240:243], a[220:223], a[132:135], v[240:243]
    v_mfma_f32_16x16x32_bf16 v[240:243], a[216:219], a[128:131], v[240:243]
    s_waitcnt lgkmcnt(4)
    v_mfma_f32_16x16x32_bf16 v[128:131], a[192:195], a[160:163], v[128:131]
    ds_read_b64_tr_b16 a[208:209], v10 offset:16384
    ds_read_b64_tr_b16 a[210:211], v10 offset:18432
    v_mfma_f32_16x16x32_bf16 v[128:131], a[196:199], a[164:167], v[128:131]
    s_add_u32 s68, s4, 0x1200000
    s_addc_u32 s69, s5, 0
    ds_read_b64_tr_b16 a[212:213], v10 offset:20480
    ds_read_b64_tr_b16 a[214:215], v10 offset:22528
    v_mfma_f32_16x16x32_bf16 v[132:135], a[196:199], a[172:175], v[132:135]
    s_mov_b32 s70, 5242880
    v_mov_b32 v96, 0
    v_mov_b32 v97, 0
    v_mfma_f32_16x16x32_bf16 v[132:135], a[192:195], a[168:171], v[132:135]
    s_mov_b32 s71, 0x20000
    v_mov_b32 v98, 0
    v_mov_b32 v99, 0
    v_mfma_f32_16x16x32_bf16 v[136:139], a[192:195], a[176:179], v[136:139]
    s_lshr_b32 s29, s3, 1
    v_mov_b32 v100, 0
    v_mov_b32 v101, 0
    v_mfma_f32_16x16x32_bf16 v[136:139], a[196:199], a[180:183], v[136:139]
    s_mul_i32 s55, s29, 81920
    v_mov_b32 v102, 0
    v_mov_b32 v103, 0
    v_mfma_f32_16x16x32_bf16 v[140:143], a[196:199], a[188:191], v[140:143]
    s_and_b32 s29, s3, 1
    v_mov_b32 v104, 0
    v_mov_b32 v105, 0
    v_mfma_f32_16x16x32_bf16 v[140:143], a[192:195], a[184:187], v[140:143]
    s_waitcnt lgkmcnt(4)
    v_mov_b32 v106, 0
    v_mov_b32 v107, 0
    v_mfma_f32_16x16x32_bf16 v[156:159], a[200:203], a[184:187], v[156:159]
    s_mul_i32 s29, s29, 5120
    ds_read_b64_tr_b16 a[216:217], v11 offset:16384
    ds_read_b64_tr_b16 a[218:219], v11 offset:18432
    v_mfma_f32_16x16x32_bf16 v[156:159], a[204:207], a[188:191], v[156:159]
    s_add_u32 s55, s55, s29
    ds_read_b64_tr_b16 a[220:221], v11 offset:20480
    ds_read_b64_tr_b16 a[222:223], v11 offset:22528
    v_mfma_f32_16x16x32_bf16 v[152:155], a[204:207], a[180:183], v[152:155]
    s_and_b32 s54, s2, 3
    v_mov_b32 v108, 0
    v_mov_b32 v109, 0
    v_mfma_f32_16x16x32_bf16 v[152:155], a[200:203], a[176:179], v[152:155]
    s_lshl_b32 s54, s54, 15
    v_mov_b32 v110, 0
    v_mov_b32 v111, 0
    v_mfma_f32_16x16x32_bf16 v[148:151], a[200:203], a[168:171], v[148:151]
    v_mov_b32 v112, 0
    v_mov_b32 v113, 0
    v_mfma_f32_16x16x32_bf16 v[148:151], a[204:207], a[172:175], v[148:151]
    v_mov_b32 v114, 0
    v_mov_b32 v115, 0
    v_mfma_f32_16x16x32_bf16 v[144:147], a[204:207], a[164:167], v[144:147]
    v_mov_b32 v116, 0
    v_mov_b32 v117, 0
    v_mfma_f32_16x16x32_bf16 v[144:147], a[200:203], a[160:163], v[144:147]
    s_waitcnt lgkmcnt(4)
    v_mov_b32 v118, 0
    v_mov_b32 v119, 0
    v_mfma_f32_16x16x32_bf16 v[160:163], a[208:211], a[160:163], v[160:163]
    ds_read_b64_tr_b16 a[192:193], v8 offset:24576
    ds_read_b64_tr_b16 a[194:195], v8 offset:26624
    v_mfma_f32_16x16x32_bf16 v[160:163], a[212:215], a[164:167], v[160:163]
    ds_read_b64_tr_b16 a[196:197], v8 offset:28672
    ds_read_b64_tr_b16 a[198:199], v8 offset:30720
    v_mfma_f32_16x16x32_bf16 v[164:167], a[212:215], a[172:175], v[164:167]
    v_mov_b32 v120, 0
    v_mov_b32 v121, 0
    v_mfma_f32_16x16x32_bf16 v[164:167], a[208:211], a[168:171], v[164:167]
    v_mov_b32 v122, 0
    v_mov_b32 v123, 0
    v_mfma_f32_16x16x32_bf16 v[168:171], a[208:211], a[176:179], v[168:171]
    v_mov_b32 v124, 0
    v_mov_b32 v125, 0
    v_mfma_f32_16x16x32_bf16 v[168:171], a[212:215], a[180:183], v[168:171]
    v_mov_b32 v126, 0
    v_mov_b32 v127, 0
    v_mfma_f32_16x16x32_bf16 v[172:175], a[212:215], a[188:191], v[172:175]
    v_mfma_f32_16x16x32_bf16 v[172:175], a[208:211], a[184:187], v[172:175]
    s_waitcnt lgkmcnt(4)
    v_mfma_f32_16x16x32_bf16 v[188:191], a[216:219], a[184:187], v[188:191]
    ds_read_b64_tr_b16 a[200:201], v9 offset:24576
    ds_read_b64_tr_b16 a[202:203], v9 offset:26624
    v_mfma_f32_16x16x32_bf16 v[188:191], a[220:223], a[188:191], v[188:191]
    ds_read_b64_tr_b16 a[204:205], v9 offset:28672
    ds_read_b64_tr_b16 a[206:207], v9 offset:30720
    v_mfma_f32_16x16x32_bf16 v[184:187], a[220:223], a[180:183], v[184:187]
    v_mfma_f32_16x16x32_bf16 v[184:187], a[216:219], a[176:179], v[184:187]
    v_mfma_f32_16x16x32_bf16 v[180:183], a[216:219], a[168:171], v[180:183]
    v_mfma_f32_16x16x32_bf16 v[180:183], a[220:223], a[172:175], v[180:183]
    v_mfma_f32_16x16x32_bf16 v[176:179], a[220:223], a[164:167], v[176:179]
    v_mfma_f32_16x16x32_bf16 v[176:179], a[216:219], a[160:163], v[176:179]
    s_waitcnt lgkmcnt(4)
    v_mfma_f32_16x16x32_bf16 v[192:195], a[192:195], a[160:163], v[192:195]
    ds_read_b64_tr_b16 a[208:209], v10 offset:24576
    ds_read_b64_tr_b16 a[210:211], v10 offset:26624
    v_mfma_f32_16x16x32_bf16 v[192:195], a[196:199], a[164:167], v[192:195]
    ds_read_b64_tr_b16 a[212:213], v10 offset:28672
    ds_read_b64_tr_b16 a[214:215], v10 offset:30720
    v_mfma_f32_16x16x32_bf16 v[196:199], a[196:199], a[172:175], v[196:199]
    s_waitcnt vmcnt(6)
    v_mfma_f32_16x16x32_bf16 v[196:199], a[192:195], a[168:171], v[196:199]
    s_barrier
    v_mfma_f32_16x16x32_bf16 v[200:203], a[192:195], a[176:179], v[200:203]
    s_cmp_lt_u32 s61, 8
    s_cbranch_scc1 KA_wc
KA_wcr:
    v_mfma_f32_16x16x32_bf16 v[200:203], a[196:199], a[180:183], v[200:203]
    v_mov_b32 v13, 0x100
    v_mfma_f32_16x16x32_bf16 v[204:207], a[196:199], a[188:191], v[204:207]
    buffer_atomic_add v13, v29, s[72:75], s62 offen
    v_mfma_f32_16x16x32_bf16 v[204:207], a[192:195], a[184:187], v[204:207]
    s_waitcnt lgkmcnt(4)
    v_mfma_f32_16x16x32_bf16 v[220:223], a[200:203], a[184:187], v[220:223]
    ds_read_b64_tr_b16 a[216:217], v11 offset:24576
    ds_read_b64_tr_b16 a[218:219], v11 offset:26624
    v_mfma_f32_16x16x32_bf16 v[220:223], a[204:207], a[188:191], v[220:223]
    ds_read_b64_tr_b16 a[220:221], v11 offset:28672
    ds_read_b64_tr_b16 a[222:223], v11 offset:30720
    v_mfma_f32_16x16x32_bf16 v[216:219], a[204:207], a[180:183], v[216:219]
    v_mfma_f32_16x16x32_bf16 v[216:219], a[200:203], a[176:179], v[216:219]
    v_mfma_f32_16x16x32_bf16 v[212:215], a[200:203], a[168:171], v[212:215]
    v_mfma_f32_16x16x32_bf16 v[212:215], a[204:207], a[172:175], v[212:215]
    v_mfma_f32_16x16x32_bf16 v[208:211], a[204:207], a[164:167], v[208:211]
    v_mfma_f32_16x16x32_bf16 v[208:211], a[200:203], a[160:163], v[208:211]
    s_waitcnt lgkmcnt(4)
    v_mfma_f32_16x16x32_bf16 v[224:227], a[208:211], a[160:163], v[224:227]
    v_mfma_f32_16x16x32_bf16 v[224:227], a[212:215], a[164:167], v[224:227]
    v_mfma_f32_16x16x32_bf16 v[228:231], a[212:215], a[172:175], v[228:231]
    v_mfma_f32_16x16x32_bf16 v[228:231], a[208:211], a[168:171], v[228:231]
    v_mfma_f32_16x16x32_bf16 v[232:235], a[208:211], a[176:179], v[232:235]
    v_mfma_f32_16x16x32_bf16 v[232:235], a[212:215], a[180:183], v[232:235]
    v_mfma_f32_16x16x32_bf16 v[236:239], a[212:215], a[188:191], v[236:239]
    s_waitcnt vmcnt(3) lgkmcnt(0)
    v_mfma_f32_16x16x32_bf16 v[236:239], a[208:211], a[184:187], v[236:239]
    s_barrier
    v_mfma_f32_16x16x32_bf16 v[252:255], a[216:219], a[184:187], v[252:255]
    v_mfma_f32_16x16x32_bf16 v[252:255], a[220:223], a[188:191], v[252:255]
    v_mfma_f32_16x16x32_bf16 v[248:251], a[220:223], a[180:183], v[248:251]
    v_mfma_f32_16x16x32_bf16 v[248:251], a[216:219], a[176:179], v[248:251]
    v_mfma_f32_16x16x32_bf16 v[244:247], a[216:219], a[168:171], v[244:247]
    v_mfma_f32_16x16x32_bf16 v[244:247], a[220:223], a[172:175], v[244:247]
    v_mfma_f32_16x16x32_bf16 v[240:243], a[220:223], a[164:167], v[240:243]
    v_mfma_f32_16x16x32_bf16 v[240:243], a[216:219], a[160:163], v[240:243]
    ds_read_b128 a[192:195], v5 offset:0
    ds_read_b128 a[196:199], v5 offset:1024
    ds_read_b128 a[200:203], v5 offset:2048
    ds_read_b128 a[204:207], v5 offset:3072
    ds_read_b128 a[208:211], v5 offset:4096
    ds_read_b128 a[212:215], v5 offset:5120
    ds_read_b128 a[216:219], v5 offset:6144
    ds_read_b128 a[220:223], v5 offset:7168
    v_mov_b32 v24, 0x3f803f80
    v_mov_b32 v25, 0x3f803f80
    v_mov_b32 v26, 0x3f803f80
    v_mov_b32 v27, 0x3f803f80
    v_add_u32 v8, s40, v8
    v_mov_b32 v9, v8
    v_min_u32 v10, 39, v1
    v_mul_u32_u24 v10, 3456, v10
    v_cvt_pk_bf16_f32 v13, v128, v129
    v_cvt_pk_bf16_f32 v14, v130, v131
    v_cvt_pk_bf16_f32 v15, v144, v145
    v_cvt_pk_bf16_f32 v16, v146, v147
    v_accvgpr_write_b32 a128, v13
    v_accvgpr_write_b32 a129, v14
    v_accvgpr_write_b32 a130, v15
    v_accvgpr_write_b32 a131, v16
    v_cvt_pk_bf16_f32 v17, v160, v161
    v_cvt_pk_bf16_f32 v18, v162, v163
    v_cvt_pk_bf16_f32 v19, v176, v177
    v_cvt_pk_bf16_f32 v20, v178, v179
    v_accvgpr_write_b32 a132, v17
    v_accvgpr_write_b32 a133, v18
    v_accvgpr_write_b32 a134, v19
    v_accvgpr_write_b32 a135, v20
    v_cvt_pk_bf16_f32 v13, v192, v193
    v_cvt_pk_bf16_f32 v14, v194, v195
    v_cvt_pk_bf16_f32 v15, v208, v209
    v_cvt_pk_bf16_f32 v16, v210, v211
    v_accvgpr_write_b32 a136, v13
    v_accvgpr_write_b32 a137, v14
    v_accvgpr_write_b32 a138, v15
    v_accvgpr_write_b32 a139, v16
    v_cvt_pk_bf16_f32 v17, v224, v225
    v_cvt_pk_bf16_f32 v18, v226, v227
    v_cvt_pk_bf16_f32 v19, v240, v241
    v_cvt_pk_bf16_f32 v20, v242, v243
    v_accvgpr_write_b32 a140, v17
    v_accvgpr_write_b32 a141, v18
    v_accvgpr_write_b32 a142, v19
    v_accvgpr_write_b32 a143, v20
    v_cvt_pk_bf16_f32 v13, v132, v133
    v_cvt_pk_bf16_f32 v14, v134, v135
    v_cvt_pk_bf16_f32 v15, v148, v149
    v_cvt_pk_bf16_f32 v16, v150, v151
    v_accvgpr_write_b32 a144, v13
    v_accvgpr_write_b32 a145, v14
    v_accvgpr_write_b32 a146, v15
    v_accvgpr_write_b32 a147, v16
    v_cvt_pk_bf16_f32 v17, v164, v165
    v_cvt_pk_bf16_f32 v18, v166, v167
    v_cvt_pk_bf16_f32 v19, v180, v181
    v_cvt_pk_bf16_f32 v20, v182, v183
    v_accvgpr_write_b32 a148, v17
    v_accvgpr_write_b32 a149, v18
    v_accvgpr_write_b32 a150, v19
    v_accvgpr_write_b32 a151, v20
    v_cvt_pk_bf16_f32 v13, v196, v197
    v_cvt_pk_bf16_f32 v14, v198, v199
    v_cvt_pk_bf16_f32 v15, v212, v213
    v_cvt_pk_bf16_f32 v16, v214, v215
    v_accvgpr_write_b32 a152, v13
    v_accvgpr_write_b32 a153, v14
    v_accvgpr_write_b32 a154, v15
    v_accvgpr_write_b32 a155, v16
    v_cvt_pk_bf16_f32 v17, v228, v229
    v_cvt_pk_bf16_f32 v18, v230, v231
    v_cvt_pk_bf16_f32 v19, v244, v245
    v_cvt_pk_bf16_f32 v20, v246, v247
    v_accvgpr_write_b32 a156, v17
    v_accvgpr_write_b32 a157, v18
    v_accvgpr_write_b32 a158, v19
    v_accvgpr_write_b32 a159, v20
    v_cvt_pk_bf16_f32 v13, v136, v137
    v_cvt_pk_bf16_f32 v14, v138, v139
    v_cvt_pk_bf16_f32 v15, v152, v153
    v_cvt_pk_bf16_f32 v16, v154, v155
    v_accvgpr_write_b32 a160, v13
    v_accvgpr_write_b32 a161, v14
    v_accvgpr_write_b32 a162, v15
    v_accvgpr_write_b32 a163, v16
    v_cvt_pk_bf16_f32 v17, v168, v169
    v_cvt_pk_bf16_f32 v18, v170, v171
    v_cvt_pk_bf16_f32 v19, v184, v185
    v_cvt_pk_bf16_f32 v20, v186, v187
    v_accvgpr_write_b32 a164, v17
    v_accvgpr_write_b32 a165, v18
    v_accvgpr_write_b32 a166, v19
    v_accvgpr_write_b32 a167, v20
    v_cvt_pk_bf16_f32 v13, v200, v201
    v_cvt_pk_bf16_f32 v14, v202, v203
    v_cvt_pk_bf16_f32 v15, v216, v217
    v_cvt_pk_bf16_f32 v16, v218, v219
    v_accvgpr_write_b32 a168, v13
    v_accvgpr_write_b32 a169, v14
    v_accvgpr_write_b32 a170, v15
    v_accvgpr_write_b32 a171, v16
    v_cvt_pk_bf16_f32 v17, v232, v233
    v_cvt_pk_bf16_f32 v18, v234, v235
    v_cvt_pk_bf16_f32 v19, v248, v249
    v_cvt_pk_bf16_f32 v20, v250, v251
    v_accvgpr_write_b32 a172, v17
    v_accvgpr_write_b32 a173, v18
    v_accvgpr_write_b32 a174, v19
    v_accvgpr_write_b32 a175, v20
    v_cvt_pk_bf16_f32 v13, v140, v141
    v_cvt_pk_bf16_f32 v14, v142, v143
    v_cvt_pk_bf16_f32 v15, v156, v157
    v_cvt_pk_bf16_f32 v16, v158, v159
    v_accvgpr_write_b32 a176, v13
    v_accvgpr_write_b32 a177, v14
    v_accvgpr_write_b32 a178, v15
    v_accvgpr_write_b32 a179, v16
    v_cvt_pk_bf16_f32 v17, v172, v173
    v_cvt_pk_bf16_f32 v18, v174, v175
    v_cvt_pk_bf16_f32 v19, v188, v189
    v_cvt_pk_bf16_f32 v20, v190, v191
    v_accvgpr_write_b32 a180, v17
    v_accvgpr_write_b32 a181, v18
    v_accvgpr_write_b32 a182, v19
    v_accvgpr_write_b32 a183, v20
    v_cvt_pk_bf16_f32 v13, v204, v205
    v_cvt_pk_bf16_f32 v14, v206, v207
    v_cvt_pk_bf16_f32 v15, v220, v221
    v_cvt_pk_bf16_f32 v16, v222, v223
    v_accvgpr_write_b32 a184, v13
    v_accvgpr_write_b32 a185, v14
    v_accvgpr_write_b32 a186, v15
    v_accvgpr_write_b32 a187, v16
    v_cvt_pk_bf16_f32 v17, v236, v237
    v_cvt_pk_bf16_f32 v18, v238, v239
    v_cvt_pk_bf16_f32 v19, v252, v253
    v_cvt_pk_bf16_f32 v20, v254, v255
    v_accvgpr_write_b32 a188, v17
    v_accvgpr_write_b32 a189, v18
    v_accvgpr_write_b32 a190, v19
    v_accvgpr_write_b32 a191, v20
    v_accvgpr_read_b32 v250, a227
    v_accvgpr_read_b32 v251, a228
    v_accvgpr_read_b32 v252, a229
    v_accvgpr_read_b32 v253, a230
    v_accvgpr_read_b32 v254, a231
    buffer_load_dword v31, v29, s[72:75], s62 offen sc1
    s_waitcnt lgkmcnt(0)
    s_branch K2_QKd0
KA_spin_ini:
    s_cmp_lg_u32 s3, 0
    s_cbranch_scc1 KA_ret_ini
    s_mov_b32 s29, 0x20000
KA_spinl_ini:
    s_sleep 8
    buffer_load_dword v31, v29, s[76:79], 0 offen sc1
    s_waitcnt vmcnt(0)
    v_cmp_gt_u32 vcc, 1, v31
    s_sub_u32 s29, s29, 1
    s_cmp_eq_u32 s29, 0
    s_cbranch_scc1 KA_ret_ini
    s_and_b32 s28, vcc_lo, 1
    s_cmp_lg_u32 s28, 0
    s_cbranch_scc1 KA_spinl_ini
    s_branch KA_ret_ini
KA_spin_mod:
    s_cmp_lg_u32 s3, 0
    s_cbranch_scc1 KA_ret_mod
    s_mov_b32 s29, 0x20000
KA_spinl_mod:
    s_sleep 8
    v_lshrrev_b32 v31, 3, v1
    v_lshl_or_b32 v31, v31, 26, s43
    v_lshl_or_b32 v31, v1, 7, v31
    buffer_load_dword v31, v31, s[72:75], s41 offen sc1
    s_waitcnt vmcnt(0)
    v_cmp_gt_u32 vcc, 20, v31
    s_sub_u32 s29, s29, 1
    s_cmp_eq_u32 s29, 0
    s_cbranch_scc1 KA_ret_mod
    s_and_b32 s28, vcc_lo, 15
    s_cmp_lg_u32 s28, 0
    s_cbranch_scc1 KA_spinl_mod
    s_branch KA_ret_mod
KA_spin_h:
    s_cmp_lg_u32 s3, 0
    s_cbranch_scc1 KA_ret_h
    s_mov_b32 s29, 0x20000
KA_spinl_h:
    s_sleep 8
    v_lshrrev_b32 v31, 3, v1
    v_lshl_or_b32 v31, v31, 26, s43
    v_lshl_or_b32 v31, v1, 7, v31
    buffer_load_dword v31, v31, s[72:75], s25 offen sc1
    s_waitcnt vmcnt(0)
    v_cmp_gt_u32 vcc, 8, v31
    s_sub_u32 s29, s29, 1
    s_cmp_eq_u32 s29, 0
    s_cbranch_scc1 KA_ret_h
    s_and_b32 s28, vcc_lo, 15
    s_cmp_lg_u32 s28, 0
    s_cbranch_scc1 KA_spinl_h
    s_branch KA_ret_h
KA_wb:
    s_cmp_lg_u32 s3, 0
    s_cbranch_scc1 KA_wbr
    buffer_wbl2 sc1
    s_waitcnt vmcnt(0)
    s_branch KA_wbr
KA_spin_kv:
    s_cmp_lg_u32 s3, 0
    s_cbranch_scc1 KA_ret_kv
    s_mov_b32 s29, 0x20000
KA_spinl_kv:
    s_sleep 8
    buffer_load_dword v31, v29, s[72:75], s62 offen sc1
    s_waitcnt vmcnt(0)
    v_and_b32 v31, 0xff, v31
    v_cmp_gt_u32 vcc, 8, v31
    s_sub_u32 s29, s29, 1
    s_cmp_eq_u32 s29, 0
    s_cbranch_scc1 KA_ret_kv
    s_and_b32 s28, vcc_lo, 1
    s_cmp_lg_u32 s28, 0
    s_cbranch_scc1 KA_spinl_kv
    s_branch KA_ret_kv
KA_wc:
    s_cmp_lg_u32 s3, 0
    s_cbranch_scc1 KA_wcr
    buffer_wbl2 sc1
    s_waitcnt vmcnt(0)
    s_branch KA_wcr
KA_spin_vv:
    s_cmp_lg_u32 s3, 0
    s_cbranch_scc1 KA_ret_vv
    s_mov_b32 s29, 0x20000
KA_spinl_vv:
    s_sleep 8
    buffer_load_dword v31, v29, s[72:75], s62 offen sc1
    s_waitcnt vmcnt(0)
    v_cmp_gt_u32 vcc, 2048, v31
    s_sub_u32 s29, s29, 1
    s_cmp_eq_u32 s29, 0
    s_cbranch_scc1 KA_ret_vv
    s_and_b32 s28, vcc_lo, 1
    s_cmp_lg_u32 s28, 0
    s_cbranch_scc1 KA_spinl_vv
    s_branch KA_ret_vv
    .p2align 6
K2_PVd1:
    v_mfma_f32_16x16x32_bf16 a[0:3], v[128:131], v[64:67], a[0:3]
    s_mov_b32 m0, s77
    v_exp_f32 v32, v32
    v_mfma_f32_16x16x32_bf16 a[4:7], v[128:131], v[72:75], a[4:7]
    buffer_load_dwordx4 v3, s[96:99], s76 offen lds
    v_mfma_f32_16x16x32_bf16 a[8:11], v[128:131], v[80:83], a[8:11]
    s_cmp_gt_u32 s31, s42
    s_cselect_b32 s28, s32, s60
    s_cselect_b32 s81, 16384, s41
    v_mfma_f32_16x16x32_bf16 a[12:15], v[128:131], v[88:91], a[12:15]
    s_lshr_b32 s80, s31, 1
    v_exp_f32 v33, v33
    v_mfma_f32_16x16x32_bf16 a[28:31], v[132:135], v[88:91], a[28:31]
    s_sub_u32 s80, s80, 5
    v_cvt_pk_bf16_f32 v32, v32, v33
    v_xor_b32 v6, 0x18000, v6
    v_mfma_f32_16x16x32_bf16 a[24:27], v[132:135], v[80:83], a[24:27]
    s_add_u32 m0, s34, 24576
    v_exp_f32 v34, v34
    v_mfma_f32_16x16x32_bf16 a[20:23], v[132:135], v[72:75], a[20:23]
    buffer_load_dwordx4 v28, s[16:19], s28 offen offset:0 sc1 lds
    v_mfma_f32_16x16x32_bf16 a[16:19], v[132:135], v[64:67], a[16:19]
    s_cmp_ge_u32 s31, s87
    s_cselect_b32 s29, s33, s60
    s_cselect_b32 s82, 16384, s41
    v_mfma_f32_16x16x32_bf16 v[112:115], v[24:27], v[64:67], v[112:115]
    s_waitcnt lgkmcnt(0)
    v_exp_f32 v35, v35
    v_mfma_f32_16x16x32_bf16 a[32:35], v[136:139], v[64:67], a[32:35]
    s_min_u32 s80, s80, 8
    ds_read_b128 a[192:195], v5 offset:16384
    v_cvt_pk_bf16_f32 v33, v34, v35
    v_mfma_f32_16x16x32_bf16 a[36:39], v[136:139], v[72:75], a[36:39]
    s_mul_i32 s79, s80, s84
    v_exp_f32 v40, v40
    v_mfma_f32_16x16x32_bf16 a[40:43], v[136:139], v[80:83], a[40:43]
    buffer_load_dwordx4 v28, s[16:19], s28 offen offset:1024 sc1 lds
    v_mfma_f32_16x16x32_bf16 a[44:47], v[136:139], v[88:91], a[44:47]
    s_add_u32 s32, s32, s81
    v_exp_f32 v41, v41
    v_mfma_f32_16x16x32_bf16 a[60:63], v[140:143], v[88:91], a[60:63]
    s_add_u32 s79, s79, s83
    ds_read_b128 a[196:199], v5 offset:17408
    v_cvt_pk_bf16_f32 v40, v40, v41
    v_mfma_f32_16x16x32_bf16 a[56:59], v[140:143], v[80:83], a[56:59]
    s_add_u32 m0, s35, 0
    v_exp_f32 v42, v42
    v_mfma_f32_16x16x32_bf16 a[52:55], v[140:143], v[72:75], a[52:55]
    buffer_load_dwordx4 v4, s[20:23], s33 offen offset:0 sc1 lds
    v_mfma_f32_16x16x32_bf16 a[48:51], v[140:143], v[64:67], a[48:51]
    s_mul_i32 s78, s80, 0x420
    v_exp_f32 v43, v43
    v_mfma_f32_16x16x32_bf16 v[116:119], v[24:27], v[72:75], v[116:119]
    s_and_b32 s78, s78, 0x1060
    ds_read_b128 a[200:203], v5 offset:18432
    v_cvt_pk_bf16_f32 v41, v42, v43
    v_mfma_f32_16x16x32_bf16 a[64:67], v[144:147], v[64:67], a[64:67]
    s_lshr_b32 s80, s80, 3
    v_exp_f32 v48, v48
    v_mfma_f32_16x16x32_bf16 a[68:71], v[144:147], v[72:75], a[68:71]
    buffer_load_dwordx4 v4, s[20:23], s33 offen offset:1024 sc1 lds
    v_mfma_f32_16x16x32_bf16 a[72:75], v[144:147], v[80:83], a[72:75]
    s_lshl_b32 s80, s80, 26
    v_exp_f32 v49, v49
    v_mfma_f32_16x16x32_bf16 a[76:79], v[144:147], v[88:91], a[76:79]
    s_add_u32 s79, s79, s80
    ds_read_b128 a[204:207], v5 offset:19456
    v_cvt_pk_bf16_f32 v48, v48, v49
    v_mfma_f32_16x16x32_bf16 a[92:95], v[148:151], v[88:91], a[92:95]
    s_add_u32 m0, s35, 8192
    v_exp_f32 v50, v50
    v_mfma_f32_16x16x32_bf16 a[88:91], v[148:151], v[80:83], a[88:91]
    buffer_load_dwordx4 v28, s[20:23], s29 offen offset:0 sc1 lds
    v_mfma_f32_16x16x32_bf16 a[84:87], v[148:151], v[72:75], a[84:87]
    v_exp_f32 v51, v51
    v_mfma_f32_16x16x32_bf16 a[80:83], v[148:151], v[64:67], a[80:83]
    ds_read_b128 a[208:211], v5 offset:20480
    v_cvt_pk_bf16_f32 v49, v50, v51
    v_mfma_f32_16x16x32_bf16 v[120:123], v[24:27], v[80:83], v[120:123]
    v_exp_f32 v56, v56
    v_mfma_f32_16x16x32_bf16 a[96:99], v[152:155], v[64:67], a[96:99]
    buffer_load_dwordx4 v28, s[20:23], s29 offen offset:1024 sc1 lds
    v_mfma_f32_16x16x32_bf16 a[100:103], v[152:155], v[72:75], a[100:103]
    s_add_u32 s33, s33, s82
    v_exp_f32 v57, v57
    v_mfma_f32_16x16x32_bf16 a[104:107], v[152:155], v[80:83], a[104:107]
    ds_read_b128 a[212:215], v5 offset:21504
    v_cvt_pk_bf16_f32 v56, v56, v57
    v_mfma_f32_16x16x32_bf16 a[108:111], v[152:155], v[88:91], a[108:111]
    s_xor_b32 s34, s34, 0x38000
    ds_read_b128 a[216:219], v5 offset:22528
    ds_read_b128 a[220:223], v5 offset:23552
    v_mfma_f32_16x16x32_bf16 a[124:127], v[156:159], v[88:91], a[124:127]
    v_exp_f32 v58, v58
    v_mfma_f32_16x16x32_bf16 a[120:123], v[156:159], v[80:83], a[120:123]
    v_exp_f32 v59, v59
    v_mfma_f32_16x16x32_bf16 a[116:119], v[156:159], v[72:75], a[116:119]
    s_cmp_ge_u32 s31, s37
    v_cvt_pk_bf16_f32 v57, v58, v59
    v_xor_b32 v9, s78, v8
    v_mfma_f32_16x16x32_bf16 a[112:115], v[156:159], v[64:67], a[112:115]
    s_waitcnt lgkmcnt(4)
    v_mfma_f32_16x16x32_bf16 v[124:127], v[24:27], v[88:91], v[124:127]
    s_cbranch_scc1 K2_toS
K2_QKd1:
    v_mfma_f32_16x16x32_bf16 v[64:67], a[192:195], a[128:131], v[96:99]
    s_add_u32 m0, s34, 0
    v_exp_f32 v36, v36
    v_mfma_f32_16x16x32_bf16 v[64:67], a[196:199], a[132:135], v[64:67]
    buffer_load_dwordx4 v4, s[16:19], s32 offen offset:0 sc1 lds
    v_mfma_f32_16x16x32_bf16 v[64:67], a[200:203], a[136:139], v[64:67]
    s_add_u32 s31, s31, 1
    v_exp_f32 v37, v37
    v_mfma_f32_16x16x32_bf16 v[64:67], a[204:207], a[140:143], v[64:67]
    v_cvt_pk_bf16_f32 v34, v36, v37
    v_mfma_f32_16x16x32_bf16 v[72:75], a[204:207], a[156:159], v[100:103]
    s_waitcnt lgkmcnt(0)
    v_exp_f32 v38, v38
    v_mfma_f32_16x16x32_bf16 v[72:75], a[200:203], a[152:155], v[72:75]
    buffer_load_dwordx4 v4, s[16:19], s32 offen offset:1024 sc1 lds
    v_mfma_f32_16x16x32_bf16 v[72:75], a[196:199], a[148:151], v[72:75]
    v_exp_f32 v39, v39
    v_mfma_f32_16x16x32_bf16 v[72:75], a[192:195], a[144:147], v[72:75]
    v_cvt_pk_bf16_f32 v35, v38, v39
    v_mfma_f32_16x16x32_bf16 v[80:83], a[192:195], a[160:163], v[104:107]
    v_exp_f32 v44, v44
    v_mfma_f32_16x16x32_bf16 v[80:83], a[196:199], a[164:167], v[80:83]
    ds_read_b64_tr_b16 v[220:221], v9 offset:0
    ds_read_b64_tr_b16 v[222:223], v9 offset:2048
    v_mfma_f32_16x16x32_bf16 v[80:83], a[200:203], a[168:171], v[80:83]
    v_exp_f32 v45, v45
    v_mfma_f32_16x16x32_bf16 v[80:83], a[204:207], a[172:175], v[80:83]
    v_cvt_pk_bf16_f32 v42, v44, v45
    v_mfma_f32_16x16x32_bf16 v[88:91], a[204:207], a[188:191], v[108:111]
    s_waitcnt vmcnt(12)
    v_exp_f32 v46, v46
    v_mfma_f32_16x16x32_bf16 v[88:91], a[200:203], a[184:187], v[88:91]
    s_barrier
    v_mfma_f32_16x16x32_bf16 v[88:91], a[196:199], a[180:183], v[88:91]
    v_exp_f32 v47, v47
    v_mfma_f32_16x16x32_bf16 v[88:91], a[192:195], a[176:179], v[88:91]
    ds_read_b128 v[128:131], v6 offset:0
    v_cvt_pk_bf16_f32 v43, v46, v47
    v_mfma_f32_16x16x32_bf16 v[92:95], a[208:211], a[176:179], v[108:111]
    v_exp_f32 v52, v52
    v_mfma_f32_16x16x32_bf16 v[92:95], a[212:215], a[180:183], v[92:95]
    ds_read_b128 v[132:135], v6 offset:1024
    ds_read_b128 v[136:139], v6 offset:2048
    v_mfma_f32_16x16x32_bf16 v[92:95], a[216:219], a[184:187], v[92:95]
    v_exp_f32 v53, v53
    v_mfma_f32_16x16x32_bf16 v[92:95], a[220:223], a[188:191], v[92:95]
    ds_read_b128 v[140:143], v6 offset:3072
    v_cvt_pk_bf16_f32 v50, v52, v53
    v_mfma_f32_16x16x32_bf16 v[84:87], a[220:223], a[172:175], v[104:107]
    v_exp_f32 v54, v54
    v_mfma_f32_16x16x32_bf16 v[84:87], a[216:219], a[168:171], v[84:87]
    ds_read_b128 v[144:147], v6 offset:4096
    ds_read_b128 v[148:151], v6 offset:5120
    v_mfma_f32_16x16x32_bf16 v[84:87], a[212:215], a[164:167], v[84:87]
    v_exp_f32 v55, v55
    v_mfma_f32_16x16x32_bf16 v[84:87], a[208:211], a[160:163], v[84:87]
    ds_read_b128 v[152:155], v6 offset:6144
    v_cvt_pk_bf16_f32 v51, v54, v55
    v_mfma_f32_16x16x32_bf16 v[76:79], a[208:211], a[144:147], v[100:103]
    v_exp_f32 v60, v60
    v_mfma_f32_16x16x32_bf16 v[76:79], a[212:215], a[148:151], v[76:79]
    v_exp_f32 v61, v61
    v_mfma_f32_16x16x32_bf16 v[76:79], a[216:219], a[152:155], v[76:79]
    ds_read_b128 v[156:159], v6 offset:7168
    v_cvt_pk_bf16_f32 v58, v60, v61
    v_mfma_f32_16x16x32_bf16 v[76:79], a[220:223], a[156:159], v[76:79]
    v_exp_f32 v62, v62
    v_mfma_f32_16x16x32_bf16 v[68:71], a[220:223], a[140:143], v[96:99]
    s_cmp_ge_u32 s31, s42
    v_exp_f32 v63, v63
    v_mfma_f32_16x16x32_bf16 v[68:71], a[216:219], a[136:139], v[68:71]
    v_cvt_pk_bf16_f32 v59, v62, v63
    v_mfma_f32_16x16x32_bf16 v[68:71], a[212:215], a[132:135], v[68:71]
    s_waitcnt lgkmcnt(3)
    v_mfma_f32_16x16x32_bf16 v[68:71], a[208:211], a[128:131], v[68:71]
    s_cbranch_scc1 K2_Md1
K2_PVd0:
    v_mfma_f32_16x16x32_bf16 a[0:3], v[128:131], v[32:35], a[0:3]
    v_exp_f32 v64, v64
    v_mfma_f32_16x16x32_bf16 a[4:7], v[128:131], v[40:43], a[4:7]
    buffer_store_dwordx4 v[220:223], v2, s[8:11], s79 offen sc1
    v_mfma_f32_16x16x32_bf16 a[8:11], v[128:131], v[48:51], a[8:11]
    s_cmp_gt_u32 s31, s42
    s_cselect_b32 s28, s32, s60
    s_cselect_b32 s81, 16384, s41
    v_mfma_f32_16x16x32_bf16 a[12:15], v[128:131], v[56:59], a[12:15]
    s_lshr_b32 s80, s31, 1
    v_exp_f32 v65, v65
    v_mfma_f32_16x16x32_bf16 a[28:31], v[132:135], v[56:59], a[28:31]
    s_min_u32 s80, s80, 7
    v_cvt_pk_bf16_f32 v64, v64, v65
    v_xor_b32 v5, 0x38000, v5
    v_mfma_f32_16x16x32_bf16 a[24:27], v[132:135], v[48:51], a[24:27]
    s_add_u32 m0, s34, 8192
    v_exp_f32 v66, v66
    v_mfma_f32_16x16x32_bf16 a[20:23], v[132:135], v[40:43], a[20:23]
    buffer_load_dwordx4 v28, s[16:19], s28 offen offset:0 sc1 lds
    v_mfma_f32_16x16x32_bf16 a[16:19], v[132:135], v[32:35], a[16:19]
    s_cmp_ge_u32 s31, s87
    s_cselect_b32 s29, s33, s60
    s_cselect_b32 s82, 16384, s41
    v_mfma_f32_16x16x32_bf16 v[112:115], v[24:27], v[32:35], v[112:115]
    s_waitcnt lgkmcnt(0)
    v_exp_f32 v67, v67
    v_mfma_f32_16x16x32_bf16 a[32:35], v[136:139], v[32:35], a[32:35]
    s_lshl_b32 s77, s80, 10
    ds_read_b128 a[192:195], v5 offset:0
    v_cvt_pk_bf16_f32 v65, v66, v67
    v_mfma_f32_16x16x32_bf16 a[36:39], v[136:139], v[40:43], a[36:39]
    s_add_u32 s77, s77, s40
    v_exp_f32 v72, v72
    v_mfma_f32_16x16x32_bf16 a[40:43], v[136:139], v[48:51], a[40:43]
    buffer_load_dwordx4 v28, s[16:19], s28 offen offset:1024 sc1 lds
    v_mfma_f32_16x16x32_bf16 a[44:47], v[136:139], v[56:59], a[44:47]
    s_add_u32 s32, s32, s81
    v_exp_f32 v73, v73
    v_mfma_f32_16x16x32_bf16 a[60:63], v[140:143], v[56:59], a[60:63]
    s_and_b32 s76, s80, 3
    ds_read_b128 a[196:199], v5 offset:1024
    v_cvt_pk_bf16_f32 v72, v72, v73
    v_mfma_f32_16x16x32_bf16 a[56:59], v[140:143], v[48:51], a[56:59]
    s_add_u32 m0, s35, 16384
    v_exp_f32 v74, v74
    v_mfma_f32_16x16x32_bf16 a[52:55], v[140:143], v[40:43], a[52:55]
    buffer_load_dwordx4 v4, s[20:23], s33 offen offset:0 sc1 lds
    v_mfma_f32_16x16x32_bf16 a[48:51], v[140:143], v[32:35], a[48:51]
    s_mul_i32 s76, s76, 10240
    v_exp_f32 v75, v75
    v_mfma_f32_16x16x32_bf16 v[116:119], v[24:27], v[40:43], v[116:119]
    s_lshr_b32 s80, s80, 2
    ds_read_b128 a[200:203], v5 offset:2048
    v_cvt_pk_bf16_f32 v73, v74, v75
    v_mfma_f32_16x16x32_bf16 a[64:67], v[144:147], v[32:35], a[64:67]
    s_lshl_b32 s80, s80, 7
    v_exp_f32 v80, v80
    v_mfma_f32_16x16x32_bf16 a[68:71], v[144:147], v[40:43], a[68:71]
    buffer_load_dwordx4 v4, s[20:23], s33 offen offset:1024 sc1 lds
    v_mfma_f32_16x16x32_bf16 a[72:75], v[144:147], v[48:51], a[72:75]
    s_add_u32 s76, s76, s80
    v_exp_f32 v81, v81
    v_mfma_f32_16x16x32_bf16 a[76:79], v[144:147], v[56:59], a[76:79]
    s_add_u32 s76, s76, s36
    ds_read_b128 a[204:207], v5 offset:3072
    v_cvt_pk_bf16_f32 v80, v80, v81
    v_mfma_f32_16x16x32_bf16 a[92:95], v[148:151], v[56:59], a[92:95]
    s_add_u32 m0, s35, 24576
    v_exp_f32 v82, v82
    v_mfma_f32_16x16x32_bf16 a[88:91], v[148:151], v[48:51], a[88:91]
    buffer_load_dwordx4 v28, s[20:23], s29 offen offset:0 sc1 lds
    v_mfma_f32_16x16x32_bf16 a[84:87], v[148:151], v[40:43], a[84:87]
    v_exp_f32 v83, v83
    v_mfma_f32_16x16x32_bf16 a[80:83], v[148:151], v[32:35], a[80:83]
    ds_read_b128 a[208:211], v5 offset:4096
    v_cvt_pk_bf16_f32 v81, v82, v83
    v_mfma_f32_16x16x32_bf16 v[120:123], v[24:27], v[48:51], v[120:123]
    v_exp_f32 v88, v88
    v_mfma_f32_16x16x32_bf16 a[96:99], v[152:155], v[32:35], a[96:99]
    buffer_load_dwordx4 v28, s[20:23], s29 offen offset:1024 sc1 lds
    v_mfma_f32_16x16x32_bf16 a[100:103], v[152:155], v[40:43], a[100:103]
    s_add_u32 s33, s33, s82
    v_exp_f32 v89, v89
    v_mfma_f32_16x16x32_bf16 a[104:107], v[152:155], v[48:51], a[104:107]
    ds_read_b128 a[212:215], v5 offset:5120
    v_cvt_pk_bf16_f32 v88, v88, v89
    v_mfma_f32_16x16x32_bf16 a[108:111], v[152:155], v[56:59], a[108:111]
    s_xor_b32 s35, s35, 0x18000
    ds_read_b128 a[216:219], v5 offset:6144
    ds_read_b128 a[220:223], v5 offset:7168
    v_mfma_f32_16x16x32_bf16 a[124:127], v[156:159], v[56:59], a[124:127]
    v_exp_f32 v90, v90
    v_mfma_f32_16x16x32_bf16 a[120:123], v[156:159], v[48:51], a[120:123]
    v_exp_f32 v91, v91
    v_mfma_f32_16x16x32_bf16 a[116:119], v[156:159], v[40:43], a[116:119]
    s_cmp_ge_u32 s31, s37
    v_cvt_pk_bf16_f32 v89, v90, v91
    v_mfma_f32_16x16x32_bf16 a[112:115], v[156:159], v[32:35], a[112:115]
    s_waitcnt lgkmcnt(4)
    v_mfma_f32_16x16x32_bf16 v[124:127], v[24:27], v[56:59], v[124:127]
    s_cbranch_scc1 K2_QKs0
K2_QKd0:
    v_mfma_f32_16x16x32_bf16 v[32:35], a[192:195], a[128:131], v[96:99]
    s_add_u32 m0, s34, 16384
    v_exp_f32 v68, v68
    v_mfma_f32_16x16x32_bf16 v[32:35], a[196:199], a[132:135], v[32:35]
    buffer_load_dwordx4 v4, s[16:19], s32 offen offset:0 sc1 lds
    v_mfma_f32_16x16x32_bf16 v[32:35], a[200:203], a[136:139], v[32:35]
    s_add_u32 s31, s31, 1
    v_exp_f32 v69, v69
    v_mfma_f32_16x16x32_bf16 v[32:35], a[204:207], a[140:143], v[32:35]
    v_cvt_pk_bf16_f32 v66, v68, v69
    v_mfma_f32_16x16x32_bf16 v[40:43], a[204:207], a[156:159], v[100:103]
    s_waitcnt lgkmcnt(0)
    v_exp_f32 v70, v70
    v_mfma_f32_16x16x32_bf16 v[40:43], a[200:203], a[152:155], v[40:43]
    buffer_load_dwordx4 v4, s[16:19], s32 offen offset:1024 sc1 lds
    v_mfma_f32_16x16x32_bf16 v[40:43], a[196:199], a[148:151], v[40:43]
    v_exp_f32 v71, v71
    v_mfma_f32_16x16x32_bf16 v[40:43], a[192:195], a[144:147], v[40:43]
    v_cvt_pk_bf16_f32 v67, v70, v71
    v_mfma_f32_16x16x32_bf16 v[48:51], a[192:195], a[160:163], v[104:107]
    v_exp_f32 v76, v76
    v_mfma_f32_16x16x32_bf16 v[48:51], a[196:199], a[164:167], v[48:51]
    v_mfma_f32_16x16x32_bf16 v[48:51], a[200:203], a[168:171], v[48:51]
    v_exp_f32 v77, v77
    v_mfma_f32_16x16x32_bf16 v[48:51], a[204:207], a[172:175], v[48:51]
    v_cvt_pk_bf16_f32 v74, v76, v77
    v_mfma_f32_16x16x32_bf16 v[56:59], a[204:207], a[188:191], v[108:111]
    s_waitcnt vmcnt(12)
    v_exp_f32 v78, v78
    v_mfma_f32_16x16x32_bf16 v[56:59], a[200:203], a[184:187], v[56:59]
    s_barrier
    v_mfma_f32_16x16x32_bf16 v[56:59], a[196:199], a[180:183], v[56:59]
    v_exp_f32 v79, v79
    v_mfma_f32_16x16x32_bf16 v[56:59], a[192:195], a[176:179], v[56:59]
    ds_read_b128 v[128:131], v6 offset:16384
    v_cvt_pk_bf16_f32 v75, v78, v79
    v_mfma_f32_16x16x32_bf16 v[60:63], a[208:211], a[176:179], v[108:111]
    v_exp_f32 v84, v84
    v_mfma_f32_16x16x32_bf16 v[60:63], a[212:215], a[180:183], v[60:63]
    ds_read_b128 v[132:135], v6 offset:17408
    ds_read_b128 v[136:139], v6 offset:18432
    v_mfma_f32_16x16x32_bf16 v[60:63], a[216:219], a[184:187], v[60:63]
    v_exp_f32 v85, v85
    v_mfma_f32_16x16x32_bf16 v[60:63], a[220:223], a[188:191], v[60:63]
    ds_read_b128 v[140:143], v6 offset:19456
    v_cvt_pk_bf16_f32 v82, v84, v85
    v_mfma_f32_16x16x32_bf16 v[52:55], a[220:223], a[172:175], v[104:107]
    v_exp_f32 v86, v86
    v_mfma_f32_16x16x32_bf16 v[52:55], a[216:219], a[168:171], v[52:55]
    ds_read_b128 v[144:147], v6 offset:20480
    ds_read_b128 v[148:151], v6 offset:21504
    v_mfma_f32_16x16x32_bf16 v[52:55], a[212:215], a[164:167], v[52:55]
    v_exp_f32 v87, v87
    v_mfma_f32_16x16x32_bf16 v[52:55], a[208:211], a[160:163], v[52:55]
    ds_read_b128 v[152:155], v6 offset:22528
    v_cvt_pk_bf16_f32 v83, v86, v87
    v_mfma_f32_16x16x32_bf16 v[44:47], a[208:211], a[144:147], v[100:103]
    v_exp_f32 v92, v92
    v_mfma_f32_16x16x32_bf16 v[44:47], a[212:215], a[148:151], v[44:47]
    v_exp_f32 v93, v93
    v_mfma_f32_16x16x32_bf16 v[44:47], a[216:219], a[152:155], v[44:47]
    ds_read_b128 v[156:159], v6 offset:23552
    v_cvt_pk_bf16_f32 v90, v92, v93
    v_mfma_f32_16x16x32_bf16 v[44:47], a[220:223], a[156:159], v[44:47]
    v_exp_f32 v94, v94
    v_mfma_f32_16x16x32_bf16 v[36:39], a[220:223], a[140:143], v[96:99]
    s_cmp_lt_u32 s31, s43
    v_exp_f32 v95, v95
    v_mfma_f32_16x16x32_bf16 v[36:39], a[216:219], a[136:139], v[36:39]
    v_cvt_pk_bf16_f32 v91, v94, v95
    v_mfma_f32_16x16x32_bf16 v[36:39], a[212:215], a[132:135], v[36:39]
    s_waitcnt lgkmcnt(3)
    v_mfma_f32_16x16x32_bf16 v[36:39], a[208:211], a[128:131], v[36:39]
    s_cbranch_scc1 K2_PVd1
    s_cmp_ge_u32 s31, s42
    s_cbranch_scc1 K2_Md0
K2_EVT:
    s_cmp_eq_u32 s31, 0
    s_cbranch_scc1 K2_first
    s_cmp_eq_u32 s31, s85
    s_cbranch_scc1 K2_evA
K2_EVT2:
    s_cmp_eq_u32 s31, s86
    s_cbranch_scc1 K2_evN
K2_EVT3:
    s_cmp_lt_u32 s31, s30
    s_cselect_b32 s43, s42, 32
    s_min_u32 s43, s43, s86
    s_min_u32 s43, s43, s85
    s_cmp_le_u32 s31, s30
    s_cbranch_scc1 K2_PVd1
    s_branch K2_PVs1
K2_evA:
    v_rcp_f32 v216, v112
    s_lshl_b32 s28, s56, 17
    v_accvgpr_read_b32 v192, a0
    v_accvgpr_read_b32 v193, a1
    v_accvgpr_read_b32 v194, a2
    v_accvgpr_read_b32 v195, a3
    v_accvgpr_read_b32 v196, a16
    v_accvgpr_read_b32 v197, a17
    v_accvgpr_read_b32 v198, a18
    v_accvgpr_read_b32 v199, a19
    v_mul_f32 v192, v192, v216
    v_mul_f32 v193, v193, v216
    v_mul_f32 v194, v194, v216
    v_mul_f32 v195, v195, v216
    v_mul_f32 v196, v196, v216
    v_mul_f32 v197, v197, v216
    v_mul_f32 v198, v198, v216
    v_mul_f32 v199, v199, v216
    v_cvt_pk_bf16_f32 v200, v192, v193
    v_cvt_pk_bf16_f32 v201, v194, v195
    v_cvt_pk_bf16_f32 v202, v196, v197
    v_cvt_pk_bf16_f32 v203, v198, v199
    buffer_store_dwordx4 v[200:203], v2, s[64:67], s28 offen offset:0 sc1
    v_accvgpr_read_b32 v204, a32
    v_accvgpr_read_b32 v205, a33
    v_accvgpr_read_b32 v206, a34
    v_accvgpr_read_b32 v207, a35
    v_accvgpr_read_b32 v208, a48
    v_accvgpr_read_b32 v209, a49
    v_accvgpr_read_b32 v210, a50
    v_accvgpr_read_b32 v211, a51
    v_mul_f32 v204, v204, v216
    v_mul_f32 v205, v205, v216
    v_mul_f32 v206, v206, v216
    v_mul_f32 v207, v207, v216
    v_mul_f32 v208, v208, v216
    v_mul_f32 v209, v209, v216
    v_mul_f32 v210, v210, v216
    v_mul_f32 v211, v211, v216
    v_cvt_pk_bf16_f32 v212, v204, v205
    v_cvt_pk_bf16_f32 v213, v206, v207
    v_cvt_pk_bf16_f32 v214, v208, v209
    v_cvt_pk_bf16_f32 v215, v210, v211
    buffer_store_dwordx4 v[212:215], v2, s[64:67], s28 offen offset:1024 sc1
    v_accvgpr_read_b32 v192, a64
    v_accvgpr_read_b32 v193, a65
    v_accvgpr_read_b32 v194, a66
    v_accvgpr_read_b32 v195, a67
    v_accvgpr_read_b32 v196, a80
    v_accvgpr_read_b32 v197, a81
    v_accvgpr_read_b32 v198, a82
    v_accvgpr_read_b32 v199, a83
    v_mul_f32 v192, v192, v216
    v_mul_f32 v193, v193, v216
    v_mul_f32 v194, v194, v216
    v_mul_f32 v195, v195, v216
    v_mul_f32 v196, v196, v216
    v_mul_f32 v197, v197, v216
    v_mul_f32 v198, v198, v216
    v_mul_f32 v199, v199, v216
    v_cvt_pk_bf16_f32 v200, v192, v193
    v_cvt_pk_bf16_f32 v201, v194, v195
    v_cvt_pk_bf16_f32 v202, v196, v197
    v_cvt_pk_bf16_f32 v203, v198, v199
    buffer_store_dwordx4 v[200:203], v2, s[64:67], s28 offen offset:2048 sc1
    v_accvgpr_read_b32 v204, a96
    v_accvgpr_read_b32 v205, a97
    v_accvgpr_read_b32 v206, a98
    v_accvgpr_read_b32 v207, a99
    v_accvgpr_read_b32 v208, a112
    v_accvgpr_read_b32 v209, a113
    v_accvgpr_read_b32 v210, a114
    v_accvgpr_read_b32 v211, a115
    v_mul_f32 v204, v204, v216
    v_mul_f32 v205, v205, v216
    v_mul_f32 v206, v206, v216
    v_mul_f32 v207, v207, v216
    v_mul_f32 v208, v208, v216
    v_mul_f32 v209, v209, v216
    v_mul_f32 v210, v210, v216
    v_mul_f32 v211, v211, v216
    v_cvt_pk_bf16_f32 v212, v204, v205
    v_cvt_pk_bf16_f32 v213, v206, v207
    v_cvt_pk_bf16_f32 v214, v208, v209
    v_cvt_pk_bf16_f32 v215, v210, v211
    buffer_store_dwordx4 v[212:215], v2, s[64:67], s28 offen offset:3072 sc1
    v_rcp_f32 v216, v116
    s_lshl_b32 s28, s57, 17
    v_accvgpr_read_b32 v192, a4
    v_accvgpr_read_b32 v193, a5
    v_accvgpr_read_b32 v194, a6
    v_accvgpr_read_b32 v195, a7
    v_accvgpr_read_b32 v196, a20
    v_accvgpr_read_b32 v197, a21
    v_accvgpr_read_b32 v198, a22
    v_accvgpr_read_b32 v199, a23
    v_mul_f32 v192, v192, v216
    v_mul_f32 v193, v193, v216
    v_mul_f32 v194, v194, v216
    v_mul_f32 v195, v195, v216
    v_mul_f32 v196, v196, v216
    v_mul_f32 v197, v197, v216
    v_mul_f32 v198, v198, v216
    v_mul_f32 v199, v199, v216
    v_cvt_pk_bf16_f32 v200, v192, v193
    v_cvt_pk_bf16_f32 v201, v194, v195
    v_cvt_pk_bf16_f32 v202, v196, v197
    v_cvt_pk_bf16_f32 v203, v198, v199
    buffer_store_dwordx4 v[200:203], v2, s[64:67], s28 offen offset:0 sc1
    v_accvgpr_read_b32 v204, a36
    v_accvgpr_read_b32 v205, a37
    v_accvgpr_read_b32 v206, a38
    v_accvgpr_read_b32 v207, a39
    v_accvgpr_read_b32 v208, a52
    v_accvgpr_read_b32 v209, a53
    v_accvgpr_read_b32 v210, a54
    v_accvgpr_read_b32 v211, a55
    v_mul_f32 v204, v204, v216
    v_mul_f32 v205, v205, v216
    v_mul_f32 v206, v206, v216
    v_mul_f32 v207, v207, v216
    v_mul_f32 v208, v208, v216
    v_mul_f32 v209, v209, v216
    v_mul_f32 v210, v210, v216
    v_mul_f32 v211, v211, v216
    v_cvt_pk_bf16_f32 v212, v204, v205
    v_cvt_pk_bf16_f32 v213, v206, v207
    v_cvt_pk_bf16_f32 v214, v208, v209
    v_cvt_pk_bf16_f32 v215, v210, v211
    buffer_store_dwordx4 v[212:215], v2, s[64:67], s28 offen offset:1024 sc1
    v_accvgpr_read_b32 v192, a68
    v_accvgpr_read_b32 v193, a69
    v_accvgpr_read_b32 v194, a70
    v_accvgpr_read_b32 v195, a71
    v_accvgpr_read_b32 v196, a84
    v_accvgpr_read_b32 v197, a85
    v_accvgpr_read_b32 v198, a86
    v_accvgpr_read_b32 v199, a87
    v_mul_f32 v192, v192, v216
    v_mul_f32 v193, v193, v216
    v_mul_f32 v194, v194, v216
    v_mul_f32 v195, v195, v216
    v_mul_f32 v196, v196, v216
    v_mul_f32 v197, v197, v216
    v_mul_f32 v198, v198, v216
    v_mul_f32 v199, v199, v216
    v_cvt_pk_bf16_f32 v200, v192, v193
    v_cvt_pk_bf16_f32 v201, v194, v195
    v_cvt_pk_bf16_f32 v202, v196, v197
    v_cvt_pk_bf16_f32 v203, v198, v199
    buffer_store_dwordx4 v[200:203], v2, s[64:67], s28 offen offset:2048 sc1
    v_accvgpr_read_b32 v204, a100
    v_accvgpr_read_b32 v205, a101
    v_accvgpr_read_b32 v206, a102
    v_accvgpr_read_b32 v207, a103
    v_accvgpr_read_b32 v208, a116
    v_accvgpr_read_b32 v209, a117
    v_accvgpr_read_b32 v210, a118
    v_accvgpr_read_b32 v211, a119
    v_mul_f32 v204, v204, v216
    v_mul_f32 v205, v205, v216
    v_mul_f32 v206, v206, v216
    v_mul_f32 v207, v207, v216
    v_mul_f32 v208, v208, v216
    v_mul_f32 v209, v209, v216
    v_mul_f32 v210, v210, v216
    v_mul_f32 v211, v211, v216
    v_cvt_pk_bf16_f32 v212, v204, v205
    v_cvt_pk_bf16_f32 v213, v206, v207
    v_cvt_pk_bf16_f32 v214, v208, v209
    v_cvt_pk_bf16_f32 v215, v210, v211
    buffer_store_dwordx4 v[212:215], v2, s[64:67], s28 offen offset:3072 sc1
    s_movk_i32 s85, 99
    s_branch K2_EVT2
K2_evN:
    s_and_b32 s28, s2, 7
    s_lshl_b32 s28, s28, 7
    s_add_u32 s28, s28, 16384
    v_mov_b32 v13, 1
    buffer_atomic_add v13, v29, s[72:75], s28 offen offset:4
    s_getpc_b64 s[12:13]
KA_pc3:
    s_add_u32 s12, s12, K2_tail-KA_pc3
    s_addc_u32 s13, s13, 0
    s_mov_b32 s14, KA_last-K2_tail
    s_mov_b32 s15, 0x20000
    s_lshr_b32 s28, s2, 3
    s_lshl_b32 s28, s28, 2
    s_add_u32 s28, s28, s3
    s_lshl_b32 s28, s28, 7
    v_lshlrev_b32 v13, 14, v1
    buffer_load_dword v249, v13, s[12:15], s28 offen
    s_movk_i32 s86, 99
    s_branch K2_EVT3
K2_toS:
    s_cmp_lt_u32 s31, 32
    s_cbranch_scc1 K2_QKs1
    buffer_load_dword v31, v14, s[72:75], s52 offen offset:4 sc1
    s_waitcnt lgkmcnt(0)
    ds_read_b128 a[224:227], v5 offset:24576
    ds_read_b128 a[228:231], v5 offset:25600
    ds_read_b128 a[232:235], v5 offset:26624
    ds_read_b128 a[236:239], v5 offset:27648
    ds_read_b128 a[240:243], v5 offset:28672
    ds_read_b128 a[244:247], v5 offset:29696
    ds_read_b128 a[248:251], v5 offset:30720
    ds_read_b128 a[252:255], v5 offset:31744
    s_waitcnt lgkmcnt(6)
    s_branch K2_fin
K2_first:
    ds_read_b128 a[192:195], v5 offset:16384
    ds_read_b128 a[196:199], v5 offset:17408
    ds_read_b128 a[200:203], v5 offset:18432
    ds_read_b128 a[204:207], v5 offset:19456
    ds_read_b128 a[208:211], v5 offset:20480
    ds_read_b128 a[212:215], v5 offset:21504
    ds_read_b128 a[216:219], v5 offset:22528
    ds_read_b128 a[220:223], v5 offset:23552
    s_waitcnt vmcnt(2)
    v_cmp_gt_u32 vcc, 2048, v31
    s_nop 0
    s_and_b32 s28, vcc_lo, 1
    s_cmp_gt_u32 s28, s40
    s_cbranch_scc1 KA_spin_vv
KA_ret_vv:
    s_barrier
    s_add_u32 m0, s35, 0
    s_nop 0
    buffer_load_dwordx4 v4, s[20:23], s33 offen offset:0 sc1 lds
    buffer_load_dwordx4 v4, s[20:23], s33 offen offset:1024 sc1 lds
    s_add_u32 s33, s33, 8192
    s_add_u32 m0, s35, 16384
    s_nop 0
    buffer_load_dwordx4 v4, s[20:23], s33 offen offset:0 sc1 lds
    buffer_load_dwordx4 v4, s[20:23], s33 offen offset:1024 sc1 lds
    s_add_u32 s33, s33, 8192
    s_xor_b32 s35, s35, 0x18000
    s_add_u32 m0, s35, 0
    s_nop 0
    buffer_load_dwordx4 v4, s[20:23], s33 offen offset:0 sc1 lds
    buffer_load_dwordx4 v4, s[20:23], s33 offen offset:1024 sc1 lds
    s_add_u32 s33, s33, 8192
    s_cmp_lg_u32 s38, 0
    s_cbranch_scc1 K2_nomax
    v_max3_f32 v13, v32, v33, v34
    v_max3_f32 v13, v13, v35, v36
    v_max3_f32 v13, v13, v37, v38
    v_max_f32 v13, v13, v39
    v_max3_f32 v14, v40, v41, v42
    v_max3_f32 v14, v14, v43, v44
    v_max3_f32 v14, v14, v45, v46
    v_max_f32 v14, v14, v47
    v_max3_f32 v15, v48, v49, v50
    v_max3_f32 v15, v15, v51, v52
    v_max3_f32 v15, v15, v53, v54
    v_max_f32 v15, v15, v55
    v_max3_f32 v16, v56, v57, v58
    v_max3_f32 v16, v16, v59, v60
    v_max3_f32 v16, v16, v61, v62
    v_max_f32 v16, v16, v63
    v_mov_b32 v17, v13
    v_mov_b32 v18, v14
    v_mov_b32 v19, v15
    v_mov_b32 v20, v16
    v_permlane32_swap_b32 v13, v17
    v_permlane32_swap_b32 v14, v18
    v_permlane32_swap_b32 v15, v19
    v_permlane32_swap_b32 v16, v20
    v_max_f32 v13, v13, v17
    v_max_f32 v14, v14, v18
    v_max_f32 v15, v15, v19
    v_max_f32 v16, v16, v20
    v_mov_b32 v17, v13
    v_mov_b32 v18, v14
    v_mov_b32 v19, v15
    v_mov_b32 v20, v16
    v_permlane16_swap_b32 v13, v17
    v_permlane16_swap_b32 v14, v18
    v_permlane16_swap_b32 v15, v19
    v_permlane16_swap_b32 v16, v20
    v_max_f32 v13, v13, v17
    v_max_f32 v14, v14, v18
    v_max_f32 v15, v15, v19
    v_max_f32 v16, v16, v20
    v_sub_f32 v96, 0, v13
    v_sub_f32 v97, 0, v13
    v_sub_f32 v98, 0, v13
    v_sub_f32 v99, 0, v13
    v_sub_f32 v32, v32, v13
    v_sub_f32 v33, v33, v13
    v_sub_f32 v34, v34, v13
    v_sub_f32 v35, v35, v13
    v_sub_f32 v36, v36, v13
    v_sub_f32 v37, v37, v13
    v_sub_f32 v38, v38, v13
    v_sub_f32 v39, v39, v13
    v_sub_f32 v100, 0, v14
    v_sub_f32 v101, 0, v14
    v_sub_f32 v102, 0, v14
    v_sub_f32 v103, 0, v14
    v_sub_f32 v40, v40, v14
    v_sub_f32 v41, v41, v14
    v_sub_f32 v42, v42, v14
    v_sub_f32 v43, v43, v14
    v_sub_f32 v44, v44, v14
    v_sub_f32 v45, v45, v14
    v_sub_f32 v46, v46, v14
    v_sub_f32 v47, v47, v14
    v_sub_f32 v104, 0, v15
    v_sub_f32 v105, 0, v15
    v_sub_f32 v106, 0, v15
    v_sub_f32 v107, 0, v15
    v_sub_f32 v48, v48, v15
    v_sub_f32 v49, v49, v15
    v_sub_f32 v50, v50, v15
    v_sub_f32 v51, v51, v15
    v_sub_f32 v52, v52, v15
    v_sub_f32 v53, v53, v15
    v_sub_f32 v54, v54, v15
    v_sub_f32 v55, v55, v15
    v_sub_f32 v108, 0, v16
    v_sub_f32 v109, 0, v16
    v_sub_f32 v110, 0, v16
    v_sub_f32 v111, 0, v16
    v_sub_f32 v56, v56, v16
    v_sub_f32 v57, v57, v16
    v_sub_f32 v58, v58, v16
    v_sub_f32 v59, v59, v16
    v_sub_f32 v60, v60, v16
    v_sub_f32 v61, v61, v16
    v_sub_f32 v62, v62, v16
    v_sub_f32 v63, v63, v16
K2_nomax:
    s_add_u32 s32, s32, 8192
    s_xor_b32 s34, s34, 0x38000
    s_min_u32 s43, s42, s86
    v_exp_f32 v32, v32
    v_exp_f32 v33, v33
    v_exp_f32 v34, v34
    v_exp_f32 v35, v35
    v_exp_f32 v40, v40
    v_exp_f32 v41, v41
    v_exp_f32 v42, v42
    v_exp_f32 v43, v43
    v_exp_f32 v48, v48
    v_exp_f32 v49, v49
    v_exp_f32 v50, v50
    v_exp_f32 v51, v51
    v_exp_f32 v56, v56
    v_exp_f32 v57, v57
    v_exp_f32 v58, v58
    v_exp_f32 v59, v59
    v_cvt_pk_bf16_f32 v32, v32, v33
    v_cvt_pk_bf16_f32 v33, v34, v35
    v_cvt_pk_bf16_f32 v40, v40, v41
    v_cvt_pk_bf16_f32 v41, v42, v43
    v_cvt_pk_bf16_f32 v48, v48, v49
    v_cvt_pk_bf16_f32 v49, v50, v51
    v_cvt_pk_bf16_f32 v56, v56, v57
    v_cvt_pk_bf16_f32 v57, v58, v59
    s_waitcnt vmcnt(4) lgkmcnt(0)
    s_branch K2_QKd1
K2_Md1:
    s_add_u32 s28, s31, 2
    s_cmp_ge_u32 s28, s30
    s_cbranch_scc1 K2_Md1b
    s_lshl_b32 s28, s31, 1
    s_sub_u32 s28, s56, s28
    s_lshl_b32 s28, s28, 4
    v_add_u32 v13, s28, v7
    v_cmp_gt_i32 s[44:45], 0, v13
    v_cmp_gt_i32 s[46:47], 1, v13
    v_cmp_gt_i32 s[48:49], 2, v13
    v_cmp_gt_i32 s[50:51], 3, v13
    v_cndmask_b32 v64, v64, v12, s[44:45]
    v_cndmask_b32 v65, v65, v12, s[46:47]
    v_cndmask_b32 v66, v66, v12, s[48:49]
    v_cndmask_b32 v67, v67, v12, s[50:51]
    v_cmp_gt_i32 s[44:45], 16, v13
    v_cmp_gt_i32 s[46:47], 17, v13
    v_cmp_gt_i32 s[48:49], 18, v13
    v_cmp_gt_i32 s[50:51], 19, v13
    v_cndmask_b32 v68, v68, v12, s[44:45]
    v_cndmask_b32 v69, v69, v12, s[46:47]
    v_cndmask_b32 v70, v70, v12, s[48:49]
    v_cndmask_b32 v71, v71, v12, s[50:51]
    s_branch K2_PVd0
K2_Md1b:
    s_lshl_b32 s28, s31, 1
    s_sub_u32 s28, s57, s28
    s_lshl_b32 s28, s28, 4
    v_add_u32 v13, s28, v7
    v_mov_b32 v64, v12
    v_mov_b32 v65, v12
    v_mov_b32 v66, v12
    v_mov_b32 v67, v12
    v_mov_b32 v68, v12
    v_mov_b32 v69, v12
    v_mov_b32 v70, v12
    v_mov_b32 v71, v12
    v_cmp_gt_i32 s[44:45], 0, v13
    v_cmp_gt_i32 s[46:47], 1, v13
    v_cmp_gt_i32 s[48:49], 2, v13
    v_cmp_gt_i32 s[50:51], 3, v13
    v_cndmask_b32 v72, v72, v12, s[44:45]
    v_cndmask_b32 v73, v73, v12, s[46:47]
    v_cndmask_b32 v74, v74, v12, s[48:49]
    v_cndmask_b32 v75, v75, v12, s[50:51]
    v_cmp_gt_i32 s[44:45], 16, v13
    v_cmp_gt_i32 s[46:47], 17, v13
    v_cmp_gt_i32 s[48:49], 18, v13
    v_cmp_gt_i32 s[50:51], 19, v13
    v_cndmask_b32 v76, v76, v12, s[44:45]
    v_cndmask_b32 v77, v77, v12, s[46:47]
    v_cndmask_b32 v78, v78, v12, s[48:49]
    v_cndmask_b32 v79, v79, v12, s[50:51]
    s_branch K2_PVd0
K2_Md0:
    s_add_u32 s28, s31, 2
    s_cmp_ge_u32 s28, s30
    s_cbranch_scc1 K2_Md0b
    global_load_dword v255, v10, s[6:7]
    s_lshl_b32 s28, s31, 1
    s_sub_u32 s28, s56, s28
    s_lshl_b32 s28, s28, 4
    v_add_u32 v13, s28, v7
    v_cmp_gt_i32 s[44:45], 0, v13
    v_cmp_gt_i32 s[46:47], 1, v13
    v_cmp_gt_i32 s[48:49], 2, v13
    v_cmp_gt_i32 s[50:51], 3, v13
    v_cndmask_b32 v32, v32, v12, s[44:45]
    v_cndmask_b32 v33, v33, v12, s[46:47]
    v_cndmask_b32 v34, v34, v12, s[48:49]
    v_cndmask_b32 v35, v35, v12, s[50:51]
    v_cmp_gt_i32 s[44:45], 16, v13
    v_cmp_gt_i32 s[46:47], 17, v13
    v_cmp_gt_i32 s[48:49], 18, v13
    v_cmp_gt_i32 s[50:51], 19, v13
    v_cndmask_b32 v36, v36, v12, s[44:45]
    v_cndmask_b32 v37, v37, v12, s[46:47]
    v_cndmask_b32 v38, v38, v12, s[48:49]
    v_cndmask_b32 v39, v39, v12, s[50:51]
    s_branch K2_EVT
K2_Md0b:
    s_lshl_b32 s28, s31, 1
    s_sub_u32 s28, s57, s28
    s_lshl_b32 s28, s28, 4
    v_add_u32 v13, s28, v7
    v_mov_b32 v32, v12
    v_mov_b32 v33, v12
    v_mov_b32 v34, v12
    v_mov_b32 v35, v12
    v_mov_b32 v36, v12
    v_mov_b32 v37, v12
    v_mov_b32 v38, v12
    v_mov_b32 v39, v12
    v_cmp_gt_i32 s[44:45], 0, v13
    v_cmp_gt_i32 s[46:47], 1, v13
    v_cmp_gt_i32 s[48:49], 2, v13
    v_cmp_gt_i32 s[50:51], 3, v13
    v_cndmask_b32 v40, v40, v12, s[44:45]
    v_cndmask_b32 v41, v41, v12, s[46:47]
    v_cndmask_b32 v42, v42, v12, s[48:49]
    v_cndmask_b32 v43, v43, v12, s[50:51]
    v_cmp_gt_i32 s[44:45], 16, v13
    v_cmp_gt_i32 s[46:47], 17, v13
    v_cmp_gt_i32 s[48:49], 18, v13
    v_cmp_gt_i32 s[50:51], 19, v13
    v_cndmask_b32 v44, v44, v12, s[44:45]
    v_cndmask_b32 v45, v45, v12, s[46:47]
    v_cndmask_b32 v46, v46, v12, s[48:49]
    v_cndmask_b32 v47, v47, v12, s[50:51]
    s_branch K2_EVT
    .p2align 6
K2_PVs1:
    v_mfma_f32_16x16x32_bf16 a[8:11], v[128:131], v[64:67], a[8:11]
    s_mov_b32 m0, s77
    v_exp_f32 v32, v32
    v_mfma_f32_16x16x32_bf16 a[12:15], v[128:131], v[72:75], a[12:15]
    buffer_load_dwordx4 v3, s[96:99], s76 offen lds
    v_mfma_f32_16x16x32_bf16 a[28:31], v[132:135], v[72:75], a[28:31]
    ds_read_b128 v[160:163], v6 offset:24576
    ds_read_b128 v[164:167], v6 offset:25600
    v_mfma_f32_16x16x32_bf16 a[24:27], v[132:135], v[64:67], a[24:27]
    s_waitcnt lgkmcnt(2)
    v_exp_f32 v33, v33
    v_mfma_f32_16x16x32_bf16 a[40:43], v[136:139], v[64:67], a[40:43]
    s_lshr_b32 s80, s31, 1
    ds_read_b128 v[168:171], v6 offset:26624
    ds_read_b128 v[172:175], v6 offset:27648
    v_mfma_f32_16x16x32_bf16 a[44:47], v[136:139], v[72:75], a[44:47]
    s_add_u32 m0, s34, 24576
    v_exp_f32 v34, v34
    v_mfma_f32_16x16x32_bf16 a[60:63], v[140:143], v[72:75], a[60:63]
    buffer_load_dwordx4 v28, s[16:19], s32 offen offset:0 sc1 lds
    v_mfma_f32_16x16x32_bf16 a[56:59], v[140:143], v[64:67], a[56:59]
    s_sub_u32 s80, s80, 5
    ds_read_b128 v[176:179], v6 offset:28672
    ds_read_b128 v[180:183], v6 offset:29696
    v_mfma_f32_16x16x32_bf16 v[120:123], v[24:27], v[64:67], v[120:123]
    s_min_u32 s80, s80, 8
    v_exp_f32 v35, v35
    v_mfma_f32_16x16x32_bf16 a[72:75], v[144:147], v[64:67], a[72:75]
    s_mul_i32 s79, s80, s84
    ds_read_b128 v[184:187], v6 offset:30720
    ds_read_b128 v[188:191], v6 offset:31744
    v_mfma_f32_16x16x32_bf16 a[76:79], v[144:147], v[72:75], a[76:79]
    s_add_u32 s79, s79, s83
    v_exp_f32 v40, v40
    v_mfma_f32_16x16x32_bf16 a[92:95], v[148:151], v[72:75], a[92:95]
    buffer_load_dwordx4 v28, s[16:19], s32 offen offset:1024 sc1 lds
    v_mfma_f32_16x16x32_bf16 a[88:91], v[148:151], v[64:67], a[88:91]
    s_add_u32 s32, s32, 16384
    v_cvt_pk_bf16_f32 v32, v32, v33
    v_xor_b32 v6, 0x18000, v6
    v_mfma_f32_16x16x32_bf16 a[104:107], v[152:155], v[64:67], a[104:107]
    s_add_u32 m0, s35, 0
    v_exp_f32 v41, v41
    v_mfma_f32_16x16x32_bf16 a[108:111], v[152:155], v[72:75], a[108:111]
    buffer_load_dwordx4 v4, s[20:23], s33 offen offset:0 sc1 lds
    v_mfma_f32_16x16x32_bf16 a[124:127], v[156:159], v[72:75], a[124:127]
    s_mul_i32 s78, s80, 0x420
    v_exp_f32 v42, v42
    v_mfma_f32_16x16x32_bf16 a[120:123], v[156:159], v[64:67], a[120:123]
    s_and_b32 s78, s78, 0x1060
    ds_read_b128 a[192:195], v5 offset:16384
    v_cvt_pk_bf16_f32 v33, v34, v35
    v_mfma_f32_16x16x32_bf16 v[124:127], v[24:27], v[72:75], v[124:127]
    s_waitcnt lgkmcnt(1)
    v_exp_f32 v43, v43
    v_mfma_f32_16x16x32_bf16 a[8:11], v[160:163], v[80:83], a[8:11]
    buffer_load_dwordx4 v4, s[20:23], s33 offen offset:1024 sc1 lds
    v_mfma_f32_16x16x32_bf16 a[12:15], v[160:163], v[88:91], a[12:15]
    s_lshr_b32 s80, s80, 3
    ds_read_b128 a[196:199], v5 offset:17408
    v_cvt_pk_bf16_f32 v40, v40, v41
    v_mfma_f32_16x16x32_bf16 a[28:31], v[164:167], v[88:91], a[28:31]
    s_lshl_b32 s80, s80, 26
    v_exp_f32 v48, v48
    v_mfma_f32_16x16x32_bf16 a[24:27], v[164:167], v[80:83], a[24:27]
    s_add_u32 s79, s79, s80
    ds_read_b128 a[200:203], v5 offset:18432
    v_cvt_pk_bf16_f32 v41, v42, v43
    v_mfma_f32_16x16x32_bf16 a[40:43], v[168:171], v[80:83], a[40:43]
    s_add_u32 m0, s35, 8192
    v_exp_f32 v49, v49
    v_mfma_f32_16x16x32_bf16 a[44:47], v[168:171], v[88:91], a[44:47]
    buffer_load_dwordx4 v28, s[20:23], s33 offen offset:0 sc1 lds
    v_mfma_f32_16x16x32_bf16 a[60:63], v[172:175], v[88:91], a[60:63]
    ds_read_b128 a[204:207], v5 offset:19456
    v_cvt_pk_bf16_f32 v48, v48, v49
    v_mfma_f32_16x16x32_bf16 a[56:59], v[172:175], v[80:83], a[56:59]
    v_exp_f32 v50, v50
    v_mfma_f32_16x16x32_bf16 v[120:123], v[24:27], v[80:83], v[120:123]
    ds_read_b128 a[208:211], v5 offset:20480
    ds_read_b128 a[212:215], v5 offset:21504
    v_mfma_f32_16x16x32_bf16 a[72:75], v[176:179], v[80:83], a[72:75]
    v_exp_f32 v51, v51
    v_mfma_f32_16x16x32_bf16 a[76:79], v[176:179], v[88:91], a[76:79]
    buffer_load_dwordx4 v28, s[20:23], s33 offen offset:1024 sc1 lds
    v_mfma_f32_16x16x32_bf16 a[92:95], v[180:183], v[88:91], a[92:95]
    s_add_u32 s33, s33, 16384
    v_exp_f32 v56, v56
    v_mfma_f32_16x16x32_bf16 a[88:91], v[180:183], v[80:83], a[88:91]
    ds_read_b128 a[216:219], v5 offset:22528
    v_cvt_pk_bf16_f32 v49, v50, v51
    v_mfma_f32_16x16x32_bf16 a[104:107], v[184:187], v[80:83], a[104:107]
    s_xor_b32 s34, s34, 0x38000
    v_exp_f32 v57, v57
    v_mfma_f32_16x16x32_bf16 a[108:111], v[184:187], v[88:91], a[108:111]
    ds_read_b128 a[220:223], v5 offset:23552
    v_cvt_pk_bf16_f32 v56, v56, v57
    v_mfma_f32_16x16x32_bf16 a[124:127], v[188:191], v[88:91], a[124:127]
    v_exp_f32 v58, v58
    v_mfma_f32_16x16x32_bf16 a[120:123], v[188:191], v[80:83], a[120:123]
    v_exp_f32 v59, v59
    v_mfma_f32_16x16x32_bf16 v[124:127], v[24:27], v[88:91], v[124:127]
    s_waitcnt lgkmcnt(4)
    v_cvt_pk_bf16_f32 v57, v58, v59
    v_xor_b32 v9, s78, v8
K2_QKs1:
    v_mfma_f32_16x16x32_bf16 v[64:67], a[192:195], a[160:163], v[104:107]
    v_exp_f32 v36, v36
    v_mfma_f32_16x16x32_bf16 v[64:67], a[196:199], a[164:167], v[64:67]
    ds_read_b128 a[224:227], v5 offset:24576
    ds_read_b128 a[228:231], v5 offset:25600
    v_mfma_f32_16x16x32_bf16 v[64:67], a[200:203], a[168:171], v[64:67]
    s_add_u32 s31, s31, 1
    v_exp_f32 v37, v37
    v_mfma_f32_16x16x32_bf16 v[64:67], a[204:207], a[172:175], v[64:67]
    ds_read_b128 a[232:235], v5 offset:26624
    ds_read_b128 a[236:239], v5 offset:27648
    v_mfma_f32_16x16x32_bf16 v[72:75], a[204:207], a[188:191], v[108:111]
    v_exp_f32 v38, v38
    v_mfma_f32_16x16x32_bf16 v[72:75], a[200:203], a[184:187], v[72:75]
    ds_read_b128 a[240:243], v5 offset:28672
    ds_read_b128 a[244:247], v5 offset:29696
    v_mfma_f32_16x16x32_bf16 v[72:75], a[196:199], a[180:183], v[72:75]
    s_waitcnt lgkmcnt(6)
    v_exp_f32 v39, v39
    v_mfma_f32_16x16x32_bf16 v[72:75], a[192:195], a[176:179], v[72:75]
    ds_read_b128 a[248:251], v5 offset:30720
    ds_read_b128 a[252:255], v5 offset:31744
    v_mfma_f32_16x16x32_bf16 v[76:79], a[208:211], a[176:179], v[108:111]
    s_add_u32 m0, s34, 0
    v_exp_f32 v44, v44
    v_mfma_f32_16x16x32_bf16 v[76:79], a[212:215], a[180:183], v[76:79]
    buffer_load_dwordx4 v4, s[16:19], s32 offen offset:0 sc1 lds
    v_mfma_f32_16x16x32_bf16 v[76:79], a[216:219], a[184:187], v[76:79]
    v_exp_f32 v45, v45
    v_mfma_f32_16x16x32_bf16 v[76:79], a[220:223], a[188:191], v[76:79]
    v_cvt_pk_bf16_f32 v34, v36, v37
    v_cvt_pk_bf16_f32 v35, v38, v39
    v_mfma_f32_16x16x32_bf16 v[68:71], a[220:223], a[172:175], v[104:107]
    v_exp_f32 v46, v46
    v_mfma_f32_16x16x32_bf16 v[68:71], a[216:219], a[168:171], v[68:71]
    buffer_load_dwordx4 v4, s[16:19], s32 offen offset:1024 sc1 lds
    v_mfma_f32_16x16x32_bf16 v[68:71], a[212:215], a[164:167], v[68:71]
    s_waitcnt vmcnt(14) lgkmcnt(0)
    v_exp_f32 v47, v47
    v_mfma_f32_16x16x32_bf16 v[68:71], a[208:211], a[160:163], v[68:71]
    s_barrier
    v_mfma_f32_16x16x32_bf16 v[80:83], a[224:227], a[160:163], v[104:107]
    ds_read_b64_tr_b16 v[220:221], v9 offset:0
    ds_read_b64_tr_b16 v[222:223], v9 offset:2048
    v_mfma_f32_16x16x32_bf16 v[80:83], a[228:231], a[164:167], v[80:83]
    v_exp_f32 v52, v52
    v_mfma_f32_16x16x32_bf16 v[80:83], a[232:235], a[168:171], v[80:83]
    ds_read_b128 v[128:131], v6 offset:0
    ds_read_b128 v[132:135], v6 offset:1024
    v_mfma_f32_16x16x32_bf16 v[80:83], a[236:239], a[172:175], v[80:83]
    v_exp_f32 v53, v53
    v_mfma_f32_16x16x32_bf16 v[88:91], a[236:239], a[188:191], v[108:111]
    ds_read_b128 v[136:139], v6 offset:2048
    v_cvt_pk_bf16_f32 v42, v44, v45
    v_mfma_f32_16x16x32_bf16 v[88:91], a[232:235], a[184:187], v[88:91]
    v_exp_f32 v54, v54
    v_mfma_f32_16x16x32_bf16 v[88:91], a[228:231], a[180:183], v[88:91]
    ds_read_b128 v[140:143], v6 offset:3072
    v_cvt_pk_bf16_f32 v43, v46, v47
    v_mfma_f32_16x16x32_bf16 v[88:91], a[224:227], a[176:179], v[88:91]
    v_exp_f32 v55, v55
    v_mfma_f32_16x16x32_bf16 v[92:95], a[240:243], a[176:179], v[108:111]
    ds_read_b128 v[144:147], v6 offset:4096
    ds_read_b128 v[148:151], v6 offset:5120
    v_mfma_f32_16x16x32_bf16 v[92:95], a[244:247], a[180:183], v[92:95]
    v_exp_f32 v60, v60
    v_mfma_f32_16x16x32_bf16 v[92:95], a[248:251], a[184:187], v[92:95]
    ds_read_b128 v[152:155], v6 offset:6144
    v_cvt_pk_bf16_f32 v50, v52, v53
    v_mfma_f32_16x16x32_bf16 v[92:95], a[252:255], a[188:191], v[92:95]
    v_exp_f32 v61, v61
    v_mfma_f32_16x16x32_bf16 v[84:87], a[252:255], a[172:175], v[104:107]
    ds_read_b128 v[156:159], v6 offset:7168
    v_cvt_pk_bf16_f32 v51, v54, v55
    v_mfma_f32_16x16x32_bf16 v[84:87], a[248:251], a[168:171], v[84:87]
    v_exp_f32 v62, v62
    v_mfma_f32_16x16x32_bf16 v[84:87], a[244:247], a[164:167], v[84:87]
    v_exp_f32 v63, v63
    v_mfma_f32_16x16x32_bf16 v[84:87], a[240:243], a[160:163], v[84:87]
    s_waitcnt lgkmcnt(4)
    v_cvt_pk_bf16_f32 v58, v60, v61
    v_cvt_pk_bf16_f32 v59, v62, v63
K2_PVs0:
    v_mfma_f32_16x16x32_bf16 a[8:11], v[128:131], v[32:35], a[8:11]
    v_exp_f32 v64, v64
    v_mfma_f32_16x16x32_bf16 a[12:15], v[128:131], v[40:43], a[12:15]
    buffer_store_dwordx4 v[220:223], v2, s[8:11], s79 offen sc1
    v_mfma_f32_16x16x32_bf16 a[28:31], v[132:135], v[40:43], a[28:31]
    ds_read_b128 v[160:163], v6 offset:8192
    ds_read_b128 v[164:167], v6 offset:9216
    v_mfma_f32_16x16x32_bf16 a[24:27], v[132:135], v[32:35], a[24:27]
    s_waitcnt lgkmcnt(2)
    v_exp_f32 v65, v65
    v_mfma_f32_16x16x32_bf16 a[40:43], v[136:139], v[32:35], a[40:43]
    s_lshr_b32 s80, s31, 1
    ds_read_b128 v[168:171], v6 offset:10240
    ds_read_b128 v[172:175], v6 offset:11264
    v_mfma_f32_16x16x32_bf16 a[44:47], v[136:139], v[40:43], a[44:47]
    s_add_u32 m0, s34, 8192
    v_exp_f32 v66, v66
    v_mfma_f32_16x16x32_bf16 a[60:63], v[140:143], v[40:43], a[60:63]
    buffer_load_dwordx4 v28, s[16:19], s32 offen offset:0 sc1 lds
    v_mfma_f32_16x16x32_bf16 a[56:59], v[140:143], v[32:35], a[56:59]
    s_min_u32 s80, s80, 7
    ds_read_b128 v[176:179], v6 offset:12288
    ds_read_b128 v[180:183], v6 offset:13312
    v_mfma_f32_16x16x32_bf16 v[120:123], v[24:27], v[32:35], v[120:123]
    s_lshl_b32 s77, s80, 10
    v_exp_f32 v67, v67
    v_mfma_f32_16x16x32_bf16 a[72:75], v[144:147], v[32:35], a[72:75]
    s_add_u32 s77, s77, s40
    ds_read_b128 v[184:187], v6 offset:14336
    ds_read_b128 v[188:191], v6 offset:15360
    v_mfma_f32_16x16x32_bf16 a[76:79], v[144:147], v[40:43], a[76:79]
    s_and_b32 s76, s80, 3
    v_exp_f32 v72, v72
    v_mfma_f32_16x16x32_bf16 a[92:95], v[148:151], v[40:43], a[92:95]
    buffer_load_dwordx4 v28, s[16:19], s32 offen offset:1024 sc1 lds
    v_mfma_f32_16x16x32_bf16 a[88:91], v[148:151], v[32:35], a[88:91]
    s_add_u32 s32, s32, 16384
    v_cvt_pk_bf16_f32 v64, v64, v65
    v_xor_b32 v5, 0x38000, v5
    v_mfma_f32_16x16x32_bf16 a[104:107], v[152:155], v[32:35], a[104:107]
    s_add_u32 m0, s35, 16384
    v_exp_f32 v73, v73
    v_mfma_f32_16x16x32_bf16 a[108:111], v[152:155], v[40:43], a[108:111]
    buffer_load_dwordx4 v4, s[20:23], s33 offen offset:0 sc1 lds
    v_mfma_f32_16x16x32_bf16 a[124:127], v[156:159], v[40:43], a[124:127]
    s_mul_i32 s76, s76, 10240
    v_exp_f32 v74, v74
    v_mfma_f32_16x16x32_bf16 a[120:123], v[156:159], v[32:35], a[120:123]
    s_lshr_b32 s80, s80, 2
    ds_read_b128 a[192:195], v5 offset:0
    v_cvt_pk_bf16_f32 v65, v66, v67
    v_mfma_f32_16x16x32_bf16 v[124:127], v[24:27], v[40:43], v[124:127]
    s_waitcnt lgkmcnt(1)
    v_exp_f32 v75, v75
    v_mfma_f32_16x16x32_bf16 a[8:11], v[160:163], v[48:51], a[8:11]
    buffer_load_dwordx4 v4, s[20:23], s33 offen offset:1024 sc1 lds
    v_mfma_f32_16x16x32_bf16 a[12:15], v[160:163], v[56:59], a[12:15]
    s_lshl_b32 s80, s80, 7
    ds_read_b128 a[196:199], v5 offset:1024
    v_cvt_pk_bf16_f32 v72, v72, v73
    v_mfma_f32_16x16x32_bf16 a[28:31], v[164:167], v[56:59], a[28:31]
    s_add_u32 s76, s76, s80
    v_exp_f32 v80, v80
    v_mfma_f32_16x16x32_bf16 a[24:27], v[164:167], v[48:51], a[24:27]
    s_add_u32 s76, s76, s36
    ds_read_b128 a[200:203], v5 offset:2048
    v_cvt_pk_bf16_f32 v73, v74, v75
    v_mfma_f32_16x16x32_bf16 a[40:43], v[168:171], v[48:51], a[40:43]
    s_add_u32 m0, s35, 24576
    v_exp_f32 v81, v81
    v_mfma_f32_16x16x32_bf16 a[44:47], v[168:171], v[56:59], a[44:47]
    buffer_load_dwordx4 v28, s[20:23], s33 offen offset:0 sc1 lds
    v_mfma_f32_16x16x32_bf16 a[60:63], v[172:175], v[56:59], a[60:63]
    ds_read_b128 a[204:207], v5 offset:3072
    v_cvt_pk_bf16_f32 v80, v80, v81
    v_mfma_f32_16x16x32_bf16 a[56:59], v[172:175], v[48:51], a[56:59]
    v_exp_f32 v82, v82
    v_mfma_f32_16x16x32_bf16 v[120:123], v[24:27], v[48:51], v[120:123]
    ds_read_b128 a[208:211], v5 offset:4096
    ds_read_b128 a[212:215], v5 offset:5120
    v_mfma_f32_16x16x32_bf16 a[72:75], v[176:179], v[48:51], a[72:75]
    v_exp_f32 v83, v83
    v_mfma_f32_16x16x32_bf16 a[76:79], v[176:179], v[56:59], a[76:79]
    buffer_load_dwordx4 v28, s[20:23], s33 offen offset:1024 sc1 lds
    v_mfma_f32_16x16x32_bf16 a[92:95], v[180:183], v[56:59], a[92:95]
    s_add_u32 s33, s33, 16384
    v_exp_f32 v88, v88
    v_mfma_f32_16x16x32_bf16 a[88:91], v[180:183], v[48:51], a[88:91]
    ds_read_b128 a[216:219], v5 offset:6144
    v_cvt_pk_bf16_f32 v81, v82, v83
    v_mfma_f32_16x16x32_bf16 a[104:107], v[184:187], v[48:51], a[104:107]
    s_xor_b32 s35, s35, 0x18000
    v_exp_f32 v89, v89
    v_mfma_f32_16x16x32_bf16 a[108:111], v[184:187], v[56:59], a[108:111]
    ds_read_b128 a[220:223], v5 offset:7168
    v_cvt_pk_bf16_f32 v88, v88, v89
    v_mfma_f32_16x16x32_bf16 a[124:127], v[188:191], v[56:59], a[124:127]
    v_exp_f32 v90, v90
    v_mfma_f32_16x16x32_bf16 a[120:123], v[188:191], v[48:51], a[120:123]
    v_exp_f32 v91, v91
    v_mfma_f32_16x16x32_bf16 v[124:127], v[24:27], v[56:59], v[124:127]
    s_waitcnt lgkmcnt(4)
    v_cvt_pk_bf16_f32 v89, v90, v91
K2_QKs0:
    v_mfma_f32_16x16x32_bf16 v[32:35], a[192:195], a[160:163], v[104:107]
    v_exp_f32 v68, v68
    v_mfma_f32_16x16x32_bf16 v[32:35], a[196:199], a[164:167], v[32:35]
    ds_read_b128 a[224:227], v5 offset:8192
    ds_read_b128 a[228:231], v5 offset:9216
    v_mfma_f32_16x16x32_bf16 v[32:35], a[200:203], a[168:171], v[32:35]
    s_add_u32 s31, s31, 1
    v_exp_f32 v69, v69
    v_mfma_f32_16x16x32_bf16 v[32:35], a[204:207], a[172:175], v[32:35]
    ds_read_b128 a[232:235], v5 offset:10240
    ds_read_b128 a[236:239], v5 offset:11264
    v_mfma_f32_16x16x32_bf16 v[40:43], a[204:207], a[188:191], v[108:111]
    v_exp_f32 v70, v70
    v_mfma_f32_16x16x32_bf16 v[40:43], a[200:203], a[184:187], v[40:43]
    ds_read_b128 a[240:243], v5 offset:12288
    ds_read_b128 a[244:247], v5 offset:13312
    v_mfma_f32_16x16x32_bf16 v[40:43], a[196:199], a[180:183], v[40:43]
    s_waitcnt lgkmcnt(6)
    v_exp_f32 v71, v71
    v_mfma_f32_16x16x32_bf16 v[40:43], a[192:195], a[176:179], v[40:43]
    ds_read_b128 a[248:251], v5 offset:14336
    ds_read_b128 a[252:255], v5 offset:15360
    v_mfma_f32_16x16x32_bf16 v[44:47], a[208:211], a[176:179], v[108:111]
    s_add_u32 m0, s34, 16384
    v_exp_f32 v76, v76
    v_mfma_f32_16x16x32_bf16 v[44:47], a[212:215], a[180:183], v[44:47]
    buffer_load_dwordx4 v4, s[16:19], s32 offen offset:0 sc1 lds
    v_mfma_f32_16x16x32_bf16 v[44:47], a[216:219], a[184:187], v[44:47]
    v_exp_f32 v77, v77
    v_mfma_f32_16x16x32_bf16 v[44:47], a[220:223], a[188:191], v[44:47]
    v_cvt_pk_bf16_f32 v66, v68, v69
    v_cvt_pk_bf16_f32 v67, v70, v71
    v_mfma_f32_16x16x32_bf16 v[36:39], a[220:223], a[172:175], v[104:107]
    v_exp_f32 v78, v78
    v_mfma_f32_16x16x32_bf16 v[36:39], a[216:219], a[168:171], v[36:39]
    buffer_load_dwordx4 v4, s[16:19], s32 offen offset:1024 sc1 lds
    v_mfma_f32_16x16x32_bf16 v[36:39], a[212:215], a[164:167], v[36:39]
    s_waitcnt vmcnt(14) lgkmcnt(0)
    v_exp_f32 v79, v79
    v_mfma_f32_16x16x32_bf16 v[36:39], a[208:211], a[160:163], v[36:39]
    s_barrier
    v_mfma_f32_16x16x32_bf16 v[48:51], a[224:227], a[160:163], v[104:107]
    v_exp_f32 v84, v84
    v_mfma_f32_16x16x32_bf16 v[48:51], a[228:231], a[164:167], v[48:51]
    ds_read_b128 v[128:131], v6 offset:16384
    ds_read_b128 v[132:135], v6 offset:17408
    v_mfma_f32_16x16x32_bf16 v[48:51], a[232:235], a[168:171], v[48:51]
    v_exp_f32 v85, v85
    v_mfma_f32_16x16x32_bf16 v[48:51], a[236:239], a[172:175], v[48:51]
    ds_read_b128 v[136:139], v6 offset:18432
    v_cvt_pk_bf16_f32 v74, v76, v77
    v_mfma_f32_16x16x32_bf16 v[56:59], a[236:239], a[188:191], v[108:111]
    v_exp_f32 v86, v86
    v_mfma_f32_16x16x32_bf16 v[56:59], a[232:235], a[184:187], v[56:59]
    ds_read_b128 v[140:143], v6 offset:19456
    v_cvt_pk_bf16_f32 v75, v78, v79
    v_mfma_f32_16x16x32_bf16 v[56:59], a[228:231], a[180:183], v[56:59]
    v_exp_f32 v87, v87
    v_mfma_f32_16x16x32_bf16 v[56:59], a[224:227], a[176:179], v[56:59]
    ds_read_b128 v[144:147], v6 offset:20480
    ds_read_b128 v[148:151], v6 offset:21504
    v_mfma_f32_16x16x32_bf16 v[60:63], a[240:243], a[176:179], v[108:111]
    v_exp_f32 v92, v92
    v_mfma_f32_16x16x32_bf16 v[60:63], a[244:247], a[180:183], v[60:63]
    ds_read_b128 v[152:155], v6 offset:22528
    v_cvt_pk_bf16_f32 v82, v84, v85
    v_mfma_f32_16x16x32_bf16 v[60:63], a[248:251], a[184:187], v[60:63]
    v_exp_f32 v93, v93
    v_mfma_f32_16x16x32_bf16 v[60:63], a[252:255], a[188:191], v[60:63]
    ds_read_b128 v[156:159], v6 offset:23552
    v_cvt_pk_bf16_f32 v83, v86, v87
    v_mfma_f32_16x16x32_bf16 v[52:55], a[252:255], a[172:175], v[104:107]
    v_exp_f32 v94, v94
    v_mfma_f32_16x16x32_bf16 v[52:55], a[248:251], a[168:171], v[52:55]
    s_cmp_lt_u32 s31, s43
    v_exp_f32 v95, v95
    v_mfma_f32_16x16x32_bf16 v[52:55], a[244:247], a[164:167], v[52:55]
    s_waitcnt lgkmcnt(4)
    v_cvt_pk_bf16_f32 v90, v92, v93
    v_cvt_pk_bf16_f32 v91, v94, v95
    v_mfma_f32_16x16x32_bf16 v[52:55], a[240:243], a[160:163], v[52:55]
    s_cbranch_scc1 K2_PVs1
    s_cmp_lt_u32 s31, 32
    s_cbranch_scc1 K2_EVT
    s_branch K2_tail
K2_slow:
    s_mov_b32 s38, 1
    s_barrier
    v_mov_b32 v112, v12
    v_mov_b32 v113, v12
    v_mov_b32 v114, v12
    v_mov_b32 v115, v12
    v_add_u32 v5, 0x18000, v2
    s_mov_b32 s32, 0
    s_mov_b32 s31, 0
    s_lshr_b32 s33, s18, 13
K2_slowloop:
    s_add_u32 m0, s39, 0x18000
    s_nop 0
    buffer_load_dwordx4 v4, s[16:19], s32 offen sc1 lds
    buffer_load_dwordx4 v4, s[16:19], s32 offen offset:1024 sc1 lds
    s_add_u32 s32, s32, 8192
    s_waitcnt vmcnt(0)
    s_barrier
    ds_read_b128 a[192:195], v5 offset:0
    ds_read_b128 a[196:199], v5 offset:1024
    ds_read_b128 a[200:203], v5 offset:2048
    ds_read_b128 a[204:207], v5 offset:3072
    ds_read_b128 a[208:211], v5 offset:4096
    ds_read_b128 a[212:215], v5 offset:5120
    ds_read_b128 a[216:219], v5 offset:6144
    ds_read_b128 a[220:223], v5 offset:7168
    s_waitcnt lgkmcnt(0)
    s_barrier
    v_mfma_f32_16x16x32_bf16 v[32:35], a[192:195], a[128:131], 0
    v_mfma_f32_16x16x32_bf16 v[32:35], a[196:199], a[132:135], v[32:35]
    v_mfma_f32_16x16x32_bf16 v[32:35], a[200:203], a[136:139], v[32:35]
    v_mfma_f32_16x16x32_bf16 v[32:35], a[204:207], a[140:143], v[32:35]
    v_mfma_f32_16x16x32_bf16 v[40:43], a[192:195], a[144:147], 0
    v_mfma_f32_16x16x32_bf16 v[40:43], a[196:199], a[148:151], v[40:43]
    v_mfma_f32_16x16x32_bf16 v[40:43], a[200:203], a[152:155], v[40:43]
    v_mfma_f32_16x16x32_bf16 v[40:43], a[204:207], a[156:159], v[40:43]
    v_mfma_f32_16x16x32_bf16 v[48:51], a[192:195], a[160:163], 0
    v_mfma_f32_16x16x32_bf16 v[48:51], a[196:199], a[164:167], v[48:51]
    v_mfma_f32_16x16x32_bf16 v[48:51], a[200:203], a[168:171], v[48:51]
    v_mfma_f32_16x16x32_bf16 v[48:51], a[204:207], a[172:175], v[48:51]
    v_mfma_f32_16x16x32_bf16 v[56:59], a[192:195], a[176:179], 0
    v_mfma_f32_16x16x32_bf16 v[56:59], a[196:199], a[180:183], v[56:59]
    v_mfma_f32_16x16x32_bf16 v[56:59], a[200:203], a[184:187], v[56:59]
    v_mfma_f32_16x16x32_bf16 v[56:59], a[204:207], a[188:191], v[56:59]
    v_mfma_f32_16x16x32_bf16 v[36:39], a[208:211], a[128:131], 0
    v_mfma_f32_16x16x32_bf16 v[36:39], a[212:215], a[132:135], v[36:39]
    v_mfma_f32_16x16x32_bf16 v[36:39], a[216:219], a[136:139], v[36:39]
    v_mfma_f32_16x16x32_bf16 v[36:39], a[220:223], a[140:143], v[36:39]
    v_mfma_f32_16x16x32_bf16 v[44:47], a[208:211], a[144:147], 0
    v_mfma_f32_16x16x32_bf16 v[44:47], a[212:215], a[148:151], v[44:47]
    v_mfma_f32_16x16x32_bf16 v[44:47], a[216:219], a[152:155], v[44:47]
    v_mfma_f32_16x16x32_bf16 v[44:47], a[220:223], a[156:159], v[44:47]
    v_mfma_f32_16x16x32_bf16 v[52:55], a[208:211], a[160:163], 0
    v_mfma_f32_16x16x32_bf16 v[52:55], a[212:215], a[164:167], v[52:55]
    v_mfma_f32_16x16x32_bf16 v[52:55], a[216:219], a[168:171], v[52:55]
    v_mfma_f32_16x16x32_bf16 v[52:55], a[220:223], a[172:175], v[52:55]
    v_mfma_f32_16x16x32_bf16 v[60:63], a[208:211], a[176:179], 0
    v_mfma_f32_16x16x32_bf16 v[60:63], a[212:215], a[180:183], v[60:63]
    v_mfma_f32_16x16x32_bf16 v[60:63], a[216:219], a[184:187], v[60:63]
    v_mfma_f32_16x16x32_bf16 v[60:63], a[220:223], a[188:191], v[60:63]
    s_lshl_b32 s28, s31, 1
    s_sub_u32 s29, s56, s28
    s_lshl_b32 s29, s29, 4
    v_add_u32 v13, s29, v7
    s_sub_u32 s29, s57, s28
    s_lshl_b32 s29, s29, 4
    v_add_u32 v14, s29, v7
    s_sub_u32 s29, s58, s28
    s_lshl_b32 s29, s29, 4
    v_add_u32 v15, s29, v7
    s_sub_u32 s29, s59, s28
    s_lshl_b32 s29, s29, 4
    v_add_u32 v16, s29, v7
    v_cmp_gt_i32 s[44:45], 0, v13
    v_cmp_gt_i32 s[46:47], 1, v13
    v_cmp_gt_i32 s[48:49], 2, v13
    v_cmp_gt_i32 s[50:51], 3, v13
    v_cndmask_b32 v32, v32, v12, s[44:45]
    v_cndmask_b32 v33, v33, v12, s[46:47]
    v_cndmask_b32 v34, v34, v12, s[48:49]
    v_cndmask_b32 v35, v35, v12, s[50:51]
    v_cmp_gt_i32 s[44:45], 16, v13
    v_cmp_gt_i32 s[46:47], 17, v13
    v_cmp_gt_i32 s[48:49], 18, v13
    v_cmp_gt_i32 s[50:51], 19, v13
    v_cndmask_b32 v36, v36, v12, s[44:45]
    v_cndmask_b32 v37, v37, v12, s[46:47]
    v_cndmask_b32 v38, v38, v12, s[48:49]
    v_cndmask_b32 v39, v39, v12, s[50:51]
    v_cmp_gt_i32 s[44:45], 0, v14
    v_cmp_gt_i32 s[46:47], 1, v14
    v_cmp_gt_i32 s[48:49], 2, v14
    v_cmp_gt_i32 s[50:51], 3, v14
    v_cndmask_b32 v40, v40, v12, s[44:45]
    v_cndmask_b32 v41, v41, v12, s[46:47]
    v_cndmask_b32 v42, v42, v12, s[48:49]
    v_cndmask_b32 v43, v43, v12, s[50:51]
    v_cmp_gt_i32 s[44:45], 16, v14
    v_cmp_gt_i32 s[46:47], 17, v14
    v_cmp_gt_i32 s[48:49], 18, v14
    v_cmp_gt_i32 s[50:51], 19, v14
    v_cndmask_b32 v44, v44, v12, s[44:45]
    v_cndmask_b32 v45, v45, v12, s[46:47]
    v_cndmask_b32 v46, v46, v12, s[48:49]
    v_cndmask_b32 v47, v47, v12, s[50:51]
    v_cmp_gt_i32 s[44:45], 0, v15
    v_cmp_gt_i32 s[46:47], 1, v15
    v_cmp_gt_i32 s[48:49], 2, v15
    v_cmp_gt_i32 s[50:51], 3, v15
    v_cndmask_b32 v48, v48, v12, s[44:45]
    v_cndmask_b32 v49, v49, v12, s[46:47]
    v_cndmask_b32 v50, v50, v12, s[48:49]
    v_cndmask_b32 v51, v51, v12, s[50:51]
    v_cmp_gt_i32 s[44:45], 16, v15
    v_cmp_gt_i32 s[46:47], 17, v15
    v_cmp_gt_i32 s[48:49], 18, v15
    v_cmp_gt_i32 s[50:51], 19, v15
    v_cndmask_b32 v52, v52, v12, s[44:45]
    v_cndmask_b32 v53, v53, v12, s[46:47]
    v_cndmask_b32 v54, v54, v12, s[48:49]
    v_cndmask_b32 v55, v55, v12, s[50:51]
    v_cmp_gt_i32 s[44:45], 0, v16
    v_cmp_gt_i32 s[46:47], 1, v16
    v_cmp_gt_i32 s[48:49], 2, v16
    v_cmp_gt_i32 s[50:51], 3, v16
    v_cndmask_b32 v56, v56, v12, s[44:45]
    v_cndmask_b32 v57, v57, v12, s[46:47]
    v_cndmask_b32 v58, v58, v12, s[48:49]
    v_cndmask_b32 v59, v59, v12, s[50:51]
    v_cmp_gt_i32 s[44:45], 16, v16
    v_cmp_gt_i32 s[46:47], 17, v16
    v_cmp_gt_i32 s[48:49], 18, v16
    v_cmp_gt_i32 s[50:51], 19, v16
    v_cndmask_b32 v60, v60, v12, s[44:45]
    v_cndmask_b32 v61, v61, v12, s[46:47]
    v_cndmask_b32 v62, v62, v12, s[48:49]
    v_cndmask_b32 v63, v63, v12, s[50:51]
    v_max3_f32 v112, v112, v32, v33
    v_max3_f32 v112, v112, v34, v35
    v_max3_f32 v112, v112, v36, v37
    v_max3_f32 v112, v112, v38, v39
    v_max3_f32 v113, v113, v40, v41
    v_max3_f32 v113, v113, v42, v43
    v_max3_f32 v113, v113, v44, v45
    v_max3_f32 v113, v113, v46, v47
    v_max3_f32 v114, v114, v48, v49
    v_max3_f32 v114, v114, v50, v51
    v_max3_f32 v114, v114, v52, v53
    v_max3_f32 v114, v114, v54, v55
    v_max3_f32 v115, v115, v56, v57
    v_max3_f32 v115, v115, v58, v59
    v_max3_f32 v115, v115, v60, v61
    v_max3_f32 v115, v115, v62, v63
    s_add_u32 s31, s31, 1
    s_cmp_lt_u32 s31, s33
    s_cbranch_scc1 K2_slowloop
    v_mov_b32 v17, v112
    s_nop 1
    v_permlane32_swap_b32 v112, v17
    v_max_f32 v112, v112, v17
    v_mov_b32 v17, v112
    s_nop 1
    v_permlane16_swap_b32 v112, v17
    v_max_f32 v112, v112, v17
    v_mov_b32 v17, v113
    s_nop 1
    v_permlane32_swap_b32 v113, v17
    v_max_f32 v113, v113, v17
    v_mov_b32 v17, v113
    s_nop 1
    v_permlane16_swap_b32 v113, v17
    v_max_f32 v113, v113, v17
    v_mov_b32 v17, v114
    s_nop 1
    v_permlane32_swap_b32 v114, v17
    v_max_f32 v114, v114, v17
    v_mov_b32 v17, v114
    s_nop 1
    v_permlane16_swap_b32 v114, v17
    v_max_f32 v114, v114, v17
    v_mov_b32 v17, v115
    s_nop 1
    v_permlane32_swap_b32 v115, v17
    v_max_f32 v115, v115, v17
    v_mov_b32 v17, v115
    s_nop 1
    v_permlane16_swap_b32 v115, v17
    v_max_f32 v115, v115, v17
    v_sub_f32 v96, 0, v112
    v_sub_f32 v97, 0, v112
    v_sub_f32 v98, 0, v112
    v_sub_f32 v99, 0, v112
    v_sub_f32 v100, 0, v113
    v_sub_f32 v101, 0, v113
    v_sub_f32 v102, 0, v113
    v_sub_f32 v103, 0, v113
    v_sub_f32 v104, 0, v114
    v_sub_f32 v105, 0, v114
    v_sub_f32 v106, 0, v114
    v_sub_f32 v107, 0, v114
    v_sub_f32 v108, 0, v115
    v_sub_f32 v109, 0, v115
    v_sub_f32 v110, 0, v115
    v_sub_f32 v111, 0, v115
    v_mov_b32 v112, 0
    v_mov_b32 v113, 0
    v_mov_b32 v114, 0
    v_mov_b32 v115, 0
    v_mov_b32 v116, 0
    v_mov_b32 v117, 0
    v_mov_b32 v118, 0
    v_mov_b32 v119, 0
    v_mov_b32 v120, 0
    v_mov_b32 v121, 0
    v_mov_b32 v122, 0
    v_mov_b32 v123, 0
    v_mov_b32 v124, 0
    v_mov_b32 v125, 0
    v_mov_b32 v126, 0
    v_mov_b32 v127, 0
    v_accvgpr_write_b32 a0, 0
    v_accvgpr_write_b32 a1, 0
    v_accvgpr_write_b32 a2, 0
    v_accvgpr_write_b32 a3, 0
    v_accvgpr_write_b32 a4, 0
    v_accvgpr_write_b32 a5, 0
    v_accvgpr_write_b32 a6, 0
    v_accvgpr_write_b32 a7, 0
    v_accvgpr_write_b32 a8, 0
    v_accvgpr_write_b32 a9, 0
    v_accvgpr_write_b32 a10, 0
    v_accvgpr_write_b32 a11, 0
    v_accvgpr_write_b32 a12, 0
    v_accvgpr_write_b32 a13, 0
    v_accvgpr_write_b32 a14, 0
    v_accvgpr_write_b32 a15, 0
    v_accvgpr_write_b32 a16, 0
    v_accvgpr_write_b32 a17, 0
    v_accvgpr_write_b32 a18, 0
    v_accvgpr_write_b32 a19, 0
    v_accvgpr_write_b32 a20, 0
    v_accvgpr_write_b32 a21, 0
    v_accvgpr_write_b32 a22, 0
    v_accvgpr_write_b32 a23, 0
    v_accvgpr_write_b32 a24, 0
    v_accvgpr_write_b32 a25, 0
    v_accvgpr_write_b32 a26, 0
    v_accvgpr_write_b32 a27, 0
    v_accvgpr_write_b32 a28, 0
    v_accvgpr_write_b32 a29, 0
    v_accvgpr_write_b32 a30, 0
    v_accvgpr_write_b32 a31, 0
    v_accvgpr_write_b32 a32, 0
    v_accvgpr_write_b32 a33, 0
    v_accvgpr_write_b32 a34, 0
    v_accvgpr_write_b32 a35, 0
    v_accvgpr_write_b32 a36, 0
    v_accvgpr_write_b32 a37, 0
    v_accvgpr_write_b32 a38, 0
    v_accvgpr_write_b32 a39, 0
    v_accvgpr_write_b32 a40, 0
    v_accvgpr_write_b32 a41, 0
    v_accvgpr_write_b32 a42, 0
    v_accvgpr_write_b32 a43, 0
    v_accvgpr_write_b32 a44, 0
    v_accvgpr_write_b32 a45, 0
    v_accvgpr_write_b32 a46, 0
    v_accvgpr_write_b32 a47, 0
    v_accvgpr_write_b32 a48, 0
    v_accvgpr_write_b32 a49, 0
    v_accvgpr_write_b32 a50, 0
    v_accvgpr_write_b32 a51, 0
    v_accvgpr_write_b32 a52, 0
    v_accvgpr_write_b32 a53, 0
    v_accvgpr_write_b32 a54, 0
    v_accvgpr_write_b32 a55, 0
    v_accvgpr_write_b32 a56, 0
    v_accvgpr_write_b32 a57, 0
    v_accvgpr_write_b32 a58, 0
    v_accvgpr_write_b32 a59, 0
    v_accvgpr_write_b32 a60, 0
    v_accvgpr_write_b32 a61, 0
    v_accvgpr_write_b32 a62, 0
    v_accvgpr_write_b32 a63, 0
    v_accvgpr_write_b32 a64, 0
    v_accvgpr_write_b32 a65, 0
    v_accvgpr_write_b32 a66, 0
    v_accvgpr_write_b32 a67, 0
    v_accvgpr_write_b32 a68, 0
    v_accvgpr_write_b32 a69, 0
    v_accvgpr_write_b32 a70, 0
    v_accvgpr_write_b32 a71, 0
    v_accvgpr_write_b32 a72, 0
    v_accvgpr_write_b32 a73, 0
    v_accvgpr_write_b32 a74, 0
    v_accvgpr_write_b32 a75, 0
    v_accvgpr_write_b32 a76, 0
    v_accvgpr_write_b32 a77, 0
    v_accvgpr_write_b32 a78, 0
    v_accvgpr_write_b32 a79, 0
    v_accvgpr_write_b32 a80, 0
    v_accvgpr_write_b32 a81, 0
    v_accvgpr_write_b32 a82, 0
    v_accvgpr_write_b32 a83, 0
    v_accvgpr_write_b32 a84, 0
    v_accvgpr_write_b32 a85, 0
    v_accvgpr_write_b32 a86, 0
    v_accvgpr_write_b32 a87, 0
    v_accvgpr_write_b32 a88, 0
    v_accvgpr_write_b32 a89, 0
    v_accvgpr_write_b32 a90, 0
    v_accvgpr_write_b32 a91, 0
    v_accvgpr_write_b32 a92, 0
    v_accvgpr_write_b32 a93, 0
    v_accvgpr_write_b32 a94, 0
    v_accvgpr_write_b32 a95, 0
    v_accvgpr_write_b32 a96, 0
    v_accvgpr_write_b32 a97, 0
    v_accvgpr_write_b32 a98, 0
    v_accvgpr_write_b32 a99, 0
    v_accvgpr_write_b32 a100, 0
    v_accvgpr_write_b32 a101, 0
    v_accvgpr_write_b32 a102, 0
    v_accvgpr_write_b32 a103, 0
    v_accvgpr_write_b32 a104, 0
    v_accvgpr_write_b32 a105, 0
    v_accvgpr_write_b32 a106, 0
    v_accvgpr_write_b32 a107, 0
    v_accvgpr_write_b32 a108, 0
    v_accvgpr_write_b32 a109, 0
    v_accvgpr_write_b32 a110, 0
    v_accvgpr_write_b32 a111, 0
    v_accvgpr_write_b32 a112, 0
    v_accvgpr_write_b32 a113, 0
    v_accvgpr_write_b32 a114, 0
    v_accvgpr_write_b32 a115, 0
    v_accvgpr_write_b32 a116, 0
    v_accvgpr_write_b32 a117, 0
    v_accvgpr_write_b32 a118, 0
    v_accvgpr_write_b32 a119, 0
    v_accvgpr_write_b32 a120, 0
    v_accvgpr_write_b32 a121, 0
    v_accvgpr_write_b32 a122, 0
    v_accvgpr_write_b32 a123, 0
    v_accvgpr_write_b32 a124, 0
    v_accvgpr_write_b32 a125, 0
    v_accvgpr_write_b32 a126, 0
    v_accvgpr_write_b32 a127, 0
    s_mov_b32 s32, 0
    s_mov_b32 s33, 0
    s_add_u32 s34, s39, 0x18000
    s_add_u32 s35, s39, 0x8000
    s_mov_b32 s31, -1
    s_mov_b32 s43, 0
    s_add_u32 s85, s30, 2
    s_mov_b32 s79, 0x4000000
    s_sub_u32 s87, s30, 2
    s_mov_b32 s60, 0x1000000
    s_movk_i32 s41, 8192
    v_add_u32 v5, 0x18000, v2
    v_add_u32 v6, 0x8000, v2
    s_add_u32 m0, s34, 0
    s_nop 0
    buffer_load_dwordx4 v4, s[16:19], s32 offen offset:0 sc1 lds
    buffer_load_dwordx4 v4, s[16:19], s32 offen offset:1024 sc1 lds
    s_add_u32 s32, s32, 8192
    s_add_u32 m0, s34, 16384
    s_nop 0
    buffer_load_dwordx4 v4, s[16:19], s32 offen offset:0 sc1 lds
    buffer_load_dwordx4 v4, s[16:19], s32 offen offset:1024 sc1 lds
    s_add_u32 s32, s32, 8192
    s_xor_b32 s34, s34, 0x38000
    s_add_u32 m0, s34, 0
    s_nop 0
    buffer_load_dwordx4 v4, s[16:19], s32 offen offset:0 sc1 lds
    buffer_load_dwordx4 v4, s[16:19], s32 offen offset:1024 sc1 lds
    s_add_u32 s32, s32, 8192
    v_mov_b32 v31, 0x800
    s_waitcnt vmcnt(0)
    s_barrier
    ds_read_b128 a[192:195], v5 offset:0
    ds_read_b128 a[196:199], v5 offset:1024
    ds_read_b128 a[200:203], v5 offset:2048
    ds_read_b128 a[204:207], v5 offset:3072
    ds_read_b128 a[208:211], v5 offset:4096
    ds_read_b128 a[212:215], v5 offset:5120
    ds_read_b128 a[216:219], v5 offset:6144
    ds_read_b128 a[220:223], v5 offset:7168
    s_waitcnt lgkmcnt(0)
    s_branch K2_QKd0
K2_tail:
    s_and_b32 s28, s58, 7
    s_sub_u32 s28, s28, 0
    s_lshl_b32 s28, s28, 4
    v_add_u32 v13, s28, v7
    v_cmp_gt_i32 s[44:45], 0, v13
    v_cmp_gt_i32 s[46:47], 1, v13
    v_cmp_gt_i32 s[48:49], 2, v13
    v_cmp_gt_i32 s[50:51], 3, v13
    v_cndmask_b32 v32, v32, v12, s[44:45]
    v_cndmask_b32 v33, v33, v12, s[46:47]
    v_cndmask_b32 v34, v34, v12, s[48:49]
    v_cndmask_b32 v35, v35, v12, s[50:51]
    v_cmp_gt_i32 s[44:45], 16, v13
    v_cmp_gt_i32 s[46:47], 17, v13
    v_cmp_gt_i32 s[48:49], 18, v13
    v_cmp_gt_i32 s[50:51], 19, v13
    v_cndmask_b32 v36, v36, v12, s[44:45]
    v_cndmask_b32 v37, v37, v12, s[46:47]
    v_cndmask_b32 v38, v38, v12, s[48:49]
    v_cndmask_b32 v39, v39, v12, s[50:51]
    v_cmp_gt_i32 s[44:45], 32, v13
    v_cmp_gt_i32 s[46:47], 33, v13
    v_cmp_gt_i32 s[48:49], 34, v13
    v_cmp_gt_i32 s[50:51], 35, v13
    v_cndmask_b32 v48, v48, v12, s[44:45]
    v_cndmask_b32 v49, v49, v12, s[46:47]
    v_cndmask_b32 v50, v50, v12, s[48:49]
    v_cndmask_b32 v51, v51, v12, s[50:51]
    v_cmp_gt_i32 s[44:45], 48, v13
    v_cmp_gt_i32 s[46:47], 49, v13
    v_cmp_gt_i32 s[48:49], 50, v13
    v_cmp_gt_i32 s[50:51], 51, v13
    v_cndmask_b32 v52, v52, v12, s[44:45]
    v_cndmask_b32 v53, v53, v12, s[46:47]
    v_cndmask_b32 v54, v54, v12, s[48:49]
    v_cndmask_b32 v55, v55, v12, s[50:51]
    v_lshrrev_b32 v14, 3, v1
    v_add_u32 v14, s3, v14
    v_lshlrev_b32 v14, 26, v14
    v_lshl_or_b32 v14, v1, 7, v14
    s_movk_i32 s52, 16384
    s_cmp_eq_u32 s30, 32
    s_cbranch_scc1 K2_PVd1
    v_mfma_f32_16x16x32_bf16 a[8:11], v[128:131], v[64:67], a[8:11]
    v_exp_f32 v32, v32
    v_mfma_f32_16x16x32_bf16 a[12:15], v[128:131], v[72:75], a[12:15]
    ds_read_b128 v[160:163], v6 offset:24576
    ds_read_b128 v[164:167], v6 offset:25600
    v_mfma_f32_16x16x32_bf16 a[28:31], v[132:135], v[72:75], a[28:31]
    s_waitcnt lgkmcnt(2)
    v_exp_f32 v33, v33
    v_mfma_f32_16x16x32_bf16 a[24:27], v[132:135], v[64:67], a[24:27]
    ds_read_b128 v[168:171], v6 offset:26624
    ds_read_b128 v[172:175], v6 offset:27648
    v_mfma_f32_16x16x32_bf16 a[40:43], v[136:139], v[64:67], a[40:43]
    v_exp_f32 v34, v34
    v_mfma_f32_16x16x32_bf16 a[44:47], v[136:139], v[72:75], a[44:47]
    buffer_load_dword v31, v14, s[72:75], s52 offen offset:4 sc1
    v_mfma_f32_16x16x32_bf16 a[60:63], v[140:143], v[72:75], a[60:63]
    ds_read_b128 v[176:179], v6 offset:28672
    ds_read_b128 v[180:183], v6 offset:29696
    v_mfma_f32_16x16x32_bf16 a[56:59], v[140:143], v[64:67], a[56:59]
    v_exp_f32 v35, v35
    v_mfma_f32_16x16x32_bf16 v[120:123], v[24:27], v[64:67], v[120:123]
    ds_read_b128 v[184:187], v6 offset:30720
    ds_read_b128 v[188:191], v6 offset:31744
    v_mfma_f32_16x16x32_bf16 a[72:75], v[144:147], v[64:67], a[72:75]
    v_exp_f32 v40, v40
    v_mfma_f32_16x16x32_bf16 a[76:79], v[144:147], v[72:75], a[76:79]
    v_mfma_f32_16x16x32_bf16 a[92:95], v[148:151], v[72:75], a[92:95]
    v_cvt_pk_bf16_f32 v32, v32, v33
    v_xor_b32 v6, 0x18000, v6
    v_mfma_f32_16x16x32_bf16 a[88:91], v[148:151], v[64:67], a[88:91]
    s_waitcnt lgkmcnt(0)
    v_exp_f32 v41, v41
    v_mfma_f32_16x16x32_bf16 a[104:107], v[152:155], v[64:67], a[104:107]
    ds_read_b128 a[192:195], v5 offset:16384
    ds_read_b128 a[196:199], v5 offset:17408
    v_mfma_f32_16x16x32_bf16 a[108:111], v[152:155], v[72:75], a[108:111]
    v_exp_f32 v42, v42
    v_mfma_f32_16x16x32_bf16 a[124:127], v[156:159], v[72:75], a[124:127]
    ds_read_b128 a[200:203], v5 offset:18432
    v_cvt_pk_bf16_f32 v33, v34, v35
    v_mfma_f32_16x16x32_bf16 a[120:123], v[156:159], v[64:67], a[120:123]
    v_exp_f32 v43, v43
    v_mfma_f32_16x16x32_bf16 v[124:127], v[24:27], v[72:75], v[124:127]
    ds_read_b128 a[204:207], v5 offset:19456
    ds_read_b128 a[208:211], v5 offset:20480
    v_mfma_f32_16x16x32_bf16 a[8:11], v[160:163], v[80:83], a[8:11]
    ds_read_b128 a[212:215], v5 offset:21504
    v_cvt_pk_bf16_f32 v40, v40, v41
    v_mfma_f32_16x16x32_bf16 a[12:15], v[160:163], v[88:91], a[12:15]
    v_exp_f32 v48, v48
    v_mfma_f32_16x16x32_bf16 a[28:31], v[164:167], v[88:91], a[28:31]
    ds_read_b128 a[216:219], v5 offset:22528
    v_cvt_pk_bf16_f32 v41, v42, v43
    v_mfma_f32_16x16x32_bf16 a[24:27], v[164:167], v[80:83], a[24:27]
    s_waitcnt lgkmcnt(3)
    v_exp_f32 v49, v49
    v_mfma_f32_16x16x32_bf16 a[40:43], v[168:171], v[80:83], a[40:43]
    ds_read_b128 a[220:223], v5 offset:23552
    ds_read_b128 a[224:227], v5 offset:24576
    v_mfma_f32_16x16x32_bf16 a[44:47], v[168:171], v[88:91], a[44:47]
    ds_read_b128 a[228:231], v5 offset:25600
    v_cvt_pk_bf16_f32 v48, v48, v49
    v_mfma_f32_16x16x32_bf16 a[60:63], v[172:175], v[88:91], a[60:63]
    v_exp_f32 v50, v50
    v_mfma_f32_16x16x32_bf16 a[56:59], v[172:175], v[80:83], a[56:59]
    ds_read_b128 a[232:235], v5 offset:26624
    ds_read_b128 a[236:239], v5 offset:27648
    v_mfma_f32_16x16x32_bf16 v[120:123], v[24:27], v[80:83], v[120:123]
    v_exp_f32 v51, v51
    v_mfma_f32_16x16x32_bf16 a[72:75], v[176:179], v[80:83], a[72:75]
    ds_read_b128 a[240:243], v5 offset:28672
    ds_read_b128 a[244:247], v5 offset:29696
    v_mfma_f32_16x16x32_bf16 a[76:79], v[176:179], v[88:91], a[76:79]
    s_waitcnt lgkmcnt(4)
    v_exp_f32 v56, v56
    v_mfma_f32_16x16x32_bf16 a[92:95], v[180:183], v[88:91], a[92:95]
    ds_read_b128 a[248:251], v5 offset:30720
    v_cvt_pk_bf16_f32 v49, v50, v51
    v_mfma_f32_16x16x32_bf16 a[88:91], v[180:183], v[80:83], a[88:91]
    v_exp_f32 v57, v57
    v_mfma_f32_16x16x32_bf16 a[104:107], v[184:187], v[80:83], a[104:107]
    ds_read_b128 a[252:255], v5 offset:31744
    v_cvt_pk_bf16_f32 v56, v56, v57
    v_mfma_f32_16x16x32_bf16 a[108:111], v[184:187], v[88:91], a[108:111]
    v_exp_f32 v58, v58
    v_mfma_f32_16x16x32_bf16 a[124:127], v[188:191], v[88:91], a[124:127]
    v_exp_f32 v59, v59
    v_mfma_f32_16x16x32_bf16 a[120:123], v[188:191], v[80:83], a[120:123]
    v_cvt_pk_bf16_f32 v57, v58, v59
    v_mfma_f32_16x16x32_bf16 v[124:127], v[24:27], v[88:91], v[124:127]
K2_fin:
    v_mfma_f32_16x16x32_bf16 v[72:75], a[204:207], a[188:191], v[108:111]
    v_exp_f32 v36, v36
    v_mfma_f32_16x16x32_bf16 v[72:75], a[200:203], a[184:187], v[72:75]
    v_exp_f32 v37, v37
    v_mfma_f32_16x16x32_bf16 v[72:75], a[196:199], a[180:183], v[72:75]
    v_exp_f32 v38, v38
    v_mfma_f32_16x16x32_bf16 v[72:75], a[192:195], a[176:179], v[72:75]
    s_waitcnt vmcnt(0) lgkmcnt(0)
    v_exp_f32 v39, v39
    v_mfma_f32_16x16x32_bf16 v[76:79], a[208:211], a[176:179], v[108:111]
    v_cmp_gt_u32 vcc, 32, v31
    s_nop 0
    s_and_b32 s28, vcc_lo, 0xff
    s_cmp_gt_u32 s28, s40
    s_cbranch_scc1 KA_side
KA_sider:
    v_mfma_f32_16x16x32_bf16 v[76:79], a[212:215], a[180:183], v[76:79]
    s_barrier
    v_mfma_f32_16x16x32_bf16 v[76:79], a[216:219], a[184:187], v[76:79]
    ds_read_b128 v[128:131], v6 offset:0
    ds_read_b128 v[132:135], v6 offset:1024
    v_mfma_f32_16x16x32_bf16 v[76:79], a[220:223], a[188:191], v[76:79]
    ds_read_b128 v[136:139], v6 offset:2048
    ds_read_b128 v[140:143], v6 offset:3072
    v_mfma_f32_16x16x32_bf16 v[88:91], a[236:239], a[188:191], v[108:111]
    ds_read_b128 v[144:147], v6 offset:4096
    ds_read_b128 v[148:151], v6 offset:5120
    v_mfma_f32_16x16x32_bf16 v[88:91], a[232:235], a[184:187], v[88:91]
    ds_read_b128 v[152:155], v6 offset:6144
    ds_read_b128 v[156:159], v6 offset:7168
    v_mfma_f32_16x16x32_bf16 v[88:91], a[228:231], a[180:183], v[88:91]
    v_cvt_pk_bf16_f32 v34, v36, v37
    v_cvt_pk_bf16_f32 v35, v38, v39
    v_mfma_f32_16x16x32_bf16 v[88:91], a[224:227], a[176:179], v[88:91]
    v_exp_f32 v44, v44
    v_mfma_f32_16x16x32_bf16 v[92:95], a[240:243], a[176:179], v[108:111]
    v_exp_f32 v45, v45
    v_mfma_f32_16x16x32_bf16 v[92:95], a[244:247], a[180:183], v[92:95]
    v_exp_f32 v46, v46
    v_mfma_f32_16x16x32_bf16 v[92:95], a[248:251], a[184:187], v[92:95]
    v_exp_f32 v47, v47
    v_mfma_f32_16x16x32_bf16 v[92:95], a[252:255], a[188:191], v[92:95]
    v_cvt_pk_bf16_f32 v42, v44, v45
    v_cvt_pk_bf16_f32 v43, v46, v47
    s_waitcnt lgkmcnt(0)
    s_nop 0
    v_mfma_f32_16x16x32_bf16 a[8:11], v[128:131], v[32:35], a[8:11]
    ds_read_b128 v[160:163], v6 offset:8192
    ds_read_b128 v[164:167], v6 offset:9216
    v_mfma_f32_16x16x32_bf16 a[12:15], v[128:131], v[40:43], a[12:15]
    ds_read_b128 v[168:171], v6 offset:10240
    ds_read_b128 v[172:175], v6 offset:11264
    v_mfma_f32_16x16x32_bf16 a[28:31], v[132:135], v[40:43], a[28:31]
    ds_read_b128 v[176:179], v6 offset:12288
    ds_read_b128 v[180:183], v6 offset:13312
    v_mfma_f32_16x16x32_bf16 a[24:27], v[132:135], v[32:35], a[24:27]
    ds_read_b128 v[184:187], v6 offset:14336
    ds_read_b128 v[188:191], v6 offset:15360
    v_mfma_f32_16x16x32_bf16 a[40:43], v[136:139], v[32:35], a[40:43]
    v_exp_f32 v52, v52
    v_mfma_f32_16x16x32_bf16 a[44:47], v[136:139], v[40:43], a[44:47]
    v_exp_f32 v53, v53
    v_mfma_f32_16x16x32_bf16 a[60:63], v[140:143], v[40:43], a[60:63]
    v_exp_f32 v54, v54
    v_mfma_f32_16x16x32_bf16 a[56:59], v[140:143], v[32:35], a[56:59]
    v_exp_f32 v55, v55
    v_mfma_f32_16x16x32_bf16 v[120:123], v[24:27], v[32:35], v[120:123]
    v_cvt_pk_bf16_f32 v50, v52, v53
    v_cvt_pk_bf16_f32 v51, v54, v55
    v_mfma_f32_16x16x32_bf16 a[72:75], v[144:147], v[32:35], a[72:75]
    v_exp_f32 v60, v60
    v_mfma_f32_16x16x32_bf16 a[76:79], v[144:147], v[40:43], a[76:79]
    v_exp_f32 v61, v61
    v_mfma_f32_16x16x32_bf16 a[92:95], v[148:151], v[40:43], a[92:95]
    v_exp_f32 v62, v62
    v_mfma_f32_16x16x32_bf16 a[88:91], v[148:151], v[32:35], a[88:91]
    v_exp_f32 v63, v63
    v_mfma_f32_16x16x32_bf16 a[104:107], v[152:155], v[32:35], a[104:107]
    v_cvt_pk_bf16_f32 v58, v60, v61
    v_cvt_pk_bf16_f32 v59, v62, v63
    v_mfma_f32_16x16x32_bf16 a[108:111], v[152:155], v[40:43], a[108:111]
    s_and_b32 s28, s59, 7
    s_sub_u32 s28, s28, 4
    s_lshl_b32 s28, s28, 4
    v_mfma_f32_16x16x32_bf16 a[124:127], v[156:159], v[40:43], a[124:127]
    v_add_u32 v13, s28, v7
    v_cmp_gt_i32 s[44:45], 0, v13
    v_mfma_f32_16x16x32_bf16 a[120:123], v[156:159], v[32:35], a[120:123]
    v_cmp_gt_i32 s[46:47], 1, v13
    v_cmp_gt_i32 s[48:49], 2, v13
    v_mfma_f32_16x16x32_bf16 v[124:127], v[24:27], v[40:43], v[124:127]
    v_cmp_gt_i32 s[50:51], 3, v13
    s_waitcnt lgkmcnt(0)
    v_mfma_f32_16x16x32_bf16 a[8:11], v[160:163], v[48:51], a[8:11]
    ds_read_b128 a[192:195], v6 offset:16384
    ds_read_b128 a[196:199], v6 offset:17408
    v_mfma_f32_16x16x32_bf16 a[12:15], v[160:163], v[56:59], a[12:15]
    ds_read_b128 a[200:203], v6 offset:18432
    ds_read_b128 a[204:207], v6 offset:19456
    v_mfma_f32_16x16x32_bf16 a[28:31], v[164:167], v[56:59], a[28:31]
    ds_read_b128 a[208:211], v6 offset:20480
    ds_read_b128 a[212:215], v6 offset:21504
    v_mfma_f32_16x16x32_bf16 a[24:27], v[164:167], v[48:51], a[24:27]
    ds_read_b128 a[216:219], v6 offset:22528
    ds_read_b128 a[220:223], v6 offset:23552
    v_mfma_f32_16x16x32_bf16 a[40:43], v[168:171], v[48:51], a[40:43]
    v_cndmask_b32 v72, v72, v12, s[44:45]
    v_cndmask_b32 v73, v73, v12, s[46:47]
    v_mfma_f32_16x16x32_bf16 a[44:47], v[168:171], v[56:59], a[44:47]
    v_cndmask_b32 v74, v74, v12, s[48:49]
    v_cndmask_b32 v75, v75, v12, s[50:51]
    v_mfma_f32_16x16x32_bf16 a[60:63], v[172:175], v[56:59], a[60:63]
    v_cmp_gt_i32 s[44:45], 16, v13
    v_cmp_gt_i32 s[46:47], 17, v13
    v_mfma_f32_16x16x32_bf16 a[56:59], v[172:175], v[48:51], a[56:59]
    v_cmp_gt_i32 s[48:49], 18, v13
    v_cmp_gt_i32 s[50:51], 19, v13
    v_mfma_f32_16x16x32_bf16 v[120:123], v[24:27], v[48:51], v[120:123]
    v_cndmask_b32 v76, v76, v12, s[44:45]
    v_cndmask_b32 v77, v77, v12, s[46:47]
    v_mfma_f32_16x16x32_bf16 a[72:75], v[176:179], v[48:51], a[72:75]
    v_cndmask_b32 v78, v78, v12, s[48:49]
    v_cndmask_b32 v79, v79, v12, s[50:51]
    v_mfma_f32_16x16x32_bf16 a[76:79], v[176:179], v[56:59], a[76:79]
    v_exp_f32 v72, v72
    v_mfma_f32_16x16x32_bf16 a[92:95], v[180:183], v[56:59], a[92:95]
    v_exp_f32 v73, v73
    v_mfma_f32_16x16x32_bf16 a[88:91], v[180:183], v[48:51], a[88:91]
    v_exp_f32 v74, v74
    v_mfma_f32_16x16x32_bf16 a[104:107], v[184:187], v[48:51], a[104:107]
    v_exp_f32 v75, v75
    v_mfma_f32_16x16x32_bf16 a[108:111], v[184:187], v[56:59], a[108:111]
    v_cvt_pk_bf16_f32 v72, v72, v73
    v_cvt_pk_bf16_f32 v73, v74, v75
    v_mfma_f32_16x16x32_bf16 a[124:127], v[188:191], v[56:59], a[124:127]
    v_exp_f32 v76, v76
    v_mfma_f32_16x16x32_bf16 a[120:123], v[188:191], v[48:51], a[120:123]
    v_exp_f32 v77, v77
    v_mfma_f32_16x16x32_bf16 v[124:127], v[24:27], v[56:59], v[124:127]
    v_exp_f32 v78, v78
    v_exp_f32 v79, v79
    v_cvt_pk_bf16_f32 v74, v76, v77
    v_cvt_pk_bf16_f32 v75, v78, v79
    s_waitcnt lgkmcnt(0)
    s_nop 0
    v_mfma_f32_16x16x32_bf16 v[124:127], v[24:27], v[72:75], v[124:127]
    ds_read_b128 a[224:227], v6 offset:24576
    ds_read_b128 a[228:231], v6 offset:25600
    v_mfma_f32_16x16x32_bf16 a[12:15], a[192:195], v[72:75], a[12:15]
    ds_read_b128 a[232:235], v6 offset:26624
    ds_read_b128 a[236:239], v6 offset:27648
    v_mfma_f32_16x16x32_bf16 a[28:31], a[196:199], v[72:75], a[28:31]
    ds_read_b128 a[240:243], v6 offset:28672
    ds_read_b128 a[244:247], v6 offset:29696
    v_mfma_f32_16x16x32_bf16 a[44:47], a[200:203], v[72:75], a[44:47]
    ds_read_b128 a[248:251], v6 offset:30720
    ds_read_b128 a[252:255], v6 offset:31744
    v_mfma_f32_16x16x32_bf16 a[60:63], a[204:207], v[72:75], a[60:63]
    v_cmp_gt_i32 s[44:45], 32, v13
    v_cmp_gt_i32 s[46:47], 33, v13
    v_mfma_f32_16x16x32_bf16 a[76:79], a[208:211], v[72:75], a[76:79]
    v_cmp_gt_i32 s[48:49], 34, v13
    v_cmp_gt_i32 s[50:51], 35, v13
    v_mfma_f32_16x16x32_bf16 a[92:95], a[212:215], v[72:75], a[92:95]
    v_cndmask_b32 v88, v88, v12, s[44:45]
    v_cndmask_b32 v89, v89, v12, s[46:47]
    v_mfma_f32_16x16x32_bf16 a[108:111], a[216:219], v[72:75], a[108:111]
    v_cndmask_b32 v90, v90, v12, s[48:49]
    v_cndmask_b32 v91, v91, v12, s[50:51]
    v_mfma_f32_16x16x32_bf16 a[124:127], a[220:223], v[72:75], a[124:127]
    v_cmp_gt_i32 s[44:45], 48, v13
    v_cmp_gt_i32 s[46:47], 49, v13
    v_cmp_gt_i32 s[48:49], 50, v13
    v_cmp_gt_i32 s[50:51], 51, v13
    v_cndmask_b32 v92, v92, v12, s[44:45]
    v_cndmask_b32 v93, v93, v12, s[46:47]
    v_cndmask_b32 v94, v94, v12, s[48:49]
    v_cndmask_b32 v95, v95, v12, s[50:51]
    v_exp_f32 v88, v88
    v_exp_f32 v89, v89
    v_exp_f32 v90, v90
    v_exp_f32 v91, v91
    v_cvt_pk_bf16_f32 v88, v88, v89
    v_cvt_pk_bf16_f32 v89, v90, v91
    v_exp_f32 v92, v92
    v_exp_f32 v93, v93
    v_exp_f32 v94, v94
    v_exp_f32 v95, v95
    v_cvt_pk_bf16_f32 v90, v92, v93
    v_cvt_pk_bf16_f32 v91, v94, v95
    s_waitcnt lgkmcnt(0)
    s_nop 0
    v_mfma_f32_16x16x32_bf16 v[124:127], v[24:27], v[88:91], v[124:127]
    v_rcp_f32 v216, v120
    v_mfma_f32_16x16x32_bf16 a[12:15], a[224:227], v[88:91], a[12:15]
    s_lshl_b32 s28, s58, 17
    v_accvgpr_read_b32 v192, a8
    v_accvgpr_read_b32 v193, a9
    v_mfma_f32_16x16x32_bf16 a[28:31], a[228:231], v[88:91], a[28:31]
    v_accvgpr_read_b32 v194, a10
    v_accvgpr_read_b32 v195, a11
    v_mfma_f32_16x16x32_bf16 a[44:47], a[232:235], v[88:91], a[44:47]
    v_accvgpr_read_b32 v196, a24
    v_accvgpr_read_b32 v197, a25
    v_mfma_f32_16x16x32_bf16 a[60:63], a[236:239], v[88:91], a[60:63]
    v_accvgpr_read_b32 v198, a26
    v_accvgpr_read_b32 v199, a27
    v_mfma_f32_16x16x32_bf16 a[76:79], a[240:243], v[88:91], a[76:79]
    v_mul_f32 v192, v192, v216
    v_mul_f32 v193, v193, v216
    v_mfma_f32_16x16x32_bf16 a[92:95], a[244:247], v[88:91], a[92:95]
    v_mul_f32 v194, v194, v216
    v_mul_f32 v195, v195, v216
    v_mfma_f32_16x16x32_bf16 a[108:111], a[248:251], v[88:91], a[108:111]
    v_mul_f32 v196, v196, v216
    v_mul_f32 v197, v197, v216
    v_mfma_f32_16x16x32_bf16 a[124:127], a[252:255], v[88:91], a[124:127]
    v_mul_f32 v198, v198, v216
    v_mul_f32 v199, v199, v216
    s_mov_b32 s53, s54
    s_add_u32 m0, s55, 0
    s_nop 0
    buffer_load_dwordx4 v250, s[68:71], s53 offen sc1 lds
    v_cvt_pk_bf16_f32 v200, v192, v193
    v_cvt_pk_bf16_f32 v201, v194, v195
    v_cvt_pk_bf16_f32 v202, v196, v197
    v_cvt_pk_bf16_f32 v203, v198, v199
    buffer_store_dwordx4 v[200:203], v2, s[64:67], s28 offen offset:0 sc1
    v_accvgpr_read_b32 v204, a40
    v_accvgpr_read_b32 v205, a41
    v_accvgpr_read_b32 v206, a42
    v_accvgpr_read_b32 v207, a43
    v_accvgpr_read_b32 v208, a56
    v_accvgpr_read_b32 v209, a57
    v_accvgpr_read_b32 v210, a58
    v_accvgpr_read_b32 v211, a59
    v_mul_f32 v204, v204, v216
    s_add_u32 m0, s55, 1024
    s_nop 0
    buffer_load_dwordx4 v251, s[68:71], s53 offen sc1 lds
    v_mul_f32 v205, v205, v216
    v_mul_f32 v206, v206, v216
    v_mul_f32 v207, v207, v216
    v_mul_f32 v208, v208, v216
    v_mul_f32 v209, v209, v216
    v_mul_f32 v210, v210, v216
    v_mul_f32 v211, v211, v216
    v_cvt_pk_bf16_f32 v212, v204, v205
    v_cvt_pk_bf16_f32 v213, v206, v207
    v_cvt_pk_bf16_f32 v214, v208, v209
    v_cvt_pk_bf16_f32 v215, v210, v211
    buffer_store_dwordx4 v[212:215], v2, s[64:67], s28 offen offset:1024 sc1
    v_accvgpr_read_b32 v192, a72
    v_accvgpr_read_b32 v193, a73
    s_add_u32 m0, s55, 2048
    s_nop 0
    buffer_load_dwordx4 v252, s[68:71], s53 offen sc1 lds
    v_accvgpr_read_b32 v194, a74
    v_accvgpr_read_b32 v195, a75
    v_accvgpr_read_b32 v196, a88
    v_accvgpr_read_b32 v197, a89
    v_accvgpr_read_b32 v198, a90
    v_accvgpr_read_b32 v199, a91
    v_mul_f32 v192, v192, v216
    v_mul_f32 v193, v193, v216
    v_mul_f32 v194, v194, v216
    v_mul_f32 v195, v195, v216
    v_mul_f32 v196, v196, v216
    v_mul_f32 v197, v197, v216
    s_add_u32 m0, s55, 3072
    s_nop 0
    buffer_load_dwordx4 v253, s[68:71], s53 offen sc1 lds
    v_mul_f32 v198, v198, v216
    v_mul_f32 v199, v199, v216
    v_cvt_pk_bf16_f32 v200, v192, v193
    v_cvt_pk_bf16_f32 v201, v194, v195
    v_cvt_pk_bf16_f32 v202, v196, v197
    v_cvt_pk_bf16_f32 v203, v198, v199
    buffer_store_dwordx4 v[200:203], v2, s[64:67], s28 offen offset:2048 sc1
    v_accvgpr_read_b32 v204, a104
    v_accvgpr_read_b32 v205, a105
    v_accvgpr_read_b32 v206, a106
    v_accvgpr_read_b32 v207, a107
    v_accvgpr_read_b32 v208, a120
    v_accvgpr_read_b32 v209, a121
    v_accvgpr_read_b32 v210, a122
    s_add_u32 m0, s55, 4096
    s_nop 0
    buffer_load_dwordx4 v254, s[68:71], s53 offen sc1 lds
    s_add_u32 s53, s53, 2048
    v_accvgpr_read_b32 v211, a123
    v_mul_f32 v204, v204, v216
    v_mul_f32 v205, v205, v216
    v_mul_f32 v206, v206, v216
    v_mul_f32 v207, v207, v216
    v_mul_f32 v208, v208, v216
    v_mul_f32 v209, v209, v216
    v_mul_f32 v210, v210, v216
    v_mul_f32 v211, v211, v216
    v_cvt_pk_bf16_f32 v212, v204, v205
    v_cvt_pk_bf16_f32 v213, v206, v207
    v_cvt_pk_bf16_f32 v214, v208, v209
    v_cvt_pk_bf16_f32 v215, v210, v211
    buffer_store_dwordx4 v[212:215], v2, s[64:67], s28 offen offset:3072 sc1
    v_add_f32 v14, v112, v116
    v_add_f32 v14, v14, v120
    v_add_f32 v14, v14, v124
    v_mov_b32 v15, 0x5f800000
    v_cmp_nle_f32 vcc, v14, v15
    v_and_b32 v14, 1, v1
    v_mul_u32_u24 v14, 5120, v14
    v_add_u32 v14, 10240, v14
    v_and_b32 v15, 2, v1
    v_mul_u32_u24 v15, 40960, v15
    v_add_u32 v14, v14, v15
    s_nop 0
    v_readlane_b32 s35, v14, s3
    s_cmp_lg_u64 vcc, 0
    s_cselect_b32 s29, 1, 0
    v_mov_b32 v13, s29
    s_lshl_b32 s29, s3, 2
    v_add_u32 v14, s29, v14
    ds_write_b32 v14, v13 offset:61440
    v_mov_b32 v14, s35
    v_rcp_f32 v248, v124
    s_lshl_b32 s28, s59, 17
    v_accvgpr_read_b32 v224, a12
    v_accvgpr_read_b32 v225, a13
    v_accvgpr_read_b32 v226, a14
    v_accvgpr_read_b32 v227, a15
    v_accvgpr_read_b32 v228, a28
    v_accvgpr_read_b32 v229, a29
    v_accvgpr_read_b32 v230, a30
    v_accvgpr_read_b32 v231, a31
    v_mul_f32 v224, v224, v248
    v_mul_f32 v225, v225, v248
    v_mul_f32 v226, v226, v248
    v_mul_f32 v227, v227, v248
    v_mul_f32 v228, v228, v248
    v_mul_f32 v229, v229, v248
    v_mul_f32 v230, v230, v248
    v_mul_f32 v231, v231, v248
    v_cvt_pk_bf16_f32 v232, v224, v225
    v_cvt_pk_bf16_f32 v233, v226, v227
    v_cvt_pk_bf16_f32 v234, v228, v229
    v_cvt_pk_bf16_f32 v235, v230, v231
    buffer_store_dwordx4 v[232:235], v2, s[64:67], s28 offen offset:0 sc1
    v_accvgpr_read_b32 v236, a44
    v_accvgpr_read_b32 v237, a45
    v_accvgpr_read_b32 v238, a46
    v_accvgpr_read_b32 v239, a47
    v_accvgpr_read_b32 v240, a60
    v_accvgpr_read_b32 v241, a61
    v_accvgpr_read_b32 v242, a62
    v_accvgpr_read_b32 v243, a63
    v_mul_f32 v236, v236, v248
    v_mul_f32 v237, v237, v248
    v_mul_f32 v238, v238, v248
    v_mul_f32 v239, v239, v248
    v_mul_f32 v240, v240, v248
    v_mul_f32 v241, v241, v248
    v_mul_f32 v242, v242, v248
    v_mul_f32 v243, v243, v248
    v_cvt_pk_bf16_f32 v244, v236, v237
    v_cvt_pk_bf16_f32 v245, v238, v239
    v_cvt_pk_bf16_f32 v246, v240, v241
    v_cvt_pk_bf16_f32 v247, v242, v243
    buffer_store_dwordx4 v[244:247], v2, s[64:67], s28 offen offset:1024 sc1
    v_accvgpr_read_b32 v224, a76
    v_accvgpr_read_b32 v225, a77
    v_accvgpr_read_b32 v226, a78
    v_accvgpr_read_b32 v227, a79
    v_accvgpr_read_b32 v228, a92
    v_accvgpr_read_b32 v229, a93
    v_accvgpr_read_b32 v230, a94
    v_accvgpr_read_b32 v231, a95
    v_mul_f32 v224, v224, v248
    v_mul_f32 v225, v225, v248
    v_mul_f32 v226, v226, v248
    v_mul_f32 v227, v227, v248
    v_mul_f32 v228, v228, v248
    v_mul_f32 v229, v229, v248
    v_mul_f32 v230, v230, v248
    v_mul_f32 v231, v231, v248
    v_cvt_pk_bf16_f32 v232, v224, v225
    v_cvt_pk_bf16_f32 v233, v226, v227
    v_cvt_pk_bf16_f32 v234, v228, v229
    v_cvt_pk_bf16_f32 v235, v230, v231
    buffer_store_dwordx4 v[232:235], v2, s[64:67], s28 offen offset:2048 sc1
    v_accvgpr_read_b32 v236, a108
    v_accvgpr_read_b32 v237, a109
    v_accvgpr_read_b32 v238, a110
    v_accvgpr_read_b32 v239, a111
    v_accvgpr_read_b32 v240, a124
    v_accvgpr_read_b32 v241, a125
    v_accvgpr_read_b32 v242, a126
    v_accvgpr_read_b32 v243, a127
    v_mul_f32 v236, v236, v248
    v_mul_f32 v237, v237, v248
    v_mul_f32 v238, v238, v248
    v_mul_f32 v239, v239, v248
    v_mul_f32 v240, v240, v248
    v_mul_f32 v241, v241, v248
    v_mul_f32 v242, v242, v248
    v_mul_f32 v243, v243, v248
    v_cvt_pk_bf16_f32 v244, v236, v237
    v_cvt_pk_bf16_f32 v245, v238, v239
    v_cvt_pk_bf16_f32 v246, v240, v241
    v_cvt_pk_bf16_f32 v247, v242, v243
    buffer_store_dwordx4 v[244:247], v2, s[64:67], s28 offen offset:3072 sc1
    s_cmp_eq_u32 s85, 99
    s_cbranch_scc1 K2_finB
    v_rcp_f32 v56, v112
    s_lshl_b32 s28, s56, 17
    v_accvgpr_read_b32 v32, a0
    v_accvgpr_read_b32 v33, a1
    v_accvgpr_read_b32 v34, a2
    v_accvgpr_read_b32 v35, a3
    v_accvgpr_read_b32 v36, a16
    v_accvgpr_read_b32 v37, a17
    v_accvgpr_read_b32 v38, a18
    v_accvgpr_read_b32 v39, a19
    v_mul_f32 v32, v32, v56
    v_mul_f32 v33, v33, v56
    v_mul_f32 v34, v34, v56
    v_mul_f32 v35, v35, v56
    v_mul_f32 v36, v36, v56
    v_mul_f32 v37, v37, v56
    v_mul_f32 v38, v38, v56
    v_mul_f32 v39, v39, v56
    v_cvt_pk_bf16_f32 v40, v32, v33
    v_cvt_pk_bf16_f32 v41, v34, v35
    v_cvt_pk_bf16_f32 v42, v36, v37
    v_cvt_pk_bf16_f32 v43, v38, v39
    buffer_store_dwordx4 v[40:43], v2, s[64:67], s28 offen offset:0 sc1
    v_accvgpr_read_b32 v44, a32
    v_accvgpr_read_b32 v45, a33
    v_accvgpr_read_b32 v46, a34
    v_accvgpr_read_b32 v47, a35
    v_accvgpr_read_b32 v48, a48
    v_accvgpr_read_b32 v49, a49
    v_accvgpr_read_b32 v50, a50
    v_accvgpr_read_b32 v51, a51
    v_mul_f32 v44, v44, v56
    v_mul_f32 v45, v45, v56
    v_mul_f32 v46, v46, v56
    v_mul_f32 v47, v47, v56
    v_mul_f32 v48, v48, v56
    v_mul_f32 v49, v49, v56
    v_mul_f32 v50, v50, v56
    v_mul_f32 v51, v51, v56
    v_cvt_pk_bf16_f32 v52, v44, v45
    v_cvt_pk_bf16_f32 v53, v46, v47
    v_cvt_pk_bf16_f32 v54, v48, v49
    v_cvt_pk_bf16_f32 v55, v50, v51
    buffer_store_dwordx4 v[52:55], v2, s[64:67], s28 offen offset:1024 sc1
    v_accvgpr_read_b32 v32, a64
    v_accvgpr_read_b32 v33, a65
    v_accvgpr_read_b32 v34, a66
    v_accvgpr_read_b32 v35, a67
    v_accvgpr_read_b32 v36, a80
    v_accvgpr_read_b32 v37, a81
    v_accvgpr_read_b32 v38, a82
    v_accvgpr_read_b32 v39, a83
    v_mul_f32 v32, v32, v56
    v_mul_f32 v33, v33, v56
    v_mul_f32 v34, v34, v56
    v_mul_f32 v35, v35, v56
    v_mul_f32 v36, v36, v56
    v_mul_f32 v37, v37, v56
    v_mul_f32 v38, v38, v56
    v_mul_f32 v39, v39, v56
    v_cvt_pk_bf16_f32 v40, v32, v33
    v_cvt_pk_bf16_f32 v41, v34, v35
    v_cvt_pk_bf16_f32 v42, v36, v37
    v_cvt_pk_bf16_f32 v43, v38, v39
    buffer_store_dwordx4 v[40:43], v2, s[64:67], s28 offen offset:2048 sc1
    v_accvgpr_read_b32 v44, a96
    v_accvgpr_read_b32 v45, a97
    v_accvgpr_read_b32 v46, a98
    v_accvgpr_read_b32 v47, a99
    v_accvgpr_read_b32 v48, a112
    v_accvgpr_read_b32 v49, a113
    v_accvgpr_read_b32 v50, a114
    v_accvgpr_read_b32 v51, a115
    v_mul_f32 v44, v44, v56
    v_mul_f32 v45, v45, v56
    v_mul_f32 v46, v46, v56
    v_mul_f32 v47, v47, v56
    v_mul_f32 v48, v48, v56
    v_mul_f32 v49, v49, v56
    v_mul_f32 v50, v50, v56
    v_mul_f32 v51, v51, v56
    v_cvt_pk_bf16_f32 v52, v44, v45
    v_cvt_pk_bf16_f32 v53, v46, v47
    v_cvt_pk_bf16_f32 v54, v48, v49
    v_cvt_pk_bf16_f32 v55, v50, v51
    buffer_store_dwordx4 v[52:55], v2, s[64:67], s28 offen offset:3072 sc1
    v_rcp_f32 v56, v116
    s_lshl_b32 s28, s57, 17
    v_accvgpr_read_b32 v32, a4
    v_accvgpr_read_b32 v33, a5
    v_accvgpr_read_b32 v34, a6
    v_accvgpr_read_b32 v35, a7
    v_accvgpr_read_b32 v36, a20
    v_accvgpr_read_b32 v37, a21
    v_accvgpr_read_b32 v38, a22
    v_accvgpr_read_b32 v39, a23
    v_mul_f32 v32, v32, v56
    v_mul_f32 v33, v33, v56
    v_mul_f32 v34, v34, v56
    v_mul_f32 v35, v35, v56
    v_mul_f32 v36, v36, v56
    v_mul_f32 v37, v37, v56
    v_mul_f32 v38, v38, v56
    v_mul_f32 v39, v39, v56
    v_cvt_pk_bf16_f32 v40, v32, v33
    v_cvt_pk_bf16_f32 v41, v34, v35
    v_cvt_pk_bf16_f32 v42, v36, v37
    v_cvt_pk_bf16_f32 v43, v38, v39
    buffer_store_dwordx4 v[40:43], v2, s[64:67], s28 offen offset:0 sc1
    v_accvgpr_read_b32 v44, a36
    v_accvgpr_read_b32 v45, a37
    v_accvgpr_read_b32 v46, a38
    v_accvgpr_read_b32 v47, a39
    v_accvgpr_read_b32 v48, a52
    v_accvgpr_read_b32 v49, a53
    v_accvgpr_read_b32 v50, a54
    v_accvgpr_read_b32 v51, a55
    v_mul_f32 v44, v44, v56
    v_mul_f32 v45, v45, v56
    v_mul_f32 v46, v46, v56
    v_mul_f32 v47, v47, v56
    v_mul_f32 v48, v48, v56
    v_mul_f32 v49, v49, v56
    v_mul_f32 v50, v50, v56
    v_mul_f32 v51, v51, v56
    v_cvt_pk_bf16_f32 v52, v44, v45
    v_cvt_pk_bf16_f32 v53, v46, v47
    v_cvt_pk_bf16_f32 v54, v48, v49
    v_cvt_pk_bf16_f32 v55, v50, v51
    buffer_store_dwordx4 v[52:55], v2, s[64:67], s28 offen offset:1024 sc1
    v_accvgpr_read_b32 v32, a68
    v_accvgpr_read_b32 v33, a69
    v_accvgpr_read_b32 v34, a70
    v_accvgpr_read_b32 v35, a71
    v_accvgpr_read_b32 v36, a84
    v_accvgpr_read_b32 v37, a85
    v_accvgpr_read_b32 v38, a86
    v_accvgpr_read_b32 v39, a87
    v_mul_f32 v32, v32, v56
    v_mul_f32 v33, v33, v56
    v_mul_f32 v34, v34, v56
    v_mul_f32 v35, v35, v56
    v_mul_f32 v36, v36, v56
    v_mul_f32 v37, v37, v56
    v_mul_f32 v38, v38, v56
    v_mul_f32 v39, v39, v56
    v_cvt_pk_bf16_f32 v40, v32, v33
    v_cvt_pk_bf16_f32 v41, v34, v35
    v_cvt_pk_bf16_f32 v42, v36, v37
    v_cvt_pk_bf16_f32 v43, v38, v39
    buffer_store_dwordx4 v[40:43], v2, s[64:67], s28 offen offset:2048 sc1
    v_accvgpr_read_b32 v44, a100
    v_accvgpr_read_b32 v45, a101
    v_accvgpr_read_b32 v46, a102
    v_accvgpr_read_b32 v47, a103
    v_accvgpr_read_b32 v48, a116
    v_accvgpr_read_b32 v49, a117
    v_accvgpr_read_b32 v50, a118
    v_accvgpr_read_b32 v51, a119
    v_mul_f32 v44, v44, v56
    v_mul_f32 v45, v45, v56
    v_mul_f32 v46, v46, v56
    v_mul_f32 v47, v47, v56
    v_mul_f32 v48, v48, v56
    v_mul_f32 v49, v49, v56
    v_mul_f32 v50, v50, v56
    v_mul_f32 v51, v51, v56
    v_cvt_pk_bf16_f32 v52, v44, v45
    v_cvt_pk_bf16_f32 v53, v46, v47
    v_cvt_pk_bf16_f32 v54, v48, v49
    v_cvt_pk_bf16_f32 v55, v50, v51
    buffer_store_dwordx4 v[52:55], v2, s[64:67], s28 offen offset:3072 sc1
K2_finB:
    s_waitcnt vmcnt(0) lgkmcnt(0)
    s_barrier
    ds_read_b128 v[16:19], v14 offset:61440
    s_and_b32 s28, s2, 7
    s_lshl_b32 s28, s28, 7
    s_add_u32 s24, s25, s28
    v_mov_b32 v13, 1
    s_waitcnt lgkmcnt(0)
    v_or3_b32 v16, v16, v17, v18
    v_or_b32 v16, v16, v19
    s_nop 0
    v_readfirstlane_b32 s28, v16
    s_andn2_b32 s28, s28, s38
    s_cmp_lg_u32 s28, 0
    s_cbranch_scc1 K2_slow
    buffer_atomic_add v13, v29, s[72:75], s24 offen offset:4
    s_add_u32 m0, s55, 10240
    s_nop 0
    buffer_load_dwordx4 v250, s[68:71], s53 offen sc1 lds
    s_add_u32 m0, s55, 11264
    s_nop 0
    buffer_load_dwordx4 v251, s[68:71], s53 offen sc1 lds
    s_add_u32 m0, s55, 12288
    s_nop 0
    buffer_load_dwordx4 v252, s[68:71], s53 offen sc1 lds
    s_add_u32 m0, s55, 13312
    s_nop 0
    buffer_load_dwordx4 v253, s[68:71], s53 offen sc1 lds
    s_add_u32 m0, s55, 14336
    s_nop 0
    buffer_load_dwordx4 v254, s[68:71], s53 offen sc1 lds
    s_add_u32 s53, s53, 2048
    s_add_u32 m0, s55, 20480
    s_nop 0
    buffer_load_dwordx4 v250, s[68:71], s53 offen sc1 lds
    s_add_u32 m0, s55, 21504
    s_nop 0
    buffer_load_dwordx4 v251, s[68:71], s53 offen sc1 lds
    s_add_u32 m0, s55, 22528
    s_nop 0
    buffer_load_dwordx4 v252, s[68:71], s53 offen sc1 lds
    s_add_u32 m0, s55, 23552
    s_nop 0
    buffer_load_dwordx4 v253, s[68:71], s53 offen sc1 lds
    s_add_u32 m0, s55, 24576
    s_nop 0
    buffer_load_dwordx4 v254, s[68:71], s53 offen sc1 lds
    s_add_u32 s53, s53, 2048
    s_add_u32 m0, s55, 30720
    s_nop 0
    buffer_load_dwordx4 v250, s[68:71], s53 offen sc1 lds
    s_add_u32 m0, s55, 31744
    s_nop 0
    buffer_load_dwordx4 v251, s[68:71], s53 offen sc1 lds
    s_add_u32 m0, s55, 32768
    s_nop 0
    buffer_load_dwordx4 v252, s[68:71], s53 offen sc1 lds
    s_add_u32 m0, s55, 33792
    s_nop 0
    buffer_load_dwordx4 v253, s[68:71], s53 offen sc1 lds
    s_add_u32 m0, s55, 34816
    s_nop 0
    buffer_load_dwordx4 v254, s[68:71], s53 offen sc1 lds
    s_add_u32 s53, s53, 2048
    s_bfe_u32 s41, s2, 0x10002
    s_lshl_b32 s41, s41, 3
    s_bfe_u32 s42, s2, 0x10001
    s_add_u32 s41, s41, s42
    s_lshl_b32 s28, s27, 3
    s_sub_u32 s29, 112, s28
    s_cmp_lt_u32 s41, 8
    s_cselect_b32 s28, s28, s29
    s_add_u32 s31, s28, s41
    s_bfe_u32 s28, s2, 0x20003
    s_lshl_b32 s30, s28, 1
    s_and_b32 s29, s2, 1
    s_add_u32 s30, s30, s29
    s_mov_b32 s63, s54
    s_and_b32 s28, s2, 3
    s_lshl_b32 s28, s28, 1
    s_lshl_b32 s43, 3, s28
    s_load_dwordx2 s[6:7], s[0:1], 0
    s_load_dwordx4 s[20:23], s[0:1], 56
    s_lshl_b32 s28, s3, 1
    s_add_u32 s28, s28, s31
    s_lshl_b32 s29, s28, 17
    v_add_u32 v4, s29, v2
    s_xor_b32 s28, s28, 1
    s_lshl_b32 s29, s28, 17
    v_add_u32 v5, s29, v2
    s_add_u32 s8, s4, 0x4000000
    s_addc_u32 s9, s5, 0
    s_mov_b32 s10, 16777216
    s_mov_b32 s11, 0x20000
    v_add_u32 v6, 61440, v2
    v_add_u32 v7, 122880, v2
    v_and_b32 v15, 15, v1
    v_lshrrev_b32 v16, 4, v1
    s_lshl_b32 s28, s3, 1
    s_add_u32 s28, s31, s28
    s_lshl_b32 s28, s28, 4
    v_add_u32 v15, s28, v15
    v_mul_u32_u24 v8, 1280, v15
    s_mul_i32 s29, s30, 160
    v_lshl_add_u32 v8, v16, 3, v8
    v_add_u32 v8, s29, v8
    s_mul_i32 s29, s30, 320
    v_and_b32 v13, 15, v1
    v_lshlrev_b32 v9, 4, v16
    v_lshl_add_u32 v9, v13, 6, v9
    v_add_u32 v9, s29, v9
    v_add_u32 v13, 11, v13
    v_lshrrev_b32 v13, 4, v13
    v_lshl_or_b32 v9, v13, 26, v9
    s_add_u32 s64, s4, 0x5000000
    s_addc_u32 s65, s5, 0
    s_mov_b32 s66, 7864320
    s_mov_b32 s67, 0x20000
    s_waitcnt lgkmcnt(0)
    s_mov_b32 s16, s6
    s_mov_b32 s17, s7
    s_mov_b32 s18, 2621440
    s_mov_b32 s19, 0x20000
    v_lshrrev_b32 v14, 3, v1
    v_add_u32 v14, s3, v14
    v_lshlrev_b32 v14, 26, v14
    v_lshl_or_b32 v14, v1, 7, v14
    buffer_load_dword v31, v14, s[72:75], s25 offen offset:4 sc1
    s_add_u32 m0, s55, 40960
    s_nop 0
    buffer_load_dwordx4 v250, s[68:71], s53 offen sc1 lds
    s_add_u32 m0, s55, 41984
    s_nop 0
    buffer_load_dwordx4 v251, s[68:71], s53 offen sc1 lds
    s_add_u32 m0, s55, 43008
    s_nop 0
    buffer_load_dwordx4 v252, s[68:71], s53 offen sc1 lds
    s_add_u32 m0, s55, 44032
    s_nop 0
    buffer_load_dwordx4 v253, s[68:71], s53 offen sc1 lds
    s_add_u32 m0, s55, 45056
    s_nop 0
    buffer_load_dwordx4 v254, s[68:71], s53 offen sc1 lds
    s_add_u32 s53, s53, 2048
    s_add_u32 m0, s55, 51200
    s_nop 0
    buffer_load_dwordx4 v250, s[68:71], s53 offen sc1 lds
    s_add_u32 m0, s55, 52224
    s_nop 0
    buffer_load_dwordx4 v251, s[68:71], s53 offen sc1 lds
    s_add_u32 m0, s55, 53248
    s_nop 0
    buffer_load_dwordx4 v252, s[68:71], s53 offen sc1 lds
    s_add_u32 m0, s55, 54272
    s_nop 0
    buffer_load_dwordx4 v253, s[68:71], s53 offen sc1 lds
    s_add_u32 m0, s55, 55296
    s_nop 0
    buffer_load_dwordx4 v254, s[68:71], s53 offen sc1 lds
    s_add_u32 s53, s53, 2048
    s_add_u32 m0, s55, 61440
    s_nop 0
    buffer_load_dwordx4 v250, s[68:71], s53 offen sc1 lds
    s_add_u32 m0, s55, 62464
    s_nop 0
    buffer_load_dwordx4 v251, s[68:71], s53 offen sc1 lds
    s_add_u32 m0, s55, 63488
    s_nop 0
    buffer_load_dwordx4 v252, s[68:71], s53 offen sc1 lds
    s_add_u32 m0, s55, 64512
    s_nop 0
    buffer_load_dwordx4 v253, s[68:71], s53 offen sc1 lds
    s_add_u32 m0, s55, 65536
    s_nop 0
    buffer_load_dwordx4 v254, s[68:71], s53 offen sc1 lds
    s_add_u32 s53, s53, 2048
    s_add_u32 m0, s55, 71680
    s_nop 0
    buffer_load_dwordx4 v250, s[68:71], s53 offen sc1 lds
    s_add_u32 m0, s55, 72704
    s_nop 0
    buffer_load_dwordx4 v251, s[68:71], s53 offen sc1 lds
    s_add_u32 m0, s55, 73728
    s_nop 0
    buffer_load_dwordx4 v252, s[68:71], s53 offen sc1 lds
    s_add_u32 m0, s55, 74752
    s_nop 0
    buffer_load_dwordx4 v253, s[68:71], s53 offen sc1 lds
    s_add_u32 m0, s55, 75776
    s_nop 0
    buffer_load_dwordx4 v254, s[68:71], s53 offen sc1 lds
    s_add_u32 s53, s53, 2048
    s_cmp_lg_u32 s3, 0
    s_cbranch_scc1 KB_wctx
    s_mov_b32 s29, 0x40000
    s_waitcnt vmcnt(20)
KB_lctx:
    v_cmp_gt_u32 vcc, 4, v31
    s_sub_u32 s29, s29, 1
    s_cmp_eq_u32 s29, 0
    s_cbranch_scc1 KB_wctx
    s_and_b32 s28, vcc_lo, s43
    s_cmp_eq_u32 s28, 0
    s_cbranch_scc1 KB_wctx
    buffer_load_dword v31, v14, s[72:75], s25 offen offset:4 sc1
    s_waitcnt vmcnt(0)
    s_branch KB_lctx
KB_wctx:
    s_waitcnt vmcnt(31)
    s_barrier
    buffer_load_dwordx4 a[0:3], v4, s[8:11], s63 offen offset:0 sc1
    buffer_load_dwordx4 a[4:7], v4, s[8:11], s63 offen offset:1024 sc1
    buffer_load_dwordx4 a[8:11], v5, s[8:11], s63 offen offset:0 sc1
    buffer_load_dwordx4 a[12:15], v5, s[8:11], s63 offen offset:1024 sc1
    s_add_u32 s63, s63, 2048
    buffer_load_dwordx4 a[16:19], v4, s[8:11], s63 offen offset:0 sc1
    buffer_load_dwordx4 a[20:23], v4, s[8:11], s63 offen offset:1024 sc1
    buffer_load_dwordx4 a[24:27], v5, s[8:11], s63 offen offset:0 sc1
    buffer_load_dwordx4 a[28:31], v5, s[8:11], s63 offen offset:1024 sc1
    s_add_u32 s63, s63, 2048
    ds_read_b128 a[80:83], v2 offset:0
    ds_read_b128 a[84:87], v2 offset:1024
    ds_read_b128 a[88:91], v2 offset:2048
    ds_read_b128 a[92:95], v2 offset:3072
    ds_read_b128 a[96:99], v2 offset:4096
    ds_read_b128 a[100:103], v2 offset:5120
    ds_read_b128 a[104:107], v2 offset:6144
    ds_read_b128 a[108:111], v2 offset:7168
    ds_read_b128 a[112:115], v2 offset:8192
    ds_read_b128 a[116:119], v2 offset:9216
    buffer_load_dwordx4 a[32:35], v4, s[8:11], s63 offen offset:0 sc1
    buffer_load_dwordx4 a[36:39], v4, s[8:11], s63 offen offset:1024 sc1
    buffer_load_dwordx4 a[40:43], v5, s[8:11], s63 offen offset:0 sc1
    buffer_load_dwordx4 a[44:47], v5, s[8:11], s63 offen offset:1024 sc1
    s_add_u32 s63, s63, 2048
    buffer_load_dwordx4 a[48:51], v4, s[8:11], s63 offen offset:0 sc1
    buffer_load_dwordx4 a[52:55], v4, s[8:11], s63 offen offset:1024 sc1
    buffer_load_dwordx4 a[56:59], v5, s[8:11], s63 offen offset:0 sc1
    buffer_load_dwordx4 a[60:63], v5, s[8:11], s63 offen offset:1024 sc1
    s_add_u32 s63, s63, 2048
    s_waitcnt vmcnt(12) lgkmcnt(8)
    v_mfma_f32_16x16x32_bf16 v[92:95], a[80:83], a[8:11], 0
    s_waitcnt lgkmcnt(6)
    ds_read_b128 a[120:123], v6 offset:20480
    ds_read_b128 a[124:127], v6 offset:21504
    v_mfma_f32_16x16x32_bf16 v[92:95], a[84:87], a[12:15], v[92:95]
    buffer_load_dwordx4 a[64:67], v4, s[8:11], s63 offen offset:0 sc1
    v_mfma_f32_16x16x32_bf16 v[52:55], a[84:87], a[4:7], 0
    v_mfma_f32_16x16x32_bf16 v[52:55], a[80:83], a[0:3], v[52:55]
    v_mfma_f32_16x16x32_bf16 v[56:59], a[88:91], a[0:3], 0
    s_waitcnt lgkmcnt(6)
    ds_read_b128 a[80:83], v6 offset:22528
    ds_read_b128 a[84:87], v6 offset:23552
    v_mfma_f32_16x16x32_bf16 v[56:59], a[92:95], a[4:7], v[56:59]
    buffer_load_dwordx4 a[68:71], v4, s[8:11], s63 offen offset:1024 sc1
    v_mfma_f32_16x16x32_bf16 v[96:99], a[92:95], a[12:15], 0
    v_mfma_f32_16x16x32_bf16 v[96:99], a[88:91], a[8:11], v[96:99]
    v_mfma_f32_16x16x32_bf16 v[100:103], a[96:99], a[8:11], 0
    s_waitcnt lgkmcnt(6)
    ds_read_b128 a[88:91], v6 offset:24576
    ds_read_b128 a[92:95], v6 offset:25600
    v_mfma_f32_16x16x32_bf16 v[100:103], a[100:103], a[12:15], v[100:103]
    v_mfma_f32_16x16x32_bf16 v[60:63], a[100:103], a[4:7], 0
    buffer_load_dwordx4 a[72:75], v5, s[8:11], s63 offen offset:0 sc1
    v_mfma_f32_16x16x32_bf16 v[60:63], a[96:99], a[0:3], v[60:63]
    v_mfma_f32_16x16x32_bf16 v[64:67], a[104:107], a[0:3], 0
    s_waitcnt lgkmcnt(6)
    ds_read_b128 a[96:99], v6 offset:26624
    ds_read_b128 a[100:103], v6 offset:27648
    v_mfma_f32_16x16x32_bf16 v[64:67], a[108:111], a[4:7], v[64:67]
    v_mfma_f32_16x16x32_bf16 v[104:107], a[108:111], a[12:15], 0
    v_mfma_f32_16x16x32_bf16 v[104:107], a[104:107], a[8:11], v[104:107]
    buffer_load_dwordx4 a[76:79], v5, s[8:11], s63 offen offset:1024 sc1
    v_mfma_f32_16x16x32_bf16 v[108:111], a[112:115], a[8:11], 0
    s_waitcnt lgkmcnt(6)
    ds_read_b128 a[104:107], v6 offset:28672
    ds_read_b128 a[108:111], v6 offset:29696
    v_mfma_f32_16x16x32_bf16 v[108:111], a[116:119], a[12:15], v[108:111]
    s_add_u32 s63, s63, 2048
    s_mov_b32 s52, 32768
    v_mfma_f32_16x16x32_bf16 v[68:71], a[116:119], a[4:7], 0
    v_mfma_f32_16x16x32_bf16 v[68:71], a[112:115], a[0:3], v[68:71]
    v_mfma_f32_16x16x32_bf16 v[32:35], a[120:123], a[0:3], 0
    s_waitcnt lgkmcnt(6)
    ds_read_b128 a[112:115], v2 offset:10240
    ds_read_b128 a[116:119], v2 offset:11264
    v_mfma_f32_16x16x32_bf16 v[32:35], a[124:127], a[4:7], v[32:35]
    buffer_load_dwordx4 v[200:203], v2, s[72:75], s52 offen offset:0 sc1
    v_mfma_f32_16x16x32_bf16 v[72:75], a[124:127], a[12:15], 0
    v_mfma_f32_16x16x32_bf16 v[72:75], a[120:123], a[8:11], v[72:75]
    v_mfma_f32_16x16x32_bf16 v[76:79], a[80:83], a[8:11], 0
    s_waitcnt lgkmcnt(6)
    ds_read_b128 a[120:123], v2 offset:12288
    ds_read_b128 a[124:127], v2 offset:13312
    v_mfma_f32_16x16x32_bf16 v[76:79], a[84:87], a[12:15], v[76:79]
    buffer_load_dwordx4 v[204:207], v2, s[72:75], s52 offen offset:1024 sc1
    v_mfma_f32_16x16x32_bf16 v[36:39], a[84:87], a[4:7], 0
    v_mfma_f32_16x16x32_bf16 v[36:39], a[80:83], a[0:3], v[36:39]
    v_mfma_f32_16x16x32_bf16 v[40:43], a[88:91], a[0:3], 0
    s_waitcnt lgkmcnt(6)
    ds_read_b128 a[80:83], v2 offset:14336
    ds_read_b128 a[84:87], v2 offset:15360
    v_mfma_f32_16x16x32_bf16 v[40:43], a[92:95], a[4:7], v[40:43]
    v_mfma_f32_16x16x32_bf16 v[80:83], a[92:95], a[12:15], 0
    buffer_load_dwordx4 v[208:211], v2, s[72:75], s52 offen offset:2048 sc1
    v_mfma_f32_16x16x32_bf16 v[80:83], a[88:91], a[8:11], v[80:83]
    v_mfma_f32_16x16x32_bf16 v[84:87], a[96:99], a[8:11], 0
    s_waitcnt lgkmcnt(6)
    ds_read_b128 a[88:91], v2 offset:16384
    ds_read_b128 a[92:95], v2 offset:17408
    v_mfma_f32_16x16x32_bf16 v[84:87], a[100:103], a[12:15], v[84:87]
    v_mfma_f32_16x16x32_bf16 v[44:47], a[100:103], a[4:7], 0
    v_mfma_f32_16x16x32_bf16 v[44:47], a[96:99], a[0:3], v[44:47]
    v_mfma_f32_16x16x32_bf16 v[48:51], a[104:107], a[0:3], 0
    s_waitcnt vmcnt(15) lgkmcnt(6)
    ds_read_b128 a[96:99], v2 offset:18432
    ds_read_b128 a[100:103], v2 offset:19456
    v_mfma_f32_16x16x32_bf16 v[48:51], a[108:111], a[4:7], v[48:51]
    v_mfma_f32_16x16x32_bf16 v[88:91], a[108:111], a[12:15], 0
    v_mfma_f32_16x16x32_bf16 v[88:91], a[104:107], a[8:11], v[88:91]
    v_mfma_f32_16x16x32_bf16 v[92:95], a[112:115], a[24:27], v[92:95]
    s_waitcnt lgkmcnt(6)
    ds_read_b128 a[104:107], v6 offset:30720
    ds_read_b128 a[108:111], v6 offset:31744
    v_mfma_f32_16x16x32_bf16 v[92:95], a[116:119], a[28:31], v[92:95]
    buffer_load_dwordx4 a[0:3], v4, s[8:11], s63 offen offset:0 sc1
    v_mfma_f32_16x16x32_bf16 v[52:55], a[116:119], a[20:23], v[52:55]
    v_mfma_f32_16x16x32_bf16 v[52:55], a[112:115], a[16:19], v[52:55]
    v_mfma_f32_16x16x32_bf16 v[56:59], a[120:123], a[16:19], v[56:59]
    s_waitcnt lgkmcnt(6)
    ds_read_b128 a[112:115], v6 offset:32768
    ds_read_b128 a[116:119], v6 offset:33792
    v_mfma_f32_16x16x32_bf16 v[56:59], a[124:127], a[20:23], v[56:59]
    v_mfma_f32_16x16x32_bf16 v[96:99], a[124:127], a[28:31], v[96:99]
    buffer_load_dwordx4 a[4:7], v4, s[8:11], s63 offen offset:1024 sc1
    v_mfma_f32_16x16x32_bf16 v[96:99], a[120:123], a[24:27], v[96:99]
    v_mfma_f32_16x16x32_bf16 v[100:103], a[80:83], a[24:27], v[100:103]
    s_waitcnt lgkmcnt(6)
    ds_read_b128 a[120:123], v6 offset:34816
    ds_read_b128 a[124:127], v6 offset:35840
    v_mfma_f32_16x16x32_bf16 v[100:103], a[84:87], a[28:31], v[100:103]
    v_mfma_f32_16x16x32_bf16 v[60:63], a[84:87], a[20:23], v[60:63]
    v_mfma_f32_16x16x32_bf16 v[60:63], a[80:83], a[16:19], v[60:63]
    v_mfma_f32_16x16x32_bf16 v[64:67], a[88:91], a[16:19], v[64:67]
    s_waitcnt lgkmcnt(6)
    ds_read_b128 a[80:83], v6 offset:36864
    ds_read_b128 a[84:87], v6 offset:37888
    v_mfma_f32_16x16x32_bf16 v[64:67], a[92:95], a[20:23], v[64:67]
    buffer_load_dwordx4 a[8:11], v5, s[8:11], s63 offen offset:0 sc1
    v_mfma_f32_16x16x32_bf16 v[104:107], a[92:95], a[28:31], v[104:107]
    v_mfma_f32_16x16x32_bf16 v[104:107], a[88:91], a[24:27], v[104:107]
    v_mfma_f32_16x16x32_bf16 v[108:111], a[96:99], a[24:27], v[108:111]
    s_waitcnt vmcnt(47) lgkmcnt(6)
    ds_read_b128 a[88:91], v6 offset:38912
    ds_read_b128 a[92:95], v6 offset:39936
    v_mfma_f32_16x16x32_bf16 v[108:111], a[100:103], a[28:31], v[108:111]
    s_barrier
    v_mfma_f32_16x16x32_bf16 v[68:71], a[100:103], a[20:23], v[68:71]
    buffer_load_dwordx4 a[12:15], v5, s[8:11], s63 offen offset:1024 sc1
    v_mfma_f32_16x16x32_bf16 v[68:71], a[96:99], a[16:19], v[68:71]
    s_add_u32 s63, s63, 2048
    s_movk_i32 s38, 5120
    s_movk_i32 s39, 10240
    v_mfma_f32_16x16x32_bf16 v[32:35], a[104:107], a[16:19], v[32:35]
    s_waitcnt lgkmcnt(6)
    ds_read_b128 a[96:99], v2 offset:20480
    ds_read_b128 a[100:103], v2 offset:21504
    v_mfma_f32_16x16x32_bf16 v[32:35], a[108:111], a[20:23], v[32:35]
    v_mfma_f32_16x16x32_bf16 v[72:75], a[108:111], a[28:31], v[72:75]
    v_mfma_f32_16x16x32_bf16 v[72:75], a[104:107], a[24:27], v[72:75]
    buffer_load_dwordx4 v[196:199], v9, s[72:75], s38 offen sc1
    v_mfma_f32_16x16x32_bf16 v[76:79], a[112:115], a[24:27], v[76:79]
    s_waitcnt lgkmcnt(6)
    ds_read_b128 a[104:107], v2 offset:22528
    ds_read_b128 a[108:111], v2 offset:23552
    v_mfma_f32_16x16x32_bf16 v[76:79], a[116:119], a[28:31], v[76:79]
    v_mfma_f32_16x16x32_bf16 v[36:39], a[116:119], a[20:23], v[36:39]
    v_mfma_f32_16x16x32_bf16 v[36:39], a[112:115], a[16:19], v[36:39]
    v_mfma_f32_16x16x32_bf16 v[40:43], a[120:123], a[16:19], v[40:43]
    s_waitcnt lgkmcnt(6)
    ds_read_b128 a[112:115], v2 offset:24576
    ds_read_b128 a[116:119], v2 offset:25600
    v_mfma_f32_16x16x32_bf16 v[40:43], a[124:127], a[20:23], v[40:43]
    buffer_load_dwordx4 v[216:219], v9, s[72:75], s39 offen sc1
    v_mfma_f32_16x16x32_bf16 v[80:83], a[124:127], a[28:31], v[80:83]
    v_mfma_f32_16x16x32_bf16 v[80:83], a[120:123], a[24:27], v[80:83]
    v_mfma_f32_16x16x32_bf16 v[84:87], a[80:83], a[24:27], v[84:87]
    s_waitcnt lgkmcnt(6)
    ds_read_b128 a[120:123], v2 offset:26624
    ds_read_b128 a[124:127], v2 offset:27648
    v_mfma_f32_16x16x32_bf16 v[84:87], a[84:87], a[28:31], v[84:87]
    v_mfma_f32_16x16x32_bf16 v[44:47], a[84:87], a[20:23], v[44:47]
    v_mfma_f32_16x16x32_bf16 v[44:47], a[80:83], a[16:19], v[44:47]
    v_mfma_f32_16x16x32_bf16 v[48:51], a[88:91], a[16:19], v[48:51]
    s_waitcnt vmcnt(17) lgkmcnt(6)
    ds_read_b128 a[80:83], v2 offset:28672
    ds_read_b128 a[84:87], v2 offset:29696
    v_mfma_f32_16x16x32_bf16 v[48:51], a[92:95], a[20:23], v[48:51]
    v_mfma_f32_16x16x32_bf16 v[88:91], a[92:95], a[28:31], v[88:91]
    v_mfma_f32_16x16x32_bf16 v[88:91], a[88:91], a[24:27], v[88:91]
    v_mfma_f32_16x16x32_bf16 v[92:95], a[96:99], a[40:43], v[92:95]
    s_waitcnt lgkmcnt(6)
    ds_read_b128 a[88:91], v6 offset:40960
    ds_read_b128 a[92:95], v6 offset:41984
    v_mfma_f32_16x16x32_bf16 v[92:95], a[100:103], a[44:47], v[92:95]
    buffer_load_dwordx4 a[16:19], v4, s[8:11], s63 offen offset:0 sc1
    v_mfma_f32_16x16x32_bf16 v[52:55], a[100:103], a[36:39], v[52:55]
    v_mfma_f32_16x16x32_bf16 v[52:55], a[96:99], a[32:35], v[52:55]
    v_mfma_f32_16x16x32_bf16 v[56:59], a[104:107], a[32:35], v[56:59]
    s_waitcnt lgkmcnt(6)
    ds_read_b128 a[96:99], v6 offset:43008
    ds_read_b128 a[100:103], v6 offset:44032
    v_mfma_f32_16x16x32_bf16 v[56:59], a[108:111], a[36:39], v[56:59]
    buffer_load_dwordx4 a[20:23], v4, s[8:11], s63 offen offset:1024 sc1
    v_mfma_f32_16x16x32_bf16 v[96:99], a[108:111], a[44:47], v[96:99]
    v_mfma_f32_16x16x32_bf16 v[96:99], a[104:107], a[40:43], v[96:99]
    v_mfma_f32_16x16x32_bf16 v[100:103], a[112:115], a[40:43], v[100:103]
    s_waitcnt lgkmcnt(6)
    ds_read_b128 a[104:107], v6 offset:45056
    ds_read_b128 a[108:111], v6 offset:46080
    v_mfma_f32_16x16x32_bf16 v[100:103], a[116:119], a[44:47], v[100:103]
    buffer_load_dwordx4 a[24:27], v5, s[8:11], s63 offen offset:0 sc1
    v_mfma_f32_16x16x32_bf16 v[60:63], a[116:119], a[36:39], v[60:63]
    v_mfma_f32_16x16x32_bf16 v[60:63], a[112:115], a[32:35], v[60:63]
    v_mfma_f32_16x16x32_bf16 v[64:67], a[120:123], a[32:35], v[64:67]
    s_waitcnt lgkmcnt(6)
    ds_read_b128 a[112:115], v6 offset:47104
    ds_read_b128 a[116:119], v6 offset:48128
    v_mfma_f32_16x16x32_bf16 v[64:67], a[124:127], a[36:39], v[64:67]
    buffer_load_dwordx4 a[28:31], v5, s[8:11], s63 offen offset:1024 sc1
    v_mfma_f32_16x16x32_bf16 v[104:107], a[124:127], a[44:47], v[104:107]
    s_add_u32 s63, s63, 2048
    s_add_u32 m0, s55, 0
    v_mfma_f32_16x16x32_bf16 v[104:107], a[120:123], a[40:43], v[104:107]
    v_mfma_f32_16x16x32_bf16 v[108:111], a[80:83], a[40:43], v[108:111]
    s_waitcnt lgkmcnt(6)
    ds_read_b128 a[120:123], v6 offset:49152
    ds_read_b128 a[124:127], v6 offset:50176
    v_mfma_f32_16x16x32_bf16 v[108:111], a[84:87], a[44:47], v[108:111]
    buffer_load_dwordx4 v250, s[68:71], s53 offen sc1 lds
    v_mfma_f32_16x16x32_bf16 v[68:71], a[84:87], a[36:39], v[68:71]
    s_add_u32 m0, s55, 1024
    v_mfma_f32_16x16x32_bf16 v[68:71], a[80:83], a[32:35], v[68:71]
    buffer_load_dwordx4 v251, s[68:71], s53 offen sc1 lds
    v_mfma_f32_16x16x32_bf16 v[32:35], a[88:91], a[32:35], v[32:35]
    s_waitcnt lgkmcnt(6)
    ds_read_b128 a[80:83], v2 offset:30720
    ds_read_b128 a[84:87], v2 offset:31744
    v_mfma_f32_16x16x32_bf16 v[32:35], a[92:95], a[36:39], v[32:35]
    s_add_u32 m0, s55, 2048
    v_lshlrev_b32 v20, 3, v1
    v_mfma_f32_16x16x32_bf16 v[72:75], a[92:95], a[44:47], v[72:75]
    s_mul_i32 s44, s3, 2560
    v_mfma_f32_16x16x32_bf16 v[72:75], a[88:91], a[40:43], v[72:75]
    buffer_load_dwordx4 v252, s[68:71], s53 offen sc1 lds
    v_mfma_f32_16x16x32_bf16 v[76:79], a[96:99], a[40:43], v[76:79]
    s_waitcnt lgkmcnt(6)
    ds_read_b128 a[88:91], v2 offset:32768
    ds_read_b128 a[92:95], v2 offset:33792
    v_mfma_f32_16x16x32_bf16 v[76:79], a[100:103], a[44:47], v[76:79]
    s_add_u32 m0, s55, 3072
    s_xor_b32 s46, s2, 1
    v_mfma_f32_16x16x32_bf16 v[36:39], a[100:103], a[36:39], v[36:39]
    s_mul_i32 s46, s46, 30720
    v_mfma_f32_16x16x32_bf16 v[36:39], a[96:99], a[32:35], v[36:39]
    buffer_load_dwordx4 v253, s[68:71], s53 offen sc1 lds
    v_mfma_f32_16x16x32_bf16 v[40:43], a[104:107], a[32:35], v[40:43]
    s_waitcnt lgkmcnt(6)
    ds_read_b128 a[96:99], v2 offset:34816
    ds_read_b128 a[100:103], v2 offset:35840
    v_mfma_f32_16x16x32_bf16 v[40:43], a[108:111], a[36:39], v[40:43]
    s_add_u32 m0, s55, 4096
    s_add_u32 s46, s46, s44
    v_mfma_f32_16x16x32_bf16 v[80:83], a[108:111], a[44:47], v[80:83]
    s_add_u32 s46, s46, 0
    v_mfma_f32_16x16x32_bf16 v[80:83], a[104:107], a[40:43], v[80:83]
    buffer_load_dwordx4 v254, s[68:71], s53 offen sc1 lds
    v_mfma_f32_16x16x32_bf16 v[84:87], a[112:115], a[40:43], v[84:87]
    s_waitcnt lgkmcnt(6)
    ds_read_b128 a[104:107], v2 offset:36864
    ds_read_b128 a[108:111], v2 offset:37888
    v_mfma_f32_16x16x32_bf16 v[84:87], a[116:119], a[44:47], v[84:87]
    s_add_u32 s53, s53, 2048
    s_xor_b32 s47, s2, 2
    v_mfma_f32_16x16x32_bf16 v[44:47], a[116:119], a[36:39], v[44:47]
    s_mul_i32 s47, s47, 30720
    v_mfma_f32_16x16x32_bf16 v[44:47], a[112:115], a[32:35], v[44:47]
    s_add_u32 s47, s47, s44
    v_mfma_f32_16x16x32_bf16 v[48:51], a[120:123], a[32:35], v[48:51]
    s_waitcnt vmcnt(22) lgkmcnt(6)
    ds_read_b128 a[112:115], v2 offset:38912
    ds_read_b128 a[116:119], v2 offset:39936
    v_mfma_f32_16x16x32_bf16 v[48:51], a[124:127], a[36:39], v[48:51]
    s_add_u32 s47, s47, 10240
    v_mfma_f32_16x16x32_bf16 v[88:91], a[124:127], a[44:47], v[88:91]
    s_xor_b32 s48, s2, 3
    v_mfma_f32_16x16x32_bf16 v[88:91], a[120:123], a[40:43], v[88:91]
    s_mul_i32 s48, s48, 30720
    v_mfma_f32_16x16x32_bf16 v[92:95], a[80:83], a[56:59], v[92:95]
    s_waitcnt lgkmcnt(6)
    ds_read_b128 a[120:123], v6 offset:51200
    ds_read_b128 a[124:127], v6 offset:52224
    v_mfma_f32_16x16x32_bf16 v[92:95], a[84:87], a[60:63], v[92:95]
    buffer_load_dwordx4 a[32:35], v4, s[8:11], s63 offen offset:0 sc1
    v_mfma_f32_16x16x32_bf16 v[52:55], a[84:87], a[52:55], v[52:55]
    s_add_u32 s48, s48, s44
    v_mfma_f32_16x16x32_bf16 v[52:55], a[80:83], a[48:51], v[52:55]
    s_add_u32 s48, s48, 20480
    v_mfma_f32_16x16x32_bf16 v[56:59], a[88:91], a[48:51], v[56:59]
    s_waitcnt lgkmcnt(6)
    ds_read_b128 a[80:83], v6 offset:53248
    ds_read_b128 a[84:87], v6 offset:54272
    v_mfma_f32_16x16x32_bf16 v[56:59], a[92:95], a[52:55], v[56:59]
    s_mul_i32 s49, s2, 30720
    v_mfma_f32_16x16x32_bf16 v[96:99], a[92:95], a[60:63], v[96:99]
    s_add_u32 s49, s49, s44
    v_mfma_f32_16x16x32_bf16 v[96:99], a[88:91], a[56:59], v[96:99]
    s_lshr_b32 s42, s2, 3
    v_mfma_f32_16x16x32_bf16 v[100:103], a[96:99], a[56:59], v[100:103]
    s_waitcnt lgkmcnt(6)
    ds_read_b128 a[88:91], v6 offset:55296
    ds_read_b128 a[92:95], v6 offset:56320
    v_mfma_f32_16x16x32_bf16 v[100:103], a[100:103], a[60:63], v[100:103]
    buffer_load_dwordx4 a[36:39], v4, s[8:11], s63 offen offset:1024 sc1
    v_mfma_f32_16x16x32_bf16 v[60:63], a[100:103], a[52:55], v[60:63]
    s_lshl_b32 s42, s42, 7
    v_mfma_f32_16x16x32_bf16 v[60:63], a[96:99], a[48:51], v[60:63]
    s_and_b32 s44, s2, 4
    v_mfma_f32_16x16x32_bf16 v[64:67], a[104:107], a[48:51], v[64:67]
    s_waitcnt lgkmcnt(6)
    ds_read_b128 a[96:99], v6 offset:57344
    ds_read_b128 a[100:103], v6 offset:58368
    v_mfma_f32_16x16x32_bf16 v[64:67], a[108:111], a[52:55], v[64:67]
    s_add_u32 s42, s42, s44
    v_mfma_f32_16x16x32_bf16 v[104:107], a[108:111], a[60:63], v[104:107]
    s_add_u32 s42, s42, 25600
    v_mfma_f32_16x16x32_bf16 v[104:107], a[104:107], a[56:59], v[104:107]
    v_mfma_f32_16x16x32_bf16 v[108:111], a[112:115], a[56:59], v[108:111]
    s_waitcnt vmcnt(50) lgkmcnt(6)
    ds_read_b128 a[104:107], v6 offset:59392
    ds_read_b128 a[108:111], v6 offset:60416
    v_mfma_f32_16x16x32_bf16 v[108:111], a[116:119], a[60:63], v[108:111]
    s_barrier
    v_mfma_f32_16x16x32_bf16 v[68:71], a[116:119], a[52:55], v[68:71]
    buffer_load_dwordx4 a[40:43], v5, s[8:11], s63 offen offset:0 sc1
    v_mfma_f32_16x16x32_bf16 v[68:71], a[112:115], a[48:51], v[68:71]
    v_mfma_f32_16x16x32_bf16 v[32:35], a[120:123], a[48:51], v[32:35]
    s_waitcnt lgkmcnt(6)
    ds_read_b128 a[112:115], v2 offset:40960
    ds_read_b128 a[116:119], v2 offset:41984
    v_mfma_f32_16x16x32_bf16 v[32:35], a[124:127], a[52:55], v[32:35]
    v_mfma_f32_16x16x32_bf16 v[72:75], a[124:127], a[60:63], v[72:75]
    v_mfma_f32_16x16x32_bf16 v[72:75], a[120:123], a[56:59], v[72:75]
    v_mfma_f32_16x16x32_bf16 v[76:79], a[80:83], a[56:59], v[76:79]
    s_waitcnt lgkmcnt(6)
    ds_read_b128 a[120:123], v2 offset:43008
    ds_read_b128 a[124:127], v2 offset:44032
    v_mfma_f32_16x16x32_bf16 v[76:79], a[84:87], a[60:63], v[76:79]
    v_mfma_f32_16x16x32_bf16 v[36:39], a[84:87], a[52:55], v[36:39]
    buffer_load_dwordx4 a[44:47], v5, s[8:11], s63 offen offset:1024 sc1
    v_mfma_f32_16x16x32_bf16 v[36:39], a[80:83], a[48:51], v[36:39]
    s_add_u32 s63, s63, 2048
    v_mfma_f32_16x16x32_bf16 v[40:43], a[88:91], a[48:51], v[40:43]
    s_waitcnt lgkmcnt(6)
    ds_read_b128 a[80:83], v2 offset:45056
    ds_read_b128 a[84:87], v2 offset:46080
    v_mfma_f32_16x16x32_bf16 v[40:43], a[92:95], a[52:55], v[40:43]
    v_mfma_f32_16x16x32_bf16 v[80:83], a[92:95], a[60:63], v[80:83]
    v_mfma_f32_16x16x32_bf16 v[80:83], a[88:91], a[56:59], v[80:83]
    v_mfma_f32_16x16x32_bf16 v[84:87], a[96:99], a[56:59], v[84:87]
    s_waitcnt lgkmcnt(6)
    ds_read_b128 a[88:91], v2 offset:47104
    ds_read_b128 a[92:95], v2 offset:48128
    v_mfma_f32_16x16x32_bf16 v[84:87], a[100:103], a[60:63], v[84:87]
    v_mfma_f32_16x16x32_bf16 v[44:47], a[100:103], a[52:55], v[44:47]
    v_mfma_f32_16x16x32_bf16 v[44:47], a[96:99], a[48:51], v[44:47]
    v_mfma_f32_16x16x32_bf16 v[48:51], a[104:107], a[48:51], v[48:51]
    s_waitcnt vmcnt(22) lgkmcnt(6)
    ds_read_b128 a[96:99], v2 offset:49152
    ds_read_b128 a[100:103], v2 offset:50176
    v_mfma_f32_16x16x32_bf16 v[48:51], a[108:111], a[52:55], v[48:51]
    v_mfma_f32_16x16x32_bf16 v[88:91], a[108:111], a[60:63], v[88:91]
    v_mfma_f32_16x16x32_bf16 v[88:91], a[104:107], a[56:59], v[88:91]
    v_mfma_f32_16x16x32_bf16 v[92:95], a[112:115], a[72:75], v[92:95]
    s_waitcnt lgkmcnt(6)
    ds_read_b128 a[104:107], v7 offset:0
    ds_read_b128 a[108:111], v7 offset:1024
    v_mfma_f32_16x16x32_bf16 v[92:95], a[116:119], a[76:79], v[92:95]
    buffer_load_dwordx4 a[192:195], v4, s[8:11], s63 offen offset:0 sc1
    v_mfma_f32_16x16x32_bf16 v[52:55], a[116:119], a[68:71], v[52:55]
    s_and_b32 s41, s2, 31
    v_mfma_f32_16x16x32_bf16 v[52:55], a[112:115], a[64:67], v[52:55]
    s_mov_b32 s32, s41
    v_mfma_f32_16x16x32_bf16 v[56:59], a[120:123], a[64:67], v[56:59]
    s_waitcnt lgkmcnt(6)
    ds_read_b128 a[112:115], v7 offset:2048
    ds_read_b128 a[116:119], v7 offset:3072
    v_mfma_f32_16x16x32_bf16 v[56:59], a[124:127], a[68:71], v[56:59]
    buffer_load_dwordx4 a[196:199], v4, s[8:11], s63 offen offset:1024 sc1
    v_mfma_f32_16x16x32_bf16 v[96:99], a[124:127], a[76:79], v[96:99]
    s_lshl_b32 s40, s3, 12
    v_mfma_f32_16x16x32_bf16 v[96:99], a[120:123], a[72:75], v[96:99]
    s_mov_b32 s34, 0
    v_mfma_f32_16x16x32_bf16 v[100:103], a[80:83], a[72:75], v[100:103]
    s_waitcnt lgkmcnt(6)
    ds_read_b128 a[120:123], v7 offset:4096
    ds_read_b128 a[124:127], v7 offset:5120
    v_mfma_f32_16x16x32_bf16 v[100:103], a[84:87], a[76:79], v[100:103]
    buffer_load_dwordx4 a[56:59], v5, s[8:11], s63 offen offset:0 sc1
    v_mfma_f32_16x16x32_bf16 v[60:63], a[84:87], a[68:71], v[60:63]
    s_mov_b32 s35, 26624
    v_mfma_f32_16x16x32_bf16 v[60:63], a[80:83], a[64:67], v[60:63]
    s_mov_b32 s36, 53248
    v_mfma_f32_16x16x32_bf16 v[64:67], a[88:91], a[64:67], v[64:67]
    s_waitcnt lgkmcnt(6)
    ds_read_b128 a[80:83], v7 offset:6144
    ds_read_b128 a[84:87], v7 offset:7168
    v_mfma_f32_16x16x32_bf16 v[64:67], a[92:95], a[68:71], v[64:67]
    buffer_load_dwordx4 a[60:63], v5, s[8:11], s63 offen offset:1024 sc1
    v_mfma_f32_16x16x32_bf16 v[104:107], a[92:95], a[76:79], v[104:107]
    s_add_u32 s63, s63, 2048
    s_add_u32 m0, s55, 10240
    s_mov_b32 s37, 79872
    v_mfma_f32_16x16x32_bf16 v[104:107], a[88:91], a[72:75], v[104:107]
    s_movk_i32 s28, 3456
    v_mfma_f32_16x16x32_bf16 v[108:111], a[96:99], a[72:75], v[108:111]
    s_waitcnt lgkmcnt(6)
    ds_read_b128 a[88:91], v7 offset:8192
    ds_read_b128 a[92:95], v7 offset:9216
    v_mfma_f32_16x16x32_bf16 v[108:111], a[100:103], a[76:79], v[108:111]
    buffer_load_dwordx4 v250, s[68:71], s53 offen sc1 lds
    v_mfma_f32_16x16x32_bf16 v[68:71], a[100:103], a[68:71], v[68:71]
    s_add_u32 m0, s55, 11264
    v_lshrrev_b32 v13, 3, v1
    v_mfma_f32_16x16x32_bf16 v[68:71], a[96:99], a[64:67], v[68:71]
    buffer_load_dwordx4 v251, s[68:71], s53 offen sc1 lds
    v_mfma_f32_16x16x32_bf16 v[32:35], a[104:107], a[64:67], v[32:35]
    s_waitcnt lgkmcnt(6)
    ds_read_b128 a[96:99], v2 offset:51200
    ds_read_b128 a[100:103], v2 offset:52224
    v_mfma_f32_16x16x32_bf16 v[32:35], a[108:111], a[68:71], v[32:35]
    s_add_u32 m0, s55, 12288
    v_mul_lo_u32 v3, v13, s28
    v_mfma_f32_16x16x32_bf16 v[72:75], a[108:111], a[76:79], v[72:75]
    v_lshrrev_b32 v13, 3, v1
    v_mfma_f32_16x16x32_bf16 v[72:75], a[104:107], a[72:75], v[72:75]
    buffer_load_dwordx4 v252, s[68:71], s53 offen sc1 lds
    v_mfma_f32_16x16x32_bf16 v[76:79], a[112:115], a[72:75], v[76:79]
    s_waitcnt lgkmcnt(6)
    ds_read_b128 a[104:107], v2 offset:53248
    ds_read_b128 a[108:111], v2 offset:54272
    v_mfma_f32_16x16x32_bf16 v[76:79], a[116:119], a[76:79], v[76:79]
    s_add_u32 m0, s55, 13312
    v_and_b32 v13, 6, v13
    v_mfma_f32_16x16x32_bf16 v[36:39], a[116:119], a[68:71], v[36:39]
    v_and_b32 v14, 7, v1
    v_mfma_f32_16x16x32_bf16 v[36:39], a[112:115], a[64:67], v[36:39]
    buffer_load_dwordx4 v253, s[68:71], s53 offen sc1 lds
    v_mfma_f32_16x16x32_bf16 v[40:43], a[120:123], a[64:67], v[40:43]
    s_waitcnt lgkmcnt(6)
    ds_read_b128 a[112:115], v2 offset:55296
    ds_read_b128 a[116:119], v2 offset:56320
    v_mfma_f32_16x16x32_bf16 v[40:43], a[124:127], a[68:71], v[40:43]
    s_add_u32 m0, s55, 14336
    v_xor_b32 v13, v13, v14
    v_mfma_f32_16x16x32_bf16 v[80:83], a[124:127], a[76:79], v[80:83]
    v_lshlrev_b32 v13, 4, v13
    v_mfma_f32_16x16x32_bf16 v[80:83], a[120:123], a[72:75], v[80:83]
    buffer_load_dwordx4 v254, s[68:71], s53 offen sc1 lds
    v_mfma_f32_16x16x32_bf16 v[84:87], a[80:83], a[72:75], v[84:87]
    s_waitcnt lgkmcnt(6)
    ds_read_b128 a[120:123], v2 offset:57344
    ds_read_b128 a[124:127], v2 offset:58368
    v_mfma_f32_16x16x32_bf16 v[84:87], a[84:87], a[76:79], v[84:87]
    s_add_u32 s53, s53, 2048
    v_add_u32 v3, v3, v13
    v_mfma_f32_16x16x32_bf16 v[44:47], a[84:87], a[68:71], v[44:47]
    s_cmp_ge_u32 s3, 2
    s_cselect_b32 s20, s22, s20
    s_cselect_b32 s21, s23, s21
    s_lshl_b32 s28, s41, 7
    s_and_b32 s29, s3, 1
    s_mul_i32 s29, s29, 110592
    s_add_u32 s28, s28, s29
    s_add_u32 s12, s20, s28
    s_addc_u32 s13, s21, 0
    s_sub_u32 s14, 2211840, s28
    s_mov_b32 s15, 0x20000
    s_cmp_ge_u32 s32, 27
    s_cmov_b32 s14, 0
    v_mfma_f32_16x16x32_bf16 v[44:47], a[80:83], a[64:67], v[44:47]
    s_add_u32 s28, s40, 49152
    v_mfma_f32_16x16x32_bf16 v[48:51], a[88:91], a[64:67], v[48:51]
    s_waitcnt vmcnt(24) lgkmcnt(6)
    ds_read_b128 a[80:83], v2 offset:59392
    ds_read_b128 a[84:87], v2 offset:60416
    v_mfma_f32_16x16x32_bf16 v[48:51], a[92:95], a[68:71], v[48:51]
    v_add_u32 v25, s28, v2
    v_mfma_f32_16x16x32_bf16 v[88:91], a[92:95], a[76:79], v[88:91]
    v_mfma_f32_16x16x32_bf16 v[88:91], a[88:91], a[72:75], v[88:91]
    v_mfma_f32_16x16x32_bf16 v[92:95], a[96:99], a[8:11], v[92:95]
    s_waitcnt lgkmcnt(6)
    ds_read_b128 a[88:91], v7 offset:10240
    ds_read_b128 a[92:95], v7 offset:11264
    v_mfma_f32_16x16x32_bf16 v[92:95], a[100:103], a[12:15], v[92:95]
    buffer_load_dwordx4 a[200:203], v4, s[8:11], s63 offen offset:0 sc1
    v_mfma_f32_16x16x32_bf16 v[52:55], a[100:103], a[4:7], v[52:55]
    v_mfma_f32_16x16x32_bf16 v[52:55], a[96:99], a[0:3], v[52:55]
    v_mfma_f32_16x16x32_bf16 v[56:59], a[104:107], a[0:3], v[56:59]
    s_waitcnt lgkmcnt(6)
    ds_read_b128 a[96:99], v7 offset:12288
    ds_read_b128 a[100:103], v7 offset:13312
    v_mfma_f32_16x16x32_bf16 v[56:59], a[108:111], a[4:7], v[56:59]
    buffer_load_dwordx4 a[204:207], v4, s[8:11], s63 offen offset:1024 sc1
    v_mfma_f32_16x16x32_bf16 v[96:99], a[108:111], a[12:15], v[96:99]
    v_mfma_f32_16x16x32_bf16 v[96:99], a[104:107], a[8:11], v[96:99]
    v_mfma_f32_16x16x32_bf16 v[100:103], a[112:115], a[8:11], v[100:103]
    s_waitcnt lgkmcnt(6)
    ds_read_b128 a[104:107], v7 offset:14336
    ds_read_b128 a[108:111], v7 offset:15360
    v_mfma_f32_16x16x32_bf16 v[100:103], a[116:119], a[12:15], v[100:103]
    buffer_load_dwordx4 a[72:75], v5, s[8:11], s63 offen offset:0 sc1
    v_mfma_f32_16x16x32_bf16 v[60:63], a[116:119], a[4:7], v[60:63]
    v_mfma_f32_16x16x32_bf16 v[60:63], a[112:115], a[0:3], v[60:63]
    v_mfma_f32_16x16x32_bf16 v[64:67], a[120:123], a[0:3], v[64:67]
    s_waitcnt lgkmcnt(6)
    ds_read_b128 a[112:115], v7 offset:16384
    ds_read_b128 a[116:119], v7 offset:17408
    v_mfma_f32_16x16x32_bf16 v[64:67], a[124:127], a[4:7], v[64:67]
    buffer_load_dwordx4 a[76:79], v5, s[8:11], s63 offen offset:1024 sc1
    v_mfma_f32_16x16x32_bf16 v[104:107], a[124:127], a[12:15], v[104:107]
    s_add_u32 s63, s63, 2048
    s_add_u32 m0, s55, 20480
    v_mfma_f32_16x16x32_bf16 v[104:107], a[120:123], a[8:11], v[104:107]
    v_mfma_f32_16x16x32_bf16 v[108:111], a[80:83], a[8:11], v[108:111]
    s_waitcnt vmcnt(55) lgkmcnt(6)
    ds_read_b128 a[120:123], v7 offset:18432
    ds_read_b128 a[124:127], v7 offset:19456
    v_mfma_f32_16x16x32_bf16 v[108:111], a[84:87], a[12:15], v[108:111]
    s_barrier
    v_mfma_f32_16x16x32_bf16 v[68:71], a[84:87], a[4:7], v[68:71]
    buffer_load_dwordx4 v250, s[68:71], s53 offen sc1 lds
    v_mfma_f32_16x16x32_bf16 v[68:71], a[80:83], a[0:3], v[68:71]
    s_add_u32 m0, s55, 21504
    v_mfma_f32_16x16x32_bf16 v[32:35], a[88:91], a[0:3], v[32:35]
    s_waitcnt lgkmcnt(6)
    ds_read_b128 a[80:83], v6 offset:0
    ds_read_b128 a[84:87], v6 offset:1024
    v_mfma_f32_16x16x32_bf16 v[32:35], a[92:95], a[4:7], v[32:35]
    buffer_load_dwordx4 v251, s[68:71], s53 offen sc1 lds
    v_mfma_f32_16x16x32_bf16 v[72:75], a[92:95], a[12:15], v[72:75]
    s_add_u32 m0, s55, 22528
    v_mfma_f32_16x16x32_bf16 v[72:75], a[88:91], a[8:11], v[72:75]
    buffer_load_dwordx4 v252, s[68:71], s53 offen sc1 lds
    v_mfma_f32_16x16x32_bf16 v[76:79], a[96:99], a[8:11], v[76:79]
    s_waitcnt lgkmcnt(6)
    ds_read_b128 a[88:91], v6 offset:2048
    ds_read_b128 a[92:95], v6 offset:3072
    v_mfma_f32_16x16x32_bf16 v[76:79], a[100:103], a[12:15], v[76:79]
    s_add_u32 m0, s55, 23552
    v_mfma_f32_16x16x32_bf16 v[36:39], a[100:103], a[4:7], v[36:39]
    v_mfma_f32_16x16x32_bf16 v[36:39], a[96:99], a[0:3], v[36:39]
    buffer_load_dwordx4 v253, s[68:71], s53 offen sc1 lds
    v_mfma_f32_16x16x32_bf16 v[40:43], a[104:107], a[0:3], v[40:43]
    s_waitcnt lgkmcnt(6)
    ds_read_b128 a[96:99], v6 offset:4096
    ds_read_b128 a[100:103], v6 offset:5120
    v_mfma_f32_16x16x32_bf16 v[40:43], a[108:111], a[4:7], v[40:43]
    s_add_u32 m0, s55, 24576
    v_mfma_f32_16x16x32_bf16 v[80:83], a[108:111], a[12:15], v[80:83]
    v_mfma_f32_16x16x32_bf16 v[80:83], a[104:107], a[8:11], v[80:83]
    buffer_load_dwordx4 v254, s[68:71], s53 offen sc1 lds
    v_mfma_f32_16x16x32_bf16 v[84:87], a[112:115], a[8:11], v[84:87]
    s_waitcnt lgkmcnt(6)
    ds_read_b128 a[104:107], v6 offset:6144
    ds_read_b128 a[108:111], v6 offset:7168
    v_mfma_f32_16x16x32_bf16 v[84:87], a[116:119], a[12:15], v[84:87]
    s_add_u32 s53, s53, 2048
    v_mfma_f32_16x16x32_bf16 v[44:47], a[116:119], a[4:7], v[44:47]
    v_mfma_f32_16x16x32_bf16 v[44:47], a[112:115], a[0:3], v[44:47]
    v_mfma_f32_16x16x32_bf16 v[48:51], a[120:123], a[0:3], v[48:51]
    s_waitcnt vmcnt(27) lgkmcnt(6)
    ds_read_b128 a[112:115], v6 offset:8192
    ds_read_b128 a[116:119], v6 offset:9216
    v_mfma_f32_16x16x32_bf16 v[48:51], a[124:127], a[4:7], v[48:51]
    v_mfma_f32_16x16x32_bf16 v[88:91], a[124:127], a[12:15], v[88:91]
    v_mfma_f32_16x16x32_bf16 v[88:91], a[120:123], a[8:11], v[88:91]
    v_mfma_f32_16x16x32_bf16 v[92:95], a[80:83], a[24:27], v[92:95]
    s_waitcnt lgkmcnt(6)
    ds_read_b128 a[120:123], v7 offset:20480
    ds_read_b128 a[124:127], v7 offset:21504
    v_mfma_f32_16x16x32_bf16 v[92:95], a[84:87], a[28:31], v[92:95]
    buffer_load_dwordx4 a[208:211], v4, s[8:11], s63 offen offset:0 sc1
    v_mfma_f32_16x16x32_bf16 v[52:55], a[84:87], a[20:23], v[52:55]
    v_mfma_f32_16x16x32_bf16 v[52:55], a[80:83], a[16:19], v[52:55]
    v_mfma_f32_16x16x32_bf16 v[56:59], a[88:91], a[16:19], v[56:59]
    s_waitcnt lgkmcnt(6)
    ds_read_b128 a[80:83], v7 offset:22528
    ds_read_b128 a[84:87], v7 offset:23552
    v_mfma_f32_16x16x32_bf16 v[56:59], a[92:95], a[20:23], v[56:59]
    buffer_load_dwordx4 a[212:215], v4, s[8:11], s63 offen offset:1024 sc1
    v_mfma_f32_16x16x32_bf16 v[96:99], a[92:95], a[28:31], v[96:99]
    v_mfma_f32_16x16x32_bf16 v[96:99], a[88:91], a[24:27], v[96:99]
    v_mfma_f32_16x16x32_bf16 v[100:103], a[96:99], a[24:27], v[100:103]
    s_waitcnt lgkmcnt(6)
    ds_read_b128 a[88:91], v7 offset:24576
    ds_read_b128 a[92:95], v7 offset:25600
    v_mfma_f32_16x16x32_bf16 v[100:103], a[100:103], a[28:31], v[100:103]
    buffer_load_dwordx4 a[8:11], v5, s[8:11], s63 offen offset:0 sc1
    v_mfma_f32_16x16x32_bf16 v[60:63], a[100:103], a[20:23], v[60:63]
    v_mfma_f32_16x16x32_bf16 v[60:63], a[96:99], a[16:19], v[60:63]
    v_mfma_f32_16x16x32_bf16 v[64:67], a[104:107], a[16:19], v[64:67]
    s_waitcnt lgkmcnt(6)
    ds_read_b128 a[96:99], v7 offset:26624
    ds_read_b128 a[100:103], v7 offset:27648
    v_mfma_f32_16x16x32_bf16 v[64:67], a[108:111], a[20:23], v[64:67]
    buffer_load_dwordx4 a[12:15], v5, s[8:11], s63 offen offset:1024 sc1
    v_mfma_f32_16x16x32_bf16 v[104:107], a[108:111], a[28:31], v[104:107]
    s_add_u32 s63, s63, 2048
    s_add_u32 m0, s55, 30720
    v_mfma_f32_16x16x32_bf16 v[104:107], a[104:107], a[24:27], v[104:107]
    v_mfma_f32_16x16x32_bf16 v[108:111], a[112:115], a[24:27], v[108:111]
    s_waitcnt lgkmcnt(6)
    ds_read_b128 a[104:107], v7 offset:28672
    ds_read_b128 a[108:111], v7 offset:29696
    v_mfma_f32_16x16x32_bf16 v[108:111], a[116:119], a[28:31], v[108:111]
    buffer_load_dwordx4 v250, s[68:71], s53 offen sc1 lds
    v_mfma_f32_16x16x32_bf16 v[68:71], a[116:119], a[20:23], v[68:71]
    s_add_u32 m0, s55, 31744
    v_mfma_f32_16x16x32_bf16 v[68:71], a[112:115], a[16:19], v[68:71]
    buffer_load_dwordx4 v251, s[68:71], s53 offen sc1 lds
    v_mfma_f32_16x16x32_bf16 v[32:35], a[120:123], a[16:19], v[32:35]
    s_waitcnt lgkmcnt(6)
    ds_read_b128 a[112:115], v6 offset:10240
    ds_read_b128 a[116:119], v6 offset:11264
    v_mfma_f32_16x16x32_bf16 v[32:35], a[124:127], a[20:23], v[32:35]
    s_add_u32 m0, s55, 32768
    v_mfma_f32_16x16x32_bf16 v[72:75], a[124:127], a[28:31], v[72:75]
    v_mfma_f32_16x16x32_bf16 v[72:75], a[120:123], a[24:27], v[72:75]
    buffer_load_dwordx4 v252, s[68:71], s53 offen sc1 lds
    v_mfma_f32_16x16x32_bf16 v[76:79], a[80:83], a[24:27], v[76:79]
    s_waitcnt lgkmcnt(6)
    ds_read_b128 a[120:123], v6 offset:12288
    ds_read_b128 a[124:127], v6 offset:13312
    v_mfma_f32_16x16x32_bf16 v[76:79], a[84:87], a[28:31], v[76:79]
    s_add_u32 m0, s55, 33792
    v_mfma_f32_16x16x32_bf16 v[36:39], a[84:87], a[20:23], v[36:39]
    v_mfma_f32_16x16x32_bf16 v[36:39], a[80:83], a[16:19], v[36:39]
    buffer_load_dwordx4 v253, s[68:71], s53 offen sc1 lds
    v_mfma_f32_16x16x32_bf16 v[40:43], a[88:91], a[16:19], v[40:43]
    s_waitcnt lgkmcnt(6)
    ds_read_b128 a[80:83], v6 offset:14336
    ds_read_b128 a[84:87], v6 offset:15360
    v_mfma_f32_16x16x32_bf16 v[40:43], a[92:95], a[20:23], v[40:43]
    s_add_u32 m0, s55, 34816
    v_mfma_f32_16x16x32_bf16 v[80:83], a[92:95], a[28:31], v[80:83]
    v_mfma_f32_16x16x32_bf16 v[80:83], a[88:91], a[24:27], v[80:83]
    buffer_load_dwordx4 v254, s[68:71], s53 offen sc1 lds
    v_mfma_f32_16x16x32_bf16 v[84:87], a[96:99], a[24:27], v[84:87]
    s_waitcnt lgkmcnt(6)
    ds_read_b128 a[88:91], v6 offset:16384
    ds_read_b128 a[92:95], v6 offset:17408
    v_mfma_f32_16x16x32_bf16 v[84:87], a[100:103], a[28:31], v[84:87]
    s_add_u32 s53, s53, 2048
    v_mfma_f32_16x16x32_bf16 v[44:47], a[100:103], a[20:23], v[44:47]
    v_mfma_f32_16x16x32_bf16 v[44:47], a[96:99], a[16:19], v[44:47]
    v_mfma_f32_16x16x32_bf16 v[48:51], a[104:107], a[16:19], v[48:51]
    s_waitcnt vmcnt(27) lgkmcnt(6)
    ds_read_b128 a[96:99], v6 offset:18432
    ds_read_b128 a[100:103], v6 offset:19456
    v_mfma_f32_16x16x32_bf16 v[48:51], a[108:111], a[20:23], v[48:51]
    v_mfma_f32_16x16x32_bf16 v[88:91], a[108:111], a[28:31], v[88:91]
    v_mfma_f32_16x16x32_bf16 v[88:91], a[104:107], a[24:27], v[88:91]
    v_mfma_f32_16x16x32_bf16 v[92:95], a[112:115], a[40:43], v[92:95]
    s_waitcnt lgkmcnt(6)
    ds_read_b128 a[104:107], v7 offset:30720
    ds_read_b128 a[108:111], v7 offset:31744
    v_mfma_f32_16x16x32_bf16 v[92:95], a[116:119], a[44:47], v[92:95]
    buffer_load_dwordx4 a[216:219], v4, s[8:11], s63 offen offset:0 sc1
    v_mfma_f32_16x16x32_bf16 v[52:55], a[116:119], a[36:39], v[52:55]
    v_mfma_f32_16x16x32_bf16 v[52:55], a[112:115], a[32:35], v[52:55]
    v_mfma_f32_16x16x32_bf16 v[56:59], a[120:123], a[32:35], v[56:59]
    s_waitcnt lgkmcnt(6)
    ds_read_b128 a[112:115], v7 offset:32768
    ds_read_b128 a[116:119], v7 offset:33792
    v_mfma_f32_16x16x32_bf16 v[56:59], a[124:127], a[36:39], v[56:59]
    buffer_load_dwordx4 a[220:223], v4, s[8:11], s63 offen offset:1024 sc1
    v_mfma_f32_16x16x32_bf16 v[96:99], a[124:127], a[44:47], v[96:99]
    v_mfma_f32_16x16x32_bf16 v[96:99], a[120:123], a[40:43], v[96:99]
    v_mfma_f32_16x16x32_bf16 v[100:103], a[80:83], a[40:43], v[100:103]
    s_waitcnt lgkmcnt(6)
    ds_read_b128 a[120:123], v7 offset:34816
    ds_read_b128 a[124:127], v7 offset:35840
    v_mfma_f32_16x16x32_bf16 v[100:103], a[84:87], a[44:47], v[100:103]
    buffer_load_dwordx4 a[24:27], v5, s[8:11], s63 offen offset:0 sc1
    v_mfma_f32_16x16x32_bf16 v[60:63], a[84:87], a[36:39], v[60:63]
    v_mfma_f32_16x16x32_bf16 v[60:63], a[80:83], a[32:35], v[60:63]
    v_mfma_f32_16x16x32_bf16 v[64:67], a[88:91], a[32:35], v[64:67]
    s_waitcnt lgkmcnt(6)
    ds_read_b128 a[80:83], v7 offset:36864
    ds_read_b128 a[84:87], v7 offset:37888
    v_mfma_f32_16x16x32_bf16 v[64:67], a[92:95], a[36:39], v[64:67]
    buffer_load_dwordx4 a[28:31], v5, s[8:11], s63 offen offset:1024 sc1
    v_mfma_f32_16x16x32_bf16 v[104:107], a[92:95], a[44:47], v[104:107]
    s_add_u32 s63, s63, 2048
    s_add_u32 m0, s55, 40960
    v_mfma_f32_16x16x32_bf16 v[104:107], a[88:91], a[40:43], v[104:107]
    v_mfma_f32_16x16x32_bf16 v[108:111], a[96:99], a[40:43], v[108:111]
    s_waitcnt vmcnt(22) lgkmcnt(6)
    ds_read_b128 a[88:91], v7 offset:38912
    ds_read_b128 a[92:95], v7 offset:39936
    v_mfma_f32_16x16x32_bf16 v[108:111], a[100:103], a[44:47], v[108:111]
    s_barrier
    v_mfma_f32_16x16x32_bf16 v[68:71], a[100:103], a[36:39], v[68:71]
    buffer_load_dwordx4 v250, s[68:71], s53 offen sc1 lds
    v_mfma_f32_16x16x32_bf16 v[68:71], a[96:99], a[32:35], v[68:71]
    s_add_u32 m0, s55, 41984
    v_mfma_f32_16x16x32_bf16 v[32:35], a[104:107], a[32:35], v[32:35]
    s_waitcnt lgkmcnt(6)
    ds_read_b128 a[96:99], v2 offset:0
    ds_read_b128 a[100:103], v2 offset:1024
    v_mfma_f32_16x16x32_bf16 v[32:35], a[108:111], a[36:39], v[32:35]
    buffer_load_dwordx4 v251, s[68:71], s53 offen sc1 lds
    v_mfma_f32_16x16x32_bf16 v[72:75], a[108:111], a[44:47], v[72:75]
    s_add_u32 m0, s55, 43008
    v_mfma_f32_16x16x32_bf16 v[72:75], a[104:107], a[40:43], v[72:75]
    buffer_load_dwordx4 v252, s[68:71], s53 offen sc1 lds
    v_mfma_f32_16x16x32_bf16 v[76:79], a[112:115], a[40:43], v[76:79]
    s_waitcnt lgkmcnt(6)
    ds_read_b128 a[104:107], v2 offset:2048
    ds_read_b128 a[108:111], v2 offset:3072
    v_mfma_f32_16x16x32_bf16 v[76:79], a[116:119], a[44:47], v[76:79]
    s_add_u32 m0, s55, 44032
    v_mfma_f32_16x16x32_bf16 v[36:39], a[116:119], a[36:39], v[36:39]
    v_mfma_f32_16x16x32_bf16 v[36:39], a[112:115], a[32:35], v[36:39]
    buffer_load_dwordx4 v253, s[68:71], s53 offen sc1 lds
    v_mfma_f32_16x16x32_bf16 v[40:43], a[120:123], a[32:35], v[40:43]
    s_waitcnt lgkmcnt(6)
    ds_read_b128 a[112:115], v2 offset:4096
    ds_read_b128 a[116:119], v2 offset:5120
    v_mfma_f32_16x16x32_bf16 v[40:43], a[124:127], a[36:39], v[40:43]
    s_add_u32 m0, s55, 45056
    v_mfma_f32_16x16x32_bf16 v[80:83], a[124:127], a[44:47], v[80:83]
    v_mfma_f32_16x16x32_bf16 v[80:83], a[120:123], a[40:43], v[80:83]
    buffer_load_dwordx4 v254, s[68:71], s53 offen sc1 lds
    v_mfma_f32_16x16x32_bf16 v[84:87], a[80:83], a[40:43], v[84:87]
    s_waitcnt lgkmcnt(6)
    ds_read_b128 a[120:123], v2 offset:6144
    ds_read_b128 a[124:127], v2 offset:7168
    v_mfma_f32_16x16x32_bf16 v[84:87], a[84:87], a[44:47], v[84:87]
    s_add_u32 s53, s53, 2048
    v_mfma_f32_16x16x32_bf16 v[44:47], a[84:87], a[36:39], v[44:47]
    v_mfma_f32_16x16x32_bf16 v[44:47], a[80:83], a[32:35], v[44:47]
    v_mfma_f32_16x16x32_bf16 v[48:51], a[88:91], a[32:35], v[48:51]
    s_waitcnt vmcnt(32) lgkmcnt(6)
    ds_read_b128 a[80:83], v2 offset:8192
    ds_read_b128 a[84:87], v2 offset:9216
    v_mfma_f32_16x16x32_bf16 v[48:51], a[92:95], a[36:39], v[48:51]
    v_mfma_f32_16x16x32_bf16 v[88:91], a[92:95], a[44:47], v[88:91]
    v_mfma_f32_16x16x32_bf16 v[88:91], a[88:91], a[40:43], v[88:91]
    v_mfma_f32_16x16x32_bf16 v[92:95], a[96:99], a[56:59], v[92:95]
    s_waitcnt lgkmcnt(6)
    ds_read_b128 a[88:91], v6 offset:20480
    ds_read_b128 a[92:95], v6 offset:21504
    v_mfma_f32_16x16x32_bf16 v[92:95], a[100:103], a[60:63], v[92:95]
    buffer_load_dwordx4 v[148:151], v4, s[8:11], s63 offen offset:0 sc1
    v_mfma_f32_16x16x32_bf16 v[52:55], a[100:103], a[196:199], v[52:55]
    v_mfma_f32_16x16x32_bf16 v[52:55], a[96:99], a[192:195], v[52:55]
    buffer_load_dwordx4 v[152:155], v4, s[8:11], s63 offen offset:1024 sc1
    v_mfma_f32_16x16x32_bf16 v[56:59], a[104:107], a[192:195], v[56:59]
    s_waitcnt lgkmcnt(6)
    ds_read_b128 a[96:99], v6 offset:22528
    ds_read_b128 a[100:103], v6 offset:23552
    v_mfma_f32_16x16x32_bf16 v[56:59], a[108:111], a[196:199], v[56:59]
    v_mfma_f32_16x16x32_bf16 v[96:99], a[108:111], a[60:63], v[96:99]
    buffer_load_dwordx4 a[40:43], v5, s[8:11], s63 offen offset:0 sc1
    v_mfma_f32_16x16x32_bf16 v[96:99], a[104:107], a[56:59], v[96:99]
    v_mfma_f32_16x16x32_bf16 v[100:103], a[112:115], a[56:59], v[100:103]
    s_waitcnt lgkmcnt(6)
    ds_read_b128 a[104:107], v6 offset:24576
    ds_read_b128 a[108:111], v6 offset:25600
    v_mfma_f32_16x16x32_bf16 v[100:103], a[116:119], a[60:63], v[100:103]
    buffer_load_dwordx4 a[44:47], v5, s[8:11], s63 offen offset:1024 sc1
    v_mfma_f32_16x16x32_bf16 v[60:63], a[116:119], a[196:199], v[60:63]
    s_add_u32 s63, s63, 2048
    s_add_u32 m0, s55, 51200
    v_mfma_f32_16x16x32_bf16 v[60:63], a[112:115], a[192:195], v[60:63]
    buffer_load_dwordx4 v250, s[68:71], s53 offen sc1 lds
    v_mfma_f32_16x16x32_bf16 v[64:67], a[120:123], a[192:195], v[64:67]
    s_waitcnt lgkmcnt(6)
    ds_read_b128 a[112:115], v6 offset:26624
    ds_read_b128 a[116:119], v6 offset:27648
    v_mfma_f32_16x16x32_bf16 v[64:67], a[124:127], a[196:199], v[64:67]
    s_add_u32 m0, s55, 52224
    v_mfma_f32_16x16x32_bf16 v[104:107], a[124:127], a[60:63], v[104:107]
    buffer_load_dwordx4 v251, s[68:71], s53 offen sc1 lds
    v_mfma_f32_16x16x32_bf16 v[104:107], a[120:123], a[56:59], v[104:107]
    s_add_u32 m0, s55, 53248
    v_mfma_f32_16x16x32_bf16 v[108:111], a[80:83], a[56:59], v[108:111]
    s_waitcnt lgkmcnt(6)
    ds_read_b128 a[120:123], v6 offset:28672
    ds_read_b128 a[124:127], v6 offset:29696
    v_mfma_f32_16x16x32_bf16 v[108:111], a[84:87], a[60:63], v[108:111]
    buffer_load_dwordx4 v252, s[68:71], s53 offen sc1 lds
    v_mfma_f32_16x16x32_bf16 v[68:71], a[84:87], a[196:199], v[68:71]
    s_add_u32 m0, s55, 54272
    v_mfma_f32_16x16x32_bf16 v[68:71], a[80:83], a[192:195], v[68:71]
    buffer_load_dwordx4 v253, s[68:71], s53 offen sc1 lds
    v_mfma_f32_16x16x32_bf16 v[72:75], a[92:95], a[60:63], v[72:75]
    s_waitcnt lgkmcnt(6)
    ds_read_b128 a[80:83], v2 offset:10240
    ds_read_b128 a[84:87], v2 offset:11264
    v_mfma_f32_16x16x32_bf16 v[72:75], a[88:91], a[56:59], v[72:75]
    s_add_u32 m0, s55, 55296
    v_mfma_f32_16x16x32_bf16 v[76:79], a[96:99], a[56:59], v[76:79]
    s_waitcnt lgkmcnt(6)
    ds_read_b128 a[88:91], v2 offset:12288
    ds_read_b128 a[92:95], v2 offset:13312
    v_mfma_f32_16x16x32_bf16 v[76:79], a[100:103], a[60:63], v[76:79]
    buffer_load_dwordx4 v254, s[68:71], s53 offen sc1 lds
    v_mfma_f32_16x16x32_bf16 v[80:83], a[108:111], a[60:63], v[80:83]
    s_waitcnt lgkmcnt(6)
    ds_read_b128 a[96:99], v2 offset:14336
    ds_read_b128 a[100:103], v2 offset:15360
    v_mfma_f32_16x16x32_bf16 v[80:83], a[104:107], a[56:59], v[80:83]
    s_add_u32 s53, s53, 2048
    v_mfma_f32_16x16x32_bf16 v[84:87], a[112:115], a[56:59], v[84:87]
    s_waitcnt lgkmcnt(6)
    ds_read_b128 a[104:107], v2 offset:16384
    ds_read_b128 a[108:111], v2 offset:17408
    v_mfma_f32_16x16x32_bf16 v[84:87], a[116:119], a[60:63], v[84:87]
    v_mfma_f32_16x16x32_bf16 v[88:91], a[124:127], a[60:63], v[88:91]
    s_waitcnt vmcnt(32) lgkmcnt(6)
    ds_read_b128 a[112:115], v2 offset:18432
    ds_read_b128 a[116:119], v2 offset:19456
    v_mfma_f32_16x16x32_bf16 v[88:91], a[120:123], a[56:59], v[88:91]
    v_mfma_f32_16x16x32_bf16 v[92:95], a[80:83], a[72:75], v[92:95]
    s_waitcnt lgkmcnt(6)
    ds_read_b128 a[120:123], v6 offset:30720
    ds_read_b128 a[124:127], v6 offset:31744
    v_mfma_f32_16x16x32_bf16 v[92:95], a[84:87], a[76:79], v[92:95]
    buffer_load_dwordx4 v[156:159], v4, s[8:11], s63 offen offset:0 sc1
    v_mfma_f32_16x16x32_bf16 v[52:55], a[84:87], a[204:207], v[52:55]
    v_mfma_f32_16x16x32_bf16 v[52:55], a[80:83], a[200:203], v[52:55]
    buffer_load_dwordx4 v[160:163], v4, s[8:11], s63 offen offset:1024 sc1
    v_mfma_f32_16x16x32_bf16 v[56:59], a[88:91], a[200:203], v[56:59]
    s_waitcnt lgkmcnt(6)
    ds_read_b128 a[80:83], v6 offset:32768
    ds_read_b128 a[84:87], v6 offset:33792
    v_mfma_f32_16x16x32_bf16 v[56:59], a[92:95], a[204:207], v[56:59]
    v_mfma_f32_16x16x32_bf16 v[96:99], a[92:95], a[76:79], v[96:99]
    buffer_load_dwordx4 a[56:59], v5, s[8:11], s63 offen offset:0 sc1
    v_mfma_f32_16x16x32_bf16 v[96:99], a[88:91], a[72:75], v[96:99]
    v_mfma_f32_16x16x32_bf16 v[100:103], a[96:99], a[72:75], v[100:103]
    s_waitcnt lgkmcnt(6)
    ds_read_b128 a[88:91], v6 offset:34816
    ds_read_b128 a[92:95], v6 offset:35840
    v_mfma_f32_16x16x32_bf16 v[100:103], a[100:103], a[76:79], v[100:103]
    buffer_load_dwordx4 a[60:63], v5, s[8:11], s63 offen offset:1024 sc1
    v_mfma_f32_16x16x32_bf16 v[60:63], a[100:103], a[204:207], v[60:63]
    s_add_u32 s63, s63, 2048
    s_add_u32 m0, s55, 61440
    v_mfma_f32_16x16x32_bf16 v[60:63], a[96:99], a[200:203], v[60:63]
    buffer_load_dwordx4 v250, s[68:71], s53 offen sc1 lds
    v_mfma_f32_16x16x32_bf16 v[64:67], a[104:107], a[200:203], v[64:67]
    s_waitcnt lgkmcnt(6)
    ds_read_b128 a[96:99], v6 offset:36864
    ds_read_b128 a[100:103], v6 offset:37888
    v_mfma_f32_16x16x32_bf16 v[64:67], a[108:111], a[204:207], v[64:67]
    s_add_u32 m0, s55, 62464
    v_mfma_f32_16x16x32_bf16 v[104:107], a[108:111], a[76:79], v[104:107]
    buffer_load_dwordx4 v251, s[68:71], s53 offen sc1 lds
    v_mfma_f32_16x16x32_bf16 v[104:107], a[104:107], a[72:75], v[104:107]
    s_add_u32 m0, s55, 63488
    v_mfma_f32_16x16x32_bf16 v[108:111], a[112:115], a[72:75], v[108:111]
    s_waitcnt vmcnt(24) lgkmcnt(6)
    ds_read_b128 a[104:107], v6 offset:38912
    ds_read_b128 a[108:111], v6 offset:39936
    v_mfma_f32_16x16x32_bf16 v[108:111], a[116:119], a[76:79], v[108:111]
    s_barrier
    v_mfma_f32_16x16x32_bf16 v[68:71], a[116:119], a[204:207], v[68:71]
    buffer_load_dwordx4 v252, s[68:71], s53 offen sc1 lds
    v_mfma_f32_16x16x32_bf16 v[68:71], a[112:115], a[200:203], v[68:71]
    s_add_u32 m0, s55, 64512
    v_mfma_f32_16x16x32_bf16 v[72:75], a[124:127], a[76:79], v[72:75]
    s_waitcnt lgkmcnt(6)
    ds_read_b128 a[112:115], v2 offset:20480
    ds_read_b128 a[116:119], v2 offset:21504
    v_mfma_f32_16x16x32_bf16 v[72:75], a[120:123], a[72:75], v[72:75]
    buffer_load_dwordx4 v253, s[68:71], s53 offen sc1 lds
    v_mfma_f32_16x16x32_bf16 v[76:79], a[80:83], a[72:75], v[76:79]
    s_waitcnt lgkmcnt(6)
    ds_read_b128 a[120:123], v2 offset:22528
    ds_read_b128 a[124:127], v2 offset:23552
    v_mfma_f32_16x16x32_bf16 v[76:79], a[84:87], a[76:79], v[76:79]
    s_add_u32 m0, s55, 65536
    v_mfma_f32_16x16x32_bf16 v[80:83], a[92:95], a[76:79], v[80:83]
    s_waitcnt lgkmcnt(6)
    ds_read_b128 a[80:83], v2 offset:24576
    ds_read_b128 a[84:87], v2 offset:25600
    v_mfma_f32_16x16x32_bf16 v[80:83], a[88:91], a[72:75], v[80:83]
    buffer_load_dwordx4 v254, s[68:71], s53 offen sc1 lds
    v_mfma_f32_16x16x32_bf16 v[84:87], a[96:99], a[72:75], v[84:87]
    s_waitcnt lgkmcnt(6)
    ds_read_b128 a[88:91], v2 offset:26624
    ds_read_b128 a[92:95], v2 offset:27648
    v_mfma_f32_16x16x32_bf16 v[84:87], a[100:103], a[76:79], v[84:87]
    s_add_u32 s53, s53, 2048
    v_mfma_f32_16x16x32_bf16 v[88:91], a[108:111], a[76:79], v[88:91]
    s_waitcnt vmcnt(32) lgkmcnt(6)
    ds_read_b128 a[96:99], v2 offset:28672
    ds_read_b128 a[100:103], v2 offset:29696
    v_mfma_f32_16x16x32_bf16 v[88:91], a[104:107], a[72:75], v[88:91]
    v_mfma_f32_16x16x32_bf16 v[92:95], a[112:115], a[8:11], v[92:95]
    s_waitcnt lgkmcnt(6)
    ds_read_b128 a[104:107], v6 offset:40960
    ds_read_b128 a[108:111], v6 offset:41984
    v_mfma_f32_16x16x32_bf16 v[92:95], a[116:119], a[12:15], v[92:95]
    buffer_load_dwordx4 v[164:167], v4, s[8:11], s63 offen offset:0 sc1
    v_mfma_f32_16x16x32_bf16 v[52:55], a[116:119], a[212:215], v[52:55]
    v_mfma_f32_16x16x32_bf16 v[52:55], a[112:115], a[208:211], v[52:55]
    buffer_load_dwordx4 v[168:171], v4, s[8:11], s63 offen offset:1024 sc1
    v_mfma_f32_16x16x32_bf16 v[56:59], a[120:123], a[208:211], v[56:59]
    s_waitcnt lgkmcnt(6)
    ds_read_b128 a[112:115], v6 offset:43008
    ds_read_b128 a[116:119], v6 offset:44032
    v_mfma_f32_16x16x32_bf16 v[56:59], a[124:127], a[212:215], v[56:59]
    v_mfma_f32_16x16x32_bf16 v[96:99], a[124:127], a[12:15], v[96:99]
    buffer_load_dwordx4 a[72:75], v5, s[8:11], s63 offen offset:0 sc1
    v_mfma_f32_16x16x32_bf16 v[96:99], a[120:123], a[8:11], v[96:99]
    v_mfma_f32_16x16x32_bf16 v[100:103], a[80:83], a[8:11], v[100:103]
    s_waitcnt lgkmcnt(6)
    ds_read_b128 a[120:123], v6 offset:45056
    ds_read_b128 a[124:127], v6 offset:46080
    v_mfma_f32_16x16x32_bf16 v[100:103], a[84:87], a[12:15], v[100:103]
    buffer_load_dwordx4 a[76:79], v5, s[8:11], s63 offen offset:1024 sc1
    v_mfma_f32_16x16x32_bf16 v[60:63], a[84:87], a[212:215], v[60:63]
    s_add_u32 s63, s63, 2048
    s_add_u32 m0, s55, 71680
    v_mfma_f32_16x16x32_bf16 v[60:63], a[80:83], a[208:211], v[60:63]
    buffer_load_dwordx4 v250, s[68:71], s53 offen sc1 lds
    v_mfma_f32_16x16x32_bf16 v[64:67], a[88:91], a[208:211], v[64:67]
    s_waitcnt lgkmcnt(6)
    ds_read_b128 a[80:83], v6 offset:47104
    ds_read_b128 a[84:87], v6 offset:48128
    v_mfma_f32_16x16x32_bf16 v[64:67], a[92:95], a[212:215], v[64:67]
    s_add_u32 m0, s55, 72704
    v_mfma_f32_16x16x32_bf16 v[104:107], a[92:95], a[12:15], v[104:107]
    buffer_load_dwordx4 v251, s[68:71], s53 offen sc1 lds
    v_mfma_f32_16x16x32_bf16 v[104:107], a[88:91], a[8:11], v[104:107]
    s_add_u32 m0, s55, 73728
    v_mfma_f32_16x16x32_bf16 v[108:111], a[96:99], a[8:11], v[108:111]
    s_waitcnt lgkmcnt(6)
    ds_read_b128 a[88:91], v6 offset:49152
    ds_read_b128 a[92:95], v6 offset:50176
    v_mfma_f32_16x16x32_bf16 v[108:111], a[100:103], a[12:15], v[108:111]
    buffer_load_dwordx4 v252, s[68:71], s53 offen sc1 lds
    v_mfma_f32_16x16x32_bf16 v[68:71], a[100:103], a[212:215], v[68:71]
    s_add_u32 m0, s55, 74752
    v_mfma_f32_16x16x32_bf16 v[68:71], a[96:99], a[208:211], v[68:71]
    buffer_load_dwordx4 v253, s[68:71], s53 offen sc1 lds
    v_mfma_f32_16x16x32_bf16 v[72:75], a[108:111], a[12:15], v[72:75]
    s_waitcnt lgkmcnt(6)
    ds_read_b128 a[96:99], v2 offset:30720
    ds_read_b128 a[100:103], v2 offset:31744
    v_mfma_f32_16x16x32_bf16 v[72:75], a[104:107], a[8:11], v[72:75]
    s_add_u32 m0, s55, 75776
    v_mfma_f32_16x16x32_bf16 v[76:79], a[112:115], a[8:11], v[76:79]
    s_waitcnt lgkmcnt(6)
    ds_read_b128 a[104:107], v2 offset:32768
    ds_read_b128 a[108:111], v2 offset:33792
    v_mfma_f32_16x16x32_bf16 v[76:79], a[116:119], a[12:15], v[76:79]
    buffer_load_dwordx4 v254, s[68:71], s53 offen sc1 lds
    v_mfma_f32_16x16x32_bf16 v[80:83], a[124:127], a[12:15], v[80:83]
    s_waitcnt lgkmcnt(6)
    ds_read_b128 a[112:115], v2 offset:34816
    ds_read_b128 a[116:119], v2 offset:35840
    v_mfma_f32_16x16x32_bf16 v[80:83], a[120:123], a[8:11], v[80:83]
    s_add_u32 s53, s53, 2048
    v_mfma_f32_16x16x32_bf16 v[84:87], a[80:83], a[8:11], v[84:87]
    s_waitcnt lgkmcnt(6)
    ds_read_b128 a[120:123], v2 offset:36864
    ds_read_b128 a[124:127], v2 offset:37888
    v_mfma_f32_16x16x32_bf16 v[84:87], a[84:87], a[12:15], v[84:87]
    v_mfma_f32_16x16x32_bf16 v[88:91], a[92:95], a[12:15], v[88:91]
    s_waitcnt vmcnt(32) lgkmcnt(6)
    ds_read_b128 a[80:83], v2 offset:38912
    ds_read_b128 a[84:87], v2 offset:39936
    v_mfma_f32_16x16x32_bf16 v[88:91], a[88:91], a[8:11], v[88:91]
    v_mfma_f32_16x16x32_bf16 v[92:95], a[96:99], a[24:27], v[92:95]
    s_waitcnt lgkmcnt(6)
    ds_read_b128 a[88:91], v6 offset:51200
    ds_read_b128 a[92:95], v6 offset:52224
    v_mfma_f32_16x16x32_bf16 v[92:95], a[100:103], a[28:31], v[92:95]
    buffer_load_dwordx4 v[172:175], v4, s[8:11], s63 offen offset:0 sc1
    v_mfma_f32_16x16x32_bf16 v[52:55], a[100:103], a[220:223], v[52:55]
    s_getpc_b64 s[96:97]
KA_pc2:
    s_add_u32 s96, s96, KB_x3-KA_pc2
    s_addc_u32 s97, s97, 0
    s_mov_b32 s98, KA_last-KB_x3
    s_mov_b32 s99, 0x20000
    v_mfma_f32_16x16x32_bf16 v[52:55], a[96:99], a[216:219], v[52:55]
    s_lshr_b32 s60, s2, 3
    s_lshl_b32 s60, s60, 2
    s_add_u32 s60, s60, s3
    v_mfma_f32_16x16x32_bf16 v[56:59], a[104:107], a[216:219], v[56:59]
    s_waitcnt lgkmcnt(6)
    ds_read_b128 a[96:99], v6 offset:53248
    ds_read_b128 a[100:103], v6 offset:54272
    v_mfma_f32_16x16x32_bf16 v[56:59], a[108:111], a[220:223], v[56:59]
    buffer_load_dwordx4 v[176:179], v4, s[8:11], s63 offen offset:1024 sc1
    v_mfma_f32_16x16x32_bf16 v[96:99], a[108:111], a[28:31], v[96:99]
    s_lshl_b32 s60, s60, 7
    v_lshlrev_b32 v22, 14, v1
    v_mfma_f32_16x16x32_bf16 v[96:99], a[104:107], a[24:27], v[96:99]
    buffer_load_dword v255, v22, s[96:99], s60 offen
    v_mfma_f32_16x16x32_bf16 v[100:103], a[112:115], a[24:27], v[100:103]
    s_waitcnt lgkmcnt(6)
    ds_read_b128 a[104:107], v6 offset:55296
    ds_read_b128 a[108:111], v6 offset:56320
    v_mfma_f32_16x16x32_bf16 v[100:103], a[116:119], a[28:31], v[100:103]
    buffer_load_dwordx4 a[8:11], v5, s[8:11], s63 offen offset:0 sc1
    v_mfma_f32_16x16x32_bf16 v[60:63], a[116:119], a[220:223], v[60:63]
    v_mfma_f32_16x16x32_bf16 v[60:63], a[112:115], a[216:219], v[60:63]
    v_mfma_f32_16x16x32_bf16 v[64:67], a[120:123], a[216:219], v[64:67]
    s_waitcnt lgkmcnt(6)
    ds_read_b128 a[112:115], v6 offset:57344
    ds_read_b128 a[116:119], v6 offset:58368
    v_mfma_f32_16x16x32_bf16 v[64:67], a[124:127], a[220:223], v[64:67]
    buffer_load_dwordx4 a[12:15], v5, s[8:11], s63 offen offset:1024 sc1
    v_mfma_f32_16x16x32_bf16 v[104:107], a[124:127], a[28:31], v[104:107]
    s_add_u32 s63, s63, 2048
    v_mfma_f32_16x16x32_bf16 v[104:107], a[120:123], a[24:27], v[104:107]
    v_mfma_f32_16x16x32_bf16 v[108:111], a[80:83], a[24:27], v[108:111]
    s_waitcnt vmcnt(23) lgkmcnt(6)
    ds_read_b128 a[120:123], v6 offset:59392
    ds_read_b128 a[124:127], v6 offset:60416
    v_mfma_f32_16x16x32_bf16 v[108:111], a[84:87], a[28:31], v[108:111]
    s_barrier
    v_mfma_f32_16x16x32_bf16 v[68:71], a[84:87], a[220:223], v[68:71]
    buffer_load_dwordx2 v[184:185], v8, s[16:19], 0 offen offset:0
    v_mfma_f32_16x16x32_bf16 v[68:71], a[80:83], a[216:219], v[68:71]
    v_mfma_f32_16x16x32_bf16 v[72:75], a[92:95], a[28:31], v[72:75]
    s_waitcnt lgkmcnt(6)
    ds_read_b128 a[80:83], v2 offset:40960
    ds_read_b128 a[84:87], v2 offset:41984
    v_mfma_f32_16x16x32_bf16 v[72:75], a[88:91], a[24:27], v[72:75]
    buffer_load_dwordx2 v[186:187], v8, s[16:19], 0 offen offset:32
    v_mfma_f32_16x16x32_bf16 v[76:79], a[96:99], a[24:27], v[76:79]
    s_waitcnt lgkmcnt(6)
    ds_read_b128 a[88:91], v2 offset:43008
    ds_read_b128 a[92:95], v2 offset:44032
    v_mfma_f32_16x16x32_bf16 v[76:79], a[100:103], a[28:31], v[76:79]
    v_mfma_f32_16x16x32_bf16 v[80:83], a[108:111], a[28:31], v[80:83]
    s_waitcnt lgkmcnt(6)
    ds_read_b128 a[96:99], v2 offset:45056
    ds_read_b128 a[100:103], v2 offset:46080
    v_mfma_f32_16x16x32_bf16 v[80:83], a[104:107], a[24:27], v[80:83]
    v_mfma_f32_16x16x32_bf16 v[84:87], a[112:115], a[24:27], v[84:87]
    s_waitcnt lgkmcnt(6)
    ds_read_b128 a[104:107], v2 offset:47104
    ds_read_b128 a[108:111], v2 offset:48128
    v_mfma_f32_16x16x32_bf16 v[84:87], a[116:119], a[28:31], v[84:87]
    v_mfma_f32_16x16x32_bf16 v[88:91], a[124:127], a[28:31], v[88:91]
    s_waitcnt vmcnt(30) lgkmcnt(6)
    ds_read_b128 a[112:115], v2 offset:49152
    ds_read_b128 a[116:119], v2 offset:50176
    v_mfma_f32_16x16x32_bf16 v[88:91], a[120:123], a[24:27], v[88:91]
    v_mfma_f32_16x16x32_bf16 v[92:95], a[80:83], a[40:43], v[92:95]
    s_waitcnt lgkmcnt(6)
    ds_read_b128 a[120:123], v7 offset:0
    ds_read_b128 a[124:127], v7 offset:1024
    v_mfma_f32_16x16x32_bf16 v[92:95], a[84:87], a[44:47], v[92:95]
    s_add_u32 m0, s40, 0
    v_mfma_f32_16x16x32_bf16 v[52:55], a[84:87], v[152:155], v[52:55]
    buffer_load_dwordx4 v3, s[12:15], s34 offen offset:0 lds
    v_mfma_f32_16x16x32_bf16 v[52:55], a[80:83], v[148:151], v[52:55]
    v_mfma_f32_16x16x32_bf16 v[56:59], a[88:91], v[148:151], v[56:59]
    s_waitcnt lgkmcnt(6)
    ds_read_b128 a[80:83], v7 offset:2048
    ds_read_b128 a[84:87], v7 offset:3072
    v_mfma_f32_16x16x32_bf16 v[56:59], a[92:95], v[152:155], v[56:59]
    buffer_load_dwordx4 v3, s[12:15], s35 offen offset:1024 lds
    v_mfma_f32_16x16x32_bf16 v[96:99], a[92:95], a[44:47], v[96:99]
    v_mfma_f32_16x16x32_bf16 v[96:99], a[88:91], a[40:43], v[96:99]
    v_mfma_f32_16x16x32_bf16 v[100:103], a[96:99], a[40:43], v[100:103]
    s_waitcnt lgkmcnt(6)
    ds_read_b128 a[88:91], v7 offset:4096
    ds_read_b128 a[92:95], v7 offset:5120
    v_mfma_f32_16x16x32_bf16 v[100:103], a[100:103], a[44:47], v[100:103]
    v_mfma_f32_16x16x32_bf16 v[60:63], a[100:103], v[152:155], v[60:63]
    buffer_load_dwordx4 v3, s[12:15], s36 offen offset:2048 lds
    v_mfma_f32_16x16x32_bf16 v[60:63], a[96:99], v[148:151], v[60:63]
    v_mfma_f32_16x16x32_bf16 v[64:67], a[104:107], v[148:151], v[64:67]
    s_waitcnt lgkmcnt(6)
    ds_read_b128 a[96:99], v7 offset:6144
    ds_read_b128 a[100:103], v7 offset:7168
    v_mfma_f32_16x16x32_bf16 v[64:67], a[108:111], v[152:155], v[64:67]
    v_mfma_f32_16x16x32_bf16 v[104:107], a[108:111], a[44:47], v[104:107]
    v_mfma_f32_16x16x32_bf16 v[104:107], a[104:107], a[40:43], v[104:107]
    buffer_load_dwordx4 v3, s[12:15], s37 offen offset:3072 lds
    v_mfma_f32_16x16x32_bf16 v[108:111], a[112:115], a[40:43], v[108:111]
    s_waitcnt lgkmcnt(6)
    ds_read_b128 a[104:107], v7 offset:8192
    ds_read_b128 a[108:111], v7 offset:9216
    v_mfma_f32_16x16x32_bf16 v[108:111], a[116:119], a[44:47], v[108:111]
    v_add_u32 v3, 221184, v3
    v_mfma_f32_16x16x32_bf16 v[68:71], a[116:119], v[152:155], v[68:71]
    v_mfma_f32_16x16x32_bf16 v[68:71], a[112:115], v[148:151], v[68:71]
    v_mfma_f32_16x16x32_bf16 v[72:75], a[124:127], a[44:47], v[72:75]
    s_waitcnt lgkmcnt(6)
    ds_read_b128 a[112:115], v2 offset:51200
    ds_read_b128 a[116:119], v2 offset:52224
    v_mfma_f32_16x16x32_bf16 v[72:75], a[120:123], a[40:43], v[72:75]
    buffer_load_dwordx2 v[188:189], v8, s[16:19], 0 offen offset:64
    v_mfma_f32_16x16x32_bf16 v[76:79], a[80:83], a[40:43], v[76:79]
    s_waitcnt lgkmcnt(6)
    ds_read_b128 a[120:123], v2 offset:53248
    ds_read_b128 a[124:127], v2 offset:54272
    v_mfma_f32_16x16x32_bf16 v[76:79], a[84:87], a[44:47], v[76:79]
    v_mfma_f32_16x16x32_bf16 v[80:83], a[92:95], a[44:47], v[80:83]
    s_waitcnt lgkmcnt(6)
    ds_read_b128 a[80:83], v2 offset:55296
    ds_read_b128 a[84:87], v2 offset:56320
    v_mfma_f32_16x16x32_bf16 v[80:83], a[88:91], a[40:43], v[80:83]
    v_mfma_f32_16x16x32_bf16 v[84:87], a[96:99], a[40:43], v[84:87]
    s_waitcnt lgkmcnt(6)
    ds_read_b128 a[88:91], v2 offset:57344
    ds_read_b128 a[92:95], v2 offset:58368
    v_mfma_f32_16x16x32_bf16 v[84:87], a[100:103], a[44:47], v[84:87]
    v_mfma_f32_16x16x32_bf16 v[88:91], a[108:111], a[44:47], v[88:91]
    s_waitcnt vmcnt(26) lgkmcnt(6)
    ds_read_b128 a[96:99], v2 offset:59392
    ds_read_b128 a[100:103], v2 offset:60416
    v_mfma_f32_16x16x32_bf16 v[88:91], a[104:107], a[40:43], v[88:91]
    v_mfma_f32_16x16x32_bf16 v[92:95], a[112:115], a[56:59], v[92:95]
    s_waitcnt lgkmcnt(6)
    ds_read_b128 a[104:107], v7 offset:10240
    ds_read_b128 a[108:111], v7 offset:11264
    v_mfma_f32_16x16x32_bf16 v[92:95], a[116:119], a[60:63], v[92:95]
    buffer_load_dwordx2 v[190:191], v8, s[16:19], 0 offen offset:96
    v_mfma_f32_16x16x32_bf16 v[52:55], a[116:119], v[160:163], v[52:55]
    v_mfma_f32_16x16x32_bf16 v[52:55], a[112:115], v[156:159], v[52:55]
    v_mfma_f32_16x16x32_bf16 v[56:59], a[120:123], v[156:159], v[56:59]
    s_waitcnt lgkmcnt(6)
    ds_read_b128 a[112:115], v7 offset:12288
    ds_read_b128 a[116:119], v7 offset:13312
    v_mfma_f32_16x16x32_bf16 v[56:59], a[124:127], v[160:163], v[56:59]
    v_mfma_f32_16x16x32_bf16 v[96:99], a[124:127], a[60:63], v[96:99]
    v_mfma_f32_16x16x32_bf16 v[96:99], a[120:123], a[56:59], v[96:99]
    v_mfma_f32_16x16x32_bf16 v[100:103], a[80:83], a[56:59], v[100:103]
    s_waitcnt lgkmcnt(6)
    ds_read_b128 a[120:123], v7 offset:14336
    ds_read_b128 a[124:127], v7 offset:15360
    v_mfma_f32_16x16x32_bf16 v[100:103], a[84:87], a[60:63], v[100:103]
    v_mfma_f32_16x16x32_bf16 v[60:63], a[84:87], v[160:163], v[60:63]
    v_mfma_f32_16x16x32_bf16 v[60:63], a[80:83], v[156:159], v[60:63]
    v_mfma_f32_16x16x32_bf16 v[64:67], a[88:91], v[156:159], v[64:67]
    s_waitcnt lgkmcnt(6)
    ds_read_b128 a[80:83], v7 offset:16384
    ds_read_b128 a[84:87], v7 offset:17408
    v_mfma_f32_16x16x32_bf16 v[64:67], a[92:95], v[160:163], v[64:67]
    buffer_load_dwordx2 v[192:193], v8, s[16:19], 0 offen offset:128
    v_mfma_f32_16x16x32_bf16 v[104:107], a[92:95], a[60:63], v[104:107]
    v_mfma_f32_16x16x32_bf16 v[104:107], a[88:91], a[56:59], v[104:107]
    v_mfma_f32_16x16x32_bf16 v[108:111], a[96:99], a[56:59], v[108:111]
    s_waitcnt vmcnt(14) lgkmcnt(6)
    ds_read_b128 a[88:91], v7 offset:18432
    ds_read_b128 a[92:95], v7 offset:19456
    v_mfma_f32_16x16x32_bf16 v[108:111], a[100:103], a[60:63], v[108:111]
    s_barrier
    v_mfma_f32_16x16x32_bf16 v[68:71], a[100:103], v[160:163], v[68:71]
    v_mfma_f32_16x16x32_bf16 v[68:71], a[96:99], v[156:159], v[68:71]
    v_mfma_f32_16x16x32_bf16 v[72:75], a[108:111], a[60:63], v[72:75]
    s_waitcnt lgkmcnt(6)
    ds_read_b128 a[96:99], v6 offset:0
    ds_read_b128 a[100:103], v6 offset:1024
    v_mfma_f32_16x16x32_bf16 v[72:75], a[104:107], a[56:59], v[72:75]
    v_mfma_f32_16x16x32_bf16 v[76:79], a[112:115], a[56:59], v[76:79]
    s_waitcnt lgkmcnt(6)
    ds_read_b128 a[104:107], v6 offset:2048
    ds_read_b128 a[108:111], v6 offset:3072
    v_mfma_f32_16x16x32_bf16 v[76:79], a[116:119], a[60:63], v[76:79]
    v_mfma_f32_16x16x32_bf16 v[80:83], a[124:127], a[60:63], v[80:83]
    s_waitcnt lgkmcnt(6)
    ds_read_b128 a[112:115], v6 offset:4096
    ds_read_b128 a[116:119], v6 offset:5120
    v_mfma_f32_16x16x32_bf16 v[80:83], a[120:123], a[56:59], v[80:83]
    v_mfma_f32_16x16x32_bf16 v[84:87], a[80:83], a[56:59], v[84:87]
    s_waitcnt lgkmcnt(6)
    ds_read_b128 a[120:123], v6 offset:6144
    ds_read_b128 a[124:127], v6 offset:7168
    v_mfma_f32_16x16x32_bf16 v[84:87], a[84:87], a[60:63], v[84:87]
    v_mfma_f32_16x16x32_bf16 v[88:91], a[92:95], a[60:63], v[88:91]
    s_waitcnt vmcnt(19) lgkmcnt(6)
    ds_read_b128 a[80:83], v6 offset:8192
    ds_read_b128 a[84:87], v6 offset:9216
    v_mfma_f32_16x16x32_bf16 v[88:91], a[88:91], a[56:59], v[88:91]
    v_mfma_f32_16x16x32_bf16 v[92:95], a[96:99], a[72:75], v[92:95]
    s_waitcnt lgkmcnt(6)
    ds_read_b128 a[88:91], v7 offset:20480
    ds_read_b128 a[92:95], v7 offset:21504
    v_mfma_f32_16x16x32_bf16 v[92:95], a[100:103], a[76:79], v[92:95]
    s_add_u32 m0, s40, 16384
    v_mfma_f32_16x16x32_bf16 v[52:55], a[100:103], v[168:171], v[52:55]
    buffer_load_dwordx4 v3, s[12:15], s34 offen offset:0 lds
    v_mfma_f32_16x16x32_bf16 v[52:55], a[96:99], v[164:167], v[52:55]
    v_mfma_f32_16x16x32_bf16 v[56:59], a[104:107], v[164:167], v[56:59]
    s_waitcnt lgkmcnt(6)
    ds_read_b128 a[96:99], v7 offset:22528
    ds_read_b128 a[100:103], v7 offset:23552
    v_mfma_f32_16x16x32_bf16 v[56:59], a[108:111], v[168:171], v[56:59]
    v_mfma_f32_16x16x32_bf16 v[96:99], a[108:111], a[76:79], v[96:99]
    v_mfma_f32_16x16x32_bf16 v[96:99], a[104:107], a[72:75], v[96:99]
    buffer_load_dwordx4 v3, s[12:15], s35 offen offset:1024 lds
    v_mfma_f32_16x16x32_bf16 v[100:103], a[112:115], a[72:75], v[100:103]
    s_waitcnt lgkmcnt(6)
    ds_read_b128 a[104:107], v7 offset:24576
    ds_read_b128 a[108:111], v7 offset:25600
    v_mfma_f32_16x16x32_bf16 v[100:103], a[116:119], a[76:79], v[100:103]
    v_mfma_f32_16x16x32_bf16 v[60:63], a[116:119], v[168:171], v[60:63]
    v_mfma_f32_16x16x32_bf16 v[60:63], a[112:115], v[164:167], v[60:63]
    v_mfma_f32_16x16x32_bf16 v[64:67], a[120:123], v[164:167], v[64:67]
    s_waitcnt lgkmcnt(6)
    ds_read_b128 a[112:115], v7 offset:26624
    ds_read_b128 a[116:119], v7 offset:27648
    v_mfma_f32_16x16x32_bf16 v[64:67], a[124:127], v[168:171], v[64:67]
    buffer_load_dwordx4 v3, s[12:15], s36 offen offset:2048 lds
    v_mfma_f32_16x16x32_bf16 v[104:107], a[124:127], a[76:79], v[104:107]
    v_mfma_f32_16x16x32_bf16 v[104:107], a[120:123], a[72:75], v[104:107]
    v_mfma_f32_16x16x32_bf16 v[108:111], a[80:83], a[72:75], v[108:111]
    s_waitcnt lgkmcnt(6)
    ds_read_b128 a[120:123], v7 offset:28672
    ds_read_b128 a[124:127], v7 offset:29696
    v_mfma_f32_16x16x32_bf16 v[108:111], a[84:87], a[76:79], v[108:111]
    v_mfma_f32_16x16x32_bf16 v[68:71], a[84:87], v[168:171], v[68:71]
    v_mfma_f32_16x16x32_bf16 v[68:71], a[80:83], v[164:167], v[68:71]
    buffer_load_dwordx4 v3, s[12:15], s37 offen offset:3072 lds
    v_mfma_f32_16x16x32_bf16 v[72:75], a[92:95], a[76:79], v[72:75]
    s_waitcnt lgkmcnt(6)
    ds_read_b128 a[80:83], v6 offset:10240
    ds_read_b128 a[84:87], v6 offset:11264
    v_mfma_f32_16x16x32_bf16 v[72:75], a[88:91], a[72:75], v[72:75]
    v_add_u32 v3, 221184, v3
    v_mfma_f32_16x16x32_bf16 v[76:79], a[96:99], a[72:75], v[76:79]
    s_waitcnt lgkmcnt(6)
    ds_read_b128 a[88:91], v6 offset:12288
    ds_read_b128 a[92:95], v6 offset:13312
    v_mfma_f32_16x16x32_bf16 v[76:79], a[100:103], a[76:79], v[76:79]
    v_mfma_f32_16x16x32_bf16 v[80:83], a[108:111], a[76:79], v[80:83]
    s_waitcnt lgkmcnt(6)
    ds_read_b128 a[96:99], v6 offset:14336
    ds_read_b128 a[100:103], v6 offset:15360
    v_mfma_f32_16x16x32_bf16 v[80:83], a[104:107], a[72:75], v[80:83]
    v_mfma_f32_16x16x32_bf16 v[84:87], a[112:115], a[72:75], v[84:87]
    s_waitcnt lgkmcnt(6)
    ds_read_b128 a[104:107], v6 offset:16384
    ds_read_b128 a[108:111], v6 offset:17408
    v_mfma_f32_16x16x32_bf16 v[84:87], a[116:119], a[76:79], v[84:87]
    v_mfma_f32_16x16x32_bf16 v[88:91], a[124:127], a[76:79], v[88:91]
    s_waitcnt vmcnt(13) lgkmcnt(6)
    ds_read_b128 a[112:115], v6 offset:18432
    ds_read_b128 a[116:119], v6 offset:19456
    v_mfma_f32_16x16x32_bf16 v[88:91], a[120:123], a[72:75], v[88:91]
    v_mfma_f32_16x16x32_bf16 v[92:95], a[80:83], a[8:11], v[92:95]
    s_waitcnt lgkmcnt(6)
    ds_read_b128 a[120:123], v7 offset:30720
    ds_read_b128 a[124:127], v7 offset:31744
    v_mfma_f32_16x16x32_bf16 v[92:95], a[84:87], a[12:15], v[92:95]
    s_add_u32 m0, s40, 32768
    v_mfma_f32_16x16x32_bf16 v[52:55], a[84:87], v[176:179], v[52:55]
    buffer_load_dwordx4 v3, s[12:15], s34 offen offset:0 lds
    v_mfma_f32_16x16x32_bf16 v[52:55], a[80:83], v[172:175], v[52:55]
    v_mfma_f32_16x16x32_bf16 v[56:59], a[88:91], v[172:175], v[56:59]
    s_waitcnt lgkmcnt(6)
    ds_read_b128 a[80:83], v7 offset:32768
    ds_read_b128 a[84:87], v7 offset:33792
    v_mfma_f32_16x16x32_bf16 v[56:59], a[92:95], v[176:179], v[56:59]
    buffer_load_dwordx4 v3, s[12:15], s35 offen offset:1024 lds
    v_mfma_f32_16x16x32_bf16 v[96:99], a[92:95], a[12:15], v[96:99]
    v_mfma_f32_16x16x32_bf16 v[96:99], a[88:91], a[8:11], v[96:99]
    v_mfma_f32_16x16x32_bf16 v[100:103], a[96:99], a[8:11], v[100:103]
    s_waitcnt lgkmcnt(6)
    ds_read_b128 a[88:91], v7 offset:34816
    ds_read_b128 a[92:95], v7 offset:35840
    v_mfma_f32_16x16x32_bf16 v[100:103], a[100:103], a[12:15], v[100:103]
    buffer_load_dwordx4 v3, s[12:15], s36 offen offset:2048 lds
    v_mfma_f32_16x16x32_bf16 v[60:63], a[100:103], v[176:179], v[60:63]
    v_mfma_f32_16x16x32_bf16 v[60:63], a[96:99], v[172:175], v[60:63]
    buffer_load_dwordx4 v3, s[12:15], s37 offen offset:3072 lds
    v_mfma_f32_16x16x32_bf16 v[64:67], a[104:107], v[172:175], v[64:67]
    s_waitcnt lgkmcnt(6)
    ds_read_b128 a[96:99], v7 offset:36864
    ds_read_b128 a[100:103], v7 offset:37888
    v_mfma_f32_16x16x32_bf16 v[64:67], a[108:111], v[176:179], v[64:67]
    v_add_u32 v3, 221184, v3
    v_mfma_f32_16x16x32_bf16 v[104:107], a[108:111], a[12:15], v[104:107]
    v_mfma_f32_16x16x32_bf16 v[104:107], a[104:107], a[8:11], v[104:107]
    v_mfma_f32_16x16x32_bf16 v[108:111], a[112:115], a[8:11], v[108:111]
    s_waitcnt lgkmcnt(6)
    ds_read_b128 a[104:107], v7 offset:38912
    ds_read_b128 a[108:111], v7 offset:39936
    v_mfma_f32_16x16x32_bf16 v[108:111], a[116:119], a[12:15], v[108:111]
    s_barrier
    v_mfma_f32_16x16x32_bf16 v[68:71], a[116:119], v[176:179], v[68:71]
    v_mfma_f32_16x16x32_bf16 v[68:71], a[112:115], v[172:175], v[68:71]
    v_mfma_f32_16x16x32_bf16 v[72:75], a[124:127], a[12:15], v[72:75]
    s_waitcnt lgkmcnt(6)
    ds_read_b128 a[112:115], v6 offset:20480
    ds_read_b128 a[116:119], v6 offset:21504
    v_mfma_f32_16x16x32_bf16 v[72:75], a[120:123], a[8:11], v[72:75]
    v_mfma_f32_16x16x32_bf16 v[76:79], a[80:83], a[8:11], v[76:79]
    s_waitcnt lgkmcnt(6)
    ds_read_b128 a[120:123], v6 offset:22528
    ds_read_b128 a[124:127], v6 offset:23552
    v_mfma_f32_16x16x32_bf16 v[76:79], a[84:87], a[12:15], v[76:79]
    v_cvt_pk_bf16_f32 v136, v92, v93
    v_cvt_pk_bf16_f32 v137, v94, v95
    v_mfma_f32_16x16x32_bf16 v[80:83], a[92:95], a[12:15], v[80:83]
    s_waitcnt lgkmcnt(6)
    ds_read_b128 a[80:83], v6 offset:24576
    ds_read_b128 a[84:87], v6 offset:25600
    v_mfma_f32_16x16x32_bf16 v[80:83], a[88:91], a[8:11], v[80:83]
    v_cvt_pk_bf16_f32 v138, v96, v97
    v_cvt_pk_bf16_f32 v139, v98, v99
    v_mfma_f32_16x16x32_bf16 v[84:87], a[96:99], a[8:11], v[84:87]
    s_waitcnt lgkmcnt(6)
    ds_read_b128 a[88:91], v6 offset:26624
    ds_read_b128 a[92:95], v6 offset:27648
    v_mfma_f32_16x16x32_bf16 v[84:87], a[100:103], a[12:15], v[84:87]
    v_cvt_pk_bf16_f32 v140, v100, v101
    v_cvt_pk_bf16_f32 v141, v102, v103
    v_mfma_f32_16x16x32_bf16 v[88:91], a[108:111], a[12:15], v[88:91]
    s_waitcnt lgkmcnt(6)
    ds_read_b128 a[96:99], v6 offset:28672
    ds_read_b128 a[100:103], v6 offset:29696
    v_mfma_f32_16x16x32_bf16 v[88:91], a[104:107], a[8:11], v[88:91]
    v_cvt_pk_bf16_f32 v142, v104, v105
    v_cvt_pk_bf16_f32 v143, v106, v107
    v_mfma_f32_16x16x32_bf16 v[32:35], a[112:115], a[192:195], v[32:35]
    s_waitcnt lgkmcnt(6)
    ds_read_b128 a[104:107], v6 offset:30720
    ds_read_b128 a[108:111], v6 offset:31744
    v_mfma_f32_16x16x32_bf16 v[32:35], a[116:119], a[196:199], v[32:35]
    v_cvt_pk_bf16_f32 v144, v108, v109
    v_cvt_pk_bf16_f32 v145, v110, v111
    v_mfma_f32_16x16x32_bf16 v[36:39], a[124:127], a[196:199], v[36:39]
    s_waitcnt lgkmcnt(6)
    ds_read_b128 a[112:115], v6 offset:32768
    ds_read_b128 a[116:119], v6 offset:33792
    v_mfma_f32_16x16x32_bf16 v[36:39], a[120:123], a[192:195], v[36:39]
    buffer_store_dwordx4 v[136:139], v2, s[64:67], s48 offen sc1
    v_mfma_f32_16x16x32_bf16 v[40:43], a[80:83], a[192:195], v[40:43]
    s_waitcnt lgkmcnt(6)
    ds_read_b128 a[120:123], v6 offset:34816
    ds_read_b128 a[124:127], v6 offset:35840
    v_mfma_f32_16x16x32_bf16 v[40:43], a[84:87], a[196:199], v[40:43]
    buffer_store_dwordx4 v[140:143], v2, s[64:67], s48 offen offset:1024 sc1
    v_mfma_f32_16x16x32_bf16 v[44:47], a[92:95], a[196:199], v[44:47]
    s_waitcnt lgkmcnt(6)
    ds_read_b128 a[80:83], v6 offset:36864
    ds_read_b128 a[84:87], v6 offset:37888
    v_mfma_f32_16x16x32_bf16 v[44:47], a[88:91], a[192:195], v[44:47]
    buffer_store_dwordx2 v[144:145], v20, s[64:67], s48 offen offset:2048 sc1
    v_mfma_f32_16x16x32_bf16 v[48:51], a[96:99], a[192:195], v[48:51]
    s_waitcnt lgkmcnt(6)
    ds_read_b128 a[88:91], v6 offset:38912
    ds_read_b128 a[92:95], v6 offset:39936
    v_mfma_f32_16x16x32_bf16 v[48:51], a[100:103], a[196:199], v[48:51]
    v_cvt_pk_bf16_f32 v112, v52, v53
    v_cvt_pk_bf16_f32 v113, v54, v55
    v_mfma_f32_16x16x32_bf16 v[32:35], a[108:111], a[204:207], v[32:35]
    s_waitcnt lgkmcnt(6)
    ds_read_b128 a[96:99], v6 offset:40960
    ds_read_b128 a[100:103], v6 offset:41984
    v_mfma_f32_16x16x32_bf16 v[32:35], a[104:107], a[200:203], v[32:35]
    v_cvt_pk_bf16_f32 v114, v56, v57
    v_cvt_pk_bf16_f32 v115, v58, v59
    v_mfma_f32_16x16x32_bf16 v[36:39], a[112:115], a[200:203], v[36:39]
    s_waitcnt lgkmcnt(6)
    ds_read_b128 a[104:107], v6 offset:43008
    ds_read_b128 a[108:111], v6 offset:44032
    v_mfma_f32_16x16x32_bf16 v[36:39], a[116:119], a[204:207], v[36:39]
    v_cvt_pk_bf16_f32 v116, v60, v61
    v_cvt_pk_bf16_f32 v117, v62, v63
    v_mfma_f32_16x16x32_bf16 v[40:43], a[124:127], a[204:207], v[40:43]
    s_waitcnt lgkmcnt(6)
    ds_read_b128 a[112:115], v6 offset:45056
    ds_read_b128 a[116:119], v6 offset:46080
    v_mfma_f32_16x16x32_bf16 v[40:43], a[120:123], a[200:203], v[40:43]
    v_cvt_pk_bf16_f32 v118, v64, v65
    v_cvt_pk_bf16_f32 v119, v66, v67
    v_mfma_f32_16x16x32_bf16 v[44:47], a[80:83], a[200:203], v[44:47]
    s_waitcnt lgkmcnt(6)
    ds_read_b128 a[120:123], v6 offset:47104
    ds_read_b128 a[124:127], v6 offset:48128
    v_mfma_f32_16x16x32_bf16 v[44:47], a[84:87], a[204:207], v[44:47]
    v_cvt_pk_bf16_f32 v120, v68, v69
    v_cvt_pk_bf16_f32 v121, v70, v71
    v_mfma_f32_16x16x32_bf16 v[48:51], a[92:95], a[204:207], v[48:51]
    s_waitcnt lgkmcnt(6)
    ds_read_b128 a[80:83], v6 offset:49152
    ds_read_b128 a[84:87], v6 offset:50176
    v_mfma_f32_16x16x32_bf16 v[48:51], a[88:91], a[200:203], v[48:51]
    buffer_store_dwordx4 v[112:115], v2, s[64:67], s46 offen sc1
    v_mfma_f32_16x16x32_bf16 v[32:35], a[96:99], a[208:211], v[32:35]
    s_waitcnt lgkmcnt(6)
    ds_read_b128 a[88:91], v6 offset:51200
    ds_read_b128 a[92:95], v6 offset:52224
    v_mfma_f32_16x16x32_bf16 v[32:35], a[100:103], a[212:215], v[32:35]
    buffer_store_dwordx4 v[116:119], v2, s[64:67], s46 offen offset:1024 sc1
    v_mfma_f32_16x16x32_bf16 v[36:39], a[108:111], a[212:215], v[36:39]
    s_waitcnt lgkmcnt(6)
    ds_read_b128 a[96:99], v6 offset:53248
    ds_read_b128 a[100:103], v6 offset:54272
    v_mfma_f32_16x16x32_bf16 v[36:39], a[104:107], a[208:211], v[36:39]
    buffer_store_dwordx2 v[120:121], v20, s[64:67], s46 offen offset:2048 sc1
    v_mfma_f32_16x16x32_bf16 v[40:43], a[112:115], a[208:211], v[40:43]
    s_waitcnt lgkmcnt(6)
    ds_read_b128 a[104:107], v6 offset:55296
    ds_read_b128 a[108:111], v6 offset:56320
    v_mfma_f32_16x16x32_bf16 v[40:43], a[116:119], a[212:215], v[40:43]
    v_cvt_pk_bf16_f32 v124, v72, v73
    v_cvt_pk_bf16_f32 v125, v74, v75
    v_mfma_f32_16x16x32_bf16 v[44:47], a[124:127], a[212:215], v[44:47]
    s_waitcnt lgkmcnt(6)
    ds_read_b128 a[112:115], v6 offset:57344
    ds_read_b128 a[116:119], v6 offset:58368
    v_mfma_f32_16x16x32_bf16 v[44:47], a[120:123], a[208:211], v[44:47]
    v_cvt_pk_bf16_f32 v126, v76, v77
    v_cvt_pk_bf16_f32 v127, v78, v79
    v_mfma_f32_16x16x32_bf16 v[48:51], a[80:83], a[208:211], v[48:51]
    s_waitcnt lgkmcnt(6)
    ds_read_b128 a[120:123], v6 offset:59392
    ds_read_b128 a[124:127], v6 offset:60416
    v_mfma_f32_16x16x32_bf16 v[48:51], a[84:87], a[212:215], v[48:51]
    v_cvt_pk_bf16_f32 v128, v80, v81
    v_cvt_pk_bf16_f32 v129, v82, v83
    v_mfma_f32_16x16x32_bf16 v[32:35], a[92:95], a[220:223], v[32:35]
    s_waitcnt lgkmcnt(6)
    ds_read_b128 a[80:83], v7 offset:0
    ds_read_b128 a[84:87], v7 offset:1024
    v_mfma_f32_16x16x32_bf16 v[32:35], a[88:91], a[216:219], v[32:35]
    v_cvt_pk_bf16_f32 v130, v84, v85
    v_cvt_pk_bf16_f32 v131, v86, v87
    v_mfma_f32_16x16x32_bf16 v[36:39], a[96:99], a[216:219], v[36:39]
    s_waitcnt lgkmcnt(6)
    ds_read_b128 a[88:91], v7 offset:2048
    ds_read_b128 a[92:95], v7 offset:3072
    v_mfma_f32_16x16x32_bf16 v[36:39], a[100:103], a[220:223], v[36:39]
    v_cvt_pk_bf16_f32 v132, v88, v89
    v_cvt_pk_bf16_f32 v133, v90, v91
    v_mfma_f32_16x16x32_bf16 v[40:43], a[108:111], a[220:223], v[40:43]
    s_waitcnt lgkmcnt(6)
    ds_read_b128 a[96:99], v7 offset:4096
    ds_read_b128 a[100:103], v7 offset:5120
    v_mfma_f32_16x16x32_bf16 v[40:43], a[104:107], a[216:219], v[40:43]
    buffer_store_dwordx4 v[124:127], v2, s[64:67], s47 offen sc1
    v_mfma_f32_16x16x32_bf16 v[44:47], a[112:115], a[216:219], v[44:47]
    s_waitcnt lgkmcnt(6)
    ds_read_b128 a[104:107], v7 offset:6144
    ds_read_b128 a[108:111], v7 offset:7168
    v_mfma_f32_16x16x32_bf16 v[44:47], a[116:119], a[220:223], v[44:47]
    buffer_store_dwordx4 v[128:131], v2, s[64:67], s47 offen offset:1024 sc1
    v_mfma_f32_16x16x32_bf16 v[48:51], a[124:127], a[220:223], v[48:51]
    s_waitcnt lgkmcnt(6)
    ds_read_b128 a[112:115], v7 offset:8192
    ds_read_b128 a[116:119], v7 offset:9216
    v_mfma_f32_16x16x32_bf16 v[48:51], a[120:123], a[216:219], v[48:51]
    buffer_store_dwordx2 v[132:133], v20, s[64:67], s47 offen offset:2048 sc1
    v_mfma_f32_16x16x32_bf16 v[32:35], a[80:83], v[148:151], v[32:35]
    s_waitcnt lgkmcnt(6)
    ds_read_b128 a[120:123], v7 offset:10240
    ds_read_b128 a[124:127], v7 offset:11264
    v_mfma_f32_16x16x32_bf16 v[32:35], a[84:87], v[152:155], v[32:35]
    v_mfma_f32_16x16x32_bf16 v[36:39], a[92:95], v[152:155], v[36:39]
    s_waitcnt lgkmcnt(6)
    ds_read_b128 a[80:83], v7 offset:12288
    ds_read_b128 a[84:87], v7 offset:13312
    v_mfma_f32_16x16x32_bf16 v[36:39], a[88:91], v[148:151], v[36:39]
    v_mfma_f32_16x16x32_bf16 v[40:43], a[96:99], v[148:151], v[40:43]
    s_waitcnt lgkmcnt(6)
    ds_read_b128 a[88:91], v7 offset:14336
    ds_read_b128 a[92:95], v7 offset:15360
    v_mfma_f32_16x16x32_bf16 v[40:43], a[100:103], v[152:155], v[40:43]
    v_mfma_f32_16x16x32_bf16 v[44:47], a[108:111], v[152:155], v[44:47]
    s_waitcnt lgkmcnt(6)
    ds_read_b128 a[96:99], v7 offset:16384
    ds_read_b128 a[100:103], v7 offset:17408
    v_mfma_f32_16x16x32_bf16 v[44:47], a[104:107], v[148:151], v[44:47]
    v_mfma_f32_16x16x32_bf16 v[48:51], a[112:115], v[148:151], v[48:51]
    s_waitcnt lgkmcnt(6)
    ds_read_b128 a[104:107], v7 offset:18432
    ds_read_b128 a[108:111], v7 offset:19456
    v_mfma_f32_16x16x32_bf16 v[48:51], a[116:119], v[152:155], v[48:51]
    v_mfma_f32_16x16x32_bf16 v[32:35], a[124:127], v[160:163], v[32:35]
    s_waitcnt lgkmcnt(6)
    ds_read_b128 a[112:115], v7 offset:20480
    ds_read_b128 a[116:119], v7 offset:21504
    v_mfma_f32_16x16x32_bf16 v[32:35], a[120:123], v[156:159], v[32:35]
    v_mfma_f32_16x16x32_bf16 v[36:39], a[80:83], v[156:159], v[36:39]
    s_waitcnt lgkmcnt(6)
    ds_read_b128 a[120:123], v7 offset:22528
    ds_read_b128 a[124:127], v7 offset:23552
    v_mfma_f32_16x16x32_bf16 v[36:39], a[84:87], v[160:163], v[36:39]
    v_mfma_f32_16x16x32_bf16 v[40:43], a[92:95], v[160:163], v[40:43]
    s_waitcnt lgkmcnt(6)
    ds_read_b128 a[80:83], v7 offset:24576
    ds_read_b128 a[84:87], v7 offset:25600
    v_mfma_f32_16x16x32_bf16 v[40:43], a[88:91], v[156:159], v[40:43]
    v_mfma_f32_16x16x32_bf16 v[44:47], a[96:99], v[156:159], v[44:47]
    s_waitcnt lgkmcnt(6)
    ds_read_b128 a[88:91], v7 offset:26624
    ds_read_b128 a[92:95], v7 offset:27648
    v_mfma_f32_16x16x32_bf16 v[44:47], a[100:103], v[160:163], v[44:47]
    v_mfma_f32_16x16x32_bf16 v[48:51], a[108:111], v[160:163], v[48:51]
    s_waitcnt lgkmcnt(6)
    ds_read_b128 a[96:99], v7 offset:28672
    ds_read_b128 a[100:103], v7 offset:29696
    v_mfma_f32_16x16x32_bf16 v[48:51], a[104:107], v[156:159], v[48:51]
    v_mfma_f32_16x16x32_bf16 v[32:35], a[112:115], v[164:167], v[32:35]
    s_waitcnt lgkmcnt(6)
    ds_read_b128 a[104:107], v7 offset:30720
    ds_read_b128 a[108:111], v7 offset:31744
    v_mfma_f32_16x16x32_bf16 v[32:35], a[116:119], v[168:171], v[32:35]
    v_mfma_f32_16x16x32_bf16 v[36:39], a[124:127], v[168:171], v[36:39]
    s_waitcnt lgkmcnt(6)
    ds_read_b128 a[112:115], v7 offset:32768
    ds_read_b128 a[116:119], v7 offset:33792
    v_mfma_f32_16x16x32_bf16 v[36:39], a[120:123], v[164:167], v[36:39]
    v_mfma_f32_16x16x32_bf16 v[40:43], a[80:83], v[164:167], v[40:43]
    s_waitcnt lgkmcnt(6)
    ds_read_b128 a[120:123], v7 offset:34816
    ds_read_b128 a[124:127], v7 offset:35840
    v_mfma_f32_16x16x32_bf16 v[40:43], a[84:87], v[168:171], v[40:43]
    v_mfma_f32_16x16x32_bf16 v[44:47], a[92:95], v[168:171], v[44:47]
    s_waitcnt lgkmcnt(6)
    ds_read_b128 a[80:83], v7 offset:36864
    ds_read_b128 a[84:87], v7 offset:37888
    v_mfma_f32_16x16x32_bf16 v[44:47], a[88:91], v[164:167], v[44:47]
    s_waitcnt vmcnt(0)
    s_barrier
    v_mfma_f32_16x16x32_bf16 v[48:51], a[96:99], v[164:167], v[48:51]
    s_waitcnt lgkmcnt(6)
    ds_read_b128 a[88:91], v7 offset:38912
    ds_read_b128 a[92:95], v7 offset:39936
    v_mfma_f32_16x16x32_bf16 v[48:51], a[100:103], v[168:171], v[48:51]
    v_mov_b32 v13, 1
    v_mfma_f32_16x16x32_bf16 v[32:35], a[108:111], v[176:179], v[32:35]
    s_waitcnt lgkmcnt(6)
    v_mfma_f32_16x16x32_bf16 v[32:35], a[104:107], v[172:175], v[32:35]
    buffer_atomic_add v13, v29, s[72:75], s42 offen offset:8
    v_mfma_f32_16x16x32_bf16 v[36:39], a[112:115], v[172:175], v[36:39]
    s_waitcnt lgkmcnt(4)
    v_mfma_f32_16x16x32_bf16 v[36:39], a[116:119], v[176:179], v[36:39]
    v_mfma_f32_16x16x32_bf16 v[40:43], a[124:127], v[176:179], v[40:43]
    s_waitcnt lgkmcnt(2)
    v_mfma_f32_16x16x32_bf16 v[40:43], a[120:123], v[172:175], v[40:43]
    v_mfma_f32_16x16x32_bf16 v[44:47], a[80:83], v[172:175], v[44:47]
    s_waitcnt lgkmcnt(0)
    v_mfma_f32_16x16x32_bf16 v[44:47], a[84:87], v[176:179], v[44:47]
    v_mfma_f32_16x16x32_bf16 v[48:51], a[92:95], v[176:179], v[48:51]
    v_mfma_f32_16x16x32_bf16 v[48:51], a[88:91], v[172:175], v[48:51]
KB_x3:
    v_mov_b32 v14, v29
    buffer_load_dword v31, v14, s[72:75], s42 offen offset:8 sc1
    s_movk_i32 s50, 0x3f80
    s_mov_b32 s51, 0x3f800000
    v_mov_b32 v22, 0
    v_mov_b32 v23, 0
    s_lshl_b32 s58, s3, 1
    s_add_u32 s58, s31, s58
    s_mul_i32 s56, s58, 20480
    s_mul_i32 s57, s30, 5
    s_lshr_b32 s57, s57, 1
    s_lshl_b32 s57, s57, 10
    s_add_u32 s56, s56, s57
    s_add_u32 s56, s56, 4194304
    s_lshl_b32 s58, s58, 3
    s_add_u32 s58, s58, s30
    s_mul_i32 s57, s58, 2560
    s_add_u32 s57, s57, 7340032
    s_lshl_b32 s58, s58, 7
    s_add_u32 s58, s58, 65536
    s_mov_b32 s59, 0x3f803f80
    v_lshl_or_b32 v24, v16, 26, v20
    v_lshlrev_b32 v52, 16, v184
    v_and_b32 v53, 0xffff0000, v184
    v_lshlrev_b32 v54, 16, v185
    v_and_b32 v55, 0xffff0000, v185
    v_lshlrev_b32 v56, 16, v186
    v_and_b32 v57, 0xffff0000, v186
    v_lshlrev_b32 v58, 16, v187
    v_and_b32 v59, 0xffff0000, v187
    v_lshlrev_b32 v60, 16, v188
    v_and_b32 v61, 0xffff0000, v188
    v_lshlrev_b32 v62, 16, v189
    v_and_b32 v63, 0xffff0000, v189
    v_lshlrev_b32 v64, 16, v190
    v_and_b32 v65, 0xffff0000, v190
    v_lshlrev_b32 v66, 16, v191
    v_and_b32 v67, 0xffff0000, v191
    v_lshlrev_b32 v68, 16, v192
    v_and_b32 v69, 0xffff0000, v192
    v_lshlrev_b32 v70, 16, v193
    v_and_b32 v71, 0xffff0000, v193
    s_cmp_lg_u32 s3, 0
    s_cbranch_scc1 KB_wpart
    s_mov_b32 s29, 0x40000
    s_waitcnt vmcnt(0)
KB_lpart:
    v_cmp_gt_u32 vcc, 4, v31
    s_sub_u32 s29, s29, 1
    s_cmp_eq_u32 s29, 0
    s_cbranch_scc1 KB_wpart
    s_and_b32 s28, vcc_lo, 1
    s_cmp_eq_u32 s28, 0
    s_cbranch_scc1 KB_wpart
    buffer_load_dword v31, v14, s[72:75], s42 offen offset:8 sc1
    s_waitcnt vmcnt(0)
    s_branch KB_lpart
KB_wpart:
    s_barrier
    s_add_u32 s44, s49, 0
    buffer_load_dwordx4 v[112:115], v2, s[64:67], s44 offen sc1
    buffer_load_dwordx4 v[116:119], v2, s[64:67], s44 offen offset:1024 sc1
    buffer_load_dwordx2 v[120:121], v20, s[64:67], s44 offen offset:2048 sc1
    s_add_u32 s44, s49, 10240
    buffer_load_dwordx4 v[124:127], v2, s[64:67], s44 offen sc1
    buffer_load_dwordx4 v[128:131], v2, s[64:67], s44 offen offset:1024 sc1
    buffer_load_dwordx2 v[132:133], v20, s[64:67], s44 offen offset:2048 sc1
    s_add_u32 s44, s49, 20480
    buffer_load_dwordx4 v[136:139], v2, s[64:67], s44 offen sc1
    buffer_load_dwordx4 v[140:143], v2, s[64:67], s44 offen offset:1024 sc1
    buffer_load_dwordx2 v[144:145], v20, s[64:67], s44 offen offset:2048 sc1
    s_waitcnt vmcnt(6)
    v_dot2c_f32_bf16 v32, s50, v112
    v_dot2c_f32_bf16 v33, s51, v112
    v_dot2c_f32_bf16 v34, s50, v113
    v_dot2c_f32_bf16 v35, s51, v113
    v_dot2c_f32_bf16 v36, s50, v114
    v_dot2c_f32_bf16 v37, s51, v114
    v_dot2c_f32_bf16 v38, s50, v115
    v_dot2c_f32_bf16 v39, s51, v115
    v_dot2c_f32_bf16 v40, s50, v116
    v_dot2c_f32_bf16 v41, s51, v116
    v_dot2c_f32_bf16 v42, s50, v117
    v_dot2c_f32_bf16 v43, s51, v117
    v_dot2c_f32_bf16 v44, s50, v118
    v_dot2c_f32_bf16 v45, s51, v118
    v_dot2c_f32_bf16 v46, s50, v119
    v_dot2c_f32_bf16 v47, s51, v119
    v_dot2c_f32_bf16 v48, s50, v120
    v_dot2c_f32_bf16 v49, s51, v120
    v_dot2c_f32_bf16 v50, s50, v121
    v_dot2c_f32_bf16 v51, s51, v121
    s_waitcnt vmcnt(3)
    v_dot2c_f32_bf16 v32, s50, v124
    v_dot2c_f32_bf16 v33, s51, v124
    v_dot2c_f32_bf16 v34, s50, v125
    v_dot2c_f32_bf16 v35, s51, v125
    v_dot2c_f32_bf16 v36, s50, v126
    v_dot2c_f32_bf16 v37, s51, v126
    v_dot2c_f32_bf16 v38, s50, v127
    v_dot2c_f32_bf16 v39, s51, v127
    v_dot2c_f32_bf16 v40, s50, v128
    v_dot2c_f32_bf16 v41, s51, v128
    v_dot2c_f32_bf16 v42, s50, v129
    v_dot2c_f32_bf16 v43, s51, v129
    v_dot2c_f32_bf16 v44, s50, v130
    v_dot2c_f32_bf16 v45, s51, v130
    v_dot2c_f32_bf16 v46, s50, v131
    v_dot2c_f32_bf16 v47, s51, v131
    v_dot2c_f32_bf16 v48, s50, v132
    v_dot2c_f32_bf16 v49, s51, v132
    v_dot2c_f32_bf16 v50, s50, v133
    v_dot2c_f32_bf16 v51, s51, v133
    s_waitcnt vmcnt(0)
    v_dot2c_f32_bf16 v32, s50, v136
    v_dot2c_f32_bf16 v33, s51, v136
    v_dot2c_f32_bf16 v34, s50, v137
    v_dot2c_f32_bf16 v35, s51, v137
    v_dot2c_f32_bf16 v36, s50, v138
    v_dot2c_f32_bf16 v37, s51, v138
    v_dot2c_f32_bf16 v38, s50, v139
    v_dot2c_f32_bf16 v39, s51, v139
    v_dot2c_f32_bf16 v40, s50, v140
    v_dot2c_f32_bf16 v41, s51, v140
    v_dot2c_f32_bf16 v42, s50, v141
    v_dot2c_f32_bf16 v43, s51, v141
    v_dot2c_f32_bf16 v44, s50, v142
    v_dot2c_f32_bf16 v45, s51, v142
    v_dot2c_f32_bf16 v46, s50, v143
    v_dot2c_f32_bf16 v47, s51, v143
    v_dot2c_f32_bf16 v48, s50, v144
    v_dot2c_f32_bf16 v49, s51, v144
    v_dot2c_f32_bf16 v50, s50, v145
    v_dot2c_f32_bf16 v51, s51, v145
    s_nop 2
    v_fmac_f32_dpp v52, v196, v32 row_newbcast:0 row_mask:0xf bank_mask:0xf
    v_fmac_f32_dpp v53, v197, v33 row_newbcast:0 row_mask:0xf bank_mask:0xf
    v_fmac_f32_dpp v54, v198, v34 row_newbcast:0 row_mask:0xf bank_mask:0xf
    v_fmac_f32_dpp v55, v199, v35 row_newbcast:0 row_mask:0xf bank_mask:0xf
    v_fmac_f32_dpp v56, v196, v36 row_newbcast:1 row_mask:0xf bank_mask:0xf
    v_fmac_f32_dpp v57, v197, v37 row_newbcast:1 row_mask:0xf bank_mask:0xf
    v_fmac_f32_dpp v58, v198, v38 row_newbcast:1 row_mask:0xf bank_mask:0xf
    v_fmac_f32_dpp v59, v199, v39 row_newbcast:1 row_mask:0xf bank_mask:0xf
    v_fmac_f32_dpp v60, v196, v40 row_newbcast:2 row_mask:0xf bank_mask:0xf
    v_fmac_f32_dpp v61, v197, v41 row_newbcast:2 row_mask:0xf bank_mask:0xf
    v_fmac_f32_dpp v62, v198, v42 row_newbcast:2 row_mask:0xf bank_mask:0xf
    v_fmac_f32_dpp v63, v199, v43 row_newbcast:2 row_mask:0xf bank_mask:0xf
    v_fmac_f32_dpp v64, v196, v44 row_newbcast:3 row_mask:0xf bank_mask:0xf
    v_fmac_f32_dpp v65, v197, v45 row_newbcast:3 row_mask:0xf bank_mask:0xf
    v_fmac_f32_dpp v66, v198, v46 row_newbcast:3 row_mask:0xf bank_mask:0xf
    v_fmac_f32_dpp v67, v199, v47 row_newbcast:3 row_mask:0xf bank_mask:0xf
    v_fmac_f32_dpp v68, v196, v48 row_newbcast:4 row_mask:0xf bank_mask:0xf
    v_fmac_f32_dpp v69, v197, v49 row_newbcast:4 row_mask:0xf bank_mask:0xf
    v_fmac_f32_dpp v70, v198, v50 row_newbcast:4 row_mask:0xf bank_mask:0xf
    v_fmac_f32_dpp v71, v199, v51 row_newbcast:4 row_mask:0xf bank_mask:0xf
    v_mul_f32_dpp v32, v216, v52 row_newbcast:0 row_mask:0xf bank_mask:0xf
    v_mul_f32_dpp v33, v217, v53 row_newbcast:0 row_mask:0xf bank_mask:0xf
    v_mul_f32_dpp v34, v218, v54 row_newbcast:0 row_mask:0xf bank_mask:0xf
    v_mul_f32_dpp v35, v219, v55 row_newbcast:0 row_mask:0xf bank_mask:0xf
    v_mul_f32_dpp v36, v216, v56 row_newbcast:1 row_mask:0xf bank_mask:0xf
    v_mul_f32_dpp v37, v217, v57 row_newbcast:1 row_mask:0xf bank_mask:0xf
    v_mul_f32_dpp v38, v218, v58 row_newbcast:1 row_mask:0xf bank_mask:0xf
    v_mul_f32_dpp v39, v219, v59 row_newbcast:1 row_mask:0xf bank_mask:0xf
    v_mul_f32_dpp v40, v216, v60 row_newbcast:2 row_mask:0xf bank_mask:0xf
    v_mul_f32_dpp v41, v217, v61 row_newbcast:2 row_mask:0xf bank_mask:0xf
    v_mul_f32_dpp v42, v218, v62 row_newbcast:2 row_mask:0xf bank_mask:0xf
    v_mul_f32_dpp v43, v219, v63 row_newbcast:2 row_mask:0xf bank_mask:0xf
    v_mul_f32_dpp v44, v216, v64 row_newbcast:3 row_mask:0xf bank_mask:0xf
    v_mul_f32_dpp v45, v217, v65 row_newbcast:3 row_mask:0xf bank_mask:0xf
    v_mul_f32_dpp v46, v218, v66 row_newbcast:3 row_mask:0xf bank_mask:0xf
    v_mul_f32_dpp v47, v219, v67 row_newbcast:3 row_mask:0xf bank_mask:0xf
    v_mul_f32_dpp v48, v216, v68 row_newbcast:4 row_mask:0xf bank_mask:0xf
    v_mul_f32_dpp v49, v217, v69 row_newbcast:4 row_mask:0xf bank_mask:0xf
    v_mul_f32_dpp v50, v218, v70 row_newbcast:4 row_mask:0xf bank_mask:0xf
    v_mul_f32_dpp v51, v219, v71 row_newbcast:4 row_mask:0xf bank_mask:0xf
    v_cvt_pk_bf16_f32 v84, v32, v33
    v_cvt_pk_bf16_f32 v85, v34, v35
    v_cvt_pk_bf16_f32 v86, v36, v37
    v_cvt_pk_bf16_f32 v87, v38, v39
    v_cvt_pk_bf16_f32 v88, v40, v41
    v_cvt_pk_bf16_f32 v89, v42, v43
    v_cvt_pk_bf16_f32 v90, v44, v45
    v_cvt_pk_bf16_f32 v91, v46, v47
    v_cvt_pk_bf16_f32 v92, v48, v49
    v_cvt_pk_bf16_f32 v93, v50, v51
    s_bitcmp1_b32 s30, 0
    s_cbranch_scc1 KB_odd
    buffer_store_dwordx4 v[84:87], v2, s[72:75], s56 offen offset:0 sc1
    buffer_store_dwordx4 v[88:91], v2, s[72:75], s56 offen offset:1024 sc1
    buffer_store_dwordx2 v[92:93], v20, s[72:75], s56 offen offset:2048 sc1
    s_branch KB_evn
KB_odd:
    buffer_store_dwordx2 v[84:85], v20, s[72:75], s56 offen offset:512 sc1
    buffer_store_dwordx4 v[86:89], v2, s[72:75], s56 offen offset:1024 sc1
    buffer_store_dwordx4 v[90:93], v2, s[72:75], s56 offen offset:2048 sc1
KB_evn:
    v_cvt_pk_bf16_f32 v72, v52, v53
    v_cvt_pk_bf16_f32 v73, v54, v55
    v_cvt_pk_bf16_f32 v74, v56, v57
    v_cvt_pk_bf16_f32 v75, v58, v59
    v_cvt_pk_bf16_f32 v76, v60, v61
    v_cvt_pk_bf16_f32 v77, v62, v63
    v_cvt_pk_bf16_f32 v78, v64, v65
    v_cvt_pk_bf16_f32 v79, v66, v67
    v_cvt_pk_bf16_f32 v80, v68, v69
    v_cvt_pk_bf16_f32 v81, v70, v71
    v_dot2c_f32_bf16 v22, s59, v72
    v_dot2c_f32_bf16 v23, v72, v72
    v_dot2c_f32_bf16 v22, s59, v73
    v_dot2c_f32_bf16 v23, v73, v73
    v_dot2c_f32_bf16 v22, s59, v74
    v_dot2c_f32_bf16 v23, v74, v74
    v_dot2c_f32_bf16 v22, s59, v75
    v_dot2c_f32_bf16 v23, v75, v75
    v_dot2c_f32_bf16 v22, s59, v76
    v_dot2c_f32_bf16 v23, v76, v76
    v_dot2c_f32_bf16 v22, s59, v77
    v_dot2c_f32_bf16 v23, v77, v77
    v_dot2c_f32_bf16 v22, s59, v78
    v_dot2c_f32_bf16 v23, v78, v78
    v_dot2c_f32_bf16 v22, s59, v79
    v_dot2c_f32_bf16 v23, v79, v79
    v_dot2c_f32_bf16 v22, s59, v80
    v_dot2c_f32_bf16 v23, v80, v80
    v_dot2c_f32_bf16 v22, s59, v81
    v_dot2c_f32_bf16 v23, v81, v81
    buffer_store_dwordx4 v[72:75], v2, s[72:75], s57 offen offset:0 sc1
    buffer_store_dwordx4 v[76:79], v2, s[72:75], s57 offen offset:1024 sc1
    buffer_store_dwordx2 v[80:81], v20, s[72:75], s57 offen offset:2048 sc1
    v_mov_b32 v26, v22
    v_mov_b32 v27, v23
    s_nop 0
    v_permlane32_swap_b32 v22, v26
    v_permlane32_swap_b32 v23, v27
    v_add_f32 v22, v22, v26
    v_add_f32 v23, v23, v27
    v_mov_b32 v26, v22
    v_mov_b32 v27, v23
    s_nop 0
    v_permlane16_swap_b32 v22, v26
    v_permlane16_swap_b32 v23, v27
    v_add_f32 v22, v22, v26
    v_add_f32 v23, v23, v27
    buffer_store_dwordx2 v[22:23], v24, s[72:75], s58 offen sc1
    s_waitcnt vmcnt(0)
    s_barrier
    v_mov_b32 v13, 1
    buffer_atomic_add v13, v29, s[72:75], s24 offen offset:8
    s_add_u32 m0, s40, 49152
    s_nop 0
    buffer_load_dwordx4 v3, s[12:15], s34 offen offset:0 lds
    buffer_load_dwordx4 v3, s[12:15], s35 offen offset:1024 lds
    buffer_load_dwordx4 v3, s[12:15], s36 offen offset:2048 lds
    buffer_load_dwordx4 v3, s[12:15], s37 offen offset:3072 lds
    v_add_u32 v3, 221184, v3
    s_add_u32 m0, s40, 65536
    s_nop 0
    buffer_load_dwordx4 v3, s[12:15], s34 offen offset:0 lds
    buffer_load_dwordx4 v3, s[12:15], s35 offen offset:1024 lds
    buffer_load_dwordx4 v3, s[12:15], s36 offen offset:2048 lds
    buffer_load_dwordx4 v3, s[12:15], s37 offen offset:3072 lds
    v_add_u32 v3, 221184, v3
    s_add_u32 m0, s40, 81920
    s_nop 0
    buffer_load_dwordx4 v3, s[12:15], s34 offen offset:0 lds
    buffer_load_dwordx4 v3, s[12:15], s35 offen offset:1024 lds
    buffer_load_dwordx4 v3, s[12:15], s36 offen offset:2048 lds
    buffer_load_dwordx4 v3, s[12:15], s37 offen offset:3072 lds
    v_add_u32 v3, 221184, v3
    s_add_u32 m0, s40, 98304
    s_nop 0
    buffer_load_dwordx4 v3, s[12:15], s34 offen offset:0 lds
    buffer_load_dwordx4 v3, s[12:15], s35 offen offset:1024 lds
    buffer_load_dwordx4 v3, s[12:15], s36 offen offset:2048 lds
    buffer_load_dwordx4 v3, s[12:15], s37 offen offset:3072 lds
    v_add_u32 v3, 221184, v3
    s_add_u32 m0, s40, 114688
    s_nop 0
    buffer_load_dwordx4 v3, s[12:15], s34 offen offset:0 lds
    buffer_load_dwordx4 v3, s[12:15], s35 offen offset:1024 lds
    buffer_load_dwordx4 v3, s[12:15], s36 offen offset:2048 lds
    buffer_load_dwordx4 v3, s[12:15], s37 offen offset:3072 lds
    v_add_u32 v3, 221184, v3
    s_add_u32 m0, s40, 131072
    s_nop 0
    buffer_load_dwordx4 v3, s[12:15], s34 offen offset:0 lds
    buffer_load_dwordx4 v3, s[12:15], s35 offen offset:1024 lds
    buffer_load_dwordx4 v3, s[12:15], s36 offen offset:2048 lds
    buffer_load_dwordx4 v3, s[12:15], s37 offen offset:3072 lds
    v_add_u32 v3, 221184, v3
    s_add_u32 m0, s40, 147456
    s_nop 0
    buffer_load_dwordx4 v3, s[12:15], s34 offen offset:0 lds
    buffer_load_dwordx4 v3, s[12:15], s35 offen offset:1024 lds
    buffer_load_dwordx4 v3, s[12:15], s36 offen offset:2048 lds
    buffer_load_dwordx4 v3, s[12:15], s37 offen offset:3072 lds
    v_add_u32 v3, 221184, v3
    s_lshr_b32 s41, s2, 7
    s_lshl_b32 s41, s41, 3
    s_bfe_u32 s42, s2, 0x10006
    s_add_u32 s41, s41, s42
    s_and_b32 s42, s2, 7
    s_lshl_b32 s28, s42, 3
    s_sub_u32 s29, 112, s28
    s_cmp_lt_u32 s41, 8
    s_cselect_b32 s28, s28, s29
    s_add_u32 s31, s28, s41
    s_bfe_u32 s30, s2, 0x30003
    s_lshl_b32 s42, s42, 10
    s_add_u32 s42, s42, 17408
    s_mul_i32 s28, s30, 276480
    v_add_u32 v12, s28, v2
    s_add_u32 s28, s28, 55296
    v_add_u32 v17, s28, v2
    s_add_u32 s28, s28, 55296
    v_add_u32 v18, s28, v2
    s_add_u32 s28, s28, 55296
    v_add_u32 v19, s28, v2
    s_add_u32 s28, s28, 55296
    v_add_u32 v27, s28, v2
    s_add_u32 s28, s28, 55296
    s_mul_i32 s62, s3, 14336
    s_mul_i32 s55, s3, 10240
    s_add_u32 s68, s4, 0x1800000
    s_addc_u32 s69, s5, 0
    s_mov_b32 s70, 2211840
    s_mov_b32 s71, 0x20000
    s_add_u32 s46, s62, 0
    s_add_u32 s47, s62, 2048
    s_add_u32 s48, s62, 4096
    s_add_u32 s50, s62, 6144
    s_add_u32 s51, s62, 8192
    s_add_u32 s52, s62, 10240
    s_add_u32 s53, s62, 12288
    s_cmp_eq_u32 s3, 3
    s_cselect_b32 s53, 0x1000000, s53
    s_cmp_ge_u32 s32, 27
    s_cbranch_scc1 KB_skip4
    v_and_b32 v15, 15, v1
    v_lshrrev_b32 v16, 4, v1
    s_lshl_b32 s41, s3, 2
    s_lshl_b32 s28, s27, 3
    s_sub_u32 s29, 112, s28
    s_cmp_lt_u32 s41, 8
    s_cselect_b32 s28, s28, s29
    s_add_u32 s33, s28, s41
    s_add_u32 s28, s33, 0
    s_mul_i32 s56, s28, 20480
    s_add_u32 s56, s56, 4194304
    s_add_u32 s28, s33, 1
    s_mul_i32 s57, s28, 20480
    s_add_u32 s57, s57, 4194304
    s_add_u32 s28, s33, 2
    s_mul_i32 s58, s28, 20480
    s_add_u32 s58, s58, 4194304
    s_add_u32 s28, s33, 3
    s_mul_i32 s59, s28, 20480
    s_add_u32 s59, s59, 4194304
    v_lshrrev_b32 v13, 2, v1
    v_lshrrev_b32 v14, 3, v1
    v_and_b32 v14, 3, v14
    v_lshlrev_b32 v14, 5, v14
    v_lshlrev_b32 v13, 7, v13
    v_add_u32 v13, v13, v14
    v_and_b32 v14, 3, v1
    v_lshlrev_b32 v14, 3, v14
    v_add_u32 v13, v13, v14
    v_xor_b32 v8, 0, v13
    v_xor_b32 v9, 32, v13
    v_xor_b32 v10, 64, v13
    v_xor_b32 v11, 96, v13
    s_lshl_b32 s28, s3, 5
    v_xor_b32 v24, s28, v8
    v_add_u32 v25, 0x10000, v24
    v_add_u32 v26, 0x20000, v24
    v_lshlrev_b32 v4, 3, v15
    v_lshl_add_u32 v4, v16, 8, v4
    v_lshlrev_b32 v7, 3, v1
    s_lshl_b32 s38, s33, 10
    s_add_u32 s38, s38, 65536
    v_lshlrev_b32 v5, 4, v16
    v_add_u32 v5, 0, v5
    s_lshl_b32 s28, s3, 6
    v_lshl_add_u32 v6, v15, 9, v5
    v_add_u32 v6, s28, v6
    v_lshrrev_b32 v14, 3, v1
    v_add_u32 v14, s3, v14
    v_lshlrev_b32 v14, 26, v14
    v_lshl_or_b32 v14, v1, 7, v14
    buffer_load_dword v31, v14, s[72:75], s25 offen offset:8 sc1
    s_cmp_lg_u32 s3, 0
    s_cbranch_scc1 KB_wx1
    s_mov_b32 s29, 0x40000
    s_waitcnt vmcnt(0)
KB_lx1:
    v_cmp_gt_u32 vcc, 4, v31
    s_sub_u32 s29, s29, 1
    s_cmp_eq_u32 s29, 0
    s_cbranch_scc1 KB_wx1
    s_and_b32 s28, vcc_lo, 0xff
    s_cmp_eq_u32 s28, 0
    s_cbranch_scc1 KB_wx1
    buffer_load_dword v31, v14, s[72:75], s25 offen offset:8 sc1
    s_waitcnt vmcnt(0)
    s_branch KB_lx1
KB_wx1:
    s_barrier
    buffer_load_dwordx4 a[0:3], v2, s[72:75], s56 offen offset:0 sc1
    buffer_load_dwordx4 a[4:7], v2, s[72:75], s56 offen offset:1024 sc1
    buffer_load_dwordx4 a[8:11], v2, s[72:75], s57 offen offset:0 sc1
    buffer_load_dwordx4 a[12:15], v2, s[72:75], s57 offen offset:1024 sc1
    buffer_load_dwordx4 a[16:19], v2, s[72:75], s58 offen offset:0 sc1
    buffer_load_dwordx4 a[20:23], v2, s[72:75], s58 offen offset:1024 sc1
    buffer_load_dwordx4 a[24:27], v2, s[72:75], s59 offen offset:0 sc1
    buffer_load_dwordx4 a[28:31], v2, s[72:75], s59 offen offset:1024 sc1
    buffer_load_dwordx2 a[32:33], v7, s[72:75], s56 offen offset:2048 sc1
    buffer_load_dwordx2 a[34:35], v7, s[72:75], s56 offen offset:2560 sc1
    buffer_load_dwordx4 a[36:39], v2, s[72:75], s56 offen offset:3072 sc1
    buffer_load_dwordx2 a[40:41], v7, s[72:75], s57 offen offset:2048 sc1
    s_waitcnt vmcnt(13) lgkmcnt(0)
    s_barrier
    ds_read_b64_tr_b16 a[192:193], v24 offset:0
    ds_read_b64_tr_b16 a[194:195], v24 offset:2048
    ds_read_b64_tr_b16 a[196:197], v24 offset:4096
    ds_read_b64_tr_b16 a[198:199], v24 offset:6144
    ds_read_b64_tr_b16 a[200:201], v24 offset:8192
    ds_read_b64_tr_b16 a[202:203], v24 offset:10240
    ds_read_b64_tr_b16 a[204:205], v24 offset:12288
    ds_read_b64_tr_b16 a[206:207], v24 offset:14336
    ds_read_b64_tr_b16 a[208:209], v24 offset:16384
    ds_read_b64_tr_b16 a[210:211], v24 offset:18432
    ds_read_b64_tr_b16 a[212:213], v24 offset:20480
    ds_read_b64_tr_b16 a[214:215], v24 offset:22528
    v_mov_b32 v68, v200 row_shl:2 row_mask:0xf bank_mask:0xf
    v_mov_b32 v69, v201 row_shl:2 row_mask:0xf bank_mask:0xf
    v_mov_b32 v70, v202 row_shl:2 row_mask:0xf bank_mask:0xf
    v_mov_b32 v71, v203 row_shl:2 row_mask:0xf bank_mask:0xf
    s_waitcnt lgkmcnt(4)
    s_nop 0
    v_mfma_f32_16x16x32_bf16 v[120:123], a[192:195], v[200:203], 0
    ds_read_b64_tr_b16 a[216:217], v24 offset:24576
    ds_read_b64_tr_b16 a[218:219], v24 offset:26624
    v_mfma_f32_16x16x32_bf16 v[120:123], a[196:199], v[68:71], v[120:123]
    ds_read_b64_tr_b16 a[220:221], v24 offset:28672
    ds_read_b64_tr_b16 a[222:223], v24 offset:30720
    v_mfma_f32_16x16x32_bf16 v[124:127], a[200:203], v[200:203], 0
    ds_read_b64_tr_b16 a[192:193], v24 offset:32768
    ds_read_b64_tr_b16 a[194:195], v24 offset:34816
    v_mfma_f32_16x16x32_bf16 v[124:127], a[204:207], v[68:71], v[124:127]
    ds_read_b64_tr_b16 a[196:197], v24 offset:36864
    ds_read_b64_tr_b16 a[198:199], v24 offset:38912
    v_mov_b32 v72, v200 row_shl:4 row_mask:0xf bank_mask:0xf
    v_mov_b32 v73, v201 row_shl:4 row_mask:0xf bank_mask:0xf
    v_mov_b32 v74, v202 row_shl:4 row_mask:0xf bank_mask:0xf
    v_mov_b32 v75, v203 row_shl:4 row_mask:0xf bank_mask:0xf
    v_mov_b32 v76, v200 row_shl:6 row_mask:0xf bank_mask:0xf
    v_mov_b32 v77, v201 row_shl:6 row_mask:0xf bank_mask:0xf
    v_mov_b32 v78, v202 row_shl:6 row_mask:0xf bank_mask:0xf
    v_mov_b32 v79, v203 row_shl:6 row_mask:0xf bank_mask:0xf
    s_waitcnt lgkmcnt(4)
    s_nop 0
    v_mfma_f32_16x16x32_bf16 v[120:123], a[208:211], v[72:75], v[120:123]
    ds_read_b64_tr_b16 a[200:201], v24 offset:40960
    ds_read_b64_tr_b16 a[202:203], v24 offset:43008
    v_mfma_f32_16x16x32_bf16 v[120:123], a[212:215], v[76:79], v[120:123]
    ds_read_b64_tr_b16 a[204:205], v24 offset:45056
    ds_read_b64_tr_b16 a[206:207], v24 offset:47104
    v_mfma_f32_16x16x32_bf16 v[124:127], a[216:219], v[72:75], v[124:127]
    ds_read_b64_tr_b16 a[208:209], v24 offset:49152
    ds_read_b64_tr_b16 a[210:211], v24 offset:51200
    v_mfma_f32_16x16x32_bf16 v[124:127], a[220:223], v[76:79], v[124:127]
    ds_read_b64_tr_b16 a[212:213], v24 offset:53248
    ds_read_b64_tr_b16 a[214:215], v24 offset:55296
    v_mov_b32 v64, v200 row_shl:8 row_mask:0xf bank_mask:0xf
    v_mov_b32 v65, v201 row_shl:8 row_mask:0xf bank_mask:0xf
    v_mov_b32 v66, v202 row_shl:8 row_mask:0xf bank_mask:0xf
    v_mov_b32 v67, v203 row_shl:8 row_mask:0xf bank_mask:0xf
    v_mov_b32 v68, v200 row_shl:10 row_mask:0xf bank_mask:0xf
    v_mov_b32 v69, v201 row_shl:10 row_mask:0xf bank_mask:0xf
    v_mov_b32 v70, v202 row_shl:10 row_mask:0xf bank_mask:0xf
    v_mov_b32 v71, v203 row_shl:10 row_mask:0xf bank_mask:0xf
    s_waitcnt lgkmcnt(4)
    s_nop 0
    v_mfma_f32_16x16x32_bf16 v[120:123], a[192:195], v[64:67], v[120:123]
    ds_read_b64_tr_b16 a[216:217], v24 offset:57344
    ds_read_b64_tr_b16 a[218:219], v24 offset:59392
    v_mfma_f32_16x16x32_bf16 v[120:123], a[196:199], v[68:71], v[120:123]
    ds_read_b64_tr_b16 a[220:221], v24 offset:61440
    ds_read_b64_tr_b16 a[222:223], v24 offset:63488
    v_mfma_f32_16x16x32_bf16 v[124:127], a[200:203], v[64:67], v[124:127]
    ds_read_b64_tr_b16 a[192:193], v25 offset:0
    ds_read_b64_tr_b16 a[194:195], v25 offset:2048
    v_mfma_f32_16x16x32_bf16 v[124:127], a[204:207], v[68:71], v[124:127]
    ds_read_b64_tr_b16 a[196:197], v25 offset:4096
    ds_read_b64_tr_b16 a[198:199], v25 offset:6144
    v_mov_b32 v72, v200 row_shl:12 row_mask:0xf bank_mask:0xf
    v_mov_b32 v73, v201 row_shl:12 row_mask:0xf bank_mask:0xf
    v_mov_b32 v74, v202 row_shl:12 row_mask:0xf bank_mask:0xf
    v_mov_b32 v75, v203 row_shl:12 row_mask:0xf bank_mask:0xf
    v_mov_b32 v76, v200 row_shl:14 row_mask:0xf bank_mask:0xf
    v_mov_b32 v77, v201 row_shl:14 row_mask:0xf bank_mask:0xf
    v_mov_b32 v78, v202 row_shl:14 row_mask:0xf bank_mask:0xf
    v_mov_b32 v79, v203 row_shl:14 row_mask:0xf bank_mask:0xf
    s_waitcnt lgkmcnt(4)
    s_nop 0
    v_mfma_f32_16x16x32_bf16 v[120:123], a[208:211], v[72:75], v[120:123]
    ds_read_b64_tr_b16 a[200:201], v25 offset:8192
    ds_read_b64_tr_b16 a[202:203], v25 offset:10240
    v_mfma_f32_16x16x32_bf16 v[120:123], a[212:215], v[76:79], v[120:123]
    ds_read_b64_tr_b16 a[204:205], v25 offset:12288
    ds_read_b64_tr_b16 a[206:207], v25 offset:14336
    v_mfma_f32_16x16x32_bf16 v[124:127], a[216:219], v[72:75], v[124:127]
    ds_read_b64_tr_b16 a[208:209], v25 offset:16384
    ds_read_b64_tr_b16 a[210:211], v25 offset:18432
    v_mfma_f32_16x16x32_bf16 v[124:127], a[220:223], v[76:79], v[124:127]
    ds_read_b64_tr_b16 a[212:213], v25 offset:20480
    ds_read_b64_tr_b16 a[214:215], v25 offset:22528
    v_mov_b32 v68, v204 row_shl:2 row_mask:0xf bank_mask:0xf
    v_mov_b32 v69, v205 row_shl:2 row_mask:0xf bank_mask:0xf
    v_mov_b32 v70, v206 row_shl:2 row_mask:0xf bank_mask:0xf
    v_mov_b32 v71, v207 row_shl:2 row_mask:0xf bank_mask:0xf
    s_waitcnt lgkmcnt(4)
    s_nop 0
    v_mfma_f32_16x16x32_bf16 v[120:123], a[192:195], v[204:207], v[120:123]
    ds_read_b64_tr_b16 a[216:217], v25 offset:24576
    ds_read_b64_tr_b16 a[218:219], v25 offset:26624
    v_mfma_f32_16x16x32_bf16 v[120:123], a[196:199], v[68:71], v[120:123]
    ds_read_b64_tr_b16 a[220:221], v25 offset:28672
    ds_read_b64_tr_b16 a[222:223], v25 offset:30720
    v_mfma_f32_16x16x32_bf16 v[124:127], a[200:203], v[204:207], v[124:127]
    ds_read_b64_tr_b16 a[192:193], v25 offset:32768
    ds_read_b64_tr_b16 a[194:195], v25 offset:34816
    v_mfma_f32_16x16x32_bf16 v[124:127], a[204:207], v[68:71], v[124:127]
    ds_read_b64_tr_b16 a[196:197], v25 offset:36864
    ds_read_b64_tr_b16 a[198:199], v25 offset:38912
    v_mov_b32 v72, v204 row_shl:4 row_mask:0xf bank_mask:0xf
    v_mov_b32 v73, v205 row_shl:4 row_mask:0xf bank_mask:0xf
    v_mov_b32 v74, v206 row_shl:4 row_mask:0xf bank_mask:0xf
    v_mov_b32 v75, v207 row_shl:4 row_mask:0xf bank_mask:0xf
    v_mov_b32 v76, v204 row_shl:6 row_mask:0xf bank_mask:0xf
    v_mov_b32 v77, v205 row_shl:6 row_mask:0xf bank_mask:0xf
    v_mov_b32 v78, v206 row_shl:6 row_mask:0xf bank_mask:0xf
    v_mov_b32 v79, v207 row_shl:6 row_mask:0xf bank_mask:0xf
    s_waitcnt lgkmcnt(4)
    s_nop 0
    v_mfma_f32_16x16x32_bf16 v[120:123], a[208:211], v[72:75], v[120:123]
    ds_read_b64_tr_b16 a[200:201], v25 offset:40960
    ds_read_b64_tr_b16 a[202:203], v25 offset:43008
    v_mfma_f32_16x16x32_bf16 v[120:123], a[212:215], v[76:79], v[120:123]
    ds_read_b64_tr_b16 a[204:205], v25 offset:45056
    ds_read_b64_tr_b16 a[206:207], v25 offset:47104
    v_mfma_f32_16x16x32_bf16 v[124:127], a[216:219], v[72:75], v[124:127]
    ds_read_b64_tr_b16 a[208:209], v25 offset:49152
    ds_read_b64_tr_b16 a[210:211], v25 offset:51200
    v_mfma_f32_16x16x32_bf16 v[124:127], a[220:223], v[76:79], v[124:127]
    ds_read_b64_tr_b16 a[212:213], v25 offset:53248
    ds_read_b64_tr_b16 a[214:215], v25 offset:55296
    v_mov_b32 v64, v204 row_shl:8 row_mask:0xf bank_mask:0xf
    v_mov_b32 v65, v205 row_shl:8 row_mask:0xf bank_mask:0xf
    v_mov_b32 v66, v206 row_shl:8 row_mask:0xf bank_mask:0xf
    v_mov_b32 v67, v207 row_shl:8 row_mask:0xf bank_mask:0xf
    v_mov_b32 v68, v204 row_shl:10 row_mask:0xf bank_mask:0xf
    v_mov_b32 v69, v205 row_shl:10 row_mask:0xf bank_mask:0xf
    v_mov_b32 v70, v206 row_shl:10 row_mask:0xf bank_mask:0xf
    v_mov_b32 v71, v207 row_shl:10 row_mask:0xf bank_mask:0xf
    s_waitcnt lgkmcnt(4)
    s_nop 0
    v_mfma_f32_16x16x32_bf16 v[120:123], a[192:195], v[64:67], v[120:123]
    ds_read_b64_tr_b16 a[216:217], v25 offset:57344
    ds_read_b64_tr_b16 a[218:219], v25 offset:59392
    v_mfma_f32_16x16x32_bf16 v[120:123], a[196:199], v[68:71], v[120:123]
    ds_read_b64_tr_b16 a[220:221], v25 offset:61440
    ds_read_b64_tr_b16 a[222:223], v25 offset:63488
    v_mfma_f32_16x16x32_bf16 v[124:127], a[200:203], v[64:67], v[124:127]
    ds_read_b64_tr_b16 a[192:193], v26 offset:0
    ds_read_b64_tr_b16 a[194:195], v26 offset:2048
    v_mfma_f32_16x16x32_bf16 v[124:127], a[204:207], v[68:71], v[124:127]
    ds_read_b64_tr_b16 a[196:197], v26 offset:4096
    ds_read_b64_tr_b16 a[198:199], v26 offset:6144
    v_mov_b32 v72, v204 row_shl:12 row_mask:0xf bank_mask:0xf
    v_mov_b32 v73, v205 row_shl:12 row_mask:0xf bank_mask:0xf
    v_mov_b32 v74, v206 row_shl:12 row_mask:0xf bank_mask:0xf
    v_mov_b32 v75, v207 row_shl:12 row_mask:0xf bank_mask:0xf
    v_mov_b32 v76, v204 row_shl:14 row_mask:0xf bank_mask:0xf
    v_mov_b32 v77, v205 row_shl:14 row_mask:0xf bank_mask:0xf
    v_mov_b32 v78, v206 row_shl:14 row_mask:0xf bank_mask:0xf
    v_mov_b32 v79, v207 row_shl:14 row_mask:0xf bank_mask:0xf
    s_waitcnt lgkmcnt(4)
    s_nop 0
    v_mfma_f32_16x16x32_bf16 v[120:123], a[208:211], v[72:75], v[120:123]
    ds_read_b64_tr_b16 a[200:201], v26 offset:8192
    ds_read_b64_tr_b16 a[202:203], v26 offset:10240
    v_mfma_f32_16x16x32_bf16 v[120:123], a[212:215], v[76:79], v[120:123]
    ds_read_b64_tr_b16 a[204:205], v26 offset:12288
    ds_read_b64_tr_b16 a[206:207], v26 offset:14336
    v_mfma_f32_16x16x32_bf16 v[124:127], a[216:219], v[72:75], v[124:127]
    ds_read_b64_tr_b16 a[208:209], v26 offset:16384
    ds_read_b64_tr_b16 a[210:211], v26 offset:18432
    v_mfma_f32_16x16x32_bf16 v[124:127], a[220:223], v[76:79], v[124:127]
    ds_read_b64_tr_b16 a[212:213], v26 offset:20480
    ds_read_b64_tr_b16 a[214:215], v26 offset:22528
    v_mov_b32 v68, v208 row_shl:2 row_mask:0xf bank_mask:0xf
    v_mov_b32 v69, v209 row_shl:2 row_mask:0xf bank_mask:0xf
    v_mov_b32 v70, v210 row_shl:2 row_mask:0xf bank_mask:0xf
    v_mov_b32 v71, v211 row_shl:2 row_mask:0xf bank_mask:0xf
    s_waitcnt lgkmcnt(4)
    s_nop 0
    v_mfma_f32_16x16x32_bf16 v[120:123], a[192:195], v[208:211], v[120:123]
    ds_read_b64_tr_b16 a[216:217], v26 offset:24576
    ds_read_b64_tr_b16 a[218:219], v26 offset:26624
    v_mfma_f32_16x16x32_bf16 v[120:123], a[196:199], v[68:71], v[120:123]
    ds_read_b64_tr_b16 a[220:221], v26 offset:28672
    ds_read_b64_tr_b16 a[222:223], v26 offset:30720
    v_mfma_f32_16x16x32_bf16 v[124:127], a[200:203], v[208:211], v[124:127]
    ds_read_b64_tr_b16 a[192:193], v8 offset:0
    ds_read_b64_tr_b16 a[194:195], v8 offset:2048
    v_mfma_f32_16x16x32_bf16 v[124:127], a[204:207], v[68:71], v[124:127]
    ds_read_b64_tr_b16 a[196:197], v8 offset:4096
    ds_read_b64_tr_b16 a[198:199], v8 offset:6144
    v_mov_b32 v72, v208 row_shl:4 row_mask:0xf bank_mask:0xf
    v_mov_b32 v73, v209 row_shl:4 row_mask:0xf bank_mask:0xf
    v_mov_b32 v74, v210 row_shl:4 row_mask:0xf bank_mask:0xf
    v_mov_b32 v75, v211 row_shl:4 row_mask:0xf bank_mask:0xf
    v_mov_b32 v76, v208 row_shl:6 row_mask:0xf bank_mask:0xf
    v_mov_b32 v77, v209 row_shl:6 row_mask:0xf bank_mask:0xf
    v_mov_b32 v78, v210 row_shl:6 row_mask:0xf bank_mask:0xf
    v_mov_b32 v79, v211 row_shl:6 row_mask:0xf bank_mask:0xf
    s_waitcnt lgkmcnt(4)
    s_nop 0
    v_mfma_f32_16x16x32_bf16 v[120:123], a[208:211], v[72:75], v[120:123]
    ds_read_b64_tr_b16 a[200:201], v9 offset:0
    ds_read_b64_tr_b16 a[202:203], v9 offset:2048
    v_mfma_f32_16x16x32_bf16 v[120:123], a[212:215], v[76:79], v[120:123]
    ds_read_b64_tr_b16 a[204:205], v9 offset:4096
    ds_read_b64_tr_b16 a[206:207], v9 offset:6144
    v_mfma_f32_16x16x32_bf16 v[124:127], a[216:219], v[72:75], v[124:127]
    v_mfma_f32_16x16x32_bf16 v[124:127], a[220:223], v[76:79], v[124:127]
    s_waitcnt vmcnt(4) lgkmcnt(4)
    v_mfma_f32_16x16x32_bf16 v[128:131], a[192:195], a[0:3], 0
    ds_read_b64_tr_b16 a[208:209], v10 offset:0
    ds_read_b64_tr_b16 a[210:211], v10 offset:2048
    v_mfma_f32_16x16x32_bf16 v[128:131], a[196:199], a[4:7], v[128:131]
    ds_read_b64_tr_b16 a[212:213], v10 offset:4096
    ds_read_b64_tr_b16 a[214:215], v10 offset:6144
    v_mfma_f32_16x16x32_bf16 v[132:135], a[196:199], a[12:15], 0
    buffer_load_dwordx2 a[42:43], v7, s[72:75], s57 offen offset:2560 sc1
    v_mfma_f32_16x16x32_bf16 v[132:135], a[192:195], a[8:11], v[132:135]
    v_mfma_f32_16x16x32_bf16 v[136:139], a[192:195], a[16:19], 0
    v_mfma_f32_16x16x32_bf16 v[136:139], a[196:199], a[20:23], v[136:139]
    buffer_load_dwordx4 a[44:47], v2, s[72:75], s57 offen offset:3072 sc1
    v_mfma_f32_16x16x32_bf16 v[140:143], a[196:199], a[28:31], 0
    v_mfma_f32_16x16x32_bf16 v[140:143], a[192:195], a[24:27], v[140:143]
    s_waitcnt lgkmcnt(4)
    v_mfma_f32_16x16x32_bf16 v[156:159], a[200:203], a[24:27], 0
    ds_read_b64_tr_b16 a[216:217], v11 offset:0
    ds_read_b64_tr_b16 a[218:219], v11 offset:2048
    v_mfma_f32_16x16x32_bf16 v[156:159], a[204:207], a[28:31], v[156:159]
    ds_read_b64_tr_b16 a[220:221], v11 offset:4096
    ds_read_b64_tr_b16 a[222:223], v11 offset:6144
    v_mfma_f32_16x16x32_bf16 v[152:155], a[204:207], a[20:23], 0
    buffer_load_dwordx2 a[48:49], v7, s[72:75], s58 offen offset:2048 sc1
    v_mfma_f32_16x16x32_bf16 v[152:155], a[200:203], a[16:19], v[152:155]
    v_mfma_f32_16x16x32_bf16 v[148:151], a[200:203], a[8:11], 0
    buffer_load_dwordx2 a[50:51], v7, s[72:75], s58 offen offset:2560 sc1
    v_mfma_f32_16x16x32_bf16 v[148:151], a[204:207], a[12:15], v[148:151]
    v_mfma_f32_16x16x32_bf16 v[144:147], a[204:207], a[4:7], 0
    v_mfma_f32_16x16x32_bf16 v[144:147], a[200:203], a[0:3], v[144:147]
    s_waitcnt lgkmcnt(4)
    v_mfma_f32_16x16x32_bf16 v[160:163], a[208:211], a[0:3], 0
    ds_read_b64_tr_b16 a[192:193], v8 offset:8192
    ds_read_b64_tr_b16 a[194:195], v8 offset:10240
    v_mfma_f32_16x16x32_bf16 v[160:163], a[212:215], a[4:7], v[160:163]
    ds_read_b64_tr_b16 a[196:197], v8 offset:12288
    ds_read_b64_tr_b16 a[198:199], v8 offset:14336
    v_mfma_f32_16x16x32_bf16 v[164:167], a[212:215], a[12:15], 0
    buffer_load_dwordx4 a[52:55], v2, s[72:75], s58 offen offset:3072 sc1
    v_mfma_f32_16x16x32_bf16 v[164:167], a[208:211], a[8:11], v[164:167]
    buffer_load_dwordx2 a[56:57], v7, s[72:75], s59 offen offset:2048 sc1
    v_mfma_f32_16x16x32_bf16 v[168:171], a[208:211], a[16:19], 0
    v_mfma_f32_16x16x32_bf16 v[168:171], a[212:215], a[20:23], v[168:171]
    v_mfma_f32_16x16x32_bf16 v[172:175], a[212:215], a[28:31], 0
    v_mfma_f32_16x16x32_bf16 v[172:175], a[208:211], a[24:27], v[172:175]
    s_waitcnt lgkmcnt(4)
    v_mfma_f32_16x16x32_bf16 v[188:191], a[216:219], a[24:27], 0
    ds_read_b64_tr_b16 a[200:201], v9 offset:8192
    ds_read_b64_tr_b16 a[202:203], v9 offset:10240
    v_mfma_f32_16x16x32_bf16 v[188:191], a[220:223], a[28:31], v[188:191]
    ds_read_b64_tr_b16 a[204:205], v9 offset:12288
    ds_read_b64_tr_b16 a[206:207], v9 offset:14336
    v_mfma_f32_16x16x32_bf16 v[184:187], a[220:223], a[20:23], 0
    buffer_load_dwordx2 a[58:59], v7, s[72:75], s59 offen offset:2560 sc1
    v_mfma_f32_16x16x32_bf16 v[184:187], a[216:219], a[16:19], v[184:187]
    buffer_load_dwordx4 a[60:63], v2, s[72:75], s59 offen offset:3072 sc1
    v_mfma_f32_16x16x32_bf16 v[180:183], a[216:219], a[8:11], 0
    s_add_u32 s56, s56, 4096
    s_add_u32 s57, s57, 4096
    s_add_u32 s58, s58, 4096
    v_mfma_f32_16x16x32_bf16 v[180:183], a[220:223], a[12:15], v[180:183]
    s_add_u32 s59, s59, 4096
    v_mfma_f32_16x16x32_bf16 v[176:179], a[220:223], a[4:7], 0
    buffer_load_dwordx4 a[64:67], v2, s[72:75], s56 offen offset:0 sc1
    v_mfma_f32_16x16x32_bf16 v[176:179], a[216:219], a[0:3], v[176:179]
    s_waitcnt lgkmcnt(4)
    v_mfma_f32_16x16x32_bf16 v[192:195], a[192:195], a[0:3], 0
    ds_read_b64_tr_b16 a[208:209], v10 offset:8192
    ds_read_b64_tr_b16 a[210:211], v10 offset:10240
    v_mfma_f32_16x16x32_bf16 v[192:195], a[196:199], a[4:7], v[192:195]
    ds_read_b64_tr_b16 a[212:213], v10 offset:12288
    ds_read_b64_tr_b16 a[214:215], v10 offset:14336
    v_mfma_f32_16x16x32_bf16 v[196:199], a[196:199], a[12:15], 0
    buffer_load_dwordx4 a[68:71], v2, s[72:75], s56 offen offset:1024 sc1
    v_mfma_f32_16x16x32_bf16 v[196:199], a[192:195], a[8:11], v[196:199]
    v_mfma_f32_16x16x32_bf16 v[200:203], a[192:195], a[16:19], 0
    v_mfma_f32_16x16x32_bf16 v[200:203], a[196:199], a[20:23], v[200:203]
    buffer_load_dwordx4 a[72:75], v2, s[72:75], s57 offen offset:0 sc1
    v_mfma_f32_16x16x32_bf16 v[204:207], a[196:199], a[28:31], 0
    v_mfma_f32_16x16x32_bf16 v[204:207], a[192:195], a[24:27], v[204:207]
    s_waitcnt lgkmcnt(4)
    v_mfma_f32_16x16x32_bf16 v[220:223], a[200:203], a[24:27], 0
    ds_read_b64_tr_b16 a[216:217], v11 offset:8192
    ds_read_b64_tr_b16 a[218:219], v11 offset:10240
    v_mfma_f32_16x16x32_bf16 v[220:223], a[204:207], a[28:31], v[220:223]
    ds_read_b64_tr_b16 a[220:221], v11 offset:12288
    ds_read_b64_tr_b16 a[222:223], v11 offset:14336
    v_mfma_f32_16x16x32_bf16 v[216:219], a[204:207], a[20:23], 0
    buffer_load_dwordx4 a[76:79], v2, s[72:75], s57 offen offset:1024 sc1
    v_mfma_f32_16x16x32_bf16 v[216:219], a[200:203], a[16:19], v[216:219]
    v_mfma_f32_16x16x32_bf16 v[212:215], a[200:203], a[8:11], 0
    buffer_load_dwordx4 a[80:83], v2, s[72:75], s58 offen offset:0 sc1
    v_mfma_f32_16x16x32_bf16 v[212:215], a[204:207], a[12:15], v[212:215]
    v_mfma_f32_16x16x32_bf16 v[208:211], a[204:207], a[4:7], 0
    v_mfma_f32_16x16x32_bf16 v[208:211], a[200:203], a[0:3], v[208:211]
    s_waitcnt lgkmcnt(4)
    v_mfma_f32_16x16x32_bf16 v[224:227], a[208:211], a[0:3], 0
    s_waitcnt lgkmcnt(0)
    v_mfma_f32_16x16x32_bf16 v[224:227], a[212:215], a[4:7], v[224:227]
    s_barrier
    v_mfma_f32_16x16x32_bf16 v[228:231], a[212:215], a[12:15], 0
    ds_read_b64_tr_b16 a[192:193], v8 offset:16384
    ds_read_b64_tr_b16 a[194:195], v8 offset:18432
    v_mfma_f32_16x16x32_bf16 v[228:231], a[208:211], a[8:11], v[228:231]
    ds_read_b64_tr_b16 a[196:197], v8 offset:20480
    ds_read_b64_tr_b16 a[198:199], v8 offset:22528
    v_mfma_f32_16x16x32_bf16 v[232:235], a[208:211], a[16:19], 0
    buffer_load_dwordx4 a[84:87], v2, s[72:75], s58 offen offset:1024 sc1
    v_mfma_f32_16x16x32_bf16 v[232:235], a[212:215], a[20:23], v[232:235]
    buffer_load_dwordx4 a[88:91], v2, s[72:75], s59 offen offset:0 sc1
    v_mfma_f32_16x16x32_bf16 v[236:239], a[212:215], a[28:31], 0
    buffer_load_dwordx4 a[92:95], v2, s[72:75], s59 offen offset:1024 sc1
    v_mfma_f32_16x16x32_bf16 v[236:239], a[208:211], a[24:27], v[236:239]
    s_waitcnt vmcnt(8) lgkmcnt(4)
    v_mfma_f32_16x16x32_bf16 v[252:255], a[216:219], a[24:27], 0
    v_mfma_f32_16x16x32_bf16 v[252:255], a[220:223], a[28:31], v[252:255]
    v_mfma_f32_16x16x32_bf16 v[248:251], a[220:223], a[20:23], 0
    ds_read_b64_tr_b16 a[200:201], v9 offset:16384
    ds_read_b64_tr_b16 a[202:203], v9 offset:18432
    v_mfma_f32_16x16x32_bf16 v[248:251], a[216:219], a[16:19], v[248:251]
    ds_read_b64_tr_b16 a[204:205], v9 offset:20480
    ds_read_b64_tr_b16 a[206:207], v9 offset:22528
    v_mfma_f32_16x16x32_bf16 v[244:247], a[216:219], a[8:11], 0
    v_mfma_f32_16x16x32_bf16 v[244:247], a[220:223], a[12:15], v[244:247]
    v_mfma_f32_16x16x32_bf16 v[240:243], a[220:223], a[4:7], 0
    v_mfma_f32_16x16x32_bf16 v[240:243], a[216:219], a[0:3], v[240:243]
    s_waitcnt lgkmcnt(4)
    v_mfma_f32_16x16x32_bf16 v[128:131], a[192:195], a[32:35], v[128:131]
    ds_read_b64_tr_b16 a[208:209], v10 offset:16384
    ds_read_b64_tr_b16 a[210:211], v10 offset:18432
    v_mfma_f32_16x16x32_bf16 v[128:131], a[196:199], a[36:39], v[128:131]
    ds_read_b64_tr_b16 a[212:213], v10 offset:20480
    ds_read_b64_tr_b16 a[214:215], v10 offset:22528
    v_mfma_f32_16x16x32_bf16 v[132:135], a[196:199], a[44:47], v[132:135]
    buffer_load_dwordx2 v[32:33], v4, s[72:75], s38 offen offset:0 sc1
    v_mfma_f32_16x16x32_bf16 v[132:135], a[192:195], a[40:43], v[132:135]
    ds_write_b128 v6, v[120:123]
    ds_write_b128 v6, v[124:127] offset:256
    v_mfma_f32_16x16x32_bf16 v[136:139], a[192:195], a[48:51], v[136:139]
    s_getpc_b64 s[96:97]
KA_pc1:
    s_add_u32 s96, s96, KB_x4-KA_pc1
    s_addc_u32 s97, s97, 0
    s_mov_b32 s98, KA_end-KB_x4
    s_mov_b32 s99, 0x20000
    v_mfma_f32_16x16x32_bf16 v[136:139], a[196:199], a[52:55], v[136:139]
    s_lshr_b32 s60, s2, 3
    s_lshl_b32 s60, s60, 2
    s_add_u32 s60, s60, s3
    v_mfma_f32_16x16x32_bf16 v[140:143], a[196:199], a[60:63], v[140:143]
    buffer_load_dwordx2 v[34:35], v4, s[72:75], s38 offen offset:128 sc1
    v_mfma_f32_16x16x32_bf16 v[140:143], a[192:195], a[56:59], v[140:143]
    s_waitcnt lgkmcnt(6)
    s_lshl_b32 s60, s60, 7
    v_lshlrev_b32 v30, 14, v1
    v_mfma_f32_16x16x32_bf16 v[156:159], a[200:203], a[56:59], v[156:159]
    ds_read_b64_tr_b16 a[216:217], v11 offset:16384
    ds_read_b64_tr_b16 a[218:219], v11 offset:18432
    v_mfma_f32_16x16x32_bf16 v[156:159], a[204:207], a[60:63], v[156:159]
    ds_read_b64_tr_b16 a[220:221], v11 offset:20480
    ds_read_b64_tr_b16 a[222:223], v11 offset:22528
    v_mfma_f32_16x16x32_bf16 v[152:155], a[204:207], a[52:55], v[152:155]
    buffer_load_dwordx4 a[96:99], v2, s[72:75], s56 offen offset:2048 sc1
    v_mfma_f32_16x16x32_bf16 v[152:155], a[200:203], a[48:51], v[152:155]
    buffer_load_dword v28, v30, s[96:99], s60 offen
    v_mfma_f32_16x16x32_bf16 v[148:151], a[200:203], a[40:43], v[148:151]
    v_mfma_f32_16x16x32_bf16 v[148:151], a[204:207], a[44:47], v[148:151]
    v_mfma_f32_16x16x32_bf16 v[144:147], a[204:207], a[36:39], v[144:147]
    buffer_load_dwordx2 a[100:101], v7, s[72:75], s56 offen offset:3072 sc1
    v_mfma_f32_16x16x32_bf16 v[144:147], a[200:203], a[32:35], v[144:147]
    s_waitcnt lgkmcnt(6)
    v_mfma_f32_16x16x32_bf16 v[160:163], a[208:211], a[32:35], v[160:163]
    ds_read_b64_tr_b16 a[192:193], v8 offset:24576
    ds_read_b64_tr_b16 a[194:195], v8 offset:26624
    v_mfma_f32_16x16x32_bf16 v[160:163], a[212:215], a[36:39], v[160:163]
    ds_read_b64_tr_b16 a[196:197], v8 offset:28672
    ds_read_b64_tr_b16 a[198:199], v8 offset:30720
    v_mfma_f32_16x16x32_bf16 v[164:167], a[212:215], a[44:47], v[164:167]
    buffer_load_dwordx2 a[102:103], v7, s[72:75], s56 offen offset:3584 sc1
    v_mfma_f32_16x16x32_bf16 v[164:167], a[208:211], a[40:43], v[164:167]
    v_mfma_f32_16x16x32_bf16 v[168:171], a[208:211], a[48:51], v[168:171]
    v_mfma_f32_16x16x32_bf16 v[168:171], a[212:215], a[52:55], v[168:171]
    v_mfma_f32_16x16x32_bf16 v[172:175], a[212:215], a[60:63], v[172:175]
    buffer_load_dwordx4 a[104:107], v2, s[72:75], s57 offen offset:2048 sc1
    v_mfma_f32_16x16x32_bf16 v[172:175], a[208:211], a[56:59], v[172:175]
    s_waitcnt lgkmcnt(4)
    v_mfma_f32_16x16x32_bf16 v[188:191], a[216:219], a[56:59], v[188:191]
    ds_read_b64_tr_b16 a[200:201], v9 offset:24576
    ds_read_b64_tr_b16 a[202:203], v9 offset:26624
    v_mfma_f32_16x16x32_bf16 v[188:191], a[220:223], a[60:63], v[188:191]
    ds_read_b64_tr_b16 a[204:205], v9 offset:28672
    ds_read_b64_tr_b16 a[206:207], v9 offset:30720
    v_mfma_f32_16x16x32_bf16 v[184:187], a[220:223], a[52:55], v[184:187]
    buffer_load_dwordx2 a[108:109], v7, s[72:75], s57 offen offset:3072 sc1
    v_mfma_f32_16x16x32_bf16 v[184:187], a[216:219], a[48:51], v[184:187]
    v_mfma_f32_16x16x32_bf16 v[180:183], a[216:219], a[40:43], v[180:183]
    v_mfma_f32_16x16x32_bf16 v[180:183], a[220:223], a[44:47], v[180:183]
    v_mfma_f32_16x16x32_bf16 v[176:179], a[220:223], a[36:39], v[176:179]
    buffer_load_dwordx2 a[110:111], v7, s[72:75], s57 offen offset:3584 sc1
    v_mfma_f32_16x16x32_bf16 v[176:179], a[216:219], a[32:35], v[176:179]
    s_waitcnt lgkmcnt(4)
    v_mfma_f32_16x16x32_bf16 v[192:195], a[192:195], a[32:35], v[192:195]
    ds_read_b64_tr_b16 a[208:209], v10 offset:24576
    ds_read_b64_tr_b16 a[210:211], v10 offset:26624
    v_mfma_f32_16x16x32_bf16 v[192:195], a[196:199], a[36:39], v[192:195]
    ds_read_b64_tr_b16 a[212:213], v10 offset:28672
    ds_read_b64_tr_b16 a[214:215], v10 offset:30720
    v_mfma_f32_16x16x32_bf16 v[196:199], a[196:199], a[44:47], v[196:199]
    buffer_load_dwordx4 a[112:115], v2, s[72:75], s58 offen offset:2048 sc1
    v_mfma_f32_16x16x32_bf16 v[196:199], a[192:195], a[40:43], v[196:199]
    v_mfma_f32_16x16x32_bf16 v[200:203], a[192:195], a[48:51], v[200:203]
    v_mfma_f32_16x16x32_bf16 v[200:203], a[196:199], a[52:55], v[200:203]
    v_mfma_f32_16x16x32_bf16 v[204:207], a[196:199], a[60:63], v[204:207]
    buffer_load_dwordx2 a[116:117], v7, s[72:75], s58 offen offset:3072 sc1
    v_mfma_f32_16x16x32_bf16 v[204:207], a[192:195], a[56:59], v[204:207]
    s_waitcnt lgkmcnt(4)
    v_mfma_f32_16x16x32_bf16 v[220:223], a[200:203], a[56:59], v[220:223]
    ds_read_b64_tr_b16 a[216:217], v11 offset:24576
    ds_read_b64_tr_b16 a[218:219], v11 offset:26624
    v_mfma_f32_16x16x32_bf16 v[220:223], a[204:207], a[60:63], v[220:223]
    ds_read_b64_tr_b16 a[220:221], v11 offset:28672
    ds_read_b64_tr_b16 a[222:223], v11 offset:30720
    v_mfma_f32_16x16x32_bf16 v[216:219], a[204:207], a[52:55], v[216:219]
    buffer_load_dwordx2 a[118:119], v7, s[72:75], s58 offen offset:3584 sc1
    v_mfma_f32_16x16x32_bf16 v[216:219], a[200:203], a[48:51], v[216:219]
    v_mfma_f32_16x16x32_bf16 v[212:215], a[200:203], a[40:43], v[212:215]
    v_mfma_f32_16x16x32_bf16 v[212:215], a[204:207], a[44:47], v[212:215]
    v_mfma_f32_16x16x32_bf16 v[208:211], a[204:207], a[36:39], v[208:211]
    buffer_load_dwordx4 a[120:123], v2, s[72:75], s59 offen offset:2048 sc1
    v_mfma_f32_16x16x32_bf16 v[208:211], a[200:203], a[32:35], v[208:211]
    s_waitcnt lgkmcnt(4)
    v_mfma_f32_16x16x32_bf16 v[224:227], a[208:211], a[32:35], v[224:227]
    s_waitcnt lgkmcnt(0)
    v_mfma_f32_16x16x32_bf16 v[224:227], a[212:215], a[36:39], v[224:227]
    s_barrier
    v_mfma_f32_16x16x32_bf16 v[228:231], a[212:215], a[44:47], v[228:231]
    ds_read_b64_tr_b16 a[192:193], v8 offset:32768
    ds_read_b64_tr_b16 a[194:195], v8 offset:34816
    v_mfma_f32_16x16x32_bf16 v[228:231], a[208:211], a[40:43], v[228:231]
    ds_read_b64_tr_b16 a[196:197], v8 offset:36864
    ds_read_b64_tr_b16 a[198:199], v8 offset:38912
    v_mfma_f32_16x16x32_bf16 v[232:235], a[208:211], a[48:51], v[232:235]
    buffer_load_dwordx2 a[124:125], v7, s[72:75], s59 offen offset:3072 sc1
    v_mfma_f32_16x16x32_bf16 v[232:235], a[212:215], a[52:55], v[232:235]
    v_mfma_f32_16x16x32_bf16 v[236:239], a[212:215], a[60:63], v[236:239]
    buffer_load_dwordx2 a[126:127], v7, s[72:75], s59 offen offset:3584 sc1
    v_mfma_f32_16x16x32_bf16 v[236:239], a[208:211], a[56:59], v[236:239]
    s_waitcnt vmcnt(15) lgkmcnt(4)
    s_add_u32 s56, s56, 4096
    s_add_u32 s57, s57, 4096
    v_mfma_f32_16x16x32_bf16 v[252:255], a[216:219], a[56:59], v[252:255]
    s_add_u32 s58, s58, 4096
    s_add_u32 s59, s59, 4096
    v_mfma_f32_16x16x32_bf16 v[252:255], a[220:223], a[60:63], v[252:255]
    v_mfma_f32_16x16x32_bf16 v[248:251], a[220:223], a[52:55], v[248:251]
    ds_read_b64_tr_b16 a[200:201], v9 offset:32768
    ds_read_b64_tr_b16 a[202:203], v9 offset:34816
    v_mfma_f32_16x16x32_bf16 v[248:251], a[216:219], a[48:51], v[248:251]
    ds_read_b64_tr_b16 a[204:205], v9 offset:36864
    ds_read_b64_tr_b16 a[206:207], v9 offset:38912
    v_mfma_f32_16x16x32_bf16 v[244:247], a[216:219], a[40:43], v[244:247]
    v_mfma_f32_16x16x32_bf16 v[244:247], a[220:223], a[44:47], v[244:247]
    v_mfma_f32_16x16x32_bf16 v[240:243], a[220:223], a[36:39], v[240:243]
    v_mfma_f32_16x16x32_bf16 v[240:243], a[216:219], a[32:35], v[240:243]
    s_waitcnt lgkmcnt(4)
    v_mfma_f32_16x16x32_bf16 v[128:131], a[192:195], a[64:67], v[128:131]
    s_waitcnt vmcnt(13)
    ds_read_b64_tr_b16 a[208:209], v10 offset:32768
    ds_read_b64_tr_b16 a[210:211], v10 offset:34816
    v_mfma_f32_16x16x32_bf16 v[128:131], a[196:199], a[68:71], v[128:131]
    ds_read_b64_tr_b16 a[212:213], v10 offset:36864
    ds_read_b64_tr_b16 a[214:215], v10 offset:38912
    v_mfma_f32_16x16x32_bf16 v[132:135], a[196:199], a[76:79], v[132:135]
    buffer_load_dwordx2 v[36:37], v4, s[72:75], s38 offen offset:1024 sc1
    v_mfma_f32_16x16x32_bf16 v[132:135], a[192:195], a[72:75], v[132:135]
    ds_read_b128 v[64:67], v5 offset:0
    ds_read_b128 v[68:71], v5 offset:512
    v_mfma_f32_16x16x32_bf16 v[136:139], a[192:195], a[80:83], v[136:139]
    v_add_f32 v48, v32, v34
    v_mov_b32 v13, v48
    v_mfma_f32_16x16x32_bf16 v[136:139], a[196:199], a[84:87], v[136:139]
    v_mfma_f32_16x16x32_bf16 v[140:143], a[196:199], a[92:95], v[140:143]
    buffer_load_dwordx2 v[38:39], v4, s[72:75], s38 offen offset:1152 sc1
    v_mfma_f32_16x16x32_bf16 v[140:143], a[192:195], a[88:91], v[140:143]
    s_waitcnt lgkmcnt(6)
    v_permlane32_swap_b32 v48, v13
    v_add_f32 v48, v48, v13
    v_mfma_f32_16x16x32_bf16 v[156:159], a[200:203], a[88:91], v[156:159]
    ds_read_b64_tr_b16 a[216:217], v11 offset:32768
    ds_read_b64_tr_b16 a[218:219], v11 offset:34816
    v_mfma_f32_16x16x32_bf16 v[156:159], a[204:207], a[92:95], v[156:159]
    ds_read_b64_tr_b16 a[220:221], v11 offset:36864
    ds_read_b64_tr_b16 a[222:223], v11 offset:38912
    v_mfma_f32_16x16x32_bf16 v[152:155], a[204:207], a[84:87], v[152:155]
    buffer_load_dwordx2 v[40:41], v4, s[72:75], s38 offen offset:2048 sc1
    v_mfma_f32_16x16x32_bf16 v[152:155], a[200:203], a[80:83], v[152:155]
    ds_read_b128 v[72:75], v5 offset:64
    ds_read_b128 v[76:79], v5 offset:576
    v_mfma_f32_16x16x32_bf16 v[148:151], a[200:203], a[72:75], v[148:151]
    v_mov_b32 v13, v48
    v_mfma_f32_16x16x32_bf16 v[148:151], a[204:207], a[76:79], v[148:151]
    v_mfma_f32_16x16x32_bf16 v[144:147], a[204:207], a[68:71], v[144:147]
    buffer_load_dwordx2 v[42:43], v4, s[72:75], s38 offen offset:2176 sc1
    v_mfma_f32_16x16x32_bf16 v[144:147], a[200:203], a[64:67], v[144:147]
    s_waitcnt lgkmcnt(8)
    v_permlane16_swap_b32 v48, v13
    v_add_f32 v48, v48, v13
    v_mfma_f32_16x16x32_bf16 v[160:163], a[208:211], a[64:67], v[160:163]
    ds_read_b64_tr_b16 a[192:193], v8 offset:40960
    ds_read_b64_tr_b16 a[194:195], v8 offset:43008
    v_mfma_f32_16x16x32_bf16 v[160:163], a[212:215], a[68:71], v[160:163]
    ds_read_b64_tr_b16 a[196:197], v8 offset:45056
    ds_read_b64_tr_b16 a[198:199], v8 offset:47104
    v_mfma_f32_16x16x32_bf16 v[164:167], a[212:215], a[76:79], v[164:167]
    buffer_load_dwordx2 v[44:45], v4, s[72:75], s38 offen offset:3072 sc1
    v_mfma_f32_16x16x32_bf16 v[164:167], a[208:211], a[72:75], v[164:167]
    ds_read_b128 v[80:83], v5 offset:128
    ds_read_b128 v[84:87], v5 offset:640
    v_mfma_f32_16x16x32_bf16 v[168:171], a[208:211], a[80:83], v[168:171]
    v_add_f32 v33, v33, v35
    v_mov_b32 v13, v33
    v_mfma_f32_16x16x32_bf16 v[168:171], a[212:215], a[84:87], v[168:171]
    v_mfma_f32_16x16x32_bf16 v[172:175], a[212:215], a[92:95], v[172:175]
    buffer_load_dwordx2 v[46:47], v4, s[72:75], s38 offen offset:3200 sc1
    v_mfma_f32_16x16x32_bf16 v[172:175], a[208:211], a[88:91], v[172:175]
    s_waitcnt lgkmcnt(8)
    v_permlane32_swap_b32 v33, v13
    v_add_f32 v33, v33, v13
    v_mfma_f32_16x16x32_bf16 v[188:191], a[216:219], a[88:91], v[188:191]
    ds_read_b64_tr_b16 a[200:201], v9 offset:40960
    ds_read_b64_tr_b16 a[202:203], v9 offset:43008
    v_mfma_f32_16x16x32_bf16 v[188:191], a[220:223], a[92:95], v[188:191]
    ds_read_b64_tr_b16 a[204:205], v9 offset:45056
    ds_read_b64_tr_b16 a[206:207], v9 offset:47104
    v_mfma_f32_16x16x32_bf16 v[184:187], a[220:223], a[84:87], v[184:187]
    buffer_load_dwordx4 a[0:3], v2, s[72:75], s56 offen offset:0 sc1
    v_mfma_f32_16x16x32_bf16 v[184:187], a[216:219], a[80:83], v[184:187]
    ds_read_b128 v[88:91], v5 offset:192
    ds_read_b128 v[92:95], v5 offset:704
    v_mfma_f32_16x16x32_bf16 v[180:183], a[216:219], a[72:75], v[180:183]
    v_mov_b32 v13, v33
    v_mfma_f32_16x16x32_bf16 v[180:183], a[220:223], a[76:79], v[180:183]
    v_mfma_f32_16x16x32_bf16 v[176:179], a[220:223], a[68:71], v[176:179]
    buffer_load_dwordx4 a[4:7], v2, s[72:75], s56 offen offset:1024 sc1
    v_mfma_f32_16x16x32_bf16 v[176:179], a[216:219], a[64:67], v[176:179]
    s_waitcnt lgkmcnt(8)
    v_permlane16_swap_b32 v33, v13
    v_add_f32 v33, v33, v13
    v_mfma_f32_16x16x32_bf16 v[192:195], a[192:195], a[64:67], v[192:195]
    ds_read_b64_tr_b16 a[208:209], v10 offset:40960
    ds_read_b64_tr_b16 a[210:211], v10 offset:43008
    v_mfma_f32_16x16x32_bf16 v[192:195], a[196:199], a[68:71], v[192:195]
    ds_read_b64_tr_b16 a[212:213], v10 offset:45056
    ds_read_b64_tr_b16 a[214:215], v10 offset:47104
    v_mfma_f32_16x16x32_bf16 v[196:199], a[196:199], a[76:79], v[196:199]
    buffer_load_dwordx4 a[8:11], v2, s[72:75], s57 offen offset:0 sc1
    v_mfma_f32_16x16x32_bf16 v[196:199], a[192:195], a[72:75], v[196:199]
    v_mul_f32 v48, 0xbacccccd, v48
    v_mul_f32 v33, 0x3acccccd, v33
    v_mfma_f32_16x16x32_bf16 v[200:203], a[192:195], a[80:83], v[200:203]
    v_fma_f32 v33, -v48, v48, v33
    v_max_f32 v33, 0, v33
    v_mfma_f32_16x16x32_bf16 v[200:203], a[196:199], a[84:87], v[200:203]
    v_add_f32 v20, 0x3727c5ac, v33
    v_mfma_f32_16x16x32_bf16 v[204:207], a[196:199], a[92:95], v[204:207]
    buffer_load_dwordx4 a[12:15], v2, s[72:75], s57 offen offset:1024 sc1
    v_mfma_f32_16x16x32_bf16 v[204:207], a[192:195], a[88:91], v[204:207]
    s_waitcnt lgkmcnt(6)
    v_rsq_f32 v32, v20
    v_mfma_f32_16x16x32_bf16 v[220:223], a[200:203], a[88:91], v[220:223]
    ds_read_b64_tr_b16 a[216:217], v11 offset:40960
    ds_read_b64_tr_b16 a[218:219], v11 offset:43008
    v_mfma_f32_16x16x32_bf16 v[220:223], a[204:207], a[92:95], v[220:223]
    ds_read_b64_tr_b16 a[220:221], v11 offset:45056
    ds_read_b64_tr_b16 a[222:223], v11 offset:47104
    v_mfma_f32_16x16x32_bf16 v[216:219], a[204:207], a[84:87], v[216:219]
    buffer_load_dwordx4 a[16:19], v2, s[72:75], s58 offen offset:0 sc1
    v_mfma_f32_16x16x32_bf16 v[216:219], a[200:203], a[80:83], v[216:219]
    v_mul_f32 v52, v20, v32
    v_mul_f32 v56, 0xc0135761, v32
    v_mfma_f32_16x16x32_bf16 v[212:215], a[200:203], a[72:75], v[212:215]
    v_mul_f32 v60, 0xbdd2d3e8, v32
    v_mul_f32 v32, v32, v32
    v_mfma_f32_16x16x32_bf16 v[212:215], a[204:207], a[76:79], v[212:215]
    v_mul_f32 v60, v60, v32
    v_mfma_f32_16x16x32_bf16 v[208:211], a[204:207], a[68:71], v[208:211]
    buffer_load_dwordx4 a[20:23], v2, s[72:75], s58 offen offset:1024 sc1
    v_mfma_f32_16x16x32_bf16 v[208:211], a[200:203], a[64:67], v[208:211]
    s_waitcnt lgkmcnt(4)
    v_mfma_f32_16x16x32_bf16 v[224:227], a[208:211], a[64:67], v[224:227]
    ds_read_b64_tr_b16 a[192:193], v8 offset:49152
    ds_read_b64_tr_b16 a[194:195], v8 offset:51200
    v_mfma_f32_16x16x32_bf16 v[224:227], a[212:215], a[68:71], v[224:227]
    ds_read_b64_tr_b16 a[196:197], v8 offset:53248
    ds_read_b64_tr_b16 a[198:199], v8 offset:55296
    v_mfma_f32_16x16x32_bf16 v[228:231], a[212:215], a[76:79], v[228:231]
    buffer_load_dwordx4 a[24:27], v2, s[72:75], s59 offen offset:0 sc1
    v_mfma_f32_16x16x32_bf16 v[228:231], a[208:211], a[72:75], v[228:231]
    v_mfma_f32_16x16x32_bf16 v[232:235], a[208:211], a[80:83], v[232:235]
    v_mfma_f32_16x16x32_bf16 v[232:235], a[212:215], a[84:87], v[232:235]
    v_mfma_f32_16x16x32_bf16 v[236:239], a[212:215], a[92:95], v[236:239]
    buffer_load_dwordx4 a[28:31], v2, s[72:75], s59 offen offset:1024 sc1
    v_mfma_f32_16x16x32_bf16 v[236:239], a[208:211], a[88:91], v[236:239]
    s_waitcnt vmcnt(14) lgkmcnt(4)
    v_mfma_f32_16x16x32_bf16 v[252:255], a[216:219], a[88:91], v[252:255]
    v_mfma_f32_16x16x32_bf16 v[252:255], a[220:223], a[92:95], v[252:255]
    v_mfma_f32_16x16x32_bf16 v[248:251], a[220:223], a[84:87], v[248:251]
    ds_read_b64_tr_b16 a[200:201], v9 offset:49152
    ds_read_b64_tr_b16 a[202:203], v9 offset:51200
    v_mfma_f32_16x16x32_bf16 v[248:251], a[216:219], a[80:83], v[248:251]
    ds_read_b64_tr_b16 a[204:205], v9 offset:53248
    ds_read_b64_tr_b16 a[206:207], v9 offset:55296
    v_mfma_f32_16x16x32_bf16 v[244:247], a[216:219], a[72:75], v[244:247]
    v_mfma_f32_16x16x32_bf16 v[244:247], a[220:223], a[76:79], v[244:247]
    v_mfma_f32_16x16x32_bf16 v[240:243], a[220:223], a[68:71], v[240:243]
    v_mfma_f32_16x16x32_bf16 v[240:243], a[216:219], a[64:67], v[240:243]
    s_waitcnt lgkmcnt(4)
    v_mfma_f32_16x16x32_bf16 v[128:131], a[192:195], a[96:99], v[128:131]
    s_waitcnt vmcnt(8)
    ds_read_b64_tr_b16 a[208:209], v10 offset:49152
    ds_read_b64_tr_b16 a[210:211], v10 offset:51200
    v_mfma_f32_16x16x32_bf16 v[128:131], a[196:199], a[100:103], v[128:131]
    ds_read_b64_tr_b16 a[212:213], v10 offset:53248
    ds_read_b64_tr_b16 a[214:215], v10 offset:55296
    v_mfma_f32_16x16x32_bf16 v[132:135], a[196:199], a[108:111], v[132:135]
    buffer_load_dwordx4 a[32:35], v2, s[72:75], s56 offen offset:2048 sc1
    v_mfma_f32_16x16x32_bf16 v[132:135], a[192:195], a[104:107], v[132:135]
    ds_read_b128 v[96:99], v5 offset:256
    ds_read_b128 v[100:103], v5 offset:768
    v_mfma_f32_16x16x32_bf16 v[136:139], a[192:195], a[112:115], v[136:139]
    v_add_f32 v49, v36, v38
    v_mov_b32 v13, v49
    v_mfma_f32_16x16x32_bf16 v[136:139], a[196:199], a[116:119], v[136:139]
    v_add_f32 v50, v40, v42
    v_mov_b32 v14, v50
    v_mfma_f32_16x16x32_bf16 v[140:143], a[196:199], a[124:127], v[140:143]
    buffer_load_dwordx4 a[36:39], v2, s[72:75], s56 offen offset:3072 sc1
    v_mfma_f32_16x16x32_bf16 v[140:143], a[192:195], a[120:123], v[140:143]
    s_waitcnt lgkmcnt(6)
    v_permlane32_swap_b32 v49, v13
    v_add_f32 v49, v49, v13
    v_mfma_f32_16x16x32_bf16 v[156:159], a[200:203], a[120:123], v[156:159]
    ds_read_b64_tr_b16 a[216:217], v11 offset:49152
    ds_read_b64_tr_b16 a[218:219], v11 offset:51200
    v_mfma_f32_16x16x32_bf16 v[156:159], a[204:207], a[124:127], v[156:159]
    ds_read_b64_tr_b16 a[220:221], v11 offset:53248
    ds_read_b64_tr_b16 a[222:223], v11 offset:55296
    v_mfma_f32_16x16x32_bf16 v[152:155], a[204:207], a[116:119], v[152:155]
    buffer_load_dwordx4 a[40:43], v2, s[72:75], s57 offen offset:2048 sc1
    v_mfma_f32_16x16x32_bf16 v[152:155], a[200:203], a[112:115], v[152:155]
    ds_read_b128 v[104:107], v5 offset:320
    ds_read_b128 v[108:111], v5 offset:832
    v_mfma_f32_16x16x32_bf16 v[148:151], a[200:203], a[104:107], v[148:151]
    v_mov_b32 v13, v49
    v_permlane32_swap_b32 v50, v14
    v_mfma_f32_16x16x32_bf16 v[148:151], a[204:207], a[108:111], v[148:151]
    v_add_f32 v50, v50, v14
    v_mov_b32 v14, v50
    v_mfma_f32_16x16x32_bf16 v[144:147], a[204:207], a[100:103], v[144:147]
    buffer_load_dwordx4 a[44:47], v2, s[72:75], s57 offen offset:3072 sc1
    v_mfma_f32_16x16x32_bf16 v[144:147], a[200:203], a[96:99], v[144:147]
    s_waitcnt lgkmcnt(8)
    v_permlane16_swap_b32 v49, v13
    v_add_f32 v49, v49, v13
    v_mfma_f32_16x16x32_bf16 v[160:163], a[208:211], a[96:99], v[160:163]
    ds_read_b64_tr_b16 a[192:193], v8 offset:57344
    ds_read_b64_tr_b16 a[194:195], v8 offset:59392
    v_mfma_f32_16x16x32_bf16 v[160:163], a[212:215], a[100:103], v[160:163]
    ds_read_b64_tr_b16 a[196:197], v8 offset:61440
    ds_read_b64_tr_b16 a[198:199], v8 offset:63488
    v_mfma_f32_16x16x32_bf16 v[164:167], a[212:215], a[108:111], v[164:167]
    buffer_load_dwordx4 a[48:51], v2, s[72:75], s58 offen offset:2048 sc1
    v_mfma_f32_16x16x32_bf16 v[164:167], a[208:211], a[104:107], v[164:167]
    ds_read_b128 v[112:115], v5 offset:384
    ds_read_b128 v[116:119], v5 offset:896
    v_mfma_f32_16x16x32_bf16 v[168:171], a[208:211], a[112:115], v[168:171]
    v_add_f32 v37, v37, v39
    v_mov_b32 v13, v37
    v_mfma_f32_16x16x32_bf16 v[168:171], a[212:215], a[116:119], v[168:171]
    v_permlane16_swap_b32 v50, v14
    v_add_f32 v50, v50, v14
    v_mfma_f32_16x16x32_bf16 v[172:175], a[212:215], a[124:127], v[172:175]
    buffer_load_dwordx4 a[52:55], v2, s[72:75], s58 offen offset:3072 sc1
    v_mfma_f32_16x16x32_bf16 v[172:175], a[208:211], a[120:123], v[172:175]
    s_waitcnt lgkmcnt(8)
    v_permlane32_swap_b32 v37, v13
    v_add_f32 v37, v37, v13
    v_mfma_f32_16x16x32_bf16 v[188:191], a[216:219], a[120:123], v[188:191]
    ds_read_b64_tr_b16 a[200:201], v9 offset:57344
    ds_read_b64_tr_b16 a[202:203], v9 offset:59392
    v_mfma_f32_16x16x32_bf16 v[188:191], a[220:223], a[124:127], v[188:191]
    ds_read_b64_tr_b16 a[204:205], v9 offset:61440
    ds_read_b64_tr_b16 a[206:207], v9 offset:63488
    v_mfma_f32_16x16x32_bf16 v[184:187], a[220:223], a[116:119], v[184:187]
    buffer_load_dwordx4 a[56:59], v2, s[72:75], s59 offen offset:2048 sc1
    v_mfma_f32_16x16x32_bf16 v[184:187], a[216:219], a[112:115], v[184:187]
    ds_read_b128 v[120:123], v5 offset:448
    ds_read_b128 v[124:127], v5 offset:960
    v_mfma_f32_16x16x32_bf16 v[180:183], a[216:219], a[104:107], v[180:183]
    v_mov_b32 v13, v37
    v_add_f32 v41, v41, v43
    v_mfma_f32_16x16x32_bf16 v[180:183], a[220:223], a[108:111], v[180:183]
    v_mov_b32 v14, v41
    v_mfma_f32_16x16x32_bf16 v[176:179], a[220:223], a[100:103], v[176:179]
    buffer_load_dwordx4 a[60:63], v2, s[72:75], s59 offen offset:3072 sc1
    v_mfma_f32_16x16x32_bf16 v[176:179], a[216:219], a[96:99], v[176:179]
    s_waitcnt lgkmcnt(8)
    s_add_u32 s56, s56, 4096
    s_add_u32 s57, s57, 4096
    v_mfma_f32_16x16x32_bf16 v[192:195], a[192:195], a[96:99], v[192:195]
    s_add_u32 s58, s58, 4096
    ds_read_b64_tr_b16 a[208:209], v10 offset:57344
    ds_read_b64_tr_b16 a[210:211], v10 offset:59392
    v_mfma_f32_16x16x32_bf16 v[192:195], a[196:199], a[100:103], v[192:195]
    s_add_u32 s59, s59, 4096
    ds_read_b64_tr_b16 a[212:213], v10 offset:61440
    ds_read_b64_tr_b16 a[214:215], v10 offset:63488
    v_mfma_f32_16x16x32_bf16 v[196:199], a[196:199], a[108:111], v[196:199]
    buffer_load_dwordx2 a[64:65], v7, s[72:75], s56 offen offset:0 sc1
    v_mfma_f32_16x16x32_bf16 v[196:199], a[192:195], a[104:107], v[196:199]
    v_permlane16_swap_b32 v37, v13
    v_add_f32 v37, v37, v13
    v_mfma_f32_16x16x32_bf16 v[200:203], a[192:195], a[112:115], v[200:203]
    v_mul_f32 v49, 0xbacccccd, v49
    v_mul_f32 v37, 0x3acccccd, v37
    v_mfma_f32_16x16x32_bf16 v[200:203], a[196:199], a[116:119], v[200:203]
    v_fma_f32 v37, -v49, v49, v37
    v_max_f32 v37, 0, v37
    v_mfma_f32_16x16x32_bf16 v[204:207], a[196:199], a[124:127], v[204:207]
    buffer_load_dwordx2 a[66:67], v7, s[72:75], s56 offen offset:512 sc1
    v_mfma_f32_16x16x32_bf16 v[204:207], a[192:195], a[120:123], v[204:207]
    s_waitcnt lgkmcnt(6)
    v_add_f32 v21, 0x3727c5ac, v37
    v_permlane32_swap_b32 v41, v14
    v_mfma_f32_16x16x32_bf16 v[220:223], a[200:203], a[120:123], v[220:223]
    ds_read_b64_tr_b16 a[216:217], v11 offset:57344
    ds_read_b64_tr_b16 a[218:219], v11 offset:59392
    v_mfma_f32_16x16x32_bf16 v[220:223], a[204:207], a[124:127], v[220:223]
    ds_read_b64_tr_b16 a[220:221], v11 offset:61440
    ds_read_b64_tr_b16 a[222:223], v11 offset:63488
    v_mfma_f32_16x16x32_bf16 v[216:219], a[204:207], a[116:119], v[216:219]
    buffer_load_dwordx4 a[68:71], v2, s[72:75], s56 offen offset:1024 sc1
    v_mfma_f32_16x16x32_bf16 v[216:219], a[200:203], a[112:115], v[216:219]
    v_rsq_f32 v36, v21
    v_mfma_f32_16x16x32_bf16 v[212:215], a[200:203], a[104:107], v[212:215]
    v_mul_f32 v53, v21, v36
    v_mul_f32 v57, 0xc0135761, v36
    v_mfma_f32_16x16x32_bf16 v[212:215], a[204:207], a[108:111], v[212:215]
    v_mul_f32 v61, 0xbdd2d3e8, v36
    v_mul_f32 v36, v36, v36
    v_mfma_f32_16x16x32_bf16 v[208:211], a[204:207], a[100:103], v[208:211]
    buffer_load_dwordx2 a[72:73], v7, s[72:75], s57 offen offset:0 sc1
    v_mfma_f32_16x16x32_bf16 v[208:211], a[200:203], a[96:99], v[208:211]
    s_waitcnt lgkmcnt(4)
    v_mul_f32 v61, v61, v36
    v_add_f32 v41, v41, v14
    v_mfma_f32_16x16x32_bf16 v[224:227], a[208:211], a[96:99], v[224:227]
    v_add_u32 v8, 0x10000, v8
    v_add_u32 v9, 0x10000, v9
    v_mfma_f32_16x16x32_bf16 v[224:227], a[212:215], a[100:103], v[224:227]
    v_add_u32 v10, 0x10000, v10
    v_add_u32 v11, 0x10000, v11
    v_mfma_f32_16x16x32_bf16 v[228:231], a[212:215], a[108:111], v[228:231]
    ds_read_b64_tr_b16 a[192:193], v8 offset:0
    ds_read_b64_tr_b16 a[194:195], v8 offset:2048
    v_mfma_f32_16x16x32_bf16 v[228:231], a[208:211], a[104:107], v[228:231]
    ds_read_b64_tr_b16 a[196:197], v8 offset:4096
    ds_read_b64_tr_b16 a[198:199], v8 offset:6144
    v_mfma_f32_16x16x32_bf16 v[232:235], a[208:211], a[112:115], v[232:235]
    buffer_load_dwordx2 a[74:75], v7, s[72:75], s57 offen offset:512 sc1
    v_mfma_f32_16x16x32_bf16 v[232:235], a[212:215], a[116:119], v[232:235]
    v_mov_b32 v14, v41
    v_mfma_f32_16x16x32_bf16 v[236:239], a[212:215], a[124:127], v[236:239]
    buffer_load_dwordx4 a[76:79], v2, s[72:75], s57 offen offset:1024 sc1
    v_mfma_f32_16x16x32_bf16 v[236:239], a[208:211], a[120:123], v[236:239]
    s_waitcnt vmcnt(14) lgkmcnt(4)
    v_permlane16_swap_b32 v41, v14
    v_add_f32 v41, v41, v14
    v_mfma_f32_16x16x32_bf16 v[252:255], a[216:219], a[120:123], v[252:255]
    v_mfma_f32_16x16x32_bf16 v[252:255], a[220:223], a[124:127], v[252:255]
    v_mfma_f32_16x16x32_bf16 v[248:251], a[220:223], a[116:119], v[248:251]
    ds_read_b64_tr_b16 a[200:201], v9 offset:0
    ds_read_b64_tr_b16 a[202:203], v9 offset:2048
    v_mfma_f32_16x16x32_bf16 v[248:251], a[216:219], a[112:115], v[248:251]
    ds_read_b64_tr_b16 a[204:205], v9 offset:4096
    ds_read_b64_tr_b16 a[206:207], v9 offset:6144
    v_mfma_f32_16x16x32_bf16 v[244:247], a[216:219], a[104:107], v[244:247]
    v_mfma_f32_16x16x32_bf16 v[244:247], a[220:223], a[108:111], v[244:247]
    v_mfma_f32_16x16x32_bf16 v[240:243], a[220:223], a[100:103], v[240:243]
    v_mfma_f32_16x16x32_bf16 v[240:243], a[216:219], a[96:99], v[240:243]
    s_waitcnt lgkmcnt(4)
    v_mfma_f32_16x16x32_bf16 v[128:131], a[192:195], a[0:3], v[128:131]
    ds_read_b64_tr_b16 a[208:209], v10 offset:0
    ds_read_b64_tr_b16 a[210:211], v10 offset:2048
    v_mfma_f32_16x16x32_bf16 v[128:131], a[196:199], a[4:7], v[128:131]
    ds_read_b64_tr_b16 a[212:213], v10 offset:4096
    ds_read_b64_tr_b16 a[214:215], v10 offset:6144
    v_mfma_f32_16x16x32_bf16 v[132:135], a[196:199], a[12:15], v[132:135]
    buffer_load_dwordx2 a[80:81], v7, s[72:75], s58 offen offset:0 sc1
    v_mfma_f32_16x16x32_bf16 v[132:135], a[192:195], a[8:11], v[132:135]
    v_add_f32 v51, v44, v46
    v_mov_b32 v13, v51
    v_mfma_f32_16x16x32_bf16 v[136:139], a[192:195], a[16:19], v[136:139]
    v_mul_f32 v50, 0xbacccccd, v50
    v_mul_f32 v41, 0x3acccccd, v41
    v_mfma_f32_16x16x32_bf16 v[136:139], a[196:199], a[20:23], v[136:139]
    v_permlane32_swap_b32 v51, v13
    v_add_f32 v51, v51, v13
    v_mfma_f32_16x16x32_bf16 v[140:143], a[196:199], a[28:31], v[140:143]
    buffer_load_dwordx2 a[82:83], v7, s[72:75], s58 offen offset:512 sc1
    v_mfma_f32_16x16x32_bf16 v[140:143], a[192:195], a[24:27], v[140:143]
    s_waitcnt lgkmcnt(4)
    v_mov_b32 v13, v51
    v_fma_f32 v41, -v50, v50, v41
    v_mfma_f32_16x16x32_bf16 v[156:159], a[200:203], a[24:27], v[156:159]
    ds_read_b64_tr_b16 a[216:217], v11 offset:0
    ds_read_b64_tr_b16 a[218:219], v11 offset:2048
    v_mfma_f32_16x16x32_bf16 v[156:159], a[204:207], a[28:31], v[156:159]
    ds_read_b64_tr_b16 a[220:221], v11 offset:4096
    ds_read_b64_tr_b16 a[222:223], v11 offset:6144
    v_mfma_f32_16x16x32_bf16 v[152:155], a[204:207], a[20:23], v[152:155]
    buffer_load_dwordx4 a[84:87], v2, s[72:75], s58 offen offset:1024 sc1
    v_mfma_f32_16x16x32_bf16 v[152:155], a[200:203], a[16:19], v[152:155]
    v_permlane16_swap_b32 v51, v13
    v_add_f32 v51, v51, v13
    v_mfma_f32_16x16x32_bf16 v[148:151], a[200:203], a[8:11], v[148:151]
    v_add_f32 v45, v45, v47
    v_mov_b32 v13, v45
    v_mfma_f32_16x16x32_bf16 v[148:151], a[204:207], a[12:15], v[148:151]
    v_max_f32 v41, 0, v41
    v_add_f32 v22, 0x3727c5ac, v41
    v_mfma_f32_16x16x32_bf16 v[144:147], a[204:207], a[4:7], v[144:147]
    buffer_load_dwordx2 a[88:89], v7, s[72:75], s59 offen offset:0 sc1
    v_mfma_f32_16x16x32_bf16 v[144:147], a[200:203], a[0:3], v[144:147]
    s_waitcnt lgkmcnt(4)
    v_permlane32_swap_b32 v45, v13
    v_add_f32 v45, v45, v13
    v_mfma_f32_16x16x32_bf16 v[160:163], a[208:211], a[0:3], v[160:163]
    ds_read_b64_tr_b16 a[192:193], v8 offset:8192
    ds_read_b64_tr_b16 a[194:195], v8 offset:10240
    v_mfma_f32_16x16x32_bf16 v[160:163], a[212:215], a[4:7], v[160:163]
    ds_read_b64_tr_b16 a[196:197], v8 offset:12288
    ds_read_b64_tr_b16 a[198:199], v8 offset:14336
    v_mfma_f32_16x16x32_bf16 v[164:167], a[212:215], a[12:15], v[164:167]
    buffer_load_dwordx2 a[90:91], v7, s[72:75], s59 offen offset:512 sc1
    v_mfma_f32_16x16x32_bf16 v[164:167], a[208:211], a[8:11], v[164:167]
    v_mov_b32 v13, v45
    v_mfma_f32_16x16x32_bf16 v[168:171], a[208:211], a[16:19], v[168:171]
    v_rsq_f32 v40, v22
    v_mfma_f32_16x16x32_bf16 v[168:171], a[212:215], a[20:23], v[168:171]
    v_permlane16_swap_b32 v45, v13
    v_add_f32 v45, v45, v13
    v_mfma_f32_16x16x32_bf16 v[172:175], a[212:215], a[28:31], v[172:175]
    buffer_load_dwordx4 a[92:95], v2, s[72:75], s59 offen offset:1024 sc1
    v_mfma_f32_16x16x32_bf16 v[172:175], a[208:211], a[24:27], v[172:175]
    s_waitcnt lgkmcnt(4)
    v_mul_f32 v51, 0xbacccccd, v51
    v_mul_f32 v45, 0x3acccccd, v45
    v_mfma_f32_16x16x32_bf16 v[188:191], a[216:219], a[24:27], v[188:191]
    ds_read_b64_tr_b16 a[200:201], v9 offset:8192
    ds_read_b64_tr_b16 a[202:203], v9 offset:10240
    v_mfma_f32_16x16x32_bf16 v[188:191], a[220:223], a[28:31], v[188:191]
    ds_read_b64_tr_b16 a[204:205], v9 offset:12288
    ds_read_b64_tr_b16 a[206:207], v9 offset:14336
    v_mfma_f32_16x16x32_bf16 v[184:187], a[220:223], a[20:23], v[184:187]
    buffer_load_dwordx4 a[96:99], v2, s[72:75], s56 offen offset:2048 sc1
    v_mfma_f32_16x16x32_bf16 v[184:187], a[216:219], a[16:19], v[184:187]
    v_fma_f32 v45, -v51, v51, v45
    v_max_f32 v45, 0, v45
    v_mfma_f32_16x16x32_bf16 v[180:183], a[216:219], a[8:11], v[180:183]
    v_add_f32 v23, 0x3727c5ac, v45
    v_mul_f32 v54, v22, v40
    v_mfma_f32_16x16x32_bf16 v[180:183], a[220:223], a[12:15], v[180:183]
    v_rsq_f32 v44, v23
    v_mfma_f32_16x16x32_bf16 v[176:179], a[220:223], a[4:7], v[176:179]
    buffer_load_dwordx4 a[100:103], v2, s[72:75], s56 offen offset:3072 sc1
    v_mfma_f32_16x16x32_bf16 v[176:179], a[216:219], a[0:3], v[176:179]
    s_waitcnt lgkmcnt(4)
    v_mul_f32 v55, v23, v44
    v_mul_f32 v59, 0xc0135761, v44
    v_mfma_f32_16x16x32_bf16 v[192:195], a[192:195], a[0:3], v[192:195]
    ds_read_b64_tr_b16 a[208:209], v10 offset:8192
    ds_read_b64_tr_b16 a[210:211], v10 offset:10240
    v_mfma_f32_16x16x32_bf16 v[192:195], a[196:199], a[4:7], v[192:195]
    ds_read_b64_tr_b16 a[212:213], v10 offset:12288
    ds_read_b64_tr_b16 a[214:215], v10 offset:14336
    v_mfma_f32_16x16x32_bf16 v[196:199], a[196:199], a[12:15], v[196:199]
    buffer_load_dwordx4 a[104:107], v2, s[72:75], s57 offen offset:2048 sc1
    v_mfma_f32_16x16x32_bf16 v[196:199], a[192:195], a[8:11], v[196:199]
    v_mul_f32 v63, 0xbdd2d3e8, v44
    v_mul_f32 v44, v44, v44
    v_mfma_f32_16x16x32_bf16 v[200:203], a[192:195], a[16:19], v[200:203]
    v_mul_f32 v63, v63, v44
    v_mul_f32 v58, 0xc0135761, v40
    v_mfma_f32_16x16x32_bf16 v[200:203], a[196:199], a[20:23], v[200:203]
    v_mul_f32 v62, 0xbdd2d3e8, v40
    v_mul_f32 v40, v40, v40
    v_mfma_f32_16x16x32_bf16 v[204:207], a[196:199], a[28:31], v[204:207]
    buffer_load_dwordx4 a[108:111], v2, s[72:75], s57 offen offset:3072 sc1
    v_mfma_f32_16x16x32_bf16 v[204:207], a[192:195], a[24:27], v[204:207]
    s_waitcnt lgkmcnt(4)
    v_mul_f32 v62, v62, v40
    v_mfma_f32_16x16x32_bf16 v[220:223], a[200:203], a[24:27], v[220:223]
    ds_read_b64_tr_b16 a[216:217], v11 offset:8192
    ds_read_b64_tr_b16 a[218:219], v11 offset:10240
    v_mfma_f32_16x16x32_bf16 v[220:223], a[204:207], a[28:31], v[220:223]
    ds_read_b64_tr_b16 a[220:221], v11 offset:12288
    ds_read_b64_tr_b16 a[222:223], v11 offset:14336
    v_mfma_f32_16x16x32_bf16 v[216:219], a[204:207], a[20:23], v[216:219]
    buffer_load_dwordx4 a[112:115], v2, s[72:75], s58 offen offset:2048 sc1
    v_mfma_f32_16x16x32_bf16 v[216:219], a[200:203], a[16:19], v[216:219]
    v_mfma_f32_16x16x32_bf16 v[212:215], a[200:203], a[8:11], v[212:215]
    v_mfma_f32_16x16x32_bf16 v[212:215], a[204:207], a[12:15], v[212:215]
    v_mfma_f32_16x16x32_bf16 v[208:211], a[204:207], a[4:7], v[208:211]
    buffer_load_dwordx4 a[116:119], v2, s[72:75], s58 offen offset:3072 sc1
    v_mfma_f32_16x16x32_bf16 v[208:211], a[200:203], a[0:3], v[208:211]
    s_waitcnt lgkmcnt(4)
    v_mfma_f32_16x16x32_bf16 v[224:227], a[208:211], a[0:3], v[224:227]
    ds_read_b64_tr_b16 a[192:193], v8 offset:16384
    ds_read_b64_tr_b16 a[194:195], v8 offset:18432
    v_mfma_f32_16x16x32_bf16 v[224:227], a[212:215], a[4:7], v[224:227]
    ds_read_b64_tr_b16 a[196:197], v8 offset:20480
    ds_read_b64_tr_b16 a[198:199], v8 offset:22528
    v_mfma_f32_16x16x32_bf16 v[228:231], a[212:215], a[12:15], v[228:231]
    buffer_load_dwordx4 a[120:123], v2, s[72:75], s59 offen offset:2048 sc1
    v_mfma_f32_16x16x32_bf16 v[228:231], a[208:211], a[8:11], v[228:231]
    v_mfma_f32_16x16x32_bf16 v[232:235], a[208:211], a[16:19], v[232:235]
    v_mfma_f32_16x16x32_bf16 v[232:235], a[212:215], a[20:23], v[232:235]
    v_mfma_f32_16x16x32_bf16 v[236:239], a[212:215], a[28:31], v[236:239]
    buffer_load_dwordx4 a[124:127], v2, s[72:75], s59 offen offset:3072 sc1
    v_mfma_f32_16x16x32_bf16 v[236:239], a[208:211], a[24:27], v[236:239]
    s_waitcnt vmcnt(20) lgkmcnt(4)
    s_add_u32 s56, s56, 4096
    s_add_u32 s57, s57, 4096
    v_mfma_f32_16x16x32_bf16 v[252:255], a[216:219], a[24:27], v[252:255]
    s_add_u32 s58, s58, 4096
    s_add_u32 s59, s59, 4096
    v_mfma_f32_16x16x32_bf16 v[252:255], a[220:223], a[28:31], v[252:255]
    v_mfma_f32_16x16x32_bf16 v[248:251], a[220:223], a[20:23], v[248:251]
    ds_read_b64_tr_b16 a[200:201], v9 offset:16384
    ds_read_b64_tr_b16 a[202:203], v9 offset:18432
    v_mfma_f32_16x16x32_bf16 v[248:251], a[216:219], a[16:19], v[248:251]
    ds_read_b64_tr_b16 a[204:205], v9 offset:20480
    ds_read_b64_tr_b16 a[206:207], v9 offset:22528
    v_mfma_f32_16x16x32_bf16 v[244:247], a[216:219], a[8:11], v[244:247]
    v_mfma_f32_16x16x32_bf16 v[244:247], a[220:223], a[12:15], v[244:247]
    v_mfma_f32_16x16x32_bf16 v[240:243], a[220:223], a[4:7], v[240:243]
    v_mfma_f32_16x16x32_bf16 v[240:243], a[216:219], a[0:3], v[240:243]
    s_waitcnt lgkmcnt(4)
    v_mfma_f32_16x16x32_bf16 v[128:131], a[192:195], a[32:35], v[128:131]
    ds_read_b64_tr_b16 a[208:209], v10 offset:16384
    ds_read_b64_tr_b16 a[210:211], v10 offset:18432
    v_mfma_f32_16x16x32_bf16 v[128:131], a[196:199], a[36:39], v[128:131]
    ds_read_b64_tr_b16 a[212:213], v10 offset:20480
    ds_read_b64_tr_b16 a[214:215], v10 offset:22528
    v_mfma_f32_16x16x32_bf16 v[132:135], a[196:199], a[44:47], v[132:135]
    buffer_load_dwordx4 a[0:3], v2, s[72:75], s56 offen offset:0 sc1
    v_mfma_f32_16x16x32_bf16 v[132:135], a[192:195], a[40:43], v[132:135]
    v_mfma_f32_16x16x32_bf16 v[136:139], a[192:195], a[48:51], v[136:139]
    v_mfma_f32_16x16x32_bf16 v[136:139], a[196:199], a[52:55], v[136:139]
    v_fmac_f32 v240, v48, v120
    v_fmac_f32 v241, v48, v121
    v_mfma_f32_16x16x32_bf16 v[140:143], a[196:199], a[60:63], v[140:143]
    buffer_load_dwordx2 a[4:5], v7, s[72:75], s56 offen offset:1024 sc1
    v_mfma_f32_16x16x32_bf16 v[140:143], a[192:195], a[56:59], v[140:143]
    s_waitcnt lgkmcnt(4)
    v_fmac_f32 v242, v48, v122
    v_fmac_f32 v243, v48, v123
    v_mfma_f32_16x16x32_bf16 v[156:159], a[200:203], a[56:59], v[156:159]
    ds_read_b64_tr_b16 a[216:217], v11 offset:16384
    ds_read_b64_tr_b16 a[218:219], v11 offset:18432
    v_mfma_f32_16x16x32_bf16 v[156:159], a[204:207], a[60:63], v[156:159]
    ds_read_b64_tr_b16 a[220:221], v11 offset:20480
    ds_read_b64_tr_b16 a[222:223], v11 offset:22528
    v_mfma_f32_16x16x32_bf16 v[152:155], a[204:207], a[52:55], v[152:155]
    v_fmac_f32 v240, v52, v124
    v_fmac_f32 v241, v52, v125
    v_mfma_f32_16x16x32_bf16 v[152:155], a[200:203], a[48:51], v[152:155]
    buffer_load_dwordx2 a[6:7], v7, s[72:75], s56 offen offset:1536 sc1
    v_mfma_f32_16x16x32_bf16 v[148:151], a[200:203], a[40:43], v[148:151]
    v_fmac_f32 v242, v52, v126
    v_fmac_f32 v243, v52, v127
    v_mfma_f32_16x16x32_bf16 v[148:151], a[204:207], a[44:47], v[148:151]
    v_fmac_f32 v244, v49, v120
    v_fmac_f32 v245, v49, v121
    v_mfma_f32_16x16x32_bf16 v[144:147], a[204:207], a[36:39], v[144:147]
    v_fmac_f32 v246, v49, v122
    v_fmac_f32 v247, v49, v123
    v_mfma_f32_16x16x32_bf16 v[144:147], a[200:203], a[32:35], v[144:147]
    s_waitcnt lgkmcnt(4)
    v_fmac_f32 v244, v53, v124
    v_fmac_f32 v245, v53, v125
    v_mfma_f32_16x16x32_bf16 v[160:163], a[208:211], a[32:35], v[160:163]
    ds_read_b64_tr_b16 a[192:193], v8 offset:24576
    ds_read_b64_tr_b16 a[194:195], v8 offset:26624
    v_mfma_f32_16x16x32_bf16 v[160:163], a[212:215], a[36:39], v[160:163]
    ds_read_b64_tr_b16 a[196:197], v8 offset:28672
    ds_read_b64_tr_b16 a[198:199], v8 offset:30720
    v_mfma_f32_16x16x32_bf16 v[164:167], a[212:215], a[44:47], v[164:167]
    buffer_load_dwordx4 a[8:11], v2, s[72:75], s57 offen offset:0 sc1
    v_mfma_f32_16x16x32_bf16 v[164:167], a[208:211], a[40:43], v[164:167]
    v_fmac_f32 v246, v53, v126
    v_fmac_f32 v247, v53, v127
    v_mfma_f32_16x16x32_bf16 v[168:171], a[208:211], a[48:51], v[168:171]
    buffer_load_dwordx2 a[12:13], v7, s[72:75], s57 offen offset:1024 sc1
    v_mfma_f32_16x16x32_bf16 v[168:171], a[212:215], a[52:55], v[168:171]
    v_fmac_f32 v248, v50, v120
    v_fmac_f32 v249, v50, v121
    v_mfma_f32_16x16x32_bf16 v[172:175], a[212:215], a[60:63], v[172:175]
    v_fmac_f32 v250, v50, v122
    v_fmac_f32 v251, v50, v123
    v_mfma_f32_16x16x32_bf16 v[172:175], a[208:211], a[56:59], v[172:175]
    s_waitcnt lgkmcnt(4)
    v_fmac_f32 v248, v54, v124
    v_fmac_f32 v249, v54, v125
    v_mfma_f32_16x16x32_bf16 v[188:191], a[216:219], a[56:59], v[188:191]
    ds_read_b64_tr_b16 a[200:201], v9 offset:24576
    ds_read_b64_tr_b16 a[202:203], v9 offset:26624
    v_mfma_f32_16x16x32_bf16 v[188:191], a[220:223], a[60:63], v[188:191]
    ds_read_b64_tr_b16 a[204:205], v9 offset:28672
    ds_read_b64_tr_b16 a[206:207], v9 offset:30720
    v_mfma_f32_16x16x32_bf16 v[184:187], a[220:223], a[52:55], v[184:187]
    buffer_load_dwordx2 a[14:15], v7, s[72:75], s57 offen offset:1536 sc1
    v_mfma_f32_16x16x32_bf16 v[184:187], a[216:219], a[48:51], v[184:187]
    v_fmac_f32 v250, v54, v126
    v_fmac_f32 v251, v54, v127
    v_mfma_f32_16x16x32_bf16 v[180:183], a[216:219], a[40:43], v[180:183]
    v_fmac_f32 v252, v51, v120
    v_fmac_f32 v253, v51, v121
    v_mfma_f32_16x16x32_bf16 v[180:183], a[220:223], a[44:47], v[180:183]
    v_fmac_f32 v254, v51, v122
    v_fmac_f32 v255, v51, v123
    v_mfma_f32_16x16x32_bf16 v[176:179], a[220:223], a[36:39], v[176:179]
    buffer_load_dwordx4 a[16:19], v2, s[72:75], s58 offen offset:0 sc1
    v_mfma_f32_16x16x32_bf16 v[176:179], a[216:219], a[32:35], v[176:179]
    s_waitcnt lgkmcnt(4)
    v_fmac_f32 v252, v55, v124
    v_fmac_f32 v253, v55, v125
    v_mfma_f32_16x16x32_bf16 v[192:195], a[192:195], a[32:35], v[192:195]
    ds_read_b64_tr_b16 a[208:209], v10 offset:24576
    ds_read_b64_tr_b16 a[210:211], v10 offset:26624
    v_mfma_f32_16x16x32_bf16 v[192:195], a[196:199], a[36:39], v[192:195]
    ds_read_b64_tr_b16 a[212:213], v10 offset:28672
    ds_read_b64_tr_b16 a[214:215], v10 offset:30720
    v_mfma_f32_16x16x32_bf16 v[196:199], a[196:199], a[44:47], v[196:199]
    buffer_load_dwordx2 a[20:21], v7, s[72:75], s58 offen offset:1024 sc1
    v_mfma_f32_16x16x32_bf16 v[196:199], a[192:195], a[40:43], v[196:199]
    v_fmac_f32 v254, v55, v126
    v_fmac_f32 v255, v55, v127
    v_mfma_f32_16x16x32_bf16 v[200:203], a[192:195], a[48:51], v[200:203]
    v_fmac_f32 v128, v48, v64
    v_fmac_f32 v129, v48, v65
    v_mfma_f32_16x16x32_bf16 v[200:203], a[196:199], a[52:55], v[200:203]
    v_fmac_f32 v130, v48, v66
    v_fmac_f32 v131, v48, v67
    v_mfma_f32_16x16x32_bf16 v[204:207], a[196:199], a[60:63], v[204:207]
    v_fmac_f32 v128, v52, v68
    v_fmac_f32 v129, v52, v69
    v_mfma_f32_16x16x32_bf16 v[204:207], a[192:195], a[56:59], v[204:207]
    s_waitcnt lgkmcnt(4)
    v_fmac_f32 v130, v52, v70
    v_fmac_f32 v131, v52, v71
    v_mfma_f32_16x16x32_bf16 v[220:223], a[200:203], a[56:59], v[220:223]
    ds_read_b64_tr_b16 a[216:217], v11 offset:24576
    ds_read_b64_tr_b16 a[218:219], v11 offset:26624
    v_mfma_f32_16x16x32_bf16 v[220:223], a[204:207], a[60:63], v[220:223]
    ds_read_b64_tr_b16 a[220:221], v11 offset:28672
    ds_read_b64_tr_b16 a[222:223], v11 offset:30720
    v_mfma_f32_16x16x32_bf16 v[216:219], a[204:207], a[52:55], v[216:219]
    buffer_load_dwordx2 a[22:23], v7, s[72:75], s58 offen offset:1536 sc1
    v_mfma_f32_16x16x32_bf16 v[216:219], a[200:203], a[48:51], v[216:219]
    v_fmac_f32 v132, v49, v64
    v_fmac_f32 v133, v49, v65
    v_mfma_f32_16x16x32_bf16 v[212:215], a[200:203], a[40:43], v[212:215]
    buffer_load_dwordx4 a[24:27], v2, s[72:75], s59 offen offset:0 sc1
    v_mfma_f32_16x16x32_bf16 v[212:215], a[204:207], a[44:47], v[212:215]
    v_fmac_f32 v134, v49, v66
    v_fmac_f32 v135, v49, v67
    v_mfma_f32_16x16x32_bf16 v[208:211], a[204:207], a[36:39], v[208:211]
    v_fmac_f32 v132, v53, v68
    v_fmac_f32 v133, v53, v69
    v_mfma_f32_16x16x32_bf16 v[208:211], a[200:203], a[32:35], v[208:211]
    s_waitcnt lgkmcnt(4)
    v_fmac_f32 v134, v53, v70
    v_fmac_f32 v135, v53, v71
    v_mfma_f32_16x16x32_bf16 v[224:227], a[208:211], a[32:35], v[224:227]
    ds_read_b64_tr_b16 a[192:193], v8 offset:32768
    ds_read_b64_tr_b16 a[194:195], v8 offset:34816
    v_mfma_f32_16x16x32_bf16 v[224:227], a[212:215], a[36:39], v[224:227]
    ds_read_b64_tr_b16 a[196:197], v8 offset:36864
    ds_read_b64_tr_b16 a[198:199], v8 offset:38912
    v_mfma_f32_16x16x32_bf16 v[228:231], a[212:215], a[44:47], v[228:231]
    buffer_load_dwordx2 a[28:29], v7, s[72:75], s59 offen offset:1024 sc1
    v_mfma_f32_16x16x32_bf16 v[228:231], a[208:211], a[40:43], v[228:231]
    v_fmac_f32 v136, v50, v64
    v_fmac_f32 v137, v50, v65
    v_mfma_f32_16x16x32_bf16 v[232:235], a[208:211], a[48:51], v[232:235]
    v_fmac_f32 v138, v50, v66
    v_fmac_f32 v139, v50, v67
    v_mfma_f32_16x16x32_bf16 v[232:235], a[212:215], a[52:55], v[232:235]
    buffer_load_dwordx2 a[30:31], v7, s[72:75], s59 offen offset:1536 sc1
    v_mfma_f32_16x16x32_bf16 v[236:239], a[212:215], a[60:63], v[236:239]
    v_fmac_f32 v136, v54, v68
    v_fmac_f32 v137, v54, v69
    v_mfma_f32_16x16x32_bf16 v[236:239], a[208:211], a[56:59], v[236:239]
    s_waitcnt vmcnt(20) lgkmcnt(4)
    v_fmac_f32 v138, v54, v70
    v_fmac_f32 v139, v54, v71
    v_mfma_f32_16x16x32_bf16 v[252:255], a[216:219], a[56:59], v[252:255]
    v_fmac_f32 v140, v51, v64
    v_fmac_f32 v141, v51, v65
    v_mfma_f32_16x16x32_bf16 v[252:255], a[220:223], a[60:63], v[252:255]
    v_fmac_f32 v142, v51, v66
    v_fmac_f32 v143, v51, v67
    v_mfma_f32_16x16x32_bf16 v[248:251], a[220:223], a[52:55], v[248:251]
    ds_read_b64_tr_b16 a[200:201], v9 offset:32768
    ds_read_b64_tr_b16 a[202:203], v9 offset:34816
    v_mfma_f32_16x16x32_bf16 v[248:251], a[216:219], a[48:51], v[248:251]
    ds_read_b64_tr_b16 a[204:205], v9 offset:36864
    ds_read_b64_tr_b16 a[206:207], v9 offset:38912
    v_mfma_f32_16x16x32_bf16 v[244:247], a[216:219], a[40:43], v[244:247]
    v_fmac_f32 v140, v55, v68
    v_fmac_f32 v141, v55, v69
    v_mfma_f32_16x16x32_bf16 v[244:247], a[220:223], a[44:47], v[244:247]
    v_fmac_f32 v142, v55, v70
    v_fmac_f32 v143, v55, v71
    v_mfma_f32_16x16x32_bf16 v[240:243], a[220:223], a[36:39], v[240:243]
    v_mfma_f32_16x16x32_bf16 v[240:243], a[216:219], a[32:35], v[240:243]
    s_waitcnt lgkmcnt(4)
    v_mfma_f32_16x16x32_bf16 v[128:131], a[192:195], a[64:67], v[128:131]
    ds_read_b64_tr_b16 a[208:209], v10 offset:32768
    ds_read_b64_tr_b16 a[210:211], v10 offset:34816
    v_mfma_f32_16x16x32_bf16 v[128:131], a[196:199], a[68:71], v[128:131]
    ds_read_b64_tr_b16 a[212:213], v10 offset:36864
    ds_read_b64_tr_b16 a[214:215], v10 offset:38912
    v_mfma_f32_16x16x32_bf16 v[132:135], a[196:199], a[76:79], v[132:135]
    buffer_load_dwordx4 a[32:35], v2, s[72:75], s56 offen offset:2048 sc1
    v_mfma_f32_16x16x32_bf16 v[132:135], a[192:195], a[72:75], v[132:135]
    v_fmac_f32 v224, v48, v112
    v_fmac_f32 v225, v48, v113
    v_mfma_f32_16x16x32_bf16 v[136:139], a[192:195], a[80:83], v[136:139]
    v_fmac_f32 v226, v48, v114
    v_fmac_f32 v227, v48, v115
    v_mfma_f32_16x16x32_bf16 v[136:139], a[196:199], a[84:87], v[136:139]
    v_fmac_f32 v224, v52, v116
    v_fmac_f32 v225, v52, v117
    v_mfma_f32_16x16x32_bf16 v[140:143], a[196:199], a[92:95], v[140:143]
    buffer_load_dwordx4 a[36:39], v2, s[72:75], s56 offen offset:3072 sc1
    v_mfma_f32_16x16x32_bf16 v[140:143], a[192:195], a[88:91], v[140:143]
    s_waitcnt lgkmcnt(4)
    v_fmac_f32 v226, v52, v118
    v_fmac_f32 v227, v52, v119
    v_mfma_f32_16x16x32_bf16 v[156:159], a[200:203], a[88:91], v[156:159]
    ds_read_b64_tr_b16 a[216:217], v11 offset:32768
    ds_read_b64_tr_b16 a[218:219], v11 offset:34816
    v_mfma_f32_16x16x32_bf16 v[156:159], a[204:207], a[92:95], v[156:159]
    ds_read_b64_tr_b16 a[220:221], v11 offset:36864
    ds_read_b64_tr_b16 a[222:223], v11 offset:38912
    v_mfma_f32_16x16x32_bf16 v[152:155], a[204:207], a[84:87], v[152:155]
    v_fmac_f32 v228, v49, v112
    v_fmac_f32 v229, v49, v113
    v_mfma_f32_16x16x32_bf16 v[152:155], a[200:203], a[80:83], v[152:155]
    buffer_load_dwordx4 a[40:43], v2, s[72:75], s57 offen offset:2048 sc1
    v_mfma_f32_16x16x32_bf16 v[148:151], a[200:203], a[72:75], v[148:151]
    v_fmac_f32 v230, v49, v114
    v_fmac_f32 v231, v49, v115
    v_mfma_f32_16x16x32_bf16 v[148:151], a[204:207], a[76:79], v[148:151]
    v_fmac_f32 v228, v53, v116
    v_fmac_f32 v229, v53, v117
    v_mfma_f32_16x16x32_bf16 v[144:147], a[204:207], a[68:71], v[144:147]
    v_fmac_f32 v230, v53, v118
    v_fmac_f32 v231, v53, v119
    v_mfma_f32_16x16x32_bf16 v[144:147], a[200:203], a[64:67], v[144:147]
    s_waitcnt lgkmcnt(4)
    v_fmac_f32 v232, v50, v112
    v_fmac_f32 v233, v50, v113
    v_mfma_f32_16x16x32_bf16 v[160:163], a[208:211], a[64:67], v[160:163]
    ds_read_b64_tr_b16 a[192:193], v8 offset:40960
    ds_read_b64_tr_b16 a[194:195], v8 offset:43008
    v_mfma_f32_16x16x32_bf16 v[160:163], a[212:215], a[68:71], v[160:163]
    ds_read_b64_tr_b16 a[196:197], v8 offset:45056
    ds_read_b64_tr_b16 a[198:199], v8 offset:47104
    v_mfma_f32_16x16x32_bf16 v[164:167], a[212:215], a[76:79], v[164:167]
    buffer_load_dwordx4 a[44:47], v2, s[72:75], s57 offen offset:3072 sc1
    v_mfma_f32_16x16x32_bf16 v[164:167], a[208:211], a[72:75], v[164:167]
    v_fmac_f32 v234, v50, v114
    v_fmac_f32 v235, v50, v115
    v_mfma_f32_16x16x32_bf16 v[168:171], a[208:211], a[80:83], v[168:171]
    buffer_load_dwordx4 a[48:51], v2, s[72:75], s58 offen offset:2048 sc1
    v_mfma_f32_16x16x32_bf16 v[168:171], a[212:215], a[84:87], v[168:171]
    v_fmac_f32 v232, v54, v116
    v_fmac_f32 v233, v54, v117
    v_mfma_f32_16x16x32_bf16 v[172:175], a[212:215], a[92:95], v[172:175]
    v_fmac_f32 v234, v54, v118
    v_fmac_f32 v235, v54, v119
    v_mfma_f32_16x16x32_bf16 v[172:175], a[208:211], a[88:91], v[172:175]
    s_waitcnt lgkmcnt(4)
    v_fmac_f32 v236, v51, v112
    v_fmac_f32 v237, v51, v113
    v_mfma_f32_16x16x32_bf16 v[188:191], a[216:219], a[88:91], v[188:191]
    ds_read_b64_tr_b16 a[200:201], v9 offset:40960
    ds_read_b64_tr_b16 a[202:203], v9 offset:43008
    v_mfma_f32_16x16x32_bf16 v[188:191], a[220:223], a[92:95], v[188:191]
    ds_read_b64_tr_b16 a[204:205], v9 offset:45056
    ds_read_b64_tr_b16 a[206:207], v9 offset:47104
    v_mfma_f32_16x16x32_bf16 v[184:187], a[220:223], a[84:87], v[184:187]
    buffer_load_dwordx4 a[52:55], v2, s[72:75], s58 offen offset:3072 sc1
    v_mfma_f32_16x16x32_bf16 v[184:187], a[216:219], a[80:83], v[184:187]
    v_fmac_f32 v238, v51, v114
    v_fmac_f32 v239, v51, v115
    v_mfma_f32_16x16x32_bf16 v[180:183], a[216:219], a[72:75], v[180:183]
    v_fmac_f32 v236, v55, v116
    v_fmac_f32 v237, v55, v117
    v_mfma_f32_16x16x32_bf16 v[180:183], a[220:223], a[76:79], v[180:183]
    v_fmac_f32 v238, v55, v118
    v_fmac_f32 v239, v55, v119
    v_mfma_f32_16x16x32_bf16 v[176:179], a[220:223], a[68:71], v[176:179]
    buffer_load_dwordx4 a[56:59], v2, s[72:75], s59 offen offset:2048 sc1
    v_mfma_f32_16x16x32_bf16 v[176:179], a[216:219], a[64:67], v[176:179]
    s_waitcnt lgkmcnt(4)
    v_fmac_f32 v144, v48, v72
    v_fmac_f32 v145, v48, v73
    v_mfma_f32_16x16x32_bf16 v[192:195], a[192:195], a[64:67], v[192:195]
    ds_read_b64_tr_b16 a[208:209], v10 offset:40960
    ds_read_b64_tr_b16 a[210:211], v10 offset:43008
    v_mfma_f32_16x16x32_bf16 v[192:195], a[196:199], a[68:71], v[192:195]
    ds_read_b64_tr_b16 a[212:213], v10 offset:45056
    ds_read_b64_tr_b16 a[214:215], v10 offset:47104
    v_mfma_f32_16x16x32_bf16 v[196:199], a[196:199], a[76:79], v[196:199]
    buffer_load_dwordx4 a[60:63], v2, s[72:75], s59 offen offset:3072 sc1
    v_mfma_f32_16x16x32_bf16 v[196:199], a[192:195], a[72:75], v[196:199]
    s_add_u32 s56, s56, 4096
    s_add_u32 s57, s57, 4096
    s_add_u32 s58, s58, 4096
    v_mfma_f32_16x16x32_bf16 v[200:203], a[192:195], a[80:83], v[200:203]
    s_add_u32 s59, s59, 4096
    v_fmac_f32 v146, v48, v74
    v_fmac_f32 v147, v48, v75
    v_mfma_f32_16x16x32_bf16 v[200:203], a[196:199], a[84:87], v[200:203]
    v_fmac_f32 v144, v52, v76
    v_fmac_f32 v145, v52, v77
    v_mfma_f32_16x16x32_bf16 v[204:207], a[196:199], a[92:95], v[204:207]
    v_fmac_f32 v146, v52, v78
    v_fmac_f32 v147, v52, v79
    v_mfma_f32_16x16x32_bf16 v[204:207], a[192:195], a[88:91], v[204:207]
    s_waitcnt lgkmcnt(4)
    v_fmac_f32 v148, v49, v72
    v_fmac_f32 v149, v49, v73
    v_mfma_f32_16x16x32_bf16 v[220:223], a[200:203], a[88:91], v[220:223]
    ds_read_b64_tr_b16 a[216:217], v11 offset:40960
    ds_read_b64_tr_b16 a[218:219], v11 offset:43008
    v_mfma_f32_16x16x32_bf16 v[220:223], a[204:207], a[92:95], v[220:223]
    ds_read_b64_tr_b16 a[220:221], v11 offset:45056
    ds_read_b64_tr_b16 a[222:223], v11 offset:47104
    v_mfma_f32_16x16x32_bf16 v[216:219], a[204:207], a[84:87], v[216:219]
    buffer_load_dwordx4 a[128:131], v12, s[68:71], s46 offen offset:0 sc1
    v_mfma_f32_16x16x32_bf16 v[216:219], a[200:203], a[80:83], v[216:219]
    v_fmac_f32 v150, v49, v74
    v_fmac_f32 v151, v49, v75
    v_mfma_f32_16x16x32_bf16 v[212:215], a[200:203], a[72:75], v[212:215]
    buffer_load_dwordx4 a[132:135], v12, s[68:71], s46 offen offset:1024 sc1
    v_mfma_f32_16x16x32_bf16 v[212:215], a[204:207], a[76:79], v[212:215]
    v_fmac_f32 v148, v53, v76
    v_fmac_f32 v149, v53, v77
    v_mfma_f32_16x16x32_bf16 v[208:211], a[204:207], a[68:71], v[208:211]
    v_fmac_f32 v150, v53, v78
    v_fmac_f32 v151, v53, v79
    v_mfma_f32_16x16x32_bf16 v[208:211], a[200:203], a[64:67], v[208:211]
    s_waitcnt lgkmcnt(4)
    v_fmac_f32 v152, v50, v72
    v_fmac_f32 v153, v50, v73
    v_mfma_f32_16x16x32_bf16 v[224:227], a[208:211], a[64:67], v[224:227]
    s_waitcnt lgkmcnt(0)
    v_fmac_f32 v154, v50, v74
    v_fmac_f32 v155, v50, v75
    v_mfma_f32_16x16x32_bf16 v[224:227], a[212:215], a[68:71], v[224:227]
    s_barrier
    v_mfma_f32_16x16x32_bf16 v[228:231], a[212:215], a[76:79], v[228:231]
    ds_read_b64_tr_b16 a[192:193], v8 offset:49152
    ds_read_b64_tr_b16 a[194:195], v8 offset:51200
    v_mfma_f32_16x16x32_bf16 v[228:231], a[208:211], a[72:75], v[228:231]
    ds_read_b64_tr_b16 a[196:197], v8 offset:53248
    ds_read_b64_tr_b16 a[198:199], v8 offset:55296
    v_mfma_f32_16x16x32_bf16 v[232:235], a[208:211], a[80:83], v[232:235]
    buffer_load_dwordx4 a[136:139], v17, s[68:71], s46 offen offset:0 sc1
    v_mfma_f32_16x16x32_bf16 v[232:235], a[212:215], a[84:87], v[232:235]
    buffer_load_dwordx4 a[140:143], v17, s[68:71], s46 offen offset:1024 sc1
    v_mfma_f32_16x16x32_bf16 v[236:239], a[212:215], a[92:95], v[236:239]
    v_fmac_f32 v152, v54, v76
    v_fmac_f32 v153, v54, v77
    v_mfma_f32_16x16x32_bf16 v[236:239], a[208:211], a[88:91], v[236:239]
    s_waitcnt vmcnt(24) lgkmcnt(4)
    v_fmac_f32 v154, v54, v78
    v_fmac_f32 v155, v54, v79
    v_mfma_f32_16x16x32_bf16 v[252:255], a[216:219], a[88:91], v[252:255]
    v_fmac_f32 v156, v51, v72
    v_fmac_f32 v157, v51, v73
    v_mfma_f32_16x16x32_bf16 v[252:255], a[220:223], a[92:95], v[252:255]
    v_fmac_f32 v158, v51, v74
    v_fmac_f32 v159, v51, v75
    v_mfma_f32_16x16x32_bf16 v[248:251], a[220:223], a[84:87], v[248:251]
    ds_read_b64_tr_b16 a[200:201], v9 offset:49152
    ds_read_b64_tr_b16 a[202:203], v9 offset:51200
    v_mfma_f32_16x16x32_bf16 v[248:251], a[216:219], a[80:83], v[248:251]
    ds_read_b64_tr_b16 a[204:205], v9 offset:53248
    ds_read_b64_tr_b16 a[206:207], v9 offset:55296
    v_mfma_f32_16x16x32_bf16 v[244:247], a[216:219], a[72:75], v[244:247]
    v_fmac_f32 v156, v55, v76
    v_fmac_f32 v157, v55, v77
    v_mfma_f32_16x16x32_bf16 v[244:247], a[220:223], a[76:79], v[244:247]
    v_fmac_f32 v158, v55, v78
    v_fmac_f32 v159, v55, v79
    v_mfma_f32_16x16x32_bf16 v[240:243], a[220:223], a[68:71], v[240:243]
    v_mfma_f32_16x16x32_bf16 v[240:243], a[216:219], a[64:67], v[240:243]
    s_waitcnt lgkmcnt(4)
    v_mfma_f32_16x16x32_bf16 v[128:131], a[192:195], a[96:99], v[128:131]
    ds_read_b64_tr_b16 a[208:209], v10 offset:49152
    ds_read_b64_tr_b16 a[210:211], v10 offset:51200
    v_mfma_f32_16x16x32_bf16 v[128:131], a[196:199], a[100:103], v[128:131]
    ds_read_b64_tr_b16 a[212:213], v10 offset:53248
    ds_read_b64_tr_b16 a[214:215], v10 offset:55296
    v_mfma_f32_16x16x32_bf16 v[132:135], a[196:199], a[108:111], v[132:135]
    buffer_load_dwordx4 a[144:147], v18, s[68:71], s46 offen offset:0 sc1
    v_mfma_f32_16x16x32_bf16 v[132:135], a[192:195], a[104:107], v[132:135]
    v_fmac_f32 v208, v48, v104
    v_fmac_f32 v209, v48, v105
    v_mfma_f32_16x16x32_bf16 v[136:139], a[192:195], a[112:115], v[136:139]
    v_fmac_f32 v210, v48, v106
    v_fmac_f32 v211, v48, v107
    v_mfma_f32_16x16x32_bf16 v[136:139], a[196:199], a[116:119], v[136:139]
    buffer_load_dwordx4 a[148:151], v18, s[68:71], s46 offen offset:1024 sc1
    v_mfma_f32_16x16x32_bf16 v[140:143], a[196:199], a[124:127], v[140:143]
    v_fmac_f32 v208, v52, v108
    v_fmac_f32 v209, v52, v109
    v_mfma_f32_16x16x32_bf16 v[140:143], a[192:195], a[120:123], v[140:143]
    s_waitcnt lgkmcnt(4)
    v_fmac_f32 v210, v52, v110
    v_fmac_f32 v211, v52, v111
    v_mfma_f32_16x16x32_bf16 v[156:159], a[200:203], a[120:123], v[156:159]
    ds_read_b64_tr_b16 a[216:217], v11 offset:49152
    ds_read_b64_tr_b16 a[218:219], v11 offset:51200
    v_mfma_f32_16x16x32_bf16 v[156:159], a[204:207], a[124:127], v[156:159]
    ds_read_b64_tr_b16 a[220:221], v11 offset:53248
    ds_read_b64_tr_b16 a[222:223], v11 offset:55296
    v_mfma_f32_16x16x32_bf16 v[152:155], a[204:207], a[116:119], v[152:155]
    buffer_load_dwordx4 a[152:155], v19, s[68:71], s46 offen offset:0 sc1
    v_mfma_f32_16x16x32_bf16 v[152:155], a[200:203], a[112:115], v[152:155]
    v_fmac_f32 v212, v49, v104
    v_fmac_f32 v213, v49, v105
    v_mfma_f32_16x16x32_bf16 v[148:151], a[200:203], a[104:107], v[148:151]
    buffer_load_dwordx4 a[156:159], v19, s[68:71], s46 offen offset:1024 sc1
    v_mfma_f32_16x16x32_bf16 v[148:151], a[204:207], a[108:111], v[148:151]
    v_fmac_f32 v214, v49, v106
    v_fmac_f32 v215, v49, v107
    v_mfma_f32_16x16x32_bf16 v[144:147], a[204:207], a[100:103], v[144:147]
    v_fmac_f32 v212, v53, v108
    v_fmac_f32 v213, v53, v109
    v_mfma_f32_16x16x32_bf16 v[144:147], a[200:203], a[96:99], v[144:147]
    s_waitcnt lgkmcnt(4)
    v_fmac_f32 v214, v53, v110
    v_fmac_f32 v215, v53, v111
    v_mfma_f32_16x16x32_bf16 v[160:163], a[208:211], a[96:99], v[160:163]
    ds_read_b64_tr_b16 a[192:193], v8 offset:57344
    ds_read_b64_tr_b16 a[194:195], v8 offset:59392
    v_mfma_f32_16x16x32_bf16 v[160:163], a[212:215], a[100:103], v[160:163]
    ds_read_b64_tr_b16 a[196:197], v8 offset:61440
    ds_read_b64_tr_b16 a[198:199], v8 offset:63488
    v_mfma_f32_16x16x32_bf16 v[164:167], a[212:215], a[108:111], v[164:167]
    buffer_load_dwordx4 a[160:163], v27, s[68:71], s46 offen offset:0 sc1
    v_mfma_f32_16x16x32_bf16 v[164:167], a[208:211], a[104:107], v[164:167]
    buffer_load_dwordx4 a[164:167], v27, s[68:71], s46 offen offset:1024 sc1
    v_mfma_f32_16x16x32_bf16 v[168:171], a[208:211], a[112:115], v[168:171]
    s_add_u32 m0, s55, 0
    v_fmac_f32 v216, v50, v104
    v_fmac_f32 v217, v50, v105
    v_mfma_f32_16x16x32_bf16 v[168:171], a[212:215], a[116:119], v[168:171]
    v_fmac_f32 v218, v50, v106
    v_fmac_f32 v219, v50, v107
    v_mfma_f32_16x16x32_bf16 v[172:175], a[212:215], a[124:127], v[172:175]
    v_fmac_f32 v216, v54, v108
    v_fmac_f32 v217, v54, v109
    v_mfma_f32_16x16x32_bf16 v[172:175], a[208:211], a[120:123], v[172:175]
    s_waitcnt lgkmcnt(4)
    v_fmac_f32 v218, v54, v110
    v_fmac_f32 v219, v54, v111
    v_mfma_f32_16x16x32_bf16 v[188:191], a[216:219], a[120:123], v[188:191]
    ds_read_b64_tr_b16 a[200:201], v9 offset:57344
    ds_read_b64_tr_b16 a[202:203], v9 offset:59392
    v_mfma_f32_16x16x32_bf16 v[188:191], a[220:223], a[124:127], v[188:191]
    ds_read_b64_tr_b16 a[204:205], v9 offset:61440
    ds_read_b64_tr_b16 a[206:207], v9 offset:63488
    v_mfma_f32_16x16x32_bf16 v[184:187], a[220:223], a[116:119], v[184:187]
    buffer_load_dwordx4 v12, s[68:71], s50 offen offset:0 sc1 lds
    v_mfma_f32_16x16x32_bf16 v[184:187], a[216:219], a[112:115], v[184:187]
    buffer_load_dwordx4 v12, s[68:71], s50 offen offset:1024 sc1 lds
    v_mfma_f32_16x16x32_bf16 v[180:183], a[216:219], a[104:107], v[180:183]
    s_add_u32 m0, s55, 2048
    v_fmac_f32 v220, v51, v104
    v_fmac_f32 v221, v51, v105
    v_mfma_f32_16x16x32_bf16 v[180:183], a[220:223], a[108:111], v[180:183]
    v_fmac_f32 v222, v51, v106
    v_fmac_f32 v223, v51, v107
    v_mfma_f32_16x16x32_bf16 v[176:179], a[220:223], a[100:103], v[176:179]
    buffer_load_dwordx4 v17, s[68:71], s50 offen offset:0 sc1 lds
    v_mfma_f32_16x16x32_bf16 v[176:179], a[216:219], a[96:99], v[176:179]
    s_waitcnt lgkmcnt(4)
    v_fmac_f32 v220, v55, v108
    v_fmac_f32 v221, v55, v109
    v_mfma_f32_16x16x32_bf16 v[192:195], a[192:195], a[96:99], v[192:195]
    ds_read_b64_tr_b16 a[208:209], v10 offset:57344
    ds_read_b64_tr_b16 a[210:211], v10 offset:59392
    v_mfma_f32_16x16x32_bf16 v[192:195], a[196:199], a[100:103], v[192:195]
    ds_read_b64_tr_b16 a[212:213], v10 offset:61440
    ds_read_b64_tr_b16 a[214:215], v10 offset:63488
    v_mfma_f32_16x16x32_bf16 v[196:199], a[196:199], a[108:111], v[196:199]
    buffer_load_dwordx4 v17, s[68:71], s50 offen offset:1024 sc1 lds
    v_mfma_f32_16x16x32_bf16 v[196:199], a[192:195], a[104:107], v[196:199]
    s_add_u32 m0, s55, 4096
    v_fmac_f32 v222, v55, v110
    v_fmac_f32 v223, v55, v111
    v_mfma_f32_16x16x32_bf16 v[200:203], a[192:195], a[112:115], v[200:203]
    v_mfma_f32_16x16x32_bf16 v[200:203], a[196:199], a[116:119], v[200:203]
    buffer_load_dwordx4 v18, s[68:71], s50 offen offset:0 sc1 lds
    v_mfma_f32_16x16x32_bf16 v[204:207], a[196:199], a[124:127], v[204:207]
    v_mfma_f32_16x16x32_bf16 v[204:207], a[192:195], a[120:123], v[204:207]
    s_waitcnt lgkmcnt(4)
    v_mfma_f32_16x16x32_bf16 v[220:223], a[200:203], a[120:123], v[220:223]
    ds_read_b64_tr_b16 a[216:217], v11 offset:57344
    ds_read_b64_tr_b16 a[218:219], v11 offset:59392
    v_mfma_f32_16x16x32_bf16 v[220:223], a[204:207], a[124:127], v[220:223]
    ds_read_b64_tr_b16 a[220:221], v11 offset:61440
    ds_read_b64_tr_b16 a[222:223], v11 offset:63488
    v_mfma_f32_16x16x32_bf16 v[216:219], a[204:207], a[116:119], v[216:219]
    buffer_load_dwordx4 v18, s[68:71], s50 offen offset:1024 sc1 lds
    v_mfma_f32_16x16x32_bf16 v[216:219], a[200:203], a[112:115], v[216:219]
    s_add_u32 m0, s55, 6144
    v_mfma_f32_16x16x32_bf16 v[212:215], a[200:203], a[104:107], v[212:215]
    buffer_load_dwordx4 v19, s[68:71], s50 offen offset:0 sc1 lds
    v_mfma_f32_16x16x32_bf16 v[212:215], a[204:207], a[108:111], v[212:215]
    v_mfma_f32_16x16x32_bf16 v[208:211], a[204:207], a[100:103], v[208:211]
    v_mfma_f32_16x16x32_bf16 v[208:211], a[200:203], a[96:99], v[208:211]
    s_waitcnt lgkmcnt(4)
    v_mfma_f32_16x16x32_bf16 v[224:227], a[208:211], a[96:99], v[224:227]
    s_waitcnt lgkmcnt(0)
    v_mfma_f32_16x16x32_bf16 v[224:227], a[212:215], a[100:103], v[224:227]
    s_barrier
    v_mfma_f32_16x16x32_bf16 v[228:231], a[212:215], a[108:111], v[228:231]
    v_add_u32 v8, 0x10000, v8
    v_add_u32 v9, 0x10000, v9
    v_mfma_f32_16x16x32_bf16 v[228:231], a[208:211], a[104:107], v[228:231]
    v_add_u32 v10, 0x10000, v10
    v_add_u32 v11, 0x10000, v11
    v_mfma_f32_16x16x32_bf16 v[232:235], a[208:211], a[112:115], v[232:235]
    ds_read_b64_tr_b16 a[192:193], v8 offset:0
    ds_read_b64_tr_b16 a[194:195], v8 offset:2048
    v_mfma_f32_16x16x32_bf16 v[232:235], a[212:215], a[116:119], v[232:235]
    ds_read_b64_tr_b16 a[196:197], v8 offset:4096
    ds_read_b64_tr_b16 a[198:199], v8 offset:6144
    v_mfma_f32_16x16x32_bf16 v[236:239], a[212:215], a[124:127], v[236:239]
    buffer_load_dwordx4 v19, s[68:71], s50 offen offset:1024 sc1 lds
    v_mfma_f32_16x16x32_bf16 v[236:239], a[208:211], a[120:123], v[236:239]
    s_waitcnt vmcnt(26) lgkmcnt(4)
    s_add_u32 m0, s55, 8192
    v_mfma_f32_16x16x32_bf16 v[252:255], a[216:219], a[120:123], v[252:255]
    buffer_load_dwordx4 v27, s[68:71], s50 offen offset:0 sc1 lds
    v_mfma_f32_16x16x32_bf16 v[252:255], a[220:223], a[124:127], v[252:255]
    buffer_load_dwordx4 v27, s[68:71], s50 offen offset:1024 sc1 lds
    v_mfma_f32_16x16x32_bf16 v[248:251], a[220:223], a[116:119], v[248:251]
    ds_read_b64_tr_b16 a[200:201], v9 offset:0
    ds_read_b64_tr_b16 a[202:203], v9 offset:2048
    v_mfma_f32_16x16x32_bf16 v[248:251], a[216:219], a[112:115], v[248:251]
    ds_read_b64_tr_b16 a[204:205], v9 offset:4096
    ds_read_b64_tr_b16 a[206:207], v9 offset:6144
    v_mfma_f32_16x16x32_bf16 v[244:247], a[216:219], a[104:107], v[244:247]
    v_mfma_f32_16x16x32_bf16 v[244:247], a[220:223], a[108:111], v[244:247]
    v_mfma_f32_16x16x32_bf16 v[240:243], a[220:223], a[100:103], v[240:243]
    v_mfma_f32_16x16x32_bf16 v[240:243], a[216:219], a[96:99], v[240:243]
    s_waitcnt lgkmcnt(4)
    v_mfma_f32_16x16x32_bf16 v[128:131], a[192:195], a[0:3], v[128:131]
    ds_read_b64_tr_b16 a[208:209], v10 offset:0
    ds_read_b64_tr_b16 a[210:211], v10 offset:2048
    v_mfma_f32_16x16x32_bf16 v[128:131], a[196:199], a[4:7], v[128:131]
    ds_read_b64_tr_b16 a[212:213], v10 offset:4096
    ds_read_b64_tr_b16 a[214:215], v10 offset:6144
    v_mfma_f32_16x16x32_bf16 v[132:135], a[196:199], a[12:15], v[132:135]
    buffer_load_dwordx4 a[168:171], v12, s[68:71], s47 offen offset:0 sc1
    v_mfma_f32_16x16x32_bf16 v[132:135], a[192:195], a[8:11], v[132:135]
    v_mfma_f32_16x16x32_bf16 v[136:139], a[192:195], a[16:19], v[136:139]
    v_mfma_f32_16x16x32_bf16 v[136:139], a[196:199], a[20:23], v[136:139]
    buffer_load_dwordx4 a[172:175], v12, s[68:71], s47 offen offset:1024 sc1
    v_mfma_f32_16x16x32_bf16 v[140:143], a[196:199], a[28:31], v[140:143]
    v_mfma_f32_16x16x32_bf16 v[140:143], a[192:195], a[24:27], v[140:143]
    s_waitcnt lgkmcnt(4)
    v_mfma_f32_16x16x32_bf16 v[156:159], a[200:203], a[24:27], v[156:159]
    ds_read_b64_tr_b16 a[216:217], v11 offset:0
    ds_read_b64_tr_b16 a[218:219], v11 offset:2048
    v_mfma_f32_16x16x32_bf16 v[156:159], a[204:207], a[28:31], v[156:159]
    ds_read_b64_tr_b16 a[220:221], v11 offset:4096
    ds_read_b64_tr_b16 a[222:223], v11 offset:6144
    v_mfma_f32_16x16x32_bf16 v[152:155], a[204:207], a[20:23], v[152:155]
    buffer_load_dwordx4 a[176:179], v17, s[68:71], s47 offen offset:0 sc1
    v_mfma_f32_16x16x32_bf16 v[152:155], a[200:203], a[16:19], v[152:155]
    v_mfma_f32_16x16x32_bf16 v[148:151], a[200:203], a[8:11], v[148:151]
    buffer_load_dwordx4 a[180:183], v17, s[68:71], s47 offen offset:1024 sc1
    v_mfma_f32_16x16x32_bf16 v[148:151], a[204:207], a[12:15], v[148:151]
    v_mfma_f32_16x16x32_bf16 v[144:147], a[204:207], a[4:7], v[144:147]
    v_mfma_f32_16x16x32_bf16 v[144:147], a[200:203], a[0:3], v[144:147]
    s_waitcnt lgkmcnt(4)
    v_mfma_f32_16x16x32_bf16 v[160:163], a[208:211], a[0:3], v[160:163]
    ds_read_b64_tr_b16 a[192:193], v8 offset:8192
    ds_read_b64_tr_b16 a[194:195], v8 offset:10240
    v_mfma_f32_16x16x32_bf16 v[160:163], a[212:215], a[4:7], v[160:163]
    ds_read_b64_tr_b16 a[196:197], v8 offset:12288
    ds_read_b64_tr_b16 a[198:199], v8 offset:14336
    v_mfma_f32_16x16x32_bf16 v[164:167], a[212:215], a[12:15], v[164:167]
    buffer_load_dwordx4 a[184:187], v18, s[68:71], s47 offen offset:0 sc1
    v_mfma_f32_16x16x32_bf16 v[164:167], a[208:211], a[8:11], v[164:167]
    buffer_load_dwordx4 a[188:191], v18, s[68:71], s47 offen offset:1024 sc1
    v_mfma_f32_16x16x32_bf16 v[168:171], a[208:211], a[16:19], v[168:171]
    v_mfma_f32_16x16x32_bf16 v[168:171], a[212:215], a[20:23], v[168:171]
    v_mfma_f32_16x16x32_bf16 v[172:175], a[212:215], a[28:31], v[172:175]
    v_mfma_f32_16x16x32_bf16 v[172:175], a[208:211], a[24:27], v[172:175]
    s_waitcnt lgkmcnt(4)
    v_mfma_f32_16x16x32_bf16 v[188:191], a[216:219], a[24:27], v[188:191]
    ds_read_b64_tr_b16 a[200:201], v9 offset:8192
    ds_read_b64_tr_b16 a[202:203], v9 offset:10240
    v_mfma_f32_16x16x32_bf16 v[188:191], a[220:223], a[28:31], v[188:191]
    ds_read_b64_tr_b16 a[204:205], v9 offset:12288
    ds_read_b64_tr_b16 a[206:207], v9 offset:14336
    v_mfma_f32_16x16x32_bf16 v[184:187], a[220:223], a[20:23], v[184:187]
    buffer_load_dwordx4 a[224:227], v19, s[68:71], s47 offen offset:0 sc1
    v_mfma_f32_16x16x32_bf16 v[184:187], a[216:219], a[16:19], v[184:187]
    buffer_load_dwordx4 a[228:231], v19, s[68:71], s47 offen offset:1024 sc1
    v_mfma_f32_16x16x32_bf16 v[180:183], a[216:219], a[8:11], v[180:183]
    v_fmac_f32 v160, v48, v80
    v_fmac_f32 v161, v48, v81
    v_mfma_f32_16x16x32_bf16 v[180:183], a[220:223], a[12:15], v[180:183]
    v_fmac_f32 v162, v48, v82
    v_fmac_f32 v163, v48, v83
    v_mfma_f32_16x16x32_bf16 v[176:179], a[220:223], a[4:7], v[176:179]
    buffer_load_dwordx4 a[232:235], v27, s[68:71], s47 offen offset:0 sc1
    v_mfma_f32_16x16x32_bf16 v[176:179], a[216:219], a[0:3], v[176:179]
    s_waitcnt lgkmcnt(4)
    v_fmac_f32 v160, v52, v84
    v_fmac_f32 v161, v52, v85
    v_mfma_f32_16x16x32_bf16 v[192:195], a[192:195], a[0:3], v[192:195]
    ds_read_b64_tr_b16 a[208:209], v10 offset:8192
    ds_read_b64_tr_b16 a[210:211], v10 offset:10240
    v_mfma_f32_16x16x32_bf16 v[192:195], a[196:199], a[4:7], v[192:195]
    ds_read_b64_tr_b16 a[212:213], v10 offset:12288
    ds_read_b64_tr_b16 a[214:215], v10 offset:14336
    v_mfma_f32_16x16x32_bf16 v[196:199], a[196:199], a[12:15], v[196:199]
    buffer_load_dwordx4 a[236:239], v27, s[68:71], s47 offen offset:1024 sc1
    v_mfma_f32_16x16x32_bf16 v[196:199], a[192:195], a[8:11], v[196:199]
    s_add_u32 m0, s55, 40960
    v_fmac_f32 v162, v52, v86
    v_fmac_f32 v163, v52, v87
    v_mfma_f32_16x16x32_bf16 v[200:203], a[192:195], a[16:19], v[200:203]
    v_fmac_f32 v164, v49, v80
    v_fmac_f32 v165, v49, v81
    v_mfma_f32_16x16x32_bf16 v[200:203], a[196:199], a[20:23], v[200:203]
    buffer_load_dwordx4 v12, s[68:71], s51 offen offset:0 sc1 lds
    v_mfma_f32_16x16x32_bf16 v[204:207], a[196:199], a[28:31], v[204:207]
    v_fmac_f32 v166, v49, v82
    v_fmac_f32 v167, v49, v83
    v_mfma_f32_16x16x32_bf16 v[204:207], a[192:195], a[24:27], v[204:207]
    s_waitcnt lgkmcnt(4)
    v_fmac_f32 v164, v53, v84
    v_fmac_f32 v165, v53, v85
    v_mfma_f32_16x16x32_bf16 v[220:223], a[200:203], a[24:27], v[220:223]
    ds_read_b64_tr_b16 a[216:217], v11 offset:8192
    ds_read_b64_tr_b16 a[218:219], v11 offset:10240
    v_mfma_f32_16x16x32_bf16 v[220:223], a[204:207], a[28:31], v[220:223]
    ds_read_b64_tr_b16 a[220:221], v11 offset:12288
    ds_read_b64_tr_b16 a[222:223], v11 offset:14336
    v_mfma_f32_16x16x32_bf16 v[216:219], a[204:207], a[20:23], v[216:219]
    buffer_load_dwordx4 v12, s[68:71], s51 offen offset:1024 sc1 lds
    v_mfma_f32_16x16x32_bf16 v[216:219], a[200:203], a[16:19], v[216:219]
    s_add_u32 m0, s55, 43008
    v_fmac_f32 v166, v53, v86
    v_fmac_f32 v167, v53, v87
    v_mfma_f32_16x16x32_bf16 v[212:215], a[200:203], a[8:11], v[212:215]
    buffer_load_dwordx4 v17, s[68:71], s51 offen offset:0 sc1 lds
    v_mfma_f32_16x16x32_bf16 v[212:215], a[204:207], a[12:15], v[212:215]
    v_fmac_f32 v168, v50, v80
    v_fmac_f32 v169, v50, v81
    v_mfma_f32_16x16x32_bf16 v[208:211], a[204:207], a[4:7], v[208:211]
    v_fmac_f32 v170, v50, v82
    v_fmac_f32 v171, v50, v83
    v_mfma_f32_16x16x32_bf16 v[208:211], a[200:203], a[0:3], v[208:211]
    s_waitcnt lgkmcnt(4)
    v_fmac_f32 v168, v54, v84
    v_fmac_f32 v169, v54, v85
    v_mfma_f32_16x16x32_bf16 v[224:227], a[208:211], a[0:3], v[224:227]
    ds_read_b64_tr_b16 a[192:193], v8 offset:16384
    ds_read_b64_tr_b16 a[194:195], v8 offset:18432
    v_mfma_f32_16x16x32_bf16 v[224:227], a[212:215], a[4:7], v[224:227]
    ds_read_b64_tr_b16 a[196:197], v8 offset:20480
    ds_read_b64_tr_b16 a[198:199], v8 offset:22528
    v_mfma_f32_16x16x32_bf16 v[228:231], a[212:215], a[12:15], v[228:231]
    buffer_load_dwordx4 v17, s[68:71], s51 offen offset:1024 sc1 lds
    v_mfma_f32_16x16x32_bf16 v[228:231], a[208:211], a[8:11], v[228:231]
    s_add_u32 m0, s55, 45056
    v_fmac_f32 v170, v54, v86
    v_fmac_f32 v171, v54, v87
    v_mfma_f32_16x16x32_bf16 v[232:235], a[208:211], a[16:19], v[232:235]
    buffer_load_dwordx4 v18, s[68:71], s51 offen offset:0 sc1 lds
    v_mfma_f32_16x16x32_bf16 v[232:235], a[212:215], a[20:23], v[232:235]
    v_fmac_f32 v172, v51, v80
    v_fmac_f32 v173, v51, v81
    v_mfma_f32_16x16x32_bf16 v[236:239], a[212:215], a[28:31], v[236:239]
    buffer_load_dwordx4 v18, s[68:71], s51 offen offset:1024 sc1 lds
    v_mfma_f32_16x16x32_bf16 v[236:239], a[208:211], a[24:27], v[236:239]
    s_waitcnt vmcnt(36) lgkmcnt(4)
    v_fmac_f32 v174, v51, v82
    v_fmac_f32 v175, v51, v83
    v_mfma_f32_16x16x32_bf16 v[252:255], a[216:219], a[24:27], v[252:255]
    v_fmac_f32 v172, v55, v84
    v_fmac_f32 v173, v55, v85
    v_mfma_f32_16x16x32_bf16 v[252:255], a[220:223], a[28:31], v[252:255]
    v_fmac_f32 v174, v55, v86
    v_fmac_f32 v175, v55, v87
    v_mfma_f32_16x16x32_bf16 v[248:251], a[220:223], a[20:23], v[248:251]
    ds_read_b64_tr_b16 a[200:201], v9 offset:16384
    ds_read_b64_tr_b16 a[202:203], v9 offset:18432
    v_mfma_f32_16x16x32_bf16 v[248:251], a[216:219], a[16:19], v[248:251]
    ds_read_b64_tr_b16 a[204:205], v9 offset:20480
    ds_read_b64_tr_b16 a[206:207], v9 offset:22528
    v_mfma_f32_16x16x32_bf16 v[244:247], a[216:219], a[8:11], v[244:247]
    v_mfma_f32_16x16x32_bf16 v[244:247], a[220:223], a[12:15], v[244:247]
    v_mfma_f32_16x16x32_bf16 v[240:243], a[220:223], a[4:7], v[240:243]
    v_mfma_f32_16x16x32_bf16 v[240:243], a[216:219], a[0:3], v[240:243]
    s_waitcnt lgkmcnt(4)
    v_mfma_f32_16x16x32_bf16 v[128:131], a[192:195], a[32:35], v[128:131]
    s_add_u32 s8, s4, 0xa00000
    s_addc_u32 s9, s5, 0
    ds_read_b64_tr_b16 a[208:209], v10 offset:16384
    ds_read_b64_tr_b16 a[210:211], v10 offset:18432
    v_mfma_f32_16x16x32_bf16 v[128:131], a[196:199], a[36:39], v[128:131]
    s_mov_b32 s10, 7077888
    ds_read_b64_tr_b16 a[212:213], v10 offset:20480
    ds_read_b64_tr_b16 a[214:215], v10 offset:22528
    v_mfma_f32_16x16x32_bf16 v[132:135], a[196:199], a[44:47], v[132:135]
    s_add_u32 m0, s55, 47104
    v_fmac_f32 v192, v48, v96
    v_fmac_f32 v193, v48, v97
    v_mfma_f32_16x16x32_bf16 v[132:135], a[192:195], a[40:43], v[132:135]
    buffer_load_dwordx4 v19, s[68:71], s51 offen offset:0 sc1 lds
    v_mfma_f32_16x16x32_bf16 v[136:139], a[192:195], a[48:51], v[136:139]
    s_mov_b32 s11, 0x20000
    v_fmac_f32 v194, v48, v98
    v_fmac_f32 v195, v48, v99
    v_mfma_f32_16x16x32_bf16 v[136:139], a[196:199], a[52:55], v[136:139]
    s_mul_i32 s28, s33, 55296
    v_fmac_f32 v192, v52, v100
    v_fmac_f32 v193, v52, v101
    v_mfma_f32_16x16x32_bf16 v[140:143], a[196:199], a[60:63], v[140:143]
    s_mul_i32 s29, s32, 37
    v_fmac_f32 v194, v52, v102
    v_fmac_f32 v195, v52, v103
    v_mfma_f32_16x16x32_bf16 v[140:143], a[192:195], a[56:59], v[140:143]
    s_waitcnt lgkmcnt(4)
    v_fmac_f32 v196, v49, v96
    v_fmac_f32 v197, v49, v97
    v_mfma_f32_16x16x32_bf16 v[156:159], a[200:203], a[56:59], v[156:159]
    s_lshr_b32 s29, s29, 8
    ds_read_b64_tr_b16 a[216:217], v11 offset:16384
    ds_read_b64_tr_b16 a[218:219], v11 offset:18432
    v_mfma_f32_16x16x32_bf16 v[156:159], a[204:207], a[60:63], v[156:159]
    s_mul_i32 s29, s29, 7
    ds_read_b64_tr_b16 a[220:221], v11 offset:20480
    ds_read_b64_tr_b16 a[222:223], v11 offset:22528
    v_mfma_f32_16x16x32_bf16 v[152:155], a[204:207], a[52:55], v[152:155]
    buffer_load_dwordx4 v19, s[68:71], s51 offen offset:1024 sc1 lds
    v_mfma_f32_16x16x32_bf16 v[152:155], a[200:203], a[48:51], v[152:155]
    s_add_u32 m0, s55, 49152
    v_fmac_f32 v198, v49, v98
    v_fmac_f32 v199, v49, v99
    v_mfma_f32_16x16x32_bf16 v[148:151], a[200:203], a[40:43], v[148:151]
    s_add_u32 s29, s29, s32
    v_fmac_f32 v196, v53, v100
    v_fmac_f32 v197, v53, v101
    v_mfma_f32_16x16x32_bf16 v[148:151], a[204:207], a[44:47], v[148:151]
    buffer_load_dwordx4 v27, s[68:71], s51 offen offset:0 sc1 lds
    v_mfma_f32_16x16x32_bf16 v[144:147], a[204:207], a[36:39], v[144:147]
    s_lshl_b32 s29, s29, 10
    v_fmac_f32 v198, v53, v102
    v_fmac_f32 v199, v53, v103
    v_mfma_f32_16x16x32_bf16 v[144:147], a[200:203], a[32:35], v[144:147]
    s_waitcnt lgkmcnt(4)
    v_fmac_f32 v200, v50, v96
    v_fmac_f32 v201, v50, v97
    v_mfma_f32_16x16x32_bf16 v[160:163], a[208:211], a[32:35], v[160:163]
    s_add_u32 s28, s28, s29
    ds_read_b64_tr_b16 a[192:193], v8 offset:24576
    ds_read_b64_tr_b16 a[194:195], v8 offset:26624
    v_mfma_f32_16x16x32_bf16 v[160:163], a[212:215], a[36:39], v[160:163]
    ds_read_b64_tr_b16 a[196:197], v8 offset:28672
    ds_read_b64_tr_b16 a[198:199], v8 offset:30720
    v_mfma_f32_16x16x32_bf16 v[164:167], a[212:215], a[44:47], v[164:167]
    buffer_load_dwordx4 v27, s[68:71], s51 offen offset:1024 sc1 lds
    v_mfma_f32_16x16x32_bf16 v[164:167], a[208:211], a[40:43], v[164:167]
    s_add_u32 m0, s55, 81920
    v_fmac_f32 v202, v50, v98
    v_fmac_f32 v203, v50, v99
    v_mfma_f32_16x16x32_bf16 v[168:171], a[208:211], a[48:51], v[168:171]
    v_fmac_f32 v200, v54, v100
    v_fmac_f32 v201, v54, v101
    v_mfma_f32_16x16x32_bf16 v[168:171], a[212:215], a[52:55], v[168:171]
    v_fmac_f32 v202, v54, v102
    v_fmac_f32 v203, v54, v103
    v_mfma_f32_16x16x32_bf16 v[172:175], a[212:215], a[60:63], v[172:175]
    v_fmac_f32 v204, v51, v96
    v_fmac_f32 v205, v51, v97
    v_mfma_f32_16x16x32_bf16 v[172:175], a[208:211], a[56:59], v[172:175]
    s_waitcnt lgkmcnt(4)
    v_fmac_f32 v206, v51, v98
    v_fmac_f32 v207, v51, v99
    v_mfma_f32_16x16x32_bf16 v[188:191], a[216:219], a[56:59], v[188:191]
    ds_read_b64_tr_b16 a[200:201], v9 offset:24576
    ds_read_b64_tr_b16 a[202:203], v9 offset:26624
    v_mfma_f32_16x16x32_bf16 v[188:191], a[220:223], a[60:63], v[188:191]
    ds_read_b64_tr_b16 a[204:205], v9 offset:28672
    ds_read_b64_tr_b16 a[206:207], v9 offset:30720
    v_mfma_f32_16x16x32_bf16 v[184:187], a[220:223], a[52:55], v[184:187]
    buffer_load_dwordx4 v12, s[68:71], s52 offen offset:0 sc1 lds
    v_mfma_f32_16x16x32_bf16 v[184:187], a[216:219], a[48:51], v[184:187]
    v_fmac_f32 v204, v55, v100
    v_fmac_f32 v205, v55, v101
    v_mfma_f32_16x16x32_bf16 v[180:183], a[216:219], a[40:43], v[180:183]
    v_fmac_f32 v206, v55, v102
    v_fmac_f32 v207, v55, v103
    v_mfma_f32_16x16x32_bf16 v[180:183], a[220:223], a[44:47], v[180:183]
    v_add_u32 v4, s28, v2
    v_mfma_f32_16x16x32_bf16 v[176:179], a[220:223], a[36:39], v[176:179]
    buffer_load_dwordx4 v12, s[68:71], s52 offen offset:1024 sc1 lds
    v_mfma_f32_16x16x32_bf16 v[176:179], a[216:219], a[32:35], v[176:179]
    s_waitcnt lgkmcnt(4)
    s_add_u32 m0, s55, 83968
    s_movk_i32 s44, 7168
    v_mfma_f32_16x16x32_bf16 v[192:195], a[192:195], a[32:35], v[192:195]
    s_cmp_ge_u32 s32, 21
    s_cmov_b32 s44, 6144
    ds_read_b64_tr_b16 a[208:209], v10 offset:24576
    ds_read_b64_tr_b16 a[210:211], v10 offset:26624
    v_mfma_f32_16x16x32_bf16 v[192:195], a[196:199], a[36:39], v[192:195]
    ds_read_b64_tr_b16 a[212:213], v10 offset:28672
    ds_read_b64_tr_b16 a[214:215], v10 offset:30720
    v_mfma_f32_16x16x32_bf16 v[196:199], a[196:199], a[44:47], v[196:199]
    v_mfma_f32_16x16x32_bf16 v[196:199], a[192:195], a[40:43], v[196:199]
    buffer_load_dwordx4 v17, s[68:71], s52 offen offset:0 sc1 lds
    v_mfma_f32_16x16x32_bf16 v[200:203], a[192:195], a[48:51], v[200:203]
    v_fmac_f32 v176, v48, v88
    v_fmac_f32 v177, v48, v89
    v_mfma_f32_16x16x32_bf16 v[200:203], a[196:199], a[52:55], v[200:203]
    v_fmac_f32 v178, v48, v90
    v_fmac_f32 v179, v48, v91
    v_mfma_f32_16x16x32_bf16 v[204:207], a[196:199], a[60:63], v[204:207]
    v_fmac_f32 v176, v52, v92
    v_fmac_f32 v177, v52, v93
    v_mfma_f32_16x16x32_bf16 v[204:207], a[192:195], a[56:59], v[204:207]
    s_waitcnt lgkmcnt(4)
    v_fmac_f32 v178, v52, v94
    v_fmac_f32 v179, v52, v95
    v_mfma_f32_16x16x32_bf16 v[220:223], a[200:203], a[56:59], v[220:223]
    ds_read_b64_tr_b16 a[216:217], v11 offset:24576
    ds_read_b64_tr_b16 a[218:219], v11 offset:26624
    v_mfma_f32_16x16x32_bf16 v[220:223], a[204:207], a[60:63], v[220:223]
    ds_read_b64_tr_b16 a[220:221], v11 offset:28672
    ds_read_b64_tr_b16 a[222:223], v11 offset:30720
    v_mfma_f32_16x16x32_bf16 v[216:219], a[204:207], a[52:55], v[216:219]
    buffer_load_dwordx4 v17, s[68:71], s52 offen offset:1024 sc1 lds
    v_mfma_f32_16x16x32_bf16 v[216:219], a[200:203], a[48:51], v[216:219]
    s_add_u32 m0, s55, 86016
    v_fmac_f32 v180, v49, v88
    v_fmac_f32 v181, v49, v89
    v_mfma_f32_16x16x32_bf16 v[212:215], a[200:203], a[40:43], v[212:215]
    v_fmac_f32 v182, v49, v90
    v_fmac_f32 v183, v49, v91
    v_mfma_f32_16x16x32_bf16 v[212:215], a[204:207], a[44:47], v[212:215]
    v_fmac_f32 v180, v53, v92
    v_fmac_f32 v181, v53, v93
    v_mfma_f32_16x16x32_bf16 v[208:211], a[204:207], a[36:39], v[208:211]
    buffer_load_dwordx4 v18, s[68:71], s52 offen offset:0 sc1 lds
    v_mfma_f32_16x16x32_bf16 v[208:211], a[200:203], a[32:35], v[208:211]
    s_waitcnt lgkmcnt(4)
    v_fmac_f32 v182, v53, v94
    v_fmac_f32 v183, v53, v95
    v_mfma_f32_16x16x32_bf16 v[224:227], a[208:211], a[32:35], v[224:227]
    v_fmac_f32 v184, v50, v88
    v_fmac_f32 v185, v50, v89
    v_mfma_f32_16x16x32_bf16 v[224:227], a[212:215], a[36:39], v[224:227]
    v_fmac_f32 v186, v50, v90
    v_fmac_f32 v187, v50, v91
    v_mfma_f32_16x16x32_bf16 v[228:231], a[212:215], a[44:47], v[228:231]
    v_fmac_f32 v184, v54, v92
    v_fmac_f32 v185, v54, v93
    v_mfma_f32_16x16x32_bf16 v[228:231], a[208:211], a[40:43], v[228:231]
    v_fmac_f32 v186, v54, v94
    v_fmac_f32 v187, v54, v95
    v_mfma_f32_16x16x32_bf16 v[232:235], a[208:211], a[48:51], v[232:235]
    buffer_load_dwordx4 v18, s[68:71], s52 offen offset:1024 sc1 lds
    v_mfma_f32_16x16x32_bf16 v[232:235], a[212:215], a[52:55], v[232:235]
    v_fmac_f32 v188, v51, v88
    v_fmac_f32 v189, v51, v89
    v_mfma_f32_16x16x32_bf16 v[236:239], a[212:215], a[60:63], v[236:239]
    v_fmac_f32 v190, v51, v90
    v_fmac_f32 v191, v51, v91
    v_mfma_f32_16x16x32_bf16 v[236:239], a[208:211], a[56:59], v[236:239]
    s_waitcnt lgkmcnt(0)
    v_fmac_f32 v188, v55, v92
    v_fmac_f32 v189, v55, v93
    v_mfma_f32_16x16x32_bf16 v[252:255], a[216:219], a[56:59], v[252:255]
    v_fmac_f32 v190, v55, v94
    v_fmac_f32 v191, v55, v95
    v_mfma_f32_16x16x32_bf16 v[252:255], a[220:223], a[60:63], v[252:255]
    v_mfma_f32_16x16x32_bf16 v[248:251], a[220:223], a[52:55], v[248:251]
    v_mfma_f32_16x16x32_bf16 v[248:251], a[216:219], a[48:51], v[248:251]
    v_mfma_f32_16x16x32_bf16 v[244:247], a[216:219], a[40:43], v[244:247]
    v_mfma_f32_16x16x32_bf16 v[244:247], a[220:223], a[44:47], v[244:247]
    v_mfma_f32_16x16x32_bf16 v[240:243], a[220:223], a[36:39], v[240:243]
    v_mfma_f32_16x16x32_bf16 v[240:243], a[216:219], a[32:35], v[240:243]
KB_x4:
    s_barrier
    s_waitcnt vmcnt(30)
    v_mul_f32 v32, v128, v128
    s_add_u32 m0, s55, 88064
    s_nop 0
    buffer_load_dwordx4 v19, s[68:71], s52 offen offset:0 sc1 lds
    v_mul_f32 v33, v129, v129
    v_mul_f32 v34, v130, v130
    v_mul_f32 v35, v131, v131
    v_mul_f32 v36, v144, v144
    v_mul_f32 v37, v145, v145
    v_mul_f32 v38, v146, v146
    v_mul_f32 v39, v147, v147
    v_fma_f32 v32, v32, v60, v56
    v_fma_f32 v33, v33, v60, v56
    v_fma_f32 v34, v34, v60, v56
    v_fma_f32 v35, v35, v60, v56
    v_fma_f32 v36, v36, v60, v56
    v_fma_f32 v37, v37, v60, v56
    v_fma_f32 v38, v38, v60, v56
    v_fma_f32 v39, v39, v60, v56
    buffer_load_dwordx4 v19, s[68:71], s52 offen offset:1024 sc1 lds
    v_mul_f32 v32, v32, v128
    v_mul_f32 v33, v33, v129
    v_mul_f32 v34, v34, v130
    v_mul_f32 v35, v35, v131
    v_mul_f32 v36, v36, v144
    v_mul_f32 v37, v37, v145
    v_mul_f32 v38, v38, v146
    v_mul_f32 v39, v39, v147
    v_exp_f32 v32, v32
    v_exp_f32 v33, v33
    v_exp_f32 v34, v34
    v_exp_f32 v35, v35
    v_exp_f32 v36, v36
    v_exp_f32 v37, v37
    v_exp_f32 v38, v38
    v_exp_f32 v39, v39
    s_add_u32 m0, s55, 90112
    s_nop 0
    buffer_load_dwordx4 v27, s[68:71], s52 offen offset:0 sc1 lds
    v_fma_f32 v32, v32, v20, v20
    v_fma_f32 v33, v33, v20, v20
    v_fma_f32 v34, v34, v20, v20
    v_fma_f32 v35, v35, v20, v20
    v_fma_f32 v36, v36, v20, v20
    v_fma_f32 v37, v37, v20, v20
    v_fma_f32 v38, v38, v20, v20
    v_fma_f32 v39, v39, v20, v20
    v_rcp_f32 v32, v32
    v_rcp_f32 v33, v33
    v_rcp_f32 v34, v34
    v_rcp_f32 v35, v35
    v_rcp_f32 v36, v36
    v_rcp_f32 v37, v37
    v_rcp_f32 v38, v38
    buffer_load_dwordx4 v27, s[68:71], s52 offen offset:1024 sc1 lds
    v_rcp_f32 v39, v39
    v_mul_f32 v32, v32, v128
    v_mul_f32 v33, v33, v129
    v_mul_f32 v34, v34, v130
    v_mul_f32 v35, v35, v131
    v_mul_f32 v36, v36, v144
    v_mul_f32 v37, v37, v145
    v_mul_f32 v38, v38, v146
    v_mul_f32 v39, v39, v147
    v_mul_f32 v32, v32, v192
    v_mul_f32 v33, v33, v193
    v_mul_f32 v34, v34, v194
    v_mul_f32 v35, v35, v195
    v_mul_f32 v36, v36, v208
    v_mul_f32 v37, v37, v209
    v_mul_f32 v38, v38, v210
    buffer_load_dwordx4 a[64:67], v12, s[68:71], s48 offen offset:0 sc1
    v_mul_f32 v39, v39, v211
    v_cvt_pk_bf16_f32 v40, v32, v33
    v_cvt_pk_bf16_f32 v41, v34, v35
    v_cvt_pk_bf16_f32 v42, v36, v37
    v_cvt_pk_bf16_f32 v43, v38, v39
    s_mov_b32 s28, 0
    buffer_store_dwordx4 v[40:43], v4, s[8:11], s28 offen sc1
    v_mul_f32 v32, v132, v132
    v_mul_f32 v33, v133, v133
    v_mul_f32 v34, v134, v134
    v_mul_f32 v35, v135, v135
    v_mul_f32 v36, v148, v148
    v_mul_f32 v37, v149, v149
    v_mul_f32 v38, v150, v150
    v_mul_f32 v39, v151, v151
    v_fma_f32 v32, v32, v61, v57
    v_fma_f32 v33, v33, v61, v57
    v_fma_f32 v34, v34, v61, v57
    v_fma_f32 v35, v35, v61, v57
    buffer_load_dwordx4 a[68:71], v12, s[68:71], s48 offen offset:1024 sc1
    v_fma_f32 v36, v36, v61, v57
    v_fma_f32 v37, v37, v61, v57
    v_fma_f32 v38, v38, v61, v57
    v_fma_f32 v39, v39, v61, v57
    v_mul_f32 v32, v32, v132
    v_mul_f32 v33, v33, v133
    v_mul_f32 v34, v34, v134
    v_mul_f32 v35, v35, v135
    v_mul_f32 v36, v36, v148
    v_mul_f32 v37, v37, v149
    v_mul_f32 v38, v38, v150
    v_mul_f32 v39, v39, v151
    v_exp_f32 v32, v32
    v_exp_f32 v33, v33
    v_exp_f32 v34, v34
    buffer_load_dwordx4 a[72:75], v17, s[68:71], s48 offen offset:0 sc1
    v_exp_f32 v35, v35
    v_exp_f32 v36, v36
    v_exp_f32 v37, v37
    v_exp_f32 v38, v38
    v_exp_f32 v39, v39
    v_fma_f32 v32, v32, v21, v21
    v_fma_f32 v33, v33, v21, v21
    v_fma_f32 v34, v34, v21, v21
    v_fma_f32 v35, v35, v21, v21
    v_fma_f32 v36, v36, v21, v21
    v_fma_f32 v37, v37, v21, v21
    v_fma_f32 v38, v38, v21, v21
    v_fma_f32 v39, v39, v21, v21
    v_rcp_f32 v32, v32
    v_rcp_f32 v33, v33
    v_rcp_f32 v34, v34
    buffer_load_dwordx4 a[76:79], v17, s[68:71], s48 offen offset:1024 sc1
    v_rcp_f32 v35, v35
    v_rcp_f32 v36, v36
    v_rcp_f32 v37, v37
    v_rcp_f32 v38, v38
    v_rcp_f32 v39, v39
    v_mul_f32 v32, v32, v132
    v_mul_f32 v33, v33, v133
    v_mul_f32 v34, v34, v134
    v_mul_f32 v35, v35, v135
    v_mul_f32 v36, v36, v148
    v_mul_f32 v37, v37, v149
    v_mul_f32 v38, v38, v150
    v_mul_f32 v39, v39, v151
    v_mul_f32 v32, v32, v196
    v_mul_f32 v33, v33, v197
    v_mul_f32 v34, v34, v198
    buffer_load_dwordx4 a[80:83], v18, s[68:71], s48 offen offset:0 sc1
    v_mul_f32 v35, v35, v199
    v_mul_f32 v36, v36, v212
    v_mul_f32 v37, v37, v213
    v_mul_f32 v38, v38, v214
    v_mul_f32 v39, v39, v215
    v_cvt_pk_bf16_f32 v44, v32, v33
    v_cvt_pk_bf16_f32 v45, v34, v35
    v_cvt_pk_bf16_f32 v46, v36, v37
    v_cvt_pk_bf16_f32 v47, v38, v39
    s_mov_b32 s28, 55296
    buffer_store_dwordx4 v[44:47], v4, s[8:11], s28 offen sc1
    v_mul_f32 v32, v136, v136
    v_mul_f32 v33, v137, v137
    v_mul_f32 v34, v138, v138
    v_mul_f32 v35, v139, v139
    v_mul_f32 v36, v152, v152
    v_mul_f32 v37, v153, v153
    v_mul_f32 v38, v154, v154
    buffer_load_dwordx4 a[84:87], v18, s[68:71], s48 offen offset:1024 sc1
    v_mul_f32 v39, v155, v155
    v_fma_f32 v32, v32, v62, v58
    v_fma_f32 v33, v33, v62, v58
    v_fma_f32 v34, v34, v62, v58
    v_fma_f32 v35, v35, v62, v58
    v_fma_f32 v36, v36, v62, v58
    v_fma_f32 v37, v37, v62, v58
    v_fma_f32 v38, v38, v62, v58
    v_fma_f32 v39, v39, v62, v58
    v_mul_f32 v32, v32, v136
    v_mul_f32 v33, v33, v137
    v_mul_f32 v34, v34, v138
    v_mul_f32 v35, v35, v139
    v_mul_f32 v36, v36, v152
    v_mul_f32 v37, v37, v153
    v_mul_f32 v38, v38, v154
    buffer_load_dwordx4 a[88:91], v19, s[68:71], s48 offen offset:0 sc1
    v_mul_f32 v39, v39, v155
    v_exp_f32 v32, v32
    v_exp_f32 v33, v33
    v_exp_f32 v34, v34
    v_exp_f32 v35, v35
    v_exp_f32 v36, v36
    v_exp_f32 v37, v37
    v_exp_f32 v38, v38
    v_exp_f32 v39, v39
    v_fma_f32 v32, v32, v22, v22
    v_fma_f32 v33, v33, v22, v22
    v_fma_f32 v34, v34, v22, v22
    v_fma_f32 v35, v35, v22, v22
    v_fma_f32 v36, v36, v22, v22
    v_fma_f32 v37, v37, v22, v22
    buffer_load_dwordx4 a[92:95], v19, s[68:71], s48 offen offset:1024 sc1
    v_fma_f32 v38, v38, v22, v22
    v_fma_f32 v39, v39, v22, v22
    v_rcp_f32 v32, v32
    v_rcp_f32 v33, v33
    v_rcp_f32 v34, v34
    v_rcp_f32 v35, v35
    v_rcp_f32 v36, v36
    v_rcp_f32 v37, v37
    v_rcp_f32 v38, v38
    v_rcp_f32 v39, v39
    v_mul_f32 v32, v32, v136
    v_mul_f32 v33, v33, v137
    v_mul_f32 v34, v34, v138
    v_mul_f32 v35, v35, v139
    v_mul_f32 v36, v36, v152
    v_mul_f32 v37, v37, v153
    buffer_load_dwordx4 a[96:99], v27, s[68:71], s48 offen offset:0 sc1
    v_mul_f32 v38, v38, v154
    v_mul_f32 v39, v39, v155
    v_mul_f32 v32, v32, v200
    v_mul_f32 v33, v33, v201
    v_mul_f32 v34, v34, v202
    v_mul_f32 v35, v35, v203
    v_mul_f32 v36, v36, v216
    v_mul_f32 v37, v37, v217
    v_mul_f32 v38, v38, v218
    v_mul_f32 v39, v39, v219
    v_cvt_pk_bf16_f32 v40, v32, v33
    v_cvt_pk_bf16_f32 v41, v34, v35
    v_cvt_pk_bf16_f32 v42, v36, v37
    v_cvt_pk_bf16_f32 v43, v38, v39
    s_mov_b32 s28, 110592
    buffer_store_dwordx4 v[40:43], v4, s[8:11], s28 offen sc1
    v_mul_f32 v32, v140, v140
    v_mul_f32 v33, v141, v141
    v_mul_f32 v34, v142, v142
    buffer_load_dwordx4 a[100:103], v27, s[68:71], s48 offen offset:1024 sc1
    v_mul_f32 v35, v143, v143
    v_mul_f32 v36, v156, v156
    v_mul_f32 v37, v157, v157
    v_mul_f32 v38, v158, v158
    v_mul_f32 v39, v159, v159
    v_fma_f32 v32, v32, v63, v59
    v_fma_f32 v33, v33, v63, v59
    v_fma_f32 v34, v34, v63, v59
    v_fma_f32 v35, v35, v63, v59
    v_fma_f32 v36, v36, v63, v59
    v_fma_f32 v37, v37, v63, v59
    v_fma_f32 v38, v38, v63, v59
    v_fma_f32 v39, v39, v63, v59
    v_mul_f32 v32, v32, v140
    v_mul_f32 v33, v33, v141
    s_add_u32 m0, s55, 122880
    s_nop 0
    buffer_load_dwordx4 v12, s[68:71], s53 offen offset:0 sc1 lds
    v_mul_f32 v34, v34, v142
    v_mul_f32 v35, v35, v143
    v_mul_f32 v36, v36, v156
    v_mul_f32 v37, v37, v157
    v_mul_f32 v38, v38, v158
    v_mul_f32 v39, v39, v159
    v_exp_f32 v32, v32
    v_exp_f32 v33, v33
    v_exp_f32 v34, v34
    v_exp_f32 v35, v35
    v_exp_f32 v36, v36
    v_exp_f32 v37, v37
    v_exp_f32 v38, v38
    v_exp_f32 v39, v39
    v_fma_f32 v32, v32, v23, v23
    v_fma_f32 v33, v33, v23, v23
    buffer_load_dwordx4 v12, s[68:71], s53 offen offset:1024 sc1 lds
    v_fma_f32 v34, v34, v23, v23
    v_fma_f32 v35, v35, v23, v23
    v_fma_f32 v36, v36, v23, v23
    v_fma_f32 v37, v37, v23, v23
    v_fma_f32 v38, v38, v23, v23
    v_fma_f32 v39, v39, v23, v23
    v_rcp_f32 v32, v32
    v_rcp_f32 v33, v33
    v_rcp_f32 v34, v34
    v_rcp_f32 v35, v35
    v_rcp_f32 v36, v36
    v_rcp_f32 v37, v37
    v_rcp_f32 v38, v38
    v_rcp_f32 v39, v39
    v_mul_f32 v32, v32, v140
    v_mul_f32 v33, v33, v141
    s_add_u32 m0, s55, 124928
    s_nop 0
    buffer_load_dwordx4 v17, s[68:71], s53 offen offset:0 sc1 lds
    v_mul_f32 v34, v34, v142
    v_mul_f32 v35, v35, v143
    v_mul_f32 v36, v36, v156
    v_mul_f32 v37, v37, v157
    v_mul_f32 v38, v38, v158
    v_mul_f32 v39, v39, v159
    v_mul_f32 v32, v32, v204
    v_mul_f32 v33, v33, v205
    v_mul_f32 v34, v34, v206
    v_mul_f32 v35, v35, v207
    v_mul_f32 v36, v36, v220
    v_mul_f32 v37, v37, v221
    v_mul_f32 v38, v38, v222
    v_mul_f32 v39, v39, v223
    v_cvt_pk_bf16_f32 v44, v32, v33
    buffer_load_dwordx4 v17, s[68:71], s53 offen offset:1024 sc1 lds
    v_cvt_pk_bf16_f32 v45, v34, v35
    v_cvt_pk_bf16_f32 v46, v36, v37
    v_cvt_pk_bf16_f32 v47, v38, v39
    s_mov_b32 s28, 165888
    buffer_store_dwordx4 v[44:47], v4, s[8:11], s28 offen sc1
    v_add_u32 v4, s44, v4
    v_mul_f32 v32, v160, v160
    v_mul_f32 v33, v161, v161
    v_mul_f32 v34, v162, v162
    v_mul_f32 v35, v163, v163
    v_mul_f32 v36, v176, v176
    v_mul_f32 v37, v177, v177
    v_mul_f32 v38, v178, v178
    v_mul_f32 v39, v179, v179
    v_fma_f32 v32, v32, v60, v56
    v_fma_f32 v33, v33, v60, v56
    v_fma_f32 v34, v34, v60, v56
    v_fma_f32 v35, v35, v60, v56
    v_fma_f32 v36, v36, v60, v56
    s_add_u32 m0, s55, 126976
    s_nop 0
    buffer_load_dwordx4 v18, s[68:71], s53 offen offset:0 sc1 lds
    v_fma_f32 v37, v37, v60, v56
    v_fma_f32 v38, v38, v60, v56
    v_fma_f32 v39, v39, v60, v56
    v_mul_f32 v32, v32, v160
    v_mul_f32 v33, v33, v161
    v_mul_f32 v34, v34, v162
    v_mul_f32 v35, v35, v163
    v_mul_f32 v36, v36, v176
    v_mul_f32 v37, v37, v177
    v_mul_f32 v38, v38, v178
    v_mul_f32 v39, v39, v179
    v_exp_f32 v32, v32
    v_exp_f32 v33, v33
    v_exp_f32 v34, v34
    v_exp_f32 v35, v35
    buffer_load_dwordx4 v18, s[68:71], s53 offen offset:1024 sc1 lds
    v_exp_f32 v36, v36
    v_exp_f32 v37, v37
    v_exp_f32 v38, v38
    v_exp_f32 v39, v39
    v_fma_f32 v32, v32, v20, v20
    v_fma_f32 v33, v33, v20, v20
    v_fma_f32 v34, v34, v20, v20
    v_fma_f32 v35, v35, v20, v20
    v_fma_f32 v36, v36, v20, v20
    v_fma_f32 v37, v37, v20, v20
    v_fma_f32 v38, v38, v20, v20
    v_fma_f32 v39, v39, v20, v20
    v_rcp_f32 v32, v32
    v_rcp_f32 v33, v33
    v_rcp_f32 v34, v34
    v_rcp_f32 v35, v35
    s_add_u32 m0, s55, 129024
    s_nop 0
    buffer_load_dwordx4 v19, s[68:71], s53 offen offset:0 sc1 lds
    v_rcp_f32 v36, v36
    v_rcp_f32 v37, v37
    v_rcp_f32 v38, v38
    v_rcp_f32 v39, v39
    v_mul_f32 v32, v32, v160
    v_mul_f32 v33, v33, v161
    v_mul_f32 v34, v34, v162
    v_mul_f32 v35, v35, v163
    v_mul_f32 v36, v36, v176
    v_mul_f32 v37, v37, v177
    v_mul_f32 v38, v38, v178
    v_mul_f32 v39, v39, v179
    v_mul_f32 v32, v32, v224
    v_mul_f32 v33, v33, v225
    v_mul_f32 v34, v34, v226
    v_mul_f32 v35, v35, v227
    buffer_load_dwordx4 v19, s[68:71], s53 offen offset:1024 sc1 lds
    v_mul_f32 v36, v36, v240
    v_mul_f32 v37, v37, v241
    v_mul_f32 v38, v38, v242
    v_mul_f32 v39, v39, v243
    v_cvt_pk_bf16_f32 v40, v32, v33
    v_cvt_pk_bf16_f32 v41, v34, v35
    v_cvt_pk_bf16_f32 v42, v36, v37
    v_cvt_pk_bf16_f32 v43, v38, v39
    s_mov_b32 s28, 0
    buffer_store_dwordx4 v[40:43], v4, s[8:11], s28 offen sc1
    v_mul_f32 v32, v164, v164
    v_mul_f32 v33, v165, v165
    v_mul_f32 v34, v166, v166
    v_mul_f32 v35, v167, v167
    v_mul_f32 v36, v180, v180
    v_mul_f32 v37, v181, v181
    v_mul_f32 v38, v182, v182
    v_mul_f32 v39, v183, v183
    s_add_u32 m0, s55, 131072
    s_nop 0
    buffer_load_dwordx4 v27, s[68:71], s53 offen offset:0 sc1 lds
    v_fma_f32 v32, v32, v61, v57
    v_fma_f32 v33, v33, v61, v57
    v_fma_f32 v34, v34, v61, v57
    v_fma_f32 v35, v35, v61, v57
    v_fma_f32 v36, v36, v61, v57
    v_fma_f32 v37, v37, v61, v57
    v_fma_f32 v38, v38, v61, v57
    v_fma_f32 v39, v39, v61, v57
    v_mul_f32 v32, v32, v164
    v_mul_f32 v33, v33, v165
    v_mul_f32 v34, v34, v166
    v_mul_f32 v35, v35, v167
    v_mul_f32 v36, v36, v180
    v_mul_f32 v37, v37, v181
    v_mul_f32 v38, v38, v182
    v_mul_f32 v39, v39, v183
    buffer_load_dwordx4 v27, s[68:71], s53 offen offset:1024 sc1 lds
    v_exp_f32 v32, v32
    v_exp_f32 v33, v33
    v_exp_f32 v34, v34
    v_exp_f32 v35, v35
    v_exp_f32 v36, v36
    v_exp_f32 v37, v37
    v_exp_f32 v38, v38
    v_exp_f32 v39, v39
    v_fma_f32 v32, v32, v21, v21
    v_fma_f32 v33, v33, v21, v21
    v_fma_f32 v34, v34, v21, v21
    v_fma_f32 v35, v35, v21, v21
    v_fma_f32 v36, v36, v21, v21
    v_fma_f32 v37, v37, v21, v21
    v_fma_f32 v38, v38, v21, v21
    v_fma_f32 v39, v39, v21, v21
    v_rcp_f32 v32, v32
    v_rcp_f32 v33, v33
    v_rcp_f32 v34, v34
    v_rcp_f32 v35, v35
    v_rcp_f32 v36, v36
    v_rcp_f32 v37, v37
    v_rcp_f32 v38, v38
    v_rcp_f32 v39, v39
    v_mul_f32 v32, v32, v164
    v_mul_f32 v33, v33, v165
    v_mul_f32 v34, v34, v166
    v_mul_f32 v35, v35, v167
    v_mul_f32 v36, v36, v180
    v_mul_f32 v37, v37, v181
    v_mul_f32 v38, v38, v182
    v_mul_f32 v39, v39, v183
    v_mul_f32 v32, v32, v228
    v_mul_f32 v33, v33, v229
    v_mul_f32 v34, v34, v230
    v_mul_f32 v35, v35, v231
    v_mul_f32 v36, v36, v244
    v_mul_f32 v37, v37, v245
    v_mul_f32 v38, v38, v246
    v_mul_f32 v39, v39, v247
    v_cvt_pk_bf16_f32 v44, v32, v33
    v_cvt_pk_bf16_f32 v45, v34, v35
    v_cvt_pk_bf16_f32 v46, v36, v37
    v_cvt_pk_bf16_f32 v47, v38, v39
    s_mov_b32 s28, 55296
    buffer_store_dwordx4 v[44:47], v4, s[8:11], s28 offen sc1
    s_waitcnt vmcnt(8)
    s_barrier
    v_mov_b32 v13, 1
    buffer_atomic_add v13, v29, s[72:75], s24 offen offset:12
    v_mul_f32 v32, v168, v168
    v_mul_f32 v33, v169, v169
    v_mul_f32 v34, v170, v170
    v_mul_f32 v35, v171, v171
    v_mul_f32 v36, v184, v184
    v_mul_f32 v37, v185, v185
    v_mul_f32 v38, v186, v186
    v_mul_f32 v39, v187, v187
    v_fma_f32 v32, v32, v62, v58
    v_fma_f32 v33, v33, v62, v58
    v_fma_f32 v34, v34, v62, v58
    v_fma_f32 v35, v35, v62, v58
    v_fma_f32 v36, v36, v62, v58
    v_fma_f32 v37, v37, v62, v58
    v_fma_f32 v38, v38, v62, v58
    v_fma_f32 v39, v39, v62, v58
    v_mul_f32 v32, v32, v168
    v_mul_f32 v33, v33, v169
    v_mul_f32 v34, v34, v170
    v_mul_f32 v35, v35, v171
    v_mul_f32 v36, v36, v184
    v_mul_f32 v37, v37, v185
    v_mul_f32 v38, v38, v186
    v_mul_f32 v39, v39, v187
    v_exp_f32 v32, v32
    v_exp_f32 v33, v33
    v_exp_f32 v34, v34
    v_exp_f32 v35, v35
    v_exp_f32 v36, v36
    v_exp_f32 v37, v37
    v_exp_f32 v38, v38
    v_exp_f32 v39, v39
    v_fma_f32 v32, v32, v22, v22
    v_fma_f32 v33, v33, v22, v22
    v_fma_f32 v34, v34, v22, v22
    v_fma_f32 v35, v35, v22, v22
    v_fma_f32 v36, v36, v22, v22
    v_fma_f32 v37, v37, v22, v22
    v_fma_f32 v38, v38, v22, v22
    v_fma_f32 v39, v39, v22, v22
    v_rcp_f32 v32, v32
    v_rcp_f32 v33, v33
    v_rcp_f32 v34, v34
    v_rcp_f32 v35, v35
    v_rcp_f32 v36, v36
    v_rcp_f32 v37, v37
    v_rcp_f32 v38, v38
    v_rcp_f32 v39, v39
    v_mul_f32 v32, v32, v168
    v_mul_f32 v33, v33, v169
    v_mul_f32 v34, v34, v170
    v_mul_f32 v35, v35, v171
    v_mul_f32 v36, v36, v184
    v_mul_f32 v37, v37, v185
    v_mul_f32 v38, v38, v186
    v_mul_f32 v39, v39, v187
    v_mul_f32 v32, v32, v232
    v_mul_f32 v33, v33, v233
    v_mul_f32 v34, v34, v234
    v_mul_f32 v35, v35, v235
    v_mul_f32 v36, v36, v248
    v_mul_f32 v37, v37, v249
    v_mul_f32 v38, v38, v250
    v_mul_f32 v39, v39, v251
    v_cvt_pk_bf16_f32 v40, v32, v33
    v_cvt_pk_bf16_f32 v41, v34, v35
    v_cvt_pk_bf16_f32 v42, v36, v37
    v_cvt_pk_bf16_f32 v43, v38, v39
    s_mov_b32 s28, 110592
    buffer_store_dwordx4 v[40:43], v4, s[8:11], s28 offen sc1
    v_mul_f32 v32, v172, v172
    v_mul_f32 v33, v173, v173
    v_mul_f32 v34, v174, v174
    v_mul_f32 v35, v175, v175
    v_mul_f32 v36, v188, v188
    v_mul_f32 v37, v189, v189
    v_mul_f32 v38, v190, v190
    v_mul_f32 v39, v191, v191
    v_fma_f32 v32, v32, v63, v59
    v_fma_f32 v33, v33, v63, v59
    v_fma_f32 v34, v34, v63, v59
    v_fma_f32 v35, v35, v63, v59
    v_fma_f32 v36, v36, v63, v59
    v_fma_f32 v37, v37, v63, v59
    v_fma_f32 v38, v38, v63, v59
    v_fma_f32 v39, v39, v63, v59
    v_mul_f32 v32, v32, v172
    v_mul_f32 v33, v33, v173
    v_mul_f32 v34, v34, v174
    v_mul_f32 v35, v35, v175
    v_mul_f32 v36, v36, v188
    v_mul_f32 v37, v37, v189
    v_mul_f32 v38, v38, v190
    v_mul_f32 v39, v39, v191
    v_exp_f32 v32, v32
    v_exp_f32 v33, v33
    v_exp_f32 v34, v34
    v_exp_f32 v35, v35
    v_exp_f32 v36, v36
    v_exp_f32 v37, v37
    v_exp_f32 v38, v38
    v_exp_f32 v39, v39
    v_fma_f32 v32, v32, v23, v23
    v_fma_f32 v33, v33, v23, v23
    v_fma_f32 v34, v34, v23, v23
    v_fma_f32 v35, v35, v23, v23
    v_fma_f32 v36, v36, v23, v23
    v_fma_f32 v37, v37, v23, v23
    v_fma_f32 v38, v38, v23, v23
    v_fma_f32 v39, v39, v23, v23
    v_rcp_f32 v32, v32
    v_rcp_f32 v33, v33
    v_rcp_f32 v34, v34
    v_rcp_f32 v35, v35
    v_rcp_f32 v36, v36
    v_rcp_f32 v37, v37
    v_rcp_f32 v38, v38
    v_rcp_f32 v39, v39
    v_mul_f32 v32, v32, v172
    v_mul_f32 v33, v33, v173
    v_mul_f32 v34, v34, v174
    v_mul_f32 v35, v35, v175
    v_mul_f32 v36, v36, v188
    v_mul_f32 v37, v37, v189
    v_mul_f32 v38, v38, v190
    v_mul_f32 v39, v39, v191
    v_mul_f32 v32, v32, v236
    v_mul_f32 v33, v33, v237
    v_mul_f32 v34, v34, v238
    v_mul_f32 v35, v35, v239
    v_mul_f32 v36, v36, v252
    v_mul_f32 v37, v37, v253
    v_mul_f32 v38, v38, v254
    v_mul_f32 v39, v39, v255
    v_cvt_pk_bf16_f32 v44, v32, v33
    v_cvt_pk_bf16_f32 v45, v34, v35
    v_cvt_pk_bf16_f32 v46, v36, v37
    v_cvt_pk_bf16_f32 v47, v38, v39
    s_mov_b32 s28, 165888
    buffer_store_dwordx4 v[44:47], v4, s[8:11], s28 offen sc1
KB_join4:
    s_load_dwordx2 s[6:7], s[0:1], 96
    s_mul_i32 s28, s31, 55296
    v_add_u32 v4, s28, v2
    s_add_u32 s28, s28, 110592
    v_add_u32 v5, s28, v2
    s_add_u32 s28, s28, 110592
    v_add_u32 v6, s28, v2
    s_add_u32 s28, s28, 110592
    v_add_u32 v7, s28, v2
    s_add_u32 s28, s28, 110592
    s_add_u32 s8, s4, 0xa00000
    s_addc_u32 s9, s5, 0
    s_mov_b32 s10, 7077888
    s_mov_b32 s11, 0x20000
    v_add_u32 v3, s55, v2
    v_add_u32 v30, 81920, v3
    v_lshrrev_b32 v15, 2, v1
    v_and_b32 v16, 3, v1
    v_lshl_add_u32 v20, v16, 4, v15
    v_lshlrev_b32 v21, 4, v20
    v_lshlrev_b32 v20, 3, v20
    s_lshl_b32 s28, s3, 1
    s_add_u32 s28, s31, s28
    s_mul_i32 s28, s28, 20480
    s_mul_i32 s29, s30, 160
    s_add_u32 s28, s28, s29
    v_mul_u32_u24 v8, 1280, v15
    v_lshl_add_u32 v8, v16, 3, v8
    v_add_u32 v8, s28, v8
    s_lshl_b32 s29, s29, 1
    v_lshlrev_b32 v9, 4, v16
    v_add_u32 v9, s29, v9
    v_and_b32 v13, 15, v1
    v_lshrrev_b32 v22, 4, v1
    v_bfe_u32 v23, v13, 1, 2
    v_xor_b32 v22, v22, v23
    v_lshl_add_u32 v13, v13, 2, v22
    s_mul_i32 s28, s3, 20480
    v_lshl_add_u32 v10, v13, 4, s28
    v_bfe_u32 v13, v1, 3, 2
    v_xor_b32 v13, v13, v1
    s_lshl_b32 s28, s3, 10
    v_lshl_add_u32 v11, v13, 4, s28
    v_add_u32 v28, 0xa000, v11
    s_waitcnt lgkmcnt(0)
    s_mov_b32 s16, s6
    s_mov_b32 s17, s7
    s_mov_b32 s18, 2621440
    s_mov_b32 s19, 0x20000
    v_lshrrev_b32 v14, 3, v1
    v_add_u32 v14, s3, v14
    v_lshlrev_b32 v14, 26, v14
    v_lshl_or_b32 v14, v1, 7, v14
    buffer_load_dword v31, v14, s[72:75], s42 offen offset:12 sc1
    s_cmp_lg_u32 s3, 0
    s_cbranch_scc1 KB_whh
    s_mov_b32 s29, 0x40000
    s_waitcnt vmcnt(0)
KB_lhh:
    v_and_b32 v31, 0xff, v31
    v_cmp_gt_u32 vcc, 4, v31
    s_sub_u32 s29, s29, 1
    s_cmp_eq_u32 s29, 0
    s_cbranch_scc1 KB_whh
    s_and_b32 s28, vcc_lo, 0xff
    s_cmp_eq_u32 s28, 0
    s_cbranch_scc1 KB_whh
    buffer_load_dword v31, v14, s[72:75], s42 offen offset:12 sc1
    s_waitcnt vmcnt(0)
    s_branch KB_lhh
KB_whh:
    s_waitcnt vmcnt(0)
    s_barrier
    v_mov_b32 v13, 0x100
    buffer_atomic_add v13, v29, s[72:75], s24 offen offset:12
    buffer_load_dwordx4 a[0:3], v4, s[8:11], s46 offen offset:0 sc1
    buffer_load_dwordx4 a[4:7], v4, s[8:11], s46 offen offset:1024 sc1
    buffer_load_dwordx4 a[8:11], v5, s[8:11], s46 offen offset:0 sc1
    buffer_load_dwordx4 a[12:15], v5, s[8:11], s46 offen offset:1024 sc1
    buffer_load_dwordx4 a[16:19], v6, s[8:11], s46 offen offset:0 sc1
    buffer_load_dwordx4 a[20:23], v6, s[8:11], s46 offen offset:1024 sc1
    buffer_load_dwordx4 a[24:27], v7, s[8:11], s46 offen offset:0 sc1
    buffer_load_dwordx4 a[28:31], v7, s[8:11], s46 offen offset:1024 sc1
    s_waitcnt vmcnt(6)
    v_mfma_f32_16x16x32_bf16 v[32:35], a[128:131], a[0:3], 0
    buffer_load_dwordx4 a[32:35], v4, s[8:11], s47 offen offset:0 sc1
    v_mfma_f32_16x16x32_bf16 v[32:35], a[132:135], a[4:7], v[32:35]
    buffer_load_dwordx4 a[36:39], v4, s[8:11], s47 offen offset:1024 sc1
    v_mfma_f32_16x16x32_bf16 v[48:51], a[136:139], a[0:3], 0
    v_mfma_f32_16x16x32_bf16 v[48:51], a[140:143], a[4:7], v[48:51]
    buffer_load_dwordx4 a[40:43], v5, s[8:11], s47 offen offset:0 sc1
    v_mfma_f32_16x16x32_bf16 v[64:67], a[144:147], a[0:3], 0
    v_mfma_f32_16x16x32_bf16 v[64:67], a[148:151], a[4:7], v[64:67]
    buffer_load_dwordx4 a[44:47], v5, s[8:11], s47 offen offset:1024 sc1
    v_mfma_f32_16x16x32_bf16 v[80:83], a[152:155], a[0:3], 0
    v_mfma_f32_16x16x32_bf16 v[80:83], a[156:159], a[4:7], v[80:83]
    buffer_load_dwordx4 a[48:51], v6, s[8:11], s47 offen offset:0 sc1
    v_mfma_f32_16x16x32_bf16 v[96:99], a[160:163], a[0:3], 0
    v_mfma_f32_16x16x32_bf16 v[96:99], a[164:167], a[4:7], v[96:99]
    s_waitcnt vmcnt(9)
    v_mfma_f32_16x16x32_bf16 v[36:39], a[128:131], a[8:11], 0
    buffer_load_dwordx4 a[52:55], v6, s[8:11], s47 offen offset:1024 sc1
    v_mfma_f32_16x16x32_bf16 v[36:39], a[132:135], a[12:15], v[36:39]
    buffer_load_dwordx4 a[56:59], v7, s[8:11], s47 offen offset:0 sc1
    v_mfma_f32_16x16x32_bf16 v[52:55], a[136:139], a[8:11], 0
    v_mfma_f32_16x16x32_bf16 v[52:55], a[140:143], a[12:15], v[52:55]
    buffer_load_dwordx4 a[60:63], v7, s[8:11], s47 offen offset:1024 sc1
    v_mfma_f32_16x16x32_bf16 v[68:71], a[144:147], a[8:11], 0
    v_mfma_f32_16x16x32_bf16 v[68:71], a[148:151], a[12:15], v[68:71]
    buffer_load_dwordx4 v[112:115], v4, s[8:11], s48 offen offset:0 sc1
    v_mfma_f32_16x16x32_bf16 v[84:87], a[152:155], a[8:11], 0
    buffer_load_dwordx4 v[116:119], v4, s[8:11], s48 offen offset:1024 sc1
    v_mfma_f32_16x16x32_bf16 v[84:87], a[156:159], a[12:15], v[84:87]
    v_mfma_f32_16x16x32_bf16 v[100:103], a[160:163], a[8:11], 0
    buffer_load_dwordx4 v[120:123], v5, s[8:11], s48 offen offset:0 sc1
    v_mfma_f32_16x16x32_bf16 v[100:103], a[164:167], a[12:15], v[100:103]
    s_waitcnt vmcnt(13)
    v_mfma_f32_16x16x32_bf16 v[40:43], a[128:131], a[16:19], 0
    buffer_load_dwordx4 v[124:127], v5, s[8:11], s48 offen offset:1024 sc1
    v_mfma_f32_16x16x32_bf16 v[40:43], a[132:135], a[20:23], v[40:43]
    v_mfma_f32_16x16x32_bf16 v[56:59], a[136:139], a[16:19], 0
    buffer_load_dwordx4 v[128:131], v6, s[8:11], s48 offen offset:0 sc1
    v_mfma_f32_16x16x32_bf16 v[56:59], a[140:143], a[20:23], v[56:59]
    v_mfma_f32_16x16x32_bf16 v[72:75], a[144:147], a[16:19], 0
    buffer_load_dwordx4 v[132:135], v6, s[8:11], s48 offen offset:1024 sc1
    v_mfma_f32_16x16x32_bf16 v[72:75], a[148:151], a[20:23], v[72:75]
    v_mfma_f32_16x16x32_bf16 v[88:91], a[152:155], a[16:19], 0
    buffer_load_dwordx4 v[136:139], v7, s[8:11], s48 offen offset:0 sc1
    v_mfma_f32_16x16x32_bf16 v[88:91], a[156:159], a[20:23], v[88:91]
    v_mfma_f32_16x16x32_bf16 v[104:107], a[160:163], a[16:19], 0
    buffer_load_dwordx4 v[140:143], v7, s[8:11], s48 offen offset:1024 sc1
    v_mfma_f32_16x16x32_bf16 v[104:107], a[164:167], a[20:23], v[104:107]
    s_waitcnt vmcnt(16)
    v_mfma_f32_16x16x32_bf16 v[44:47], a[128:131], a[24:27], 0
    buffer_load_dword v31, v14, s[72:75], s42 offen offset:12 sc1
    v_mfma_f32_16x16x32_bf16 v[44:47], a[132:135], a[28:31], v[44:47]
    v_mfma_f32_16x16x32_bf16 v[60:63], a[136:139], a[24:27], 0
    v_mfma_f32_16x16x32_bf16 v[60:63], a[140:143], a[28:31], v[60:63]
    v_mfma_f32_16x16x32_bf16 v[76:79], a[144:147], a[24:27], 0
    v_mfma_f32_16x16x32_bf16 v[76:79], a[148:151], a[28:31], v[76:79]
    v_mfma_f32_16x16x32_bf16 v[92:95], a[152:155], a[24:27], 0
    v_mfma_f32_16x16x32_bf16 v[92:95], a[156:159], a[28:31], v[92:95]
    v_mfma_f32_16x16x32_bf16 v[108:111], a[160:163], a[24:27], 0
    v_mfma_f32_16x16x32_bf16 v[108:111], a[164:167], a[28:31], v[108:111]
    s_waitcnt vmcnt(9)
    v_mfma_f32_16x16x32_bf16 v[32:35], a[168:171], a[32:35], v[32:35]
    s_movk_i32 s38, 12800
    s_movk_i32 s39, 10240
    s_lshl_b32 s28, s3, 1
    v_mfma_f32_16x16x32_bf16 v[32:35], a[172:175], a[36:39], v[32:35]
    s_add_u32 s28, s31, s28
    s_lshl_b32 s28, s28, 3
    s_add_u32 s28, s28, s30
    v_mfma_f32_16x16x32_bf16 v[36:39], a[172:175], a[44:47], v[36:39]
    s_mul_i32 s28, s28, 2560
    s_add_u32 s28, s28, 7340032
    v_mfma_f32_16x16x32_bf16 v[36:39], a[168:171], a[40:43], v[36:39]
    buffer_load_dwordx4 v[184:187], v21, s[72:75], s28 offen offset:0 sc1
    v_mfma_f32_16x16x32_bf16 v[40:43], a[168:171], a[48:51], v[40:43]
    buffer_load_dwordx4 v[188:191], v21, s[72:75], s28 offen offset:1024 sc1
    v_mfma_f32_16x16x32_bf16 v[40:43], a[172:175], a[52:55], v[40:43]
    buffer_load_dwordx2 v[192:193], v20, s[72:75], s28 offen offset:2048 sc1
    v_mfma_f32_16x16x32_bf16 v[44:47], a[172:175], a[60:63], v[44:47]
    buffer_load_dwordx4 v[196:199], v9, s[72:75], s38 offen offset:0 sc1
    v_mfma_f32_16x16x32_bf16 v[44:47], a[168:171], a[56:59], v[44:47]
    v_mfma_f32_16x16x32_bf16 v[60:63], a[176:179], a[56:59], v[60:63]
    buffer_load_dwordx4 v[200:203], v9, s[72:75], s38 offen offset:64 sc1
    v_mfma_f32_16x16x32_bf16 v[60:63], a[180:183], a[60:63], v[60:63]
    v_mfma_f32_16x16x32_bf16 v[56:59], a[180:183], a[52:55], v[56:59]
    buffer_load_dwordx4 v[204:207], v9, s[72:75], s38 offen offset:128 sc1
    v_mfma_f32_16x16x32_bf16 v[56:59], a[176:179], a[48:51], v[56:59]
    v_mfma_f32_16x16x32_bf16 v[52:55], a[176:179], a[40:43], v[52:55]
    buffer_load_dwordx4 v[208:211], v9, s[72:75], s38 offen offset:192 sc1
    v_mfma_f32_16x16x32_bf16 v[52:55], a[180:183], a[44:47], v[52:55]
    v_mfma_f32_16x16x32_bf16 v[48:51], a[180:183], a[36:39], v[48:51]
    buffer_load_dwordx4 v[212:215], v9, s[72:75], s38 offen offset:256 sc1
    v_mfma_f32_16x16x32_bf16 v[48:51], a[176:179], a[32:35], v[48:51]
    v_mfma_f32_16x16x32_bf16 v[64:67], a[184:187], a[32:35], v[64:67]
    v_mfma_f32_16x16x32_bf16 v[64:67], a[188:191], a[36:39], v[64:67]
    v_mfma_f32_16x16x32_bf16 v[68:71], a[188:191], a[44:47], v[68:71]
    v_mfma_f32_16x16x32_bf16 v[68:71], a[184:187], a[40:43], v[68:71]
    v_mfma_f32_16x16x32_bf16 v[72:75], a[184:187], a[48:51], v[72:75]
    v_mfma_f32_16x16x32_bf16 v[72:75], a[188:191], a[52:55], v[72:75]
    v_mfma_f32_16x16x32_bf16 v[76:79], a[188:191], a[60:63], v[76:79]
    v_mfma_f32_16x16x32_bf16 v[76:79], a[184:187], a[56:59], v[76:79]
    v_mfma_f32_16x16x32_bf16 v[92:95], a[224:227], a[56:59], v[92:95]
    v_mfma_f32_16x16x32_bf16 v[92:95], a[228:231], a[60:63], v[92:95]
    v_mfma_f32_16x16x32_bf16 v[88:91], a[228:231], a[52:55], v[88:91]
    v_mfma_f32_16x16x32_bf16 v[88:91], a[224:227], a[48:51], v[88:91]
    v_mfma_f32_16x16x32_bf16 v[84:87], a[224:227], a[40:43], v[84:87]
    v_mfma_f32_16x16x32_bf16 v[84:87], a[228:231], a[44:47], v[84:87]
    v_mfma_f32_16x16x32_bf16 v[80:83], a[228:231], a[36:39], v[80:83]
    v_mfma_f32_16x16x32_bf16 v[80:83], a[224:227], a[32:35], v[80:83]
    v_mfma_f32_16x16x32_bf16 v[96:99], a[232:235], a[32:35], v[96:99]
    v_mfma_f32_16x16x32_bf16 v[96:99], a[236:239], a[36:39], v[96:99]
    v_mfma_f32_16x16x32_bf16 v[100:103], a[236:239], a[44:47], v[100:103]
    v_mfma_f32_16x16x32_bf16 v[100:103], a[232:235], a[40:43], v[100:103]
    v_mfma_f32_16x16x32_bf16 v[104:107], a[232:235], a[48:51], v[104:107]
    v_mfma_f32_16x16x32_bf16 v[104:107], a[236:239], a[52:55], v[104:107]
    v_mfma_f32_16x16x32_bf16 v[108:111], a[236:239], a[60:63], v[108:111]
    v_mfma_f32_16x16x32_bf16 v[108:111], a[232:235], a[56:59], v[108:111]
    s_waitcnt vmcnt(8)
    s_cmp_lg_u32 s3, 0
    s_cbranch_scc1 KB_wh2
    s_mov_b32 s29, 0x40000
KB_lh2:
    v_cmp_gt_u32 vcc, 1024, v31
    s_sub_u32 s29, s29, 1
    s_cmp_eq_u32 s29, 0
    s_cbranch_scc1 KB_wh2
    s_and_b32 s28, vcc_lo, 0xff
    s_cmp_eq_u32 s28, 0
    s_cbranch_scc1 KB_wh2
    v_lshrrev_b32 v14, 3, v1
    v_add_u32 v14, s3, v14
    v_lshlrev_b32 v14, 26, v14
    v_lshl_or_b32 v14, v1, 7, v14
    buffer_load_dword v31, v14, s[72:75], s42 offen offset:12 sc1
    s_waitcnt vmcnt(0)
    s_branch KB_lh2
KB_wh2:
    s_barrier
    buffer_load_dwordx4 v[144:147], v4, s[8:11], s50 offen offset:0 sc1
    buffer_load_dwordx4 v[148:151], v4, s[8:11], s50 offen offset:1024 sc1
    buffer_load_dwordx4 v[152:155], v5, s[8:11], s50 offen offset:0 sc1
    buffer_load_dwordx4 v[156:159], v5, s[8:11], s50 offen offset:1024 sc1
    buffer_load_dwordx4 v[160:163], v6, s[8:11], s50 offen offset:0 sc1
    buffer_load_dwordx4 v[164:167], v6, s[8:11], s50 offen offset:1024 sc1
    buffer_load_dwordx4 v[168:171], v7, s[8:11], s50 offen offset:0 sc1
    buffer_load_dwordx4 v[172:175], v7, s[8:11], s50 offen offset:1024 sc1
    v_mfma_f32_16x16x32_bf16 v[32:35], a[64:67], v[112:115], v[32:35]
    buffer_load_dwordx4 a[0:3], v4, s[8:11], s51 offen offset:0 sc1
    v_mfma_f32_16x16x32_bf16 v[32:35], a[68:71], v[116:119], v[32:35]
    ds_read_b128 a[128:131], v3 offset:0
    ds_read_b128 a[132:135], v3 offset:1024
    v_mfma_f32_16x16x32_bf16 v[36:39], a[68:71], v[124:127], v[36:39]
    ds_read_b128 a[136:139], v3 offset:2048
    ds_read_b128 a[140:143], v3 offset:3072
    v_mfma_f32_16x16x32_bf16 v[36:39], a[64:67], v[120:123], v[36:39]
    ds_read_b128 a[144:147], v3 offset:4096
    ds_read_b128 a[148:151], v3 offset:5120
    v_mfma_f32_16x16x32_bf16 v[40:43], a[64:67], v[128:131], v[40:43]
    ds_read_b128 a[152:155], v3 offset:6144
    ds_read_b128 a[156:159], v3 offset:7168
    v_mfma_f32_16x16x32_bf16 v[40:43], a[68:71], v[132:135], v[40:43]
    ds_read_b128 a[160:163], v3 offset:8192
    ds_read_b128 a[164:167], v3 offset:9216
    v_mfma_f32_16x16x32_bf16 v[44:47], a[68:71], v[140:143], v[44:47]
    buffer_load_dwordx4 a[4:7], v4, s[8:11], s51 offen offset:1024 sc1
    v_mfma_f32_16x16x32_bf16 v[44:47], a[64:67], v[136:139], v[44:47]
    buffer_load_dwordx4 a[8:11], v5, s[8:11], s51 offen offset:0 sc1
    v_mfma_f32_16x16x32_bf16 v[60:63], a[72:75], v[136:139], v[60:63]
    buffer_load_dwordx4 a[12:15], v5, s[8:11], s51 offen offset:1024 sc1
    v_mfma_f32_16x16x32_bf16 v[60:63], a[76:79], v[140:143], v[60:63]
    buffer_load_dwordx4 a[16:19], v6, s[8:11], s51 offen offset:0 sc1
    v_mfma_f32_16x16x32_bf16 v[56:59], a[76:79], v[132:135], v[56:59]
    buffer_load_dwordx4 a[20:23], v6, s[8:11], s51 offen offset:1024 sc1
    v_mfma_f32_16x16x32_bf16 v[56:59], a[72:75], v[128:131], v[56:59]
    v_mfma_f32_16x16x32_bf16 v[52:55], a[72:75], v[120:123], v[52:55]
    buffer_load_dwordx4 a[24:27], v7, s[8:11], s51 offen offset:0 sc1
    v_mfma_f32_16x16x32_bf16 v[52:55], a[76:79], v[124:127], v[52:55]
    v_mfma_f32_16x16x32_bf16 v[48:51], a[76:79], v[116:119], v[48:51]
    buffer_load_dwordx4 a[28:31], v7, s[8:11], s51 offen offset:1024 sc1
    v_mfma_f32_16x16x32_bf16 v[48:51], a[72:75], v[112:115], v[48:51]
    v_mfma_f32_16x16x32_bf16 v[64:67], a[80:83], v[112:115], v[64:67]
    buffer_load_dwordx4 a[32:35], v4, s[8:11], s52 offen offset:0 sc1
    v_mfma_f32_16x16x32_bf16 v[64:67], a[84:87], v[116:119], v[64:67]
    v_mfma_f32_16x16x32_bf16 v[68:71], a[84:87], v[124:127], v[68:71]
    buffer_load_dwordx4 a[36:39], v4, s[8:11], s52 offen offset:1024 sc1
    v_mfma_f32_16x16x32_bf16 v[68:71], a[80:83], v[120:123], v[68:71]
    v_mfma_f32_16x16x32_bf16 v[72:75], a[80:83], v[128:131], v[72:75]
    buffer_load_dwordx4 a[40:43], v5, s[8:11], s52 offen offset:0 sc1
    v_mfma_f32_16x16x32_bf16 v[72:75], a[84:87], v[132:135], v[72:75]
    v_mfma_f32_16x16x32_bf16 v[76:79], a[84:87], v[140:143], v[76:79]
    buffer_load_dwordx4 a[44:47], v5, s[8:11], s52 offen offset:1024 sc1
    v_mfma_f32_16x16x32_bf16 v[76:79], a[80:83], v[136:139], v[76:79]
    v_mfma_f32_16x16x32_bf16 v[92:95], a[88:91], v[136:139], v[92:95]
    buffer_load_dwordx4 a[48:51], v6, s[8:11], s52 offen offset:0 sc1
    v_mfma_f32_16x16x32_bf16 v[92:95], a[92:95], v[140:143], v[92:95]
    v_mfma_f32_16x16x32_bf16 v[88:91], a[92:95], v[132:135], v[88:91]
    buffer_load_dwordx4 a[52:55], v6, s[8:11], s52 offen offset:1024 sc1
    v_mfma_f32_16x16x32_bf16 v[88:91], a[88:91], v[128:131], v[88:91]
    v_mfma_f32_16x16x32_bf16 v[84:87], a[88:91], v[120:123], v[84:87]
    buffer_load_dwordx4 a[56:59], v7, s[8:11], s52 offen offset:0 sc1
    v_mfma_f32_16x16x32_bf16 v[84:87], a[92:95], v[124:127], v[84:87]
    v_mfma_f32_16x16x32_bf16 v[80:83], a[92:95], v[116:119], v[80:83]
    buffer_load_dwordx4 a[60:63], v7, s[8:11], s52 offen offset:1024 sc1
    v_mfma_f32_16x16x32_bf16 v[80:83], a[88:91], v[112:115], v[80:83]
    v_mfma_f32_16x16x32_bf16 v[96:99], a[96:99], v[112:115], v[96:99]
    v_mfma_f32_16x16x32_bf16 v[96:99], a[100:103], v[116:119], v[96:99]
    v_mfma_f32_16x16x32_bf16 v[100:103], a[100:103], v[124:127], v[100:103]
    v_mfma_f32_16x16x32_bf16 v[100:103], a[96:99], v[120:123], v[100:103]
    v_mfma_f32_16x16x32_bf16 v[104:107], a[96:99], v[128:131], v[104:107]
    v_mfma_f32_16x16x32_bf16 v[104:107], a[100:103], v[132:135], v[104:107]
    v_mfma_f32_16x16x32_bf16 v[108:111], a[100:103], v[140:143], v[108:111]
    v_mfma_f32_16x16x32_bf16 v[108:111], a[96:99], v[136:139], v[108:111]
    s_waitcnt vmcnt(16) lgkmcnt(0)
    v_mfma_f32_16x16x32_bf16 v[32:35], a[128:131], v[144:147], v[32:35]
    buffer_load_dwordx4 v[112:115], v4, s[8:11], s53 offen offset:0 sc1
    v_mfma_f32_16x16x32_bf16 v[32:35], a[132:135], v[148:151], v[32:35]
    ds_read_b128 a[168:171], v3 offset:40960
    v_mfma_f32_16x16x32_bf16 v[36:39], a[132:135], v[156:159], v[36:39]
    ds_read_b128 a[172:175], v3 offset:41984
    v_mfma_f32_16x16x32_bf16 v[36:39], a[128:131], v[152:155], v[36:39]
    ds_read_b128 a[176:179], v3 offset:43008
    v_mfma_f32_16x16x32_bf16 v[40:43], a[128:131], v[160:163], v[40:43]
    ds_read_b128 a[180:183], v3 offset:44032
    v_mfma_f32_16x16x32_bf16 v[40:43], a[132:135], v[164:167], v[40:43]
    ds_read_b128 a[184:187], v3 offset:45056
    v_mfma_f32_16x16x32_bf16 v[44:47], a[132:135], v[172:175], v[44:47]
    ds_read_b128 a[188:191], v3 offset:46080
    v_mfma_f32_16x16x32_bf16 v[44:47], a[128:131], v[168:171], v[44:47]
    ds_read_b128 a[224:227], v3 offset:47104
    v_mfma_f32_16x16x32_bf16 v[60:63], a[136:139], v[168:171], v[60:63]
    ds_read_b128 a[228:231], v3 offset:48128
    v_mfma_f32_16x16x32_bf16 v[60:63], a[140:143], v[172:175], v[60:63]
    ds_read_b128 a[232:235], v3 offset:49152
    v_mfma_f32_16x16x32_bf16 v[56:59], a[140:143], v[164:167], v[56:59]
    ds_read_b128 a[236:239], v3 offset:50176
    v_mfma_f32_16x16x32_bf16 v[56:59], a[136:139], v[160:163], v[56:59]
    buffer_load_dwordx4 v[116:119], v4, s[8:11], s53 offen offset:1024 sc1
    v_mfma_f32_16x16x32_bf16 v[52:55], a[136:139], v[152:155], v[52:55]
    buffer_load_dwordx4 v[120:123], v5, s[8:11], s53 offen offset:0 sc1
    v_mfma_f32_16x16x32_bf16 v[52:55], a[140:143], v[156:159], v[52:55]
    buffer_load_dwordx4 v[124:127], v5, s[8:11], s53 offen offset:1024 sc1
    v_mfma_f32_16x16x32_bf16 v[48:51], a[140:143], v[148:151], v[48:51]
    buffer_load_dwordx4 v[128:131], v6, s[8:11], s53 offen offset:0 sc1
    v_mfma_f32_16x16x32_bf16 v[48:51], a[136:139], v[144:147], v[48:51]
    buffer_load_dwordx4 v[132:135], v6, s[8:11], s53 offen offset:1024 sc1
    v_mfma_f32_16x16x32_bf16 v[64:67], a[144:147], v[144:147], v[64:67]
    buffer_load_dwordx4 v[136:139], v7, s[8:11], s53 offen offset:0 sc1
    v_mfma_f32_16x16x32_bf16 v[64:67], a[148:151], v[148:151], v[64:67]
    buffer_load_dwordx4 v[140:143], v7, s[8:11], s53 offen offset:1024 sc1
    v_mfma_f32_16x16x32_bf16 v[68:71], a[148:151], v[156:159], v[68:71]
    v_mfma_f32_16x16x32_bf16 v[68:71], a[144:147], v[152:155], v[68:71]
    v_mfma_f32_16x16x32_bf16 v[72:75], a[144:147], v[160:163], v[72:75]
    v_mfma_f32_16x16x32_bf16 v[72:75], a[148:151], v[164:167], v[72:75]
    v_mfma_f32_16x16x32_bf16 v[76:79], a[148:151], v[172:175], v[76:79]
    v_mfma_f32_16x16x32_bf16 v[76:79], a[144:147], v[168:171], v[76:79]
    v_mfma_f32_16x16x32_bf16 v[92:95], a[152:155], v[168:171], v[92:95]
    v_mfma_f32_16x16x32_bf16 v[92:95], a[156:159], v[172:175], v[92:95]
    v_mfma_f32_16x16x32_bf16 v[88:91], a[156:159], v[164:167], v[88:91]
    v_mfma_f32_16x16x32_bf16 v[88:91], a[152:155], v[160:163], v[88:91]
    v_mfma_f32_16x16x32_bf16 v[84:87], a[152:155], v[152:155], v[84:87]
    v_mfma_f32_16x16x32_bf16 v[84:87], a[156:159], v[156:159], v[84:87]
    v_mfma_f32_16x16x32_bf16 v[80:83], a[156:159], v[148:151], v[80:83]
    v_mfma_f32_16x16x32_bf16 v[80:83], a[152:155], v[144:147], v[80:83]
    v_mfma_f32_16x16x32_bf16 v[96:99], a[160:163], v[144:147], v[96:99]
    v_mfma_f32_16x16x32_bf16 v[96:99], a[164:167], v[148:151], v[96:99]
    v_mfma_f32_16x16x32_bf16 v[100:103], a[164:167], v[156:159], v[100:103]
    v_mfma_f32_16x16x32_bf16 v[100:103], a[160:163], v[152:155], v[100:103]
    v_mfma_f32_16x16x32_bf16 v[104:107], a[160:163], v[160:163], v[104:107]
    v_mfma_f32_16x16x32_bf16 v[104:107], a[164:167], v[164:167], v[104:107]
    v_mfma_f32_16x16x32_bf16 v[108:111], a[164:167], v[172:175], v[108:111]
    v_mfma_f32_16x16x32_bf16 v[108:111], a[160:163], v[168:171], v[108:111]
    s_waitcnt vmcnt(16) lgkmcnt(0)
    v_mfma_f32_16x16x32_bf16 v[32:35], a[168:171], a[0:3], v[32:35]
    v_mfma_f32_16x16x32_bf16 v[32:35], a[172:175], a[4:7], v[32:35]
    ds_read_b128 a[64:67], v30 offset:0
    v_mfma_f32_16x16x32_bf16 v[36:39], a[172:175], a[12:15], v[36:39]
    ds_read_b128 a[68:71], v30 offset:1024
    v_mfma_f32_16x16x32_bf16 v[36:39], a[168:171], a[8:11], v[36:39]
    ds_read_b128 a[72:75], v30 offset:2048
    v_mfma_f32_16x16x32_bf16 v[40:43], a[168:171], a[16:19], v[40:43]
    ds_read_b128 a[76:79], v30 offset:3072
    v_mfma_f32_16x16x32_bf16 v[40:43], a[172:175], a[20:23], v[40:43]
    ds_read_b128 a[80:83], v30 offset:4096
    v_mfma_f32_16x16x32_bf16 v[44:47], a[172:175], a[28:31], v[44:47]
    ds_read_b128 a[84:87], v30 offset:5120
    v_mfma_f32_16x16x32_bf16 v[44:47], a[168:171], a[24:27], v[44:47]
    ds_read_b128 a[88:91], v30 offset:6144
    v_mfma_f32_16x16x32_bf16 v[60:63], a[176:179], a[24:27], v[60:63]
    ds_read_b128 a[92:95], v30 offset:7168
    v_mfma_f32_16x16x32_bf16 v[60:63], a[180:183], a[28:31], v[60:63]
    ds_read_b128 a[96:99], v30 offset:8192
    v_mfma_f32_16x16x32_bf16 v[56:59], a[180:183], a[20:23], v[56:59]
    ds_read_b128 a[100:103], v30 offset:9216
    v_mfma_f32_16x16x32_bf16 v[56:59], a[176:179], a[16:19], v[56:59]
    v_mfma_f32_16x16x32_bf16 v[52:55], a[176:179], a[8:11], v[52:55]
    v_mfma_f32_16x16x32_bf16 v[52:55], a[180:183], a[12:15], v[52:55]
    v_mfma_f32_16x16x32_bf16 v[48:51], a[180:183], a[4:7], v[48:51]
    v_mfma_f32_16x16x32_bf16 v[48:51], a[176:179], a[0:3], v[48:51]
    v_mfma_f32_16x16x32_bf16 v[64:67], a[184:187], a[0:3], v[64:67]
    v_mfma_f32_16x16x32_bf16 v[64:67], a[188:191], a[4:7], v[64:67]
    v_mfma_f32_16x16x32_bf16 v[68:71], a[188:191], a[12:15], v[68:71]
    v_mfma_f32_16x16x32_bf16 v[68:71], a[184:187], a[8:11], v[68:71]
    v_mfma_f32_16x16x32_bf16 v[72:75], a[184:187], a[16:19], v[72:75]
    v_mfma_f32_16x16x32_bf16 v[72:75], a[188:191], a[20:23], v[72:75]
    v_mfma_f32_16x16x32_bf16 v[76:79], a[188:191], a[28:31], v[76:79]
    v_mfma_f32_16x16x32_bf16 v[76:79], a[184:187], a[24:27], v[76:79]
    v_mfma_f32_16x16x32_bf16 v[92:95], a[224:227], a[24:27], v[92:95]
    v_mfma_f32_16x16x32_bf16 v[92:95], a[228:231], a[28:31], v[92:95]
    v_mfma_f32_16x16x32_bf16 v[88:91], a[228:231], a[20:23], v[88:91]
    v_mfma_f32_16x16x32_bf16 v[88:91], a[224:227], a[16:19], v[88:91]
    v_mfma_f32_16x16x32_bf16 v[84:87], a[224:227], a[8:11], v[84:87]
    v_mfma_f32_16x16x32_bf16 v[84:87], a[228:231], a[12:15], v[84:87]
    v_mfma_f32_16x16x32_bf16 v[80:83], a[228:231], a[4:7], v[80:83]
    v_mfma_f32_16x16x32_bf16 v[80:83], a[224:227], a[0:3], v[80:83]
    v_mfma_f32_16x16x32_bf16 v[96:99], a[232:235], a[0:3], v[96:99]
    v_mfma_f32_16x16x32_bf16 v[96:99], a[236:239], a[4:7], v[96:99]
    v_mfma_f32_16x16x32_bf16 v[100:103], a[236:239], a[12:15], v[100:103]
    v_mfma_f32_16x16x32_bf16 v[100:103], a[232:235], a[8:11], v[100:103]
    v_mfma_f32_16x16x32_bf16 v[104:107], a[232:235], a[16:19], v[104:107]
    v_mfma_f32_16x16x32_bf16 v[104:107], a[236:239], a[20:23], v[104:107]
    v_mfma_f32_16x16x32_bf16 v[108:111], a[236:239], a[28:31], v[108:111]
    v_mfma_f32_16x16x32_bf16 v[108:111], a[232:235], a[24:27], v[108:111]
    s_waitcnt vmcnt(8) lgkmcnt(0)
    v_mfma_f32_16x16x32_bf16 v[32:35], a[64:67], a[32:35], v[32:35]
    v_mfma_f32_16x16x32_bf16 v[32:35], a[68:71], a[36:39], v[32:35]
    ds_read_b128 a[128:131], v30 offset:40960
    v_mfma_f32_16x16x32_bf16 v[36:39], a[68:71], a[44:47], v[36:39]
    ds_read_b128 a[132:135], v30 offset:41984
    v_mfma_f32_16x16x32_bf16 v[36:39], a[64:67], a[40:43], v[36:39]
    ds_read_b128 a[136:139], v30 offset:43008
    v_mfma_f32_16x16x32_bf16 v[40:43], a[64:67], a[48:51], v[40:43]
    ds_read_b128 a[140:143], v30 offset:44032
    v_mfma_f32_16x16x32_bf16 v[40:43], a[68:71], a[52:55], v[40:43]
    ds_read_b128 a[144:147], v30 offset:45056
    v_mfma_f32_16x16x32_bf16 v[44:47], a[68:71], a[60:63], v[44:47]
    ds_read_b128 a[148:151], v30 offset:46080
    v_mfma_f32_16x16x32_bf16 v[44:47], a[64:67], a[56:59], v[44:47]
    ds_read_b128 a[152:155], v30 offset:47104
    v_mfma_f32_16x16x32_bf16 v[60:63], a[72:75], a[56:59], v[60:63]
    ds_read_b128 a[156:159], v30 offset:48128
    v_mfma_f32_16x16x32_bf16 v[60:63], a[76:79], a[60:63], v[60:63]
    ds_read_b128 a[160:163], v30 offset:49152
    v_mfma_f32_16x16x32_bf16 v[56:59], a[76:79], a[52:55], v[56:59]
    ds_read_b128 a[164:167], v30 offset:50176
    v_mfma_f32_16x16x32_bf16 v[56:59], a[72:75], a[48:51], v[56:59]
    v_mfma_f32_16x16x32_bf16 v[52:55], a[72:75], a[40:43], v[52:55]
    s_waitcnt vmcnt(32)
    v_lshlrev_b32 v220, 16, v184
    v_and_b32 v221, 0xffff0000, v184
    v_mfma_f32_16x16x32_bf16 v[52:55], a[76:79], a[44:47], v[52:55]
    v_lshlrev_b32 v222, 16, v185
    v_and_b32 v223, 0xffff0000, v185
    v_mfma_f32_16x16x32_bf16 v[48:51], a[76:79], a[36:39], v[48:51]
    v_lshlrev_b32 v224, 16, v186
    v_and_b32 v225, 0xffff0000, v186
    v_mfma_f32_16x16x32_bf16 v[48:51], a[72:75], a[32:35], v[48:51]
    v_lshlrev_b32 v226, 16, v187
    v_and_b32 v227, 0xffff0000, v187
    v_mfma_f32_16x16x32_bf16 v[64:67], a[80:83], a[32:35], v[64:67]
    v_lshlrev_b32 v228, 16, v188
    v_and_b32 v229, 0xffff0000, v188
    v_mfma_f32_16x16x32_bf16 v[64:67], a[84:87], a[36:39], v[64:67]
    v_lshlrev_b32 v230, 16, v189
    v_and_b32 v231, 0xffff0000, v189
    v_mfma_f32_16x16x32_bf16 v[68:71], a[84:87], a[44:47], v[68:71]
    v_lshlrev_b32 v232, 16, v190
    v_and_b32 v233, 0xffff0000, v190
    v_mfma_f32_16x16x32_bf16 v[68:71], a[80:83], a[40:43], v[68:71]
    v_lshlrev_b32 v234, 16, v191
    v_and_b32 v235, 0xffff0000, v191
    v_mfma_f32_16x16x32_bf16 v[72:75], a[80:83], a[48:51], v[72:75]
    v_lshlrev_b32 v236, 16, v192
    v_and_b32 v237, 0xffff0000, v192
    v_mfma_f32_16x16x32_bf16 v[72:75], a[84:87], a[52:55], v[72:75]
    v_lshlrev_b32 v238, 16, v193
    v_and_b32 v239, 0xffff0000, v193
    v_mfma_f32_16x16x32_bf16 v[76:79], a[84:87], a[60:63], v[76:79]
    v_mfma_f32_16x16x32_bf16 v[76:79], a[80:83], a[56:59], v[76:79]
    v_mfma_f32_16x16x32_bf16 v[92:95], a[88:91], a[56:59], v[92:95]
    v_mfma_f32_16x16x32_bf16 v[92:95], a[92:95], a[60:63], v[92:95]
    v_mfma_f32_16x16x32_bf16 v[88:91], a[92:95], a[52:55], v[88:91]
    v_mfma_f32_16x16x32_bf16 v[88:91], a[88:91], a[48:51], v[88:91]
    v_mfma_f32_16x16x32_bf16 v[84:87], a[88:91], a[40:43], v[84:87]
    v_mfma_f32_16x16x32_bf16 v[84:87], a[92:95], a[44:47], v[84:87]
    v_mfma_f32_16x16x32_bf16 v[80:83], a[92:95], a[36:39], v[80:83]
    v_mfma_f32_16x16x32_bf16 v[80:83], a[88:91], a[32:35], v[80:83]
    v_mfma_f32_16x16x32_bf16 v[96:99], a[96:99], a[32:35], v[96:99]
    v_mfma_f32_16x16x32_bf16 v[96:99], a[100:103], a[36:39], v[96:99]
    v_mfma_f32_16x16x32_bf16 v[100:103], a[100:103], a[44:47], v[100:103]
    v_mfma_f32_16x16x32_bf16 v[100:103], a[96:99], a[40:43], v[100:103]
    v_mfma_f32_16x16x32_bf16 v[104:107], a[96:99], a[48:51], v[104:107]
    v_mfma_f32_16x16x32_bf16 v[104:107], a[100:103], a[52:55], v[104:107]
    v_mfma_f32_16x16x32_bf16 v[108:111], a[100:103], a[60:63], v[108:111]
    v_mfma_f32_16x16x32_bf16 v[108:111], a[96:99], a[56:59], v[108:111]
    s_waitcnt vmcnt(0) lgkmcnt(0)
    s_barrier
    v_mfma_f32_16x16x32_bf16 v[32:35], a[128:131], v[112:115], v[32:35]
    v_mfma_f32_16x16x32_bf16 v[32:35], a[132:135], v[116:119], v[32:35]
    v_mfma_f32_16x16x32_bf16 v[36:39], a[132:135], v[124:127], v[36:39]
    v_mfma_f32_16x16x32_bf16 v[36:39], a[128:131], v[120:123], v[36:39]
    v_mfma_f32_16x16x32_bf16 v[40:43], a[128:131], v[128:131], v[40:43]
    v_mfma_f32_16x16x32_bf16 v[40:43], a[132:135], v[132:135], v[40:43]
    v_mfma_f32_16x16x32_bf16 v[44:47], a[132:135], v[140:143], v[44:47]
    v_mfma_f32_16x16x32_bf16 v[44:47], a[128:131], v[136:139], v[44:47]
    v_mfma_f32_16x16x32_bf16 v[60:63], a[136:139], v[136:139], v[60:63]
    v_mfma_f32_16x16x32_bf16 v[60:63], a[140:143], v[140:143], v[60:63]
    v_mfma_f32_16x16x32_bf16 v[56:59], a[140:143], v[132:135], v[56:59]
    v_mfma_f32_16x16x32_bf16 v[56:59], a[136:139], v[128:131], v[56:59]
    v_mfma_f32_16x16x32_bf16 v[52:55], a[136:139], v[120:123], v[52:55]
    ds_write_b128 v10, v[32:35] offset:0
    v_mfma_f32_16x16x32_bf16 v[52:55], a[140:143], v[124:127], v[52:55]
    ds_write_b128 v10, v[36:39] offset:1024
    v_mfma_f32_16x16x32_bf16 v[48:51], a[140:143], v[116:119], v[48:51]
    ds_write_b128 v10, v[40:43] offset:2048
    v_mfma_f32_16x16x32_bf16 v[48:51], a[136:139], v[112:115], v[48:51]
    ds_write_b128 v10, v[44:47] offset:3072
    v_mfma_f32_16x16x32_bf16 v[64:67], a[144:147], v[112:115], v[64:67]
    v_mfma_f32_16x16x32_bf16 v[64:67], a[148:151], v[116:119], v[64:67]
    v_mfma_f32_16x16x32_bf16 v[68:71], a[148:151], v[124:127], v[68:71]
    v_mfma_f32_16x16x32_bf16 v[68:71], a[144:147], v[120:123], v[68:71]
    v_mfma_f32_16x16x32_bf16 v[72:75], a[144:147], v[128:131], v[72:75]
    ds_write_b128 v10, v[60:63] offset:7168
    v_mfma_f32_16x16x32_bf16 v[72:75], a[148:151], v[132:135], v[72:75]
    ds_write_b128 v10, v[56:59] offset:6144
    v_mfma_f32_16x16x32_bf16 v[76:79], a[148:151], v[140:143], v[76:79]
    ds_write_b128 v10, v[52:55] offset:5120
    v_mfma_f32_16x16x32_bf16 v[76:79], a[144:147], v[136:139], v[76:79]
    ds_write_b128 v10, v[48:51] offset:4096
    v_mfma_f32_16x16x32_bf16 v[92:95], a[152:155], v[136:139], v[92:95]
    v_mfma_f32_16x16x32_bf16 v[92:95], a[156:159], v[140:143], v[92:95]
    v_mfma_f32_16x16x32_bf16 v[88:91], a[156:159], v[132:135], v[88:91]
    v_mfma_f32_16x16x32_bf16 v[88:91], a[152:155], v[128:131], v[88:91]
    v_mfma_f32_16x16x32_bf16 v[84:87], a[152:155], v[120:123], v[84:87]
    ds_write_b128 v10, v[64:67] offset:8192
    v_mfma_f32_16x16x32_bf16 v[84:87], a[156:159], v[124:127], v[84:87]
    ds_write_b128 v10, v[68:71] offset:9216
    v_mfma_f32_16x16x32_bf16 v[80:83], a[156:159], v[116:119], v[80:83]
    ds_write_b128 v10, v[72:75] offset:10240
    v_mfma_f32_16x16x32_bf16 v[80:83], a[152:155], v[112:115], v[80:83]
    ds_write_b128 v10, v[76:79] offset:11264
    v_mfma_f32_16x16x32_bf16 v[96:99], a[160:163], v[112:115], v[96:99]
    s_waitcnt lgkmcnt(4)
    v_mfma_f32_16x16x32_bf16 v[96:99], a[164:167], v[116:119], v[96:99]
    v_mfma_f32_16x16x32_bf16 v[100:103], a[164:167], v[124:127], v[100:103]
    v_mfma_f32_16x16x32_bf16 v[100:103], a[160:163], v[120:123], v[100:103]
    v_mfma_f32_16x16x32_bf16 v[104:107], a[160:163], v[128:131], v[104:107]
    ds_write_b128 v10, v[92:95] offset:15360
    v_mfma_f32_16x16x32_bf16 v[104:107], a[164:167], v[132:135], v[104:107]
    ds_write_b128 v10, v[88:91] offset:14336
    v_mfma_f32_16x16x32_bf16 v[108:111], a[164:167], v[140:143], v[108:111]
    ds_write_b128 v10, v[84:87] offset:13312
    v_mfma_f32_16x16x32_bf16 v[108:111], a[160:163], v[136:139], v[108:111]
    ds_write_b128 v10, v[80:83] offset:12288
    s_waitcnt lgkmcnt(4)
    s_nop 3
    ds_write_b128 v10, v[96:99] offset:16384
    ds_write_b128 v10, v[100:103] offset:17408
    ds_write_b128 v10, v[104:107] offset:18432
    ds_write_b128 v10, v[108:111] offset:19456
    s_waitcnt lgkmcnt(0)
    s_barrier
    ds_read_b128 v[32:35], v11 offset:0
    ds_read_b128 v[36:39], v11 offset:4096
    ds_read_b128 v[40:43], v11 offset:8192
    ds_read_b128 v[44:47], v11 offset:12288
    ds_read_b128 v[48:51], v11 offset:16384
    ds_read_b128 v[52:55], v11 offset:20480
    ds_read_b128 v[56:59], v11 offset:24576
    ds_read_b128 v[60:63], v11 offset:28672
    ds_read_b128 v[64:67], v11 offset:32768
    ds_read_b128 v[68:71], v11 offset:36864
    ds_read_b128 v[72:75], v28 offset:0
    ds_read_b128 v[76:79], v28 offset:4096
    ds_read_b128 v[80:83], v28 offset:8192
    ds_read_b128 v[84:87], v28 offset:12288
    ds_read_b128 v[88:91], v28 offset:16384
    s_waitcnt lgkmcnt(5)
    ds_read_b128 v[92:95], v28 offset:20480
    ds_read_b128 v[96:99], v28 offset:24576
    ds_read_b128 v[100:103], v28 offset:28672
    ds_read_b128 v[104:107], v28 offset:32768
    ds_read_b128 v[108:111], v28 offset:36864
    v_pk_add_f32 v[32:33], v[32:33], v[52:53]
    v_pk_add_f32 v[34:35], v[34:35], v[54:55]
    v_pk_add_f32 v[36:37], v[36:37], v[56:57]
    v_pk_add_f32 v[38:39], v[38:39], v[58:59]
    v_pk_add_f32 v[40:41], v[40:41], v[60:61]
    v_pk_add_f32 v[42:43], v[42:43], v[62:63]
    v_pk_add_f32 v[44:45], v[44:45], v[64:65]
    v_pk_add_f32 v[46:47], v[46:47], v[66:67]
    v_pk_add_f32 v[48:49], v[48:49], v[68:69]
    v_pk_add_f32 v[50:51], v[50:51], v[70:71]
    s_waitcnt lgkmcnt(0)
    v_pk_add_f32 v[72:73], v[72:73], v[92:93]
    v_pk_add_f32 v[74:75], v[74:75], v[94:95]
    v_pk_add_f32 v[76:77], v[76:77], v[96:97]
    v_pk_add_f32 v[78:79], v[78:79], v[98:99]
    v_pk_add_f32 v[80:81], v[80:81], v[100:101]
    v_pk_add_f32 v[82:83], v[82:83], v[102:103]
    v_pk_add_f32 v[84:85], v[84:85], v[104:105]
    v_pk_add_f32 v[86:87], v[86:87], v[106:107]
    v_pk_add_f32 v[88:89], v[88:89], v[108:109]
    v_pk_add_f32 v[90:91], v[90:91], v[110:111]
    v_pk_add_f32 v[32:33], v[32:33], v[72:73]
    v_pk_add_f32 v[34:35], v[34:35], v[74:75]
    v_pk_add_f32 v[36:37], v[36:37], v[76:77]
    v_pk_add_f32 v[38:39], v[38:39], v[78:79]
    v_pk_add_f32 v[40:41], v[40:41], v[80:81]
    v_pk_add_f32 v[42:43], v[42:43], v[82:83]
    v_pk_add_f32 v[44:45], v[44:45], v[84:85]
    v_pk_add_f32 v[46:47], v[46:47], v[86:87]
    v_pk_add_f32 v[48:49], v[48:49], v[88:89]
    v_pk_add_f32 v[50:51], v[50:51], v[90:91]
    v_fmac_f32 v220, v196, v32
    v_fmac_f32 v221, v197, v33
    v_fmac_f32 v222, v198, v34
    v_fmac_f32 v223, v199, v35
    v_cvt_pk_bf16_f32 v72, v220, v221
    v_cvt_pk_bf16_f32 v73, v222, v223
    buffer_store_dwordx2 v[72:73], v8, s[16:19], 0 offen offset:0
    v_fmac_f32 v224, v200, v36
    v_fmac_f32 v225, v201, v37
    v_fmac_f32 v226, v202, v38
    v_fmac_f32 v227, v203, v39
    v_cvt_pk_bf16_f32 v74, v224, v225
    v_cvt_pk_bf16_f32 v75, v226, v227
    buffer_store_dwordx2 v[74:75], v8, s[16:19], 0 offen offset:32
    v_fmac_f32 v228, v204, v40
    v_fmac_f32 v229, v205, v41
    v_fmac_f32 v230, v206, v42
    v_fmac_f32 v231, v207, v43
    v_cvt_pk_bf16_f32 v76, v228, v229
    v_cvt_pk_bf16_f32 v77, v230, v231
    buffer_store_dwordx2 v[76:77], v8, s[16:19], 0 offen offset:64
    v_fmac_f32 v232, v208, v44
    v_fmac_f32 v233, v209, v45
    v_fmac_f32 v234, v210, v46
    v_fmac_f32 v235, v211, v47
    v_cvt_pk_bf16_f32 v78, v232, v233
    v_cvt_pk_bf16_f32 v79, v234, v235
    buffer_store_dwordx2 v[78:79], v8, s[16:19], 0 offen offset:96
    v_fmac_f32 v236, v212, v48
    v_fmac_f32 v237, v213, v49
    v_fmac_f32 v238, v214, v50
    v_fmac_f32 v239, v215, v51
    v_cvt_pk_bf16_f32 v80, v236, v237
    v_cvt_pk_bf16_f32 v81, v238, v239
    buffer_store_dwordx2 v[80:81], v8, s[16:19], 0 offen offset:128
    s_waitcnt vmcnt(0)
KA_end:
    s_endpgm
KB_skip4:
    s_waitcnt vmcnt(0)
    s_barrier
    v_mov_b32 v13, 1
    buffer_atomic_add v13, v29, s[72:75], s24 offen offset:12
    buffer_load_dwordx4 a[128:131], v12, s[68:71], s46 offen offset:0 sc1
    buffer_load_dwordx4 a[132:135], v12, s[68:71], s46 offen offset:1024 sc1
    buffer_load_dwordx4 a[136:139], v17, s[68:71], s46 offen offset:0 sc1
    buffer_load_dwordx4 a[140:143], v17, s[68:71], s46 offen offset:1024 sc1
    buffer_load_dwordx4 a[144:147], v18, s[68:71], s46 offen offset:0 sc1
    buffer_load_dwordx4 a[148:151], v18, s[68:71], s46 offen offset:1024 sc1
    buffer_load_dwordx4 a[152:155], v19, s[68:71], s46 offen offset:0 sc1
    buffer_load_dwordx4 a[156:159], v19, s[68:71], s46 offen offset:1024 sc1
    buffer_load_dwordx4 a[160:163], v27, s[68:71], s46 offen offset:0 sc1
    buffer_load_dwordx4 a[164:167], v27, s[68:71], s46 offen offset:1024 sc1
    s_add_u32 m0, s55, 0
    s_nop 0
    buffer_load_dwordx4 v12, s[68:71], s50 offen offset:0 sc1 lds
    buffer_load_dwordx4 v12, s[68:71], s50 offen offset:1024 sc1 lds
    s_add_u32 m0, s55, 2048
    s_nop 0
    buffer_load_dwordx4 v17, s[68:71], s50 offen offset:0 sc1 lds
    buffer_load_dwordx4 v17, s[68:71], s50 offen offset:1024 sc1 lds
    s_add_u32 m0, s55, 4096
    s_nop 0
    buffer_load_dwordx4 v18, s[68:71], s50 offen offset:0 sc1 lds
    buffer_load_dwordx4 v18, s[68:71], s50 offen offset:1024 sc1 lds
    s_add_u32 m0, s55, 6144
    s_nop 0
    buffer_load_dwordx4 v19, s[68:71], s50 offen offset:0 sc1 lds
    buffer_load_dwordx4 v19, s[68:71], s50 offen offset:1024 sc1 lds
    s_add_u32 m0, s55, 8192
    s_nop 0
    buffer_load_dwordx4 v27, s[68:71], s50 offen offset:0 sc1 lds
    buffer_load_dwordx4 v27, s[68:71], s50 offen offset:1024 sc1 lds
    buffer_load_dwordx4 a[168:171], v12, s[68:71], s47 offen offset:0 sc1
    buffer_load_dwordx4 a[172:175], v12, s[68:71], s47 offen offset:1024 sc1
    buffer_load_dwordx4 a[176:179], v17, s[68:71], s47 offen offset:0 sc1
    buffer_load_dwordx4 a[180:183], v17, s[68:71], s47 offen offset:1024 sc1
    buffer_load_dwordx4 a[184:187], v18, s[68:71], s47 offen offset:0 sc1
    buffer_load_dwordx4 a[188:191], v18, s[68:71], s47 offen offset:1024 sc1
    buffer_load_dwordx4 a[224:227], v19, s[68:71], s47 offen offset:0 sc1
    buffer_load_dwordx4 a[228:231], v19, s[68:71], s47 offen offset:1024 sc1
    buffer_load_dwordx4 a[232:235], v27, s[68:71], s47 offen offset:0 sc1
    buffer_load_dwordx4 a[236:239], v27, s[68:71], s47 offen offset:1024 sc1
    s_add_u32 m0, s55, 40960
    s_nop 0
    buffer_load_dwordx4 v12, s[68:71], s51 offen offset:0 sc1 lds
    buffer_load_dwordx4 v12, s[68:71], s51 offen offset:1024 sc1 lds
    s_add_u32 m0, s55, 43008
    s_nop 0
    buffer_load_dwordx4 v17, s[68:71], s51 offen offset:0 sc1 lds
    buffer_load_dwordx4 v17, s[68:71], s51 offen offset:1024 sc1 lds
    s_add_u32 m0, s55, 45056
    s_nop 0
    buffer_load_dwordx4 v18, s[68:71], s51 offen offset:0 sc1 lds
    buffer_load_dwordx4 v18, s[68:71], s51 offen offset:1024 sc1 lds
    s_add_u32 m0, s55, 47104
    s_nop 0
    buffer_load_dwordx4 v19, s[68:71], s51 offen offset:0 sc1 lds
    buffer_load_dwordx4 v19, s[68:71], s51 offen offset:1024 sc1 lds
    s_add_u32 m0, s55, 49152
    s_nop 0
    buffer_load_dwordx4 v27, s[68:71], s51 offen offset:0 sc1 lds
    buffer_load_dwordx4 v27, s[68:71], s51 offen offset:1024 sc1 lds
    s_waitcnt vmcnt(20)
    s_add_u32 m0, s55, 81920
    s_nop 0
    buffer_load_dwordx4 v12, s[68:71], s52 offen offset:0 sc1 lds
    buffer_load_dwordx4 v12, s[68:71], s52 offen offset:1024 sc1 lds
    s_add_u32 m0, s55, 83968
    s_nop 0
    buffer_load_dwordx4 v17, s[68:71], s52 offen offset:0 sc1 lds
    buffer_load_dwordx4 v17, s[68:71], s52 offen offset:1024 sc1 lds
    s_add_u32 m0, s55, 86016
    s_nop 0
    buffer_load_dwordx4 v18, s[68:71], s52 offen offset:0 sc1 lds
    buffer_load_dwordx4 v18, s[68:71], s52 offen offset:1024 sc1 lds
    s_add_u32 m0, s55, 88064
    s_nop 0
    buffer_load_dwordx4 v19, s[68:71], s52 offen offset:0 sc1 lds
    buffer_load_dwordx4 v19, s[68:71], s52 offen offset:1024 sc1 lds
    s_add_u32 m0, s55, 90112
    s_nop 0
    buffer_load_dwordx4 v27, s[68:71], s52 offen offset:0 sc1 lds
    buffer_load_dwordx4 v27, s[68:71], s52 offen offset:1024 sc1 lds
    buffer_load_dwordx4 a[64:67], v12, s[68:71], s48 offen offset:0 sc1
    buffer_load_dwordx4 a[68:71], v12, s[68:71], s48 offen offset:1024 sc1
    buffer_load_dwordx4 a[72:75], v17, s[68:71], s48 offen offset:0 sc1
    buffer_load_dwordx4 a[76:79], v17, s[68:71], s48 offen offset:1024 sc1
    buffer_load_dwordx4 a[80:83], v18, s[68:71], s48 offen offset:0 sc1
    buffer_load_dwordx4 a[84:87], v18, s[68:71], s48 offen offset:1024 sc1
    buffer_load_dwordx4 a[88:91], v19, s[68:71], s48 offen offset:0 sc1
    buffer_load_dwordx4 a[92:95], v19, s[68:71], s48 offen offset:1024 sc1
    buffer_load_dwordx4 a[96:99], v27, s[68:71], s48 offen offset:0 sc1
    buffer_load_dwordx4 a[100:103], v27, s[68:71], s48 offen offset:1024 sc1
    s_add_u32 m0, s55, 122880
    s_nop 0
    buffer_load_dwordx4 v12, s[68:71], s53 offen offset:0 sc1 lds
    buffer_load_dwordx4 v12, s[68:71], s53 offen offset:1024 sc1 lds
    s_add_u32 m0, s55, 124928
    s_nop 0
    buffer_load_dwordx4 v17, s[68:71], s53 offen offset:0 sc1 lds
    buffer_load_dwordx4 v17, s[68:71], s53 offen offset:1024 sc1 lds
    s_add_u32 m0, s55, 126976
    s_nop 0
    buffer_load_dwordx4 v18, s[68:71], s53 offen offset:0 sc1 lds
    buffer_load_dwordx4 v18, s[68:71], s53 offen offset:1024 sc1 lds
    s_add_u32 m0, s55, 129024
    s_nop 0
    buffer_load_dwordx4 v19, s[68:71], s53 offen offset:0 sc1 lds
    buffer_load_dwordx4 v19, s[68:71], s53 offen offset:1024 sc1 lds
    s_add_u32 m0, s55, 131072
    s_nop 0
    buffer_load_dwordx4 v27, s[68:71], s53 offen offset:0 sc1 lds
    buffer_load_dwordx4 v27, s[68:71], s53 offen offset:1024 sc1 lds
    s_branch KB_join4
KA_side:
    s_cmp_lg_u32 s3, 0
    s_cbranch_scc1 KB_wside
    s_mov_b32 s29, 0x40000
KB_lside:
    v_cmp_gt_u32 vcc, 32, v31
    s_sub_u32 s29, s29, 1
    s_cmp_eq_u32 s29, 0
    s_cbranch_scc1 KB_wside
    s_and_b32 s28, vcc_lo, 0xff
    s_cmp_eq_u32 s28, 0
    s_cbranch_scc1 KB_wside
    v_lshrrev_b32 v14, 3, v1
    v_add_u32 v14, s3, v14
    v_lshlrev_b32 v14, 26, v14
    v_lshl_or_b32 v14, v1, 7, v14
    buffer_load_dword v31, v14, s[72:75], s52 offen offset:4 sc1
    s_waitcnt vmcnt(0)
    s_branch KB_lside
KB_wside:
    s_branch KA_sider
KA_last:
.section .rodata,"a"
.p2align 6
.amdhsa_kernel adaLN_cond__compressed_kv_cla__glu_gated_geglu__prompt_kernel
  .amdhsa_next_free_vgpr 512
  .amdhsa_next_free_sgpr 102
  .amdhsa_accum_offset 256
  .amdhsa_group_segment_fixed_size 0
  .amdhsa_kernarg_size 120
  .amdhsa_user_sgpr_count 2
  .amdhsa_user_sgpr_kernarg_segment_ptr 1
  .amdhsa_system_sgpr_workgroup_id_x 1
  .amdhsa_float_denorm_mode_32 3
  .amdhsa_float_denorm_mode_16_64 3
.end_amdhsa_kernel
```
